```python
import torch

def _softmax(x, axis=-1):
    return torch.softmax(x, dim=axis)

def _gelu(x):
    return torch.nn.functional.gelu(x, approximate='tanh')

def _silu(x):
    return torch.nn.functional.silu(x)

def _sigmoid(x):
    return torch.sigmoid(x)

def _layernorm(x, axis=-1, eps=1e-05):
    m = x.mean(dim=axis, keepdim=True)
    v = x.var(dim=axis, keepdim=True, unbiased=False)
    return (x - m) / torch.sqrt(v + eps)

def _scatter_add(tgt, idx, src, axis=0):
    return tgt.clone().index_add_(axis, idx, src)

def _segment_sum(src, seg, n):
    out = torch.zeros((n,) + src.shape[1:], dtype=src.dtype)
    return out.index_add_(0, seg, src)

def _pad(x, pw):
    flat = tuple((v for pair in reversed(pw) for v in pair))
    return torch.nn.functional.pad(x, flat)
kernel_name = 'adaLN_cond__mha_block_cached__mixer_channel_mlp__prompt'

def setup_inputs():

    _w = lambda a: (lambda t: t.to(torch.bfloat16) if t.is_floating_point() else t)(torch.as_tensor(a))

    def _A_setup():
        B, Sq, D = (1, 2048, 1024)
        H, Sk, Dh = (32, 2048, 128)
        return {'x': _w((lambda *s: torch.randn(*s, dtype=torch.bfloat16) * 0.05)(B, Sq, D)), 'k_cache': _w((lambda *s: torch.randn(*s, dtype=torch.bfloat16) * 3.2)(B, H, Sk, Dh)), 'v_cache': _w((lambda *s: torch.randn(*s, dtype=torch.bfloat16) * 0.4)(B, H, Sk, Dh)), 'wq': _w((lambda *s: torch.randn(*s, dtype=torch.bfloat16) * 3.2)(D, H * Dh) * D ** (-0.5)), 'wo': _w((lambda *s: torch.randn(*s, dtype=torch.bfloat16) * 0.4)(H * Dh, D) * (H * Dh) ** (-0.5))}
    _A_in = _A_setup()

    def _B_setup():
        B, S, D, F = (1, 2048, 1024, 3584)
        return {'x': _w((lambda *s: torch.randn(*s, dtype=torch.bfloat16) * 0.05)(B, S, D)), 'w1': _w((lambda *s: torch.randn(*s, dtype=torch.bfloat16) * 3.2)(D, F) * D ** (-0.5)), 'b1': _w((lambda *s: torch.randn(*s, dtype=torch.bfloat16) * 1.6)(F)), 'w2': _w((lambda *s: torch.randn(*s, dtype=torch.bfloat16) * 0.1)(F, D) * F ** (-0.5)), 'b2': _w((lambda *s: torch.randn(*s, dtype=torch.bfloat16) * 0.2)(D))}
    _B_in = _B_setup()
    return {'A_x': _A_in['x'], 'A_k_cache': _A_in['k_cache'], 'A_v_cache': _A_in['v_cache'], 'A_wq': _A_in['wq'], 'A_wo': _A_in['wo'], 'B_x': _B_in['x'], 'B_w1': _B_in['w1'], 'B_b1': _B_in['b1'], 'B_w2': _B_in['w2'], 'B_b2': _B_in['b2'], 'c': _w((lambda *s: torch.randn(*s, dtype=torch.bfloat16) * 0.1)(1, 1024) * 8.0), 'w_mod': _w((lambda *s: torch.randn(*s, dtype=torch.bfloat16) * 0.1)(1024, 6 * 1024) * 1024 ** (-0.5) * 8.0)}

def reference(A_x, A_k_cache, A_v_cache, A_wq, A_wo, B_x, B_w1, B_b1, B_w2, B_b2, c, w_mod):

    def _A_ref(x, k_cache, v_cache, wq, wo):
        B, Sq, D = x.shape
        H, Dh = (32, 128)
        q = (lambda x, *d: x.permute(*d))((x @ wq).reshape(B, Sq, H, Dh), 0, 2, 1, 3)
        scores = torch.einsum('bhqd,bhkd->bhqk', q, k_cache) * Dh ** (-0.5)
        p = _softmax(scores, axis=-1)
        o = torch.einsum('bhqk,bhkd->bhqd', p, v_cache)
        return (lambda x, *d: x.permute(*d))(o, 0, 2, 1, 3).reshape(B, Sq, H * Dh) @ wo

    def _B_ref(x, w1, b1, w2, b2):
        y = _layernorm(x, axis=-1)
        h = _gelu(torch.einsum('bsd,df->bsf', y, w1) + b1)
        return torch.einsum('bsf,fd->bsd', h, w2) + b2
    x = A_x
    mod = (_silu(c) @ w_mod).reshape(c.shape[0], 6, 1, -1)
    sa, ca, ga, sb, cb, gb = (mod[:, 0].clone(), mod[:, 1].clone(), mod[:, 2].clone(), mod[:, 3].clone(), mod[:, 4].clone(), mod[:, 5].clone())
    h = _layernorm(x, axis=-1) * (1 + ca) + sa
    x = x + ga * _A_ref(h, A_k_cache, A_v_cache, A_wq, A_wo)
    h = _layernorm(x, axis=-1) * (1 + cb) + sb
    x = x + gb * _B_ref(h, B_w1, B_b1, B_w2, B_b2)
    return x
```

```asm
; @launch kernel=mod_kernel grid=(256,1,1) block=(256,1,1) lds=1024
; @launch kernel=attn_kernel grid=(256,1,1) block=(256,1,1) lds=163840
.amdgcn_target "amdgcn-amd-amdhsa--gfx950"
.text
.globl mod_kernel
.p2align 8
.type mod_kernel,@function
mod_kernel:
  s_cmp_ge_u32 s2, 256
  s_cbranch_scc1 mod_kernel_end1
  s_load_dwordx4 s[4:7], s[0:1], 80
  s_load_dwordx2 s[8:9], s[0:1], 112
  s_load_dwordx2 s[28:29], s[0:1], 0
  s_and_b32 s20, s2, 7
  s_lshr_b32 s21, s2, 3
  s_and_b32 s22, s21, 3
  s_lshr_b32 s21, s21, 2
  s_mul_i32 s20, s20, 8
  s_add_u32 s20, s20, s21
  s_add_u32 s20, s20, 0
  v_and_b32 v5, 255, v0
  v_lshrrev_b32 v1, 2, v5
  v_and_b32 v2, 3, v0
  s_mov_b32 s23, 12288
  v_mul_lo_u32 v3, v1, s23
  v_lshl_add_u32 v3, v2, 4, v3
  v_lshlrev_b32 v4, 1, v1
  s_mul_i32 s24, s22, 3145728
  s_lshl_b32 s21, s20, 6
  s_add_u32 s21, s21, s24
  s_lshl_b32 s24, s22, 9
  s_waitcnt lgkmcnt(0)
  s_mov_b32 s12, s6
  s_and_b32 s13, s7, 0xffff
  s_mov_b32 s14, 12582912
  s_mov_b32 s15, 0x20000
  s_mov_b32 s16, s4
  s_and_b32 s17, s5, 0xffff
  s_mov_b32 s18, 2048
  s_mov_b32 s19, 0x20000
  buffer_load_ushort v40, v4, s[16:19], s24 offen offset:0
  buffer_load_ushort v41, v4, s[16:19], s24 offen offset:128
  buffer_load_ushort v42, v4, s[16:19], s24 offen offset:256
  buffer_load_ushort v43, v4, s[16:19], s24 offen offset:384
  buffer_load_dwordx4 v[16:19], v3, s[12:15], s21 offen
  s_add_u32 s21, s21, 786432
  buffer_load_dwordx4 v[20:23], v3, s[12:15], s21 offen
  s_add_u32 s21, s21, 786432
  buffer_load_dwordx4 v[24:27], v3, s[12:15], s21 offen
  s_add_u32 s21, s21, 786432
  buffer_load_dwordx4 v[28:31], v3, s[12:15], s21 offen
  s_and_b32 s29, s29, 0xffff
  s_mov_b32 s30, 4194304
  s_mov_b32 s31, 0x20000
  v_lshlrev_b32 v6, 4, v0
  s_lshl_b32 s26, s2, 14
  buffer_load_dwordx4 v[48:51], v6, s[28:31], s26 offen
  s_add_u32 s26, s26, 4096
  buffer_load_dwordx4 v[48:51], v6, s[28:31], s26 offen
  s_add_u32 s26, s26, 4096
  buffer_load_dwordx4 v[48:51], v6, s[28:31], s26 offen
  s_add_u32 s26, s26, 4096
  buffer_load_dwordx4 v[48:51], v6, s[28:31], s26 offen
  s_getpc_b64 s[36:37]
mod_kernel_pc3:
  s_add_u32 s36, s36, mod_kernel_end1-mod_kernel_pc3
  s_addc_u32 s37, s37, 0
  s_and_b32 s37, s37, 0xffff
  s_mov_b32 s38, code_end-mod_kernel_end1
  s_mov_b32 s39, 0x20000
  s_lshr_b32 s26, s2, 3
  s_lshl_b32 s26, s26, 12
  buffer_load_dwordx4 v[48:51], v6, s[36:39], s26 offen
  s_mov_b32 s23, 0xbfb8aa3b
  s_waitcnt vmcnt(9)
  v_lshlrev_b32 v40, 16, v40
  v_lshlrev_b32 v41, 16, v41
  v_lshlrev_b32 v42, 16, v42
  v_lshlrev_b32 v43, 16, v43
  v_mul_f32 v44, s23, v40
  v_mul_f32 v45, s23, v41
  v_mul_f32 v46, s23, v42
  v_mul_f32 v47, s23, v43
  v_exp_f32 v44, v44
  v_exp_f32 v45, v45
  v_exp_f32 v46, v46
  v_exp_f32 v47, v47
  v_add_f32 v44, 1.0, v44
  v_add_f32 v45, 1.0, v45
  v_add_f32 v46, 1.0, v46
  v_add_f32 v47, 1.0, v47
  v_rcp_f32 v44, v44
  v_rcp_f32 v45, v45
  v_rcp_f32 v46, v46
  v_rcp_f32 v47, v47
  v_mul_f32 v40, v40, v44
  v_mul_f32 v41, v41, v45
  v_mul_f32 v42, v42, v46
  v_mul_f32 v43, v43, v47
  v_cvt_pk_bf16_f32 v44, v40, v41
  v_lshlrev_b32 v40, 16, v44
  v_and_b32 v41, 0xffff0000, v44
  v_cvt_pk_bf16_f32 v45, v42, v43
  v_lshlrev_b32 v42, 16, v45
  v_and_b32 v43, 0xffff0000, v45
  s_add_u32 s32, s8, 49152
  s_addc_u32 s33, s9, 0
  s_and_b32 s33, s33, 0xffff
  s_mov_b32 s34, 4096
  s_mov_b32 s35, 0x20000
  s_lshl_b32 s26, s22, 10
  s_cmp_eq_u32 s20, 0
  s_cselect_b32 s26, s26, 0x10000
  v_lshlrev_b32 v7, 2, v1
  buffer_store_dword v40, v7, s[32:35], s26 offen offset:0
  buffer_store_dword v41, v7, s[32:35], s26 offen offset:256
  buffer_store_dword v42, v7, s[32:35], s26 offen offset:512
  buffer_store_dword v43, v7, s[32:35], s26 offen offset:768
  s_add_u32 s40, s8, 8192
  s_addc_u32 s41, s9, 0
  s_and_b32 s41, s41, 0xffff
  s_mov_b32 s42, 16384
  s_mov_b32 s43, 0x20000
  s_lshl_b32 s26, s2, 10
  v_lshlrev_b32 v7, 2, v0
  v_mov_b32 v52, -1
  buffer_store_dword v52, v7, s[40:43], s26 offen
  s_add_u32 s40, s8, 655360
  s_addc_u32 s41, s9, 0
  s_and_b32 s41, s41, 0xffff
  s_mov_b32 s42, 131072
  s_mov_b32 s43, 0x20000
  v_mov_b32 v53, 0
  buffer_store_dword v53, v7, s[40:43], s26 offen
  s_waitcnt vmcnt(14)
  v_lshlrev_b32 v46, 16, v16
  v_and_b32 v47, 0xffff0000, v16
  v_mul_f32 v8, v46, v40
  v_mul_f32 v9, v47, v40
  v_lshlrev_b32 v46, 16, v17
  v_and_b32 v47, 0xffff0000, v17
  v_mul_f32 v10, v46, v40
  v_mul_f32 v11, v47, v40
  v_lshlrev_b32 v46, 16, v18
  v_and_b32 v47, 0xffff0000, v18
  v_mul_f32 v12, v46, v40
  v_mul_f32 v13, v47, v40
  v_lshlrev_b32 v46, 16, v19
  v_and_b32 v47, 0xffff0000, v19
  v_mul_f32 v14, v46, v40
  v_mul_f32 v15, v47, v40
  s_waitcnt vmcnt(13)
  v_lshlrev_b32 v46, 16, v20
  v_and_b32 v47, 0xffff0000, v20
  v_fmac_f32 v8, v46, v41
  v_fmac_f32 v9, v47, v41
  v_lshlrev_b32 v46, 16, v21
  v_and_b32 v47, 0xffff0000, v21
  v_fmac_f32 v10, v46, v41
  v_fmac_f32 v11, v47, v41
  v_lshlrev_b32 v46, 16, v22
  v_and_b32 v47, 0xffff0000, v22
  v_fmac_f32 v12, v46, v41
  v_fmac_f32 v13, v47, v41
  v_lshlrev_b32 v46, 16, v23
  v_and_b32 v47, 0xffff0000, v23
  v_fmac_f32 v14, v46, v41
  v_fmac_f32 v15, v47, v41
  s_waitcnt vmcnt(12)
  v_lshlrev_b32 v46, 16, v24
  v_and_b32 v47, 0xffff0000, v24
  v_fmac_f32 v8, v46, v42
  v_fmac_f32 v9, v47, v42
  v_lshlrev_b32 v46, 16, v25
  v_and_b32 v47, 0xffff0000, v25
  v_fmac_f32 v10, v46, v42
  v_fmac_f32 v11, v47, v42
  v_lshlrev_b32 v46, 16, v26
  v_and_b32 v47, 0xffff0000, v26
  v_fmac_f32 v12, v46, v42
  v_fmac_f32 v13, v47, v42
  v_lshlrev_b32 v46, 16, v27
  v_and_b32 v47, 0xffff0000, v27
  v_fmac_f32 v14, v46, v42
  v_fmac_f32 v15, v47, v42
  s_waitcnt vmcnt(11)
  v_lshlrev_b32 v46, 16, v28
  v_and_b32 v47, 0xffff0000, v28
  v_fmac_f32 v8, v46, v43
  v_fmac_f32 v9, v47, v43
  v_lshlrev_b32 v46, 16, v29
  v_and_b32 v47, 0xffff0000, v29
  v_fmac_f32 v10, v46, v43
  v_fmac_f32 v11, v47, v43
  v_lshlrev_b32 v46, 16, v30
  v_and_b32 v47, 0xffff0000, v30
  v_fmac_f32 v12, v46, v43
  v_fmac_f32 v13, v47, v43
  v_lshlrev_b32 v46, 16, v31
  v_and_b32 v47, 0xffff0000, v31
  v_fmac_f32 v14, v46, v43
  v_fmac_f32 v15, v47, v43
  v_add_f32_dpp v8, v8, v8 row_ror:4 row_mask:0xf bank_mask:0xf
  v_add_f32_dpp v9, v9, v9 row_ror:4 row_mask:0xf bank_mask:0xf
  v_add_f32_dpp v10, v10, v10 row_ror:4 row_mask:0xf bank_mask:0xf
  v_add_f32_dpp v11, v11, v11 row_ror:4 row_mask:0xf bank_mask:0xf
  v_add_f32_dpp v12, v12, v12 row_ror:4 row_mask:0xf bank_mask:0xf
  v_add_f32_dpp v13, v13, v13 row_ror:4 row_mask:0xf bank_mask:0xf
  v_add_f32_dpp v14, v14, v14 row_ror:4 row_mask:0xf bank_mask:0xf
  v_add_f32_dpp v15, v15, v15 row_ror:4 row_mask:0xf bank_mask:0xf
  v_add_f32_dpp v8, v8, v8 row_ror:8 row_mask:0xf bank_mask:0xf
  v_add_f32_dpp v9, v9, v9 row_ror:8 row_mask:0xf bank_mask:0xf
  v_add_f32_dpp v10, v10, v10 row_ror:8 row_mask:0xf bank_mask:0xf
  v_add_f32_dpp v11, v11, v11 row_ror:8 row_mask:0xf bank_mask:0xf
  v_add_f32_dpp v12, v12, v12 row_ror:8 row_mask:0xf bank_mask:0xf
  v_add_f32_dpp v13, v13, v13 row_ror:8 row_mask:0xf bank_mask:0xf
  v_add_f32_dpp v14, v14, v14 row_ror:8 row_mask:0xf bank_mask:0xf
  v_add_f32_dpp v15, v15, v15 row_ror:8 row_mask:0xf bank_mask:0xf
  v_permlane16_swap_b32 v8, v9
  v_permlane16_swap_b32 v10, v11
  v_permlane16_swap_b32 v12, v13
  v_permlane16_swap_b32 v14, v15
  v_add_f32 v8, v8, v9
  v_add_f32 v10, v10, v11
  v_add_f32 v12, v12, v13
  v_add_f32 v14, v14, v15
  s_nop 0
  v_permlane32_swap_b32 v8, v10
  v_permlane32_swap_b32 v12, v14
  v_add_f32 v8, v8, v10
  v_add_f32 v9, v12, v14
  v_and_b32 v1, 63, v0
  v_lshrrev_b32 v3, 4, v1
  v_lshl_add_u32 v3, v2, 3, v3
  v_lshrrev_b32 v4, 6, v0
  v_lshl_add_u32 v3, v4, 5, v3
  v_lshlrev_b32 v3, 2, v3
  ds_write2_b32 v3, v8, v9 offset0:0 offset1:4
  s_waitcnt lgkmcnt(0)
  s_barrier
  v_cmp_gt_u32 vcc, 32, v0
  s_and_saveexec_b64 s[24:25], vcc
  s_cbranch_execz mod_kernel_end1
  v_and_b32 v1, 31, v0
  v_lshrrev_b32 v2, 5, v0
  v_lshlrev_b32 v3, 9, v2
  v_lshl_add_u32 v3, v1, 2, v3
  ds_read2_b32 v[8:9], v3 offset0:0 offset1:32
  ds_read2_b32 v[10:11], v3 offset0:64 offset1:96
  s_add_u32 s12, s8, 65536
  s_addc_u32 s13, s9, 0
  s_and_b32 s13, s13, 0xffff
  s_mov_b32 s14, 98304
  s_mov_b32 s15, 0x20000
  s_mul_i32 s22, s22, 24576
  s_lshl_b32 s21, s20, 7
  s_add_u32 s21, s21, s22
  v_lshlrev_b32 v4, 2, v0
  s_waitcnt lgkmcnt(0)
  v_add_f32 v8, v8, v9
  v_add_f32 v10, v10, v11
  v_add_f32 v8, v8, v10
  buffer_store_dword v8, v4, s[12:15], s21 offen
mod_kernel_end1:
  s_endpgm
.globl attn_kernel
.p2align 8
.type attn_kernel,@function
attn_kernel:
  s_cmp_ge_u32 s2, 256
  s_cbranch_scc1 attn_kernel_end1
  s_load_dwordx4 s[4:7], s[0:1], 8
  s_load_dwordx2 s[8:9], s[0:1], 24
  s_load_dwordx2 s[10:11], s[0:1], 112
  s_load_dwordx2 s[32:33], s[0:1], 32
  s_load_dwordx2 s[36:37], s[0:1], 48
  s_load_dwordx2 s[60:61], s[0:1], 64
  s_load_dwordx2 s[64:65], s[0:1], 88
  s_load_dwordx2 s[20:21], s[0:1], 0
  v_and_b32 v1, 63, v0
  v_lshrrev_b32 v2, 6, v0
  s_and_b32 s42, s2, 7
  v_readfirstlane_b32 s44, v2
  s_lshl_b32 s42, s42, 2
  s_bfe_u32 s43, s2, 0x20003
  s_add_u32 s40, s42, s43
  s_lshr_b32 s41, s2, 5
  s_lshl_b32 s52, s44, 12
  v_lshl_add_u32 v5, v1, 4, s52
  v_lshlrev_b32 v6, 4, v0
  s_lshl_b32 s48, s2, 14
  s_waitcnt lgkmcnt(0)
  s_and_b32 s21, s21, 0xffff
  s_mov_b32 s22, 4194304
  s_mov_b32 s23, 0x20000
  s_add_u32 s24, s10, 65536
  s_addc_u32 s25, s11, 0
  s_and_b32 s25, s25, 0xffff
  s_mov_b32 s26, 98304
  s_mov_b32 s27, 0x20000
  s_mov_b32 s49, 0
  buffer_load_dwordx4 v[80:83], v6, s[24:27], s49 offen
  s_mov_b32 s49, 4096
  buffer_load_dwordx4 v[84:87], v6, s[24:27], s49 offen
  s_mov_b32 s49, 24576
  buffer_load_dwordx4 v[88:91], v6, s[24:27], s49 offen
  s_mov_b32 s49, 28672
  buffer_load_dwordx4 v[92:95], v6, s[24:27], s49 offen
  s_mov_b32 s49, 49152
  buffer_load_dwordx4 v[96:99], v6, s[24:27], s49 offen
  s_mov_b32 s49, 53248
  buffer_load_dwordx4 v[100:103], v6, s[24:27], s49 offen
  s_mov_b32 s49, 73728
  buffer_load_dwordx4 v[104:107], v6, s[24:27], s49 offen
  s_mov_b32 s49, 77824
  buffer_load_dwordx4 v[108:111], v6, s[24:27], s49 offen
  buffer_load_dwordx4 v[64:67], v5, s[20:23], s48 offen offset:0
  buffer_load_dwordx4 v[68:71], v5, s[20:23], s48 offen offset:1024
  buffer_load_dwordx4 v[72:75], v5, s[20:23], s48 offen offset:2048
  buffer_load_dwordx4 v[76:79], v5, s[20:23], s48 offen offset:3072
  v_lshrrev_b32 v26, 4, v1
  v_and_b32 v27, 15, v1
  s_lshl_b32 s45, s44, 4
  s_mov_b32 s46, 8192
  v_add_u32 v28, 0, v26
  v_and_b32 v29, 7, v28
  v_lshlrev_b32 v29, 1, v29
  v_xor_b32 v29, v29, v27
  v_add_u32 v28, s45, v28
  v_mul_lo_u32 v28, v28, s46
  v_lshl_add_u32 v40, v29, 4, v28
  v_add_u32 v28, 4, v26
  v_and_b32 v29, 7, v28
  v_lshlrev_b32 v29, 1, v29
  v_xor_b32 v29, v29, v27
  v_add_u32 v28, s45, v28
  v_mul_lo_u32 v28, v28, s46
  v_lshl_add_u32 v41, v29, 4, v28
  v_subrev_u32 v41, 1024, v41
  v_add_u32 v28, 8, v26
  v_and_b32 v29, 7, v28
  v_lshlrev_b32 v29, 1, v29
  v_xor_b32 v29, v29, v27
  v_add_u32 v28, s45, v28
  v_mul_lo_u32 v28, v28, s46
  v_lshl_add_u32 v42, v29, 4, v28
  v_subrev_u32 v42, 2048, v42
  v_add_u32 v28, 12, v26
  v_and_b32 v29, 7, v28
  v_lshlrev_b32 v29, 1, v29
  v_xor_b32 v29, v29, v27
  v_add_u32 v28, s45, v28
  v_mul_lo_u32 v28, v28, s46
  v_lshl_add_u32 v43, v29, 4, v28
  v_subrev_u32 v43, 3072, v43
  s_lshl_b32 s47, s41, 4
  s_lshl_b32 s48, s44, 2
  s_add_u32 s47, s47, s48
  s_lshl_b32 s48, s47, 10
  v_lshl_add_u32 v44, v1, 4, s48
  v_add_u32 v45, 0x20000, v44
  s_lshl_b32 s50, s40, 8
  s_mov_b32 s51, 0
  s_lshl_b32 s52, s44, 12
  s_waitcnt lgkmcnt(0)
  s_mov_b32 s12, s8
  s_and_b32 s13, s9, 0xffff
  s_mov_b32 s14, 8388608
  s_mov_b32 s15, 0x20000
  s_add_u32 s16, s10, 1048576
  s_addc_u32 s17, s11, 0
  s_and_b32 s17, s17, 0xffff
  s_mov_b32 s18, 4194304
  s_mov_b32 s19, 0x20000
  s_and_b32 s48, s41, 3
  s_mul_i32 s48, s48, 32768
  s_lshr_b32 s45, s41, 2
  s_mul_i32 s45, s45, 524288
  s_add_u32 s48, s48, s45
  s_add_u32 s48, s48, s50
  buffer_load_dwordx4 a[0:3], v40, s[12:15], s48 offen
  s_add_u32 s48, s48, 1048576
  buffer_load_dwordx4 a[0:3], v40, s[12:15], s48 offen
  s_add_u32 s48, s48, 1048576
  buffer_load_dwordx4 a[0:3], v40, s[12:15], s48 offen
  s_add_u32 s48, s48, 1048576
  buffer_load_dwordx4 a[0:3], v40, s[12:15], s48 offen
  s_add_u32 s48, s48, 1048576
  buffer_load_dwordx4 a[0:3], v40, s[12:15], s48 offen
  s_add_u32 s48, s48, 1048576
  buffer_load_dwordx4 a[0:3], v40, s[12:15], s48 offen
  s_add_u32 s48, s48, 1048576
  buffer_load_dwordx4 a[0:3], v40, s[12:15], s48 offen
  s_add_u32 s48, s48, 1048576
  buffer_load_dwordx4 a[0:3], v40, s[12:15], s48 offen
  s_add_u32 s48, s48, 1048576
  s_add_u32 s28, s10, 655360
  s_addc_u32 s29, s11, 0
  s_and_b32 s29, s29, 0xffff
  s_mov_b32 s30, 131072
  s_mov_b32 s31, 0x20000
  s_waitcnt vmcnt(12)
  v_pk_add_f32 v[80:81], v[80:81], v[88:89]
  v_pk_add_f32 v[82:83], v[82:83], v[90:91]
  v_pk_add_f32 v[84:85], v[84:85], v[92:93]
  v_pk_add_f32 v[86:87], v[86:87], v[94:95]
  v_pk_add_f32 v[80:81], v[80:81], v[96:97]
  v_pk_add_f32 v[82:83], v[82:83], v[98:99]
  v_pk_add_f32 v[84:85], v[84:85], v[100:101]
  v_pk_add_f32 v[86:87], v[86:87], v[102:103]
  v_pk_add_f32 v[80:81], v[80:81], v[104:105]
  v_pk_add_f32 v[82:83], v[82:83], v[106:107]
  v_pk_add_f32 v[84:85], v[84:85], v[108:109]
  v_pk_add_f32 v[86:87], v[86:87], v[110:111]
  v_cvt_pk_bf16_f32 v88, v80, v81
  v_lshlrev_b32 v80, 16, v88
  v_and_b32 v81, 0xffff0000, v88
  v_cvt_pk_bf16_f32 v89, v82, v83
  v_lshlrev_b32 v82, 16, v89
  v_and_b32 v83, 0xffff0000, v89
  v_cvt_pk_bf16_f32 v90, v84, v85
  v_lshlrev_b32 v84, 16, v90
  v_and_b32 v85, 0xffff0000, v90
  v_cvt_pk_bf16_f32 v91, v86, v87
  v_lshlrev_b32 v86, 16, v91
  v_and_b32 v87, 0xffff0000, v91
  v_add_f32 v84, 1.0, v84
  v_add_f32 v85, 1.0, v85
  v_add_f32 v86, 1.0, v86
  v_add_f32 v87, 1.0, v87
  v_cvt_pk_bf16_f32 v90, v84, v85
  v_lshlrev_b32 v84, 16, v90
  v_and_b32 v85, 0xffff0000, v90
  v_cvt_pk_bf16_f32 v91, v86, v87
  v_lshlrev_b32 v86, 16, v91
  v_and_b32 v87, 0xffff0000, v91
  v_lshrrev_b32 v6, 7, v0
  v_lshlrev_b32 v6, 11, v6
  v_and_b32 v7, 1, v0
  v_lshl_add_u32 v6, v7, 10, v6
  v_bfe_u32 v7, v0, 1, 6
  v_lshl_add_u32 v6, v7, 4, v6
  ds_write_b128 v6, v[80:83] offset:32768
  ds_write_b128 v6, v[84:87] offset:36864
  s_mov_b32 s56, 0x3a800000
  s_mov_b32 s57, 0xba800000
  v_lshlrev_b32 v3, 4, v1
  s_waitcnt vmcnt(8)
  v_lshlrev_b32 v128, 16, v64
  v_and_b32 v129, 0xffff0000, v64
  v_lshlrev_b32 v130, 16, v65
  v_and_b32 v131, 0xffff0000, v65
  v_lshlrev_b32 v132, 16, v66
  v_and_b32 v133, 0xffff0000, v66
  v_lshlrev_b32 v134, 16, v67
  v_and_b32 v135, 0xffff0000, v67
  v_lshlrev_b32 v136, 16, v68
  v_and_b32 v137, 0xffff0000, v68
  v_lshlrev_b32 v138, 16, v69
  v_and_b32 v139, 0xffff0000, v69
  v_lshlrev_b32 v140, 16, v70
  v_and_b32 v141, 0xffff0000, v70
  v_lshlrev_b32 v142, 16, v71
  v_and_b32 v143, 0xffff0000, v71
  v_lshlrev_b32 v144, 16, v72
  v_and_b32 v145, 0xffff0000, v72
  v_lshlrev_b32 v146, 16, v73
  v_and_b32 v147, 0xffff0000, v73
  v_lshlrev_b32 v148, 16, v74
  v_and_b32 v149, 0xffff0000, v74
  v_lshlrev_b32 v150, 16, v75
  v_and_b32 v151, 0xffff0000, v75
  v_lshlrev_b32 v152, 16, v76
  v_and_b32 v153, 0xffff0000, v76
  v_lshlrev_b32 v154, 16, v77
  v_and_b32 v155, 0xffff0000, v77
  v_lshlrev_b32 v156, 16, v78
  v_and_b32 v157, 0xffff0000, v78
  v_lshlrev_b32 v158, 16, v79
  v_and_b32 v159, 0xffff0000, v79
  s_waitcnt lgkmcnt(0)
  s_barrier
  ds_read_b128 v[112:115], v3 offset:36864
  ds_read_b128 v[116:119], v3 offset:37888
  ds_read_b128 v[120:123], v3 offset:38912
  ds_read_b128 v[124:127], v3 offset:39936
  ds_read_b128 v[96:99], v3 offset:32768
  ds_read_b128 v[100:103], v3 offset:33792
  ds_read_b128 v[104:107], v3 offset:34816
  ds_read_b128 v[108:111], v3 offset:35840
  v_pk_add_f32 v[160:161], v[128:129], v[130:131]
  v_pk_add_f32 v[184:185], v[144:145], v[146:147]
  v_pk_add_f32 v[162:163], v[132:133], v[134:135]
  v_pk_add_f32 v[186:187], v[148:149], v[150:151]
  v_pk_add_f32 v[160:161], v[160:161], v[136:137]
  v_pk_add_f32 v[184:185], v[184:185], v[152:153]
  v_pk_add_f32 v[162:163], v[162:163], v[138:139]
  v_pk_add_f32 v[186:187], v[186:187], v[154:155]
  v_pk_add_f32 v[160:161], v[160:161], v[140:141]
  v_pk_add_f32 v[184:185], v[184:185], v[156:157]
  v_pk_add_f32 v[162:163], v[162:163], v[142:143]
  v_pk_add_f32 v[186:187], v[186:187], v[158:159]
  v_pk_add_f32 v[160:161], v[160:161], v[162:163]
  v_pk_add_f32 v[184:185], v[184:185], v[186:187]
  v_add_f32 v160, v160, v161
  v_add_f32 v184, v184, v185
  s_nop 0
  v_add_f32_dpp v160, v160, v160 quad_perm:[1,0,3,2] row_mask:0xf bank_mask:0xf
  v_add_f32_dpp v184, v184, v184 quad_perm:[1,0,3,2] row_mask:0xf bank_mask:0xf
  s_nop 0
  v_add_f32_dpp v160, v160, v160 quad_perm:[2,3,0,1] row_mask:0xf bank_mask:0xf
  v_add_f32_dpp v184, v184, v184 quad_perm:[2,3,0,1] row_mask:0xf bank_mask:0xf
  s_nop 0
  v_add_f32_dpp v160, v160, v160 row_half_mirror row_mask:0xf bank_mask:0xf
  v_add_f32_dpp v184, v184, v184 row_half_mirror row_mask:0xf bank_mask:0xf
  s_nop 0
  v_add_f32_dpp v160, v160, v160 row_mirror row_mask:0xf bank_mask:0xf
  v_add_f32_dpp v184, v184, v184 row_mirror row_mask:0xf bank_mask:0xf
  v_mov_b32 v162, v160
  v_mov_b32 v186, v184
  s_nop 0
  v_permlane16_swap_b32 v160, v162
  v_permlane16_swap_b32 v184, v186
  v_add_f32 v160, v160, v162
  v_add_f32 v184, v184, v186
  v_mov_b32 v162, v160
  v_mov_b32 v186, v184
  s_nop 0
  v_permlane32_swap_b32 v160, v162
  v_permlane32_swap_b32 v184, v186
  v_add_f32 v160, v160, v162
  v_add_f32 v184, v184, v186
  v_mul_f32 v160, s57, v160
  v_mul_f32 v184, s57, v184
  v_mov_b32 v161, v160
  v_mov_b32 v185, v184
  v_pk_add_f32 v[168:169], v[128:129], v[160:161]
  v_pk_add_f32 v[192:193], v[144:145], v[184:185]
  v_pk_add_f32 v[170:171], v[130:131], v[160:161]
  v_pk_add_f32 v[194:195], v[146:147], v[184:185]
  v_pk_add_f32 v[172:173], v[132:133], v[160:161]
  v_pk_add_f32 v[196:197], v[148:149], v[184:185]
  v_pk_add_f32 v[174:175], v[134:135], v[160:161]
  v_pk_add_f32 v[198:199], v[150:151], v[184:185]
  v_pk_add_f32 v[176:177], v[136:137], v[160:161]
  v_pk_add_f32 v[200:201], v[152:153], v[184:185]
  v_pk_add_f32 v[178:179], v[138:139], v[160:161]
  v_pk_add_f32 v[202:203], v[154:155], v[184:185]
  v_pk_add_f32 v[180:181], v[140:141], v[160:161]
  v_pk_add_f32 v[204:205], v[156:157], v[184:185]
  v_pk_add_f32 v[182:183], v[142:143], v[160:161]
  v_pk_add_f32 v[206:207], v[158:159], v[184:185]
  v_pk_mul_f32 v[162:163], v[168:169], v[168:169]
  v_pk_mul_f32 v[186:187], v[192:193], v[192:193]
  v_pk_mul_f32 v[164:165], v[170:171], v[170:171]
  v_pk_mul_f32 v[188:189], v[194:195], v[194:195]
  v_pk_fma_f32 v[162:163], v[172:173], v[172:173], v[162:163]
  v_pk_fma_f32 v[186:187], v[196:197], v[196:197], v[186:187]
  v_pk_fma_f32 v[164:165], v[174:175], v[174:175], v[164:165]
  v_pk_fma_f32 v[188:189], v[198:199], v[198:199], v[188:189]
  v_pk_fma_f32 v[162:163], v[176:177], v[176:177], v[162:163]
  v_pk_fma_f32 v[186:187], v[200:201], v[200:201], v[186:187]
  v_pk_fma_f32 v[164:165], v[178:179], v[178:179], v[164:165]
  v_pk_fma_f32 v[188:189], v[202:203], v[202:203], v[188:189]
  v_pk_fma_f32 v[162:163], v[180:181], v[180:181], v[162:163]
  v_pk_fma_f32 v[186:187], v[204:205], v[204:205], v[186:187]
  v_pk_fma_f32 v[164:165], v[182:183], v[182:183], v[164:165]
  v_pk_fma_f32 v[188:189], v[206:207], v[206:207], v[188:189]
  v_pk_add_f32 v[162:163], v[162:163], v[164:165]
  v_pk_add_f32 v[186:187], v[186:187], v[188:189]
  v_add_f32 v162, v162, v163
  v_add_f32 v186, v186, v187
  v_cvt_pk_bf16_f32 v164, v160, v161
  v_cvt_pk_bf16_f32 v188, v184, v185
  v_lshlrev_b32 v160, 16, v164
  v_lshlrev_b32 v184, 16, v188
  v_and_b32 v161, 0xffff0000, v164
  v_and_b32 v185, 0xffff0000, v188
  v_pk_add_f32 v[128:129], v[128:129], v[160:161]
  v_pk_add_f32 v[144:145], v[144:145], v[184:185]
  v_pk_add_f32 v[130:131], v[130:131], v[160:161]
  v_pk_add_f32 v[146:147], v[146:147], v[184:185]
  v_pk_add_f32 v[132:133], v[132:133], v[160:161]
  v_pk_add_f32 v[148:149], v[148:149], v[184:185]
  v_pk_add_f32 v[134:135], v[134:135], v[160:161]
  v_pk_add_f32 v[150:151], v[150:151], v[184:185]
  v_pk_add_f32 v[136:137], v[136:137], v[160:161]
  v_pk_add_f32 v[152:153], v[152:153], v[184:185]
  v_pk_add_f32 v[138:139], v[138:139], v[160:161]
  v_pk_add_f32 v[154:155], v[154:155], v[184:185]
  v_pk_add_f32 v[140:141], v[140:141], v[160:161]
  v_pk_add_f32 v[156:157], v[156:157], v[184:185]
  v_pk_add_f32 v[142:143], v[142:143], v[160:161]
  v_pk_add_f32 v[158:159], v[158:159], v[184:185]
  s_nop 0
  v_add_f32_dpp v162, v162, v162 quad_perm:[1,0,3,2] row_mask:0xf bank_mask:0xf
  v_add_f32_dpp v186, v186, v186 quad_perm:[1,0,3,2] row_mask:0xf bank_mask:0xf
  s_nop 0
  v_add_f32_dpp v162, v162, v162 quad_perm:[2,3,0,1] row_mask:0xf bank_mask:0xf
  v_add_f32_dpp v186, v186, v186 quad_perm:[2,3,0,1] row_mask:0xf bank_mask:0xf
  s_nop 0
  v_add_f32_dpp v162, v162, v162 row_half_mirror row_mask:0xf bank_mask:0xf
  v_add_f32_dpp v186, v186, v186 row_half_mirror row_mask:0xf bank_mask:0xf
  s_nop 0
  v_add_f32_dpp v162, v162, v162 row_mirror row_mask:0xf bank_mask:0xf
  v_add_f32_dpp v186, v186, v186 row_mirror row_mask:0xf bank_mask:0xf
  v_mov_b32 v164, v162
  v_mov_b32 v188, v186
  s_nop 0
  v_permlane16_swap_b32 v162, v164
  v_permlane16_swap_b32 v186, v188
  v_add_f32 v162, v162, v164
  v_add_f32 v186, v186, v188
  v_mov_b32 v164, v162
  v_mov_b32 v188, v186
  s_nop 0
  v_permlane32_swap_b32 v162, v164
  v_permlane32_swap_b32 v186, v188
  v_add_f32 v162, v162, v164
  v_add_f32 v186, v186, v188
  v_cvt_pk_bf16_f32 v168, v128, v129
  v_cvt_pk_bf16_f32 v192, v144, v145
  v_cvt_pk_bf16_f32 v170, v130, v131
  v_cvt_pk_bf16_f32 v194, v146, v147
  v_cvt_pk_bf16_f32 v172, v132, v133
  v_cvt_pk_bf16_f32 v196, v148, v149
  v_cvt_pk_bf16_f32 v174, v134, v135
  v_cvt_pk_bf16_f32 v198, v150, v151
  v_cvt_pk_bf16_f32 v176, v136, v137
  v_cvt_pk_bf16_f32 v200, v152, v153
  v_cvt_pk_bf16_f32 v178, v138, v139
  v_cvt_pk_bf16_f32 v202, v154, v155
  v_cvt_pk_bf16_f32 v180, v140, v141
  v_cvt_pk_bf16_f32 v204, v156, v157
  v_cvt_pk_bf16_f32 v182, v142, v143
  v_cvt_pk_bf16_f32 v206, v158, v159
  v_mul_f32 v162, s56, v162
  v_mul_f32 v186, s56, v186
  v_cvt_pk_bf16_f32 v164, v162, v163
  v_cvt_pk_bf16_f32 v188, v186, v187
  v_lshlrev_b32 v162, 16, v164
  v_lshlrev_b32 v186, 16, v188
  v_and_b32 v163, 0xffff0000, v164
  v_and_b32 v187, 0xffff0000, v188
  v_add_f32 v162, 0x3727c5ac, v162
  v_add_f32 v186, 0x3727c5ac, v186
  v_cvt_pk_bf16_f32 v164, v162, v163
  v_cvt_pk_bf16_f32 v188, v186, v187
  v_lshlrev_b32 v162, 16, v164
  v_lshlrev_b32 v186, 16, v188
  v_and_b32 v163, 0xffff0000, v164
  v_and_b32 v187, 0xffff0000, v188
  v_sqrt_f32 v162, v162
  v_sqrt_f32 v186, v186
  v_lshlrev_b32 v128, 16, v168
  v_lshlrev_b32 v144, 16, v192
  v_and_b32 v129, 0xffff0000, v168
  v_and_b32 v145, 0xffff0000, v192
  v_lshlrev_b32 v130, 16, v170
  v_lshlrev_b32 v146, 16, v194
  v_and_b32 v131, 0xffff0000, v170
  v_and_b32 v147, 0xffff0000, v194
  v_lshlrev_b32 v132, 16, v172
  v_lshlrev_b32 v148, 16, v196
  v_and_b32 v133, 0xffff0000, v172
  v_and_b32 v149, 0xffff0000, v196
  v_lshlrev_b32 v134, 16, v174
  v_lshlrev_b32 v150, 16, v198
  v_and_b32 v135, 0xffff0000, v174
  v_and_b32 v151, 0xffff0000, v198
  v_lshlrev_b32 v136, 16, v176
  v_lshlrev_b32 v152, 16, v200
  v_and_b32 v137, 0xffff0000, v176
  v_and_b32 v153, 0xffff0000, v200
  v_lshlrev_b32 v138, 16, v178
  v_lshlrev_b32 v154, 16, v202
  v_and_b32 v139, 0xffff0000, v178
  v_and_b32 v155, 0xffff0000, v202
  v_lshlrev_b32 v140, 16, v180
  v_lshlrev_b32 v156, 16, v204
  v_and_b32 v141, 0xffff0000, v180
  v_and_b32 v157, 0xffff0000, v204
  v_lshlrev_b32 v142, 16, v182
  v_lshlrev_b32 v158, 16, v206
  v_and_b32 v143, 0xffff0000, v182
  v_and_b32 v159, 0xffff0000, v206
  v_cvt_pk_bf16_f32 v164, v162, v163
  v_cvt_pk_bf16_f32 v188, v186, v187
  v_lshlrev_b32 v162, 16, v164
  v_lshlrev_b32 v186, 16, v188
  v_and_b32 v163, 0xffff0000, v164
  v_and_b32 v187, 0xffff0000, v188
  v_rcp_f32 v162, v162
  v_rcp_f32 v186, v186
  v_mov_b32 v163, v162
  v_mov_b32 v187, v186
  v_pk_mul_f32 v[128:129], v[128:129], v[162:163]
  v_pk_mul_f32 v[144:145], v[144:145], v[186:187]
  v_pk_mul_f32 v[130:131], v[130:131], v[162:163]
  v_pk_mul_f32 v[146:147], v[146:147], v[186:187]
  v_pk_mul_f32 v[132:133], v[132:133], v[162:163]
  v_pk_mul_f32 v[148:149], v[148:149], v[186:187]
  v_pk_mul_f32 v[134:135], v[134:135], v[162:163]
  v_pk_mul_f32 v[150:151], v[150:151], v[186:187]
  v_pk_mul_f32 v[136:137], v[136:137], v[162:163]
  v_pk_mul_f32 v[152:153], v[152:153], v[186:187]
  v_pk_mul_f32 v[138:139], v[138:139], v[162:163]
  v_pk_mul_f32 v[154:155], v[154:155], v[186:187]
  v_pk_mul_f32 v[140:141], v[140:141], v[162:163]
  v_pk_mul_f32 v[156:157], v[156:157], v[186:187]
  v_pk_mul_f32 v[142:143], v[142:143], v[162:163]
  v_pk_mul_f32 v[158:159], v[158:159], v[186:187]
  v_cvt_pk_bf16_f32 v168, v128, v129
  v_cvt_pk_bf16_f32 v192, v144, v145
  v_cvt_pk_bf16_f32 v170, v130, v131
  v_cvt_pk_bf16_f32 v194, v146, v147
  v_cvt_pk_bf16_f32 v172, v132, v133
  v_cvt_pk_bf16_f32 v196, v148, v149
  v_cvt_pk_bf16_f32 v174, v134, v135
  v_cvt_pk_bf16_f32 v198, v150, v151
  v_cvt_pk_bf16_f32 v176, v136, v137
  v_cvt_pk_bf16_f32 v200, v152, v153
  v_cvt_pk_bf16_f32 v178, v138, v139
  v_cvt_pk_bf16_f32 v202, v154, v155
  v_cvt_pk_bf16_f32 v180, v140, v141
  v_cvt_pk_bf16_f32 v204, v156, v157
  v_cvt_pk_bf16_f32 v182, v142, v143
  v_cvt_pk_bf16_f32 v206, v158, v159
  v_lshlrev_b32 v128, 16, v168
  v_lshlrev_b32 v144, 16, v192
  v_and_b32 v129, 0xffff0000, v168
  v_and_b32 v145, 0xffff0000, v192
  v_lshlrev_b32 v130, 16, v170
  v_lshlrev_b32 v146, 16, v194
  v_and_b32 v131, 0xffff0000, v170
  v_and_b32 v147, 0xffff0000, v194
  v_lshlrev_b32 v132, 16, v172
  v_lshlrev_b32 v148, 16, v196
  v_and_b32 v133, 0xffff0000, v172
  v_and_b32 v149, 0xffff0000, v196
  v_lshlrev_b32 v134, 16, v174
  v_lshlrev_b32 v150, 16, v198
  v_and_b32 v135, 0xffff0000, v174
  v_and_b32 v151, 0xffff0000, v198
  v_lshlrev_b32 v136, 16, v176
  v_lshlrev_b32 v152, 16, v200
  v_and_b32 v137, 0xffff0000, v176
  v_and_b32 v153, 0xffff0000, v200
  v_lshlrev_b32 v138, 16, v178
  v_lshlrev_b32 v154, 16, v202
  v_and_b32 v139, 0xffff0000, v178
  v_and_b32 v155, 0xffff0000, v202
  v_lshlrev_b32 v140, 16, v180
  v_lshlrev_b32 v156, 16, v204
  v_and_b32 v141, 0xffff0000, v180
  v_and_b32 v157, 0xffff0000, v204
  v_lshlrev_b32 v142, 16, v182
  v_lshlrev_b32 v158, 16, v206
  v_and_b32 v143, 0xffff0000, v182
  v_and_b32 v159, 0xffff0000, v206
  s_waitcnt lgkmcnt(0)
  v_pk_mul_f32 v[128:129], v[128:129], v[112:113]
  v_pk_mul_f32 v[144:145], v[144:145], v[112:113]
  v_pk_mul_f32 v[130:131], v[130:131], v[114:115]
  v_pk_mul_f32 v[146:147], v[146:147], v[114:115]
  v_pk_mul_f32 v[132:133], v[132:133], v[116:117]
  v_pk_mul_f32 v[148:149], v[148:149], v[116:117]
  v_pk_mul_f32 v[134:135], v[134:135], v[118:119]
  v_pk_mul_f32 v[150:151], v[150:151], v[118:119]
  v_pk_mul_f32 v[136:137], v[136:137], v[120:121]
  v_pk_mul_f32 v[152:153], v[152:153], v[120:121]
  v_pk_mul_f32 v[138:139], v[138:139], v[122:123]
  v_pk_mul_f32 v[154:155], v[154:155], v[122:123]
  v_pk_mul_f32 v[140:141], v[140:141], v[124:125]
  v_pk_mul_f32 v[156:157], v[156:157], v[124:125]
  v_pk_mul_f32 v[142:143], v[142:143], v[126:127]
  v_pk_mul_f32 v[158:159], v[158:159], v[126:127]
  v_cvt_pk_bf16_f32 v168, v128, v129
  v_cvt_pk_bf16_f32 v192, v144, v145
  v_cvt_pk_bf16_f32 v170, v130, v131
  v_cvt_pk_bf16_f32 v194, v146, v147
  v_cvt_pk_bf16_f32 v172, v132, v133
  v_cvt_pk_bf16_f32 v196, v148, v149
  v_cvt_pk_bf16_f32 v174, v134, v135
  v_cvt_pk_bf16_f32 v198, v150, v151
  v_cvt_pk_bf16_f32 v176, v136, v137
  v_cvt_pk_bf16_f32 v200, v152, v153
  v_cvt_pk_bf16_f32 v178, v138, v139
  v_cvt_pk_bf16_f32 v202, v154, v155
  v_cvt_pk_bf16_f32 v180, v140, v141
  v_cvt_pk_bf16_f32 v204, v156, v157
  v_cvt_pk_bf16_f32 v182, v142, v143
  v_cvt_pk_bf16_f32 v206, v158, v159
  v_lshlrev_b32 v128, 16, v168
  v_lshlrev_b32 v144, 16, v192
  v_and_b32 v129, 0xffff0000, v168
  v_and_b32 v145, 0xffff0000, v192
  v_lshlrev_b32 v130, 16, v170
  v_lshlrev_b32 v146, 16, v194
  v_and_b32 v131, 0xffff0000, v170
  v_and_b32 v147, 0xffff0000, v194
  v_lshlrev_b32 v132, 16, v172
  v_lshlrev_b32 v148, 16, v196
  v_and_b32 v133, 0xffff0000, v172
  v_and_b32 v149, 0xffff0000, v196
  v_lshlrev_b32 v134, 16, v174
  v_lshlrev_b32 v150, 16, v198
  v_and_b32 v135, 0xffff0000, v174
  v_and_b32 v151, 0xffff0000, v198
  v_lshlrev_b32 v136, 16, v176
  v_lshlrev_b32 v152, 16, v200
  v_and_b32 v137, 0xffff0000, v176
  v_and_b32 v153, 0xffff0000, v200
  v_lshlrev_b32 v138, 16, v178
  v_lshlrev_b32 v154, 16, v202
  v_and_b32 v139, 0xffff0000, v178
  v_and_b32 v155, 0xffff0000, v202
  v_lshlrev_b32 v140, 16, v180
  v_lshlrev_b32 v156, 16, v204
  v_and_b32 v141, 0xffff0000, v180
  v_and_b32 v157, 0xffff0000, v204
  v_lshlrev_b32 v142, 16, v182
  v_lshlrev_b32 v158, 16, v206
  v_and_b32 v143, 0xffff0000, v182
  v_and_b32 v159, 0xffff0000, v206
  v_pk_add_f32 v[128:129], v[128:129], v[96:97]
  v_pk_add_f32 v[144:145], v[144:145], v[96:97]
  v_pk_add_f32 v[130:131], v[130:131], v[98:99]
  v_pk_add_f32 v[146:147], v[146:147], v[98:99]
  v_pk_add_f32 v[132:133], v[132:133], v[100:101]
  v_pk_add_f32 v[148:149], v[148:149], v[100:101]
  v_pk_add_f32 v[134:135], v[134:135], v[102:103]
  v_pk_add_f32 v[150:151], v[150:151], v[102:103]
  v_pk_add_f32 v[136:137], v[136:137], v[104:105]
  v_pk_add_f32 v[152:153], v[152:153], v[104:105]
  v_pk_add_f32 v[138:139], v[138:139], v[106:107]
  v_pk_add_f32 v[154:155], v[154:155], v[106:107]
  v_pk_add_f32 v[140:141], v[140:141], v[108:109]
  v_pk_add_f32 v[156:157], v[156:157], v[108:109]
  v_pk_add_f32 v[142:143], v[142:143], v[110:111]
  v_pk_add_f32 v[158:159], v[158:159], v[110:111]
  v_cvt_pk_bf16_f32 v64, v128, v129
  v_cvt_pk_bf16_f32 v72, v144, v145
  v_cvt_pk_bf16_f32 v65, v130, v131
  v_cvt_pk_bf16_f32 v73, v146, v147
  v_cvt_pk_bf16_f32 v66, v132, v133
  v_cvt_pk_bf16_f32 v74, v148, v149
  v_cvt_pk_bf16_f32 v67, v134, v135
  v_cvt_pk_bf16_f32 v75, v150, v151
  v_cvt_pk_bf16_f32 v68, v136, v137
  v_cvt_pk_bf16_f32 v76, v152, v153
  v_cvt_pk_bf16_f32 v69, v138, v139
  v_cvt_pk_bf16_f32 v77, v154, v155
  v_cvt_pk_bf16_f32 v70, v140, v141
  v_cvt_pk_bf16_f32 v78, v156, v157
  v_cvt_pk_bf16_f32 v71, v142, v143
  v_cvt_pk_bf16_f32 v79, v158, v159
  v_lshrrev_b32 v5, 2, v1
  v_mul_u32_u24 v5, 528, v5
  v_and_b32 v6, 1, v1
  v_lshl_add_u32 v5, v6, 8, v5
  v_bfe_u32 v6, v1, 1, 1
  v_lshl_add_u32 v5, v6, 3, v5
  v_lshl_add_u32 v5, v2, 5, v5
  ds_write_b64 v5, v[64:65] offset:0
  ds_write_b64 v5, v[66:67] offset:128
  ds_write_b64 v5, v[68:69] offset:8448
  ds_write_b64 v5, v[70:71] offset:8576
  ds_write_b64 v5, v[72:73] offset:16
  ds_write_b64 v5, v[74:75] offset:144
  ds_write_b64 v5, v[76:77] offset:8464
  ds_write_b64 v5, v[78:79] offset:8592
  v_lshrrev_b32 v6, 5, v0
  v_and_b32 v7, 31, v0
  v_mul_u32_u24 v5, 528, v6
  v_lshl_add_u32 v5, v7, 4, v5
  v_lshlrev_b32 v6, 17, v6
  v_bfe_u32 v7, v0, 3, 2
  v_lshl_add_u32 v6, v7, 8, v6
  v_and_b32 v7, 7, v0
  v_lshl_add_u32 v6, v7, 4, v6
  s_lshr_b32 s48, s2, 1
  s_lshl_b32 s48, s48, 10
  s_and_b32 s49, s2, 1
  s_lshl_b32 s49, s49, 7
  s_add_u32 s48, s48, s49
  s_waitcnt lgkmcnt(0)
  s_barrier
  ds_read_b128 v[80:83], v5 offset:0
  ds_read_b128 v[84:87], v5 offset:4224
  ds_read_b128 v[88:91], v5 offset:8448
  ds_read_b128 v[92:95], v5 offset:12672
  s_waitcnt lgkmcnt(3)
  buffer_store_dwordx4 v[80:83], v6, s[16:19], s48 offen sc1
  s_add_u32 s48, s48, 1048576
  s_waitcnt lgkmcnt(2)
  buffer_store_dwordx4 v[84:87], v6, s[16:19], s48 offen sc1
  s_add_u32 s48, s48, 1048576
  s_waitcnt lgkmcnt(1)
  buffer_store_dwordx4 v[88:91], v6, s[16:19], s48 offen sc1
  s_add_u32 s48, s48, 1048576
  s_waitcnt lgkmcnt(0)
  buffer_store_dwordx4 v[92:95], v6, s[16:19], s48 offen sc1
  s_lshl_b32 s48, s2, 7
  s_add_u32 s48, s48, 98304
  s_lshl_b32 s49, s41, 12
  s_add_u32 s49, s49, 98304
  s_waitcnt vmcnt(0)
  s_barrier
  s_cmp_lg_u32 s44, 0
  s_cbranch_scc1 attn_kernel_pub7
  v_mov_b32 v3, 0
  v_mov_b32 v4, 1
  buffer_store_dword v4, v3, s[28:31], s48 offen sc1
attn_kernel_pub7:
  v_and_b32 v3, 31, v1
  v_lshlrev_b32 v3, 7, v3
  s_add_u32 m0, s52, 98304
  s_nop 0
  buffer_load_dwordx4 v40, s[12:15], s50 offen offset:0 lds
  buffer_load_dwordx4 v41, s[12:15], s50 offen offset:1024 lds
  buffer_load_dwordx4 v42, s[12:15], s50 offen offset:2048 lds
  buffer_load_dwordx4 v43, s[12:15], s50 offen offset:3072 lds
  s_add_u32 s50, s50, 524288
  s_add_u32 m0, s52, 114688
  s_nop 0
  buffer_load_dwordx4 v40, s[12:15], s50 offen offset:0 lds
  buffer_load_dwordx4 v41, s[12:15], s50 offen offset:1024 lds
  buffer_load_dwordx4 v42, s[12:15], s50 offen offset:2048 lds
  buffer_load_dwordx4 v43, s[12:15], s50 offen offset:3072 lds
  s_add_u32 s50, s50, 524288
  s_add_u32 m0, s52, 131072
  s_nop 0
  buffer_load_dwordx4 v40, s[12:15], s50 offen offset:0 lds
  buffer_load_dwordx4 v41, s[12:15], s50 offen offset:1024 lds
  buffer_load_dwordx4 v42, s[12:15], s50 offen offset:2048 lds
  buffer_load_dwordx4 v43, s[12:15], s50 offen offset:3072 lds
  s_add_u32 s50, s50, 524288
  s_add_u32 m0, s52, 147456
  s_nop 0
  buffer_load_dwordx4 v40, s[12:15], s50 offen offset:0 lds
  buffer_load_dwordx4 v41, s[12:15], s50 offen offset:1024 lds
  buffer_load_dwordx4 v42, s[12:15], s50 offen offset:2048 lds
  buffer_load_dwordx4 v43, s[12:15], s50 offen offset:3072 lds
  s_add_u32 s50, s50, 524288
  s_add_u32 m0, s52, 65536
  s_nop 0
  buffer_load_dwordx4 v40, s[12:15], s50 offen offset:0 lds
  buffer_load_dwordx4 v41, s[12:15], s50 offen offset:1024 lds
  buffer_load_dwordx4 v42, s[12:15], s50 offen offset:2048 lds
  buffer_load_dwordx4 v43, s[12:15], s50 offen offset:3072 lds
  s_add_u32 s50, s50, 524288
  s_cmp_lg_u32 s44, 0
  s_cbranch_scc1 attn_kernel_awd9
  s_mov_b32 s53, 0x80000
attn_kernel_aw8:
  buffer_load_dword v4, v3, s[28:31], s49 offen sc1
  s_sub_u32 s53, s53, 1
  s_cselect_b64 s[58:59], 0, -1
  s_waitcnt vmcnt(0)
  v_cmp_eq_u32 vcc, 0, v4
  s_and_b64 vcc, vcc, s[58:59]
  s_cbranch_vccz attn_kernel_awd9
  s_branch attn_kernel_aw8
attn_kernel_awd9:
  s_barrier
  buffer_load_dwordx4 a[64:67], v44, s[16:19], s51 offen offset:0 sc1
  buffer_load_dwordx4 a[68:71], v44, s[16:19], s51 offen offset:1024 sc1
  buffer_load_dwordx4 a[72:75], v44, s[16:19], s51 offen offset:2048 sc1
  buffer_load_dwordx4 a[76:79], v44, s[16:19], s51 offen offset:3072 sc1
  buffer_load_dwordx4 a[80:83], v45, s[16:19], s51 offen offset:0 sc1
  buffer_load_dwordx4 a[84:87], v45, s[16:19], s51 offen offset:1024 sc1
  buffer_load_dwordx4 a[88:91], v45, s[16:19], s51 offen offset:2048 sc1
  buffer_load_dwordx4 a[92:95], v45, s[16:19], s51 offen offset:3072 sc1
  s_add_u32 s51, s51, 262144
  buffer_load_dwordx4 a[96:99], v44, s[16:19], s51 offen offset:0 sc1
  buffer_load_dwordx4 a[100:103], v44, s[16:19], s51 offen offset:1024 sc1
  buffer_load_dwordx4 a[104:107], v44, s[16:19], s51 offen offset:2048 sc1
  buffer_load_dwordx4 a[108:111], v44, s[16:19], s51 offen offset:3072 sc1
  buffer_load_dwordx4 a[112:115], v45, s[16:19], s51 offen offset:0 sc1
  buffer_load_dwordx4 a[116:119], v45, s[16:19], s51 offen offset:1024 sc1
  buffer_load_dwordx4 a[120:123], v45, s[16:19], s51 offen offset:2048 sc1
  buffer_load_dwordx4 a[124:127], v45, s[16:19], s51 offen offset:3072 sc1
  s_add_u32 s51, s51, 262144
  buffer_load_dwordx4 a[128:131], v44, s[16:19], s51 offen offset:0 sc1
  buffer_load_dwordx4 a[132:135], v44, s[16:19], s51 offen offset:1024 sc1
  buffer_load_dwordx4 a[136:139], v44, s[16:19], s51 offen offset:2048 sc1
  buffer_load_dwordx4 a[140:143], v44, s[16:19], s51 offen offset:3072 sc1
  buffer_load_dwordx4 a[144:147], v45, s[16:19], s51 offen offset:0 sc1
  buffer_load_dwordx4 a[148:151], v45, s[16:19], s51 offen offset:1024 sc1
  buffer_load_dwordx4 a[152:155], v45, s[16:19], s51 offen offset:2048 sc1
  buffer_load_dwordx4 a[156:159], v45, s[16:19], s51 offen offset:3072 sc1
  s_add_u32 s51, s51, 262144
  v_lshrrev_b32 v26, 2, v1
  v_and_b32 v27, 3, v1
  v_and_b32 v28, 7, v26
  v_lshlrev_b32 v26, 8, v26
  v_lshl_add_u32 v26, v27, 3, v26
  v_add_u32 v26, 65536, v26
  v_xor_b32 v27, 0, v28
  v_lshl_add_u32 v12, v27, 5, v26
  v_xor_b32 v27, 1, v28
  v_lshl_add_u32 v13, v27, 5, v26
  v_xor_b32 v27, 2, v28
  v_lshl_add_u32 v14, v27, 5, v26
  v_xor_b32 v27, 3, v28
  v_lshl_add_u32 v15, v27, 5, v26
  v_xor_b32 v27, 4, v28
  v_lshl_add_u32 v16, v27, 5, v26
  v_xor_b32 v27, 5, v28
  v_lshl_add_u32 v17, v27, 5, v26
  v_xor_b32 v27, 6, v28
  v_lshl_add_u32 v18, v27, 5, v26
  v_xor_b32 v27, 7, v28
  v_lshl_add_u32 v19, v27, 5, v26
  v_add_u32 v32, 0x10000, v12
  v_add_u32 v33, 0x10000, v13
  v_add_u32 v34, 0x10000, v14
  v_add_u32 v35, 0x10000, v15
  v_add_u32 v36, 0x10000, v16
  v_add_u32 v37, 0x10000, v17
  v_add_u32 v38, 0x10000, v18
  v_add_u32 v39, 0x10000, v19
  v_and_b32 v26, 15, v1
  v_lshrrev_b32 v27, 4, v1
  v_xor_b32 v28, v26, v27
  v_lshlrev_b32 v29, 8, v26
  v_xor_b32 v30, 0, v28
  v_lshl_add_u32 v8, v30, 4, v29
  v_xor_b32 v30, 4, v28
  v_lshl_add_u32 v9, v30, 4, v29
  v_xor_b32 v30, 8, v28
  v_lshl_add_u32 v10, v30, 4, v29
  v_xor_b32 v30, 12, v28
  v_lshl_add_u32 v11, v30, 4, v29
  v_lshlrev_b32 v29, 8, v27
  v_add_u32 v29, s52, v29
  v_xor_b32 v30, 0, v28
  v_lshl_add_u32 v20, v30, 4, v29
  v_xor_b32 v30, 4, v28
  v_lshl_add_u32 v21, v30, 4, v29
  v_xor_b32 v30, 8, v28
  v_lshl_add_u32 v22, v30, 4, v29
  v_xor_b32 v30, 12, v28
  v_lshl_add_u32 v23, v30, 4, v29
  v_lshlrev_b32 v30, 1, v27
  v_xor_b32 v30, v30, v26
  v_lshl_add_u32 v24, v30, 4, v29
  v_xor_b32 v30, 8, v30
  v_lshl_add_u32 v25, v30, 4, v29
  s_lshl_b32 s48, s40, 19
  s_add_u32 s20, s4, s48
  s_addc_u32 s21, s5, 0
  s_and_b32 s21, s21, 0xffff
  s_mov_b32 s22, 524288
  s_mov_b32 s23, 0x20000
  s_add_u32 s24, s6, s48
  s_addc_u32 s25, s7, 0
  s_and_b32 s25, s25, 0xffff
  s_mov_b32 s26, 524288
  s_mov_b32 s27, 0x20000
  s_add_u32 s28, s10, 8388608
  s_addc_u32 s29, s11, 0
  s_and_b32 s29, s29, 0xffff
  s_mov_b32 s30, 16777216
  s_mov_b32 s31, 0x20000
  s_mov_b32 s53, 0
  s_mov_b32 s54, 0
  s_and_b32 s33, s33, 0xffff
  s_mov_b32 s34, 8388608
  s_mov_b32 s35, 0x20000
  s_and_b32 s37, s37, 0xffff
  s_mov_b32 s38, 7340032
  s_mov_b32 s39, 0x20000
  s_and_b32 s61, s61, 0xffff
  s_mov_b32 s62, 7340032
  s_mov_b32 s63, 0x20000
  s_add_u32 s72, s10, 67108864
  s_addc_u32 s73, s11, 0
  s_and_b32 s73, s73, 0xffff
  s_mov_b32 s74, 37748736
  s_mov_b32 s75, 0x20000
  s_mov_b32 s59, 0
  s_mov_b32 s56, 0x08000000
  s_mov_b32 s49, 0x70000000
  s_lshl_b32 s48, s2, 12
  v_lshl_add_u32 v7, v0, 4, s48
  s_lshl_b32 s42, s2, 2
  s_add_u32 s42, s42, s44
  s_lshr_b32 s43, s42, 1
  s_and_b32 s45, s42, 1
  s_and_b32 s48, s43, 7
  s_lshl_b32 s48, s48, 1
  v_xor_b32 v30, s48, v26
  v_lshlrev_b32 v30, 4, v30
  v_lshl_add_u32 v54, v27, 20, v30
  s_lshl_b32 s48, s45, 22
  s_lshl_b32 s62, s43, 8
  s_add_u32 s48, s48, s62
  v_add_u32 v54, s48, v54
  v_mul_u32_u24 v31, 917504, v27
  v_add_u32 v55, v30, v31
  s_mul_i32 s48, s45, 3670016
  s_add_u32 s48, s48, s62
  s_add_u32 s48, s48, 16777216
  v_add_u32 v55, s48, v55
  s_mov_b32 s41, 25165824
  v_mov_b32 v68, -1
  v_mov_b32 v69, -1
  v_mov_b32 v70, -1
  v_mov_b32 v71, -1
  v_mul_u32_u24 v30, 74, v1
  v_lshrrev_b32 v30, 10, v30
  v_mul_u32_u24 v31, 14, v30
  v_sub_u32 v31, v1, v31
  v_mul_u32_u24 v30, 7168, v30
  v_lshl_add_u32 v56, v31, 4, v30
  s_and_b32 s48, s42, 31
  s_lshr_b32 s62, s42, 5
  s_mul_i32 s46, s48, 224
  s_mul_i32 s45, s62, 28672
  s_add_u32 s46, s46, s45
  s_mul_i32 s48, s48, 229376
  s_mul_i32 s62, s62, 896
  s_add_u32 s48, s48, s62
  s_add_u32 s48, s48, 8388608
  v_lshl_add_u32 v57, v1, 4, s48
  v_cmp_lt_u32 vcc, 55, v1
  v_mov_b32 v30, 0x70000000
  s_nop 0
  v_cndmask_b32 v56, v56, v30, vcc
  v_cndmask_b32 v57, v57, v30, vcc
  s_mov_b32 s62, 3584 * 2048
  s_and_b32 s65, s65, 0xffff
  s_mov_b32 s66, 12582912
  s_mov_b32 s67, 0x20000
  s_add_u32 s68, s10, 0
  s_addc_u32 s69, s11, 0
  s_and_b32 s69, s69, 0xffff
  s_mov_b32 s70, 1048576
  s_mov_b32 s71, 0x20000
  v_lshrrev_b32 v5, 3, v1
  v_mul_u32_u24 v4, 12288, v5
  v_and_b32 v3, 7, v1
  v_lshl_add_u32 v4, v3, 4, v4
  v_lshlrev_b32 v5, 2, v5
  s_and_b32 s48, s42, 15
  s_mul_i32 s76, s48, 786432
  s_lshr_b32 s43, s2, 2
  s_lshl_b32 s45, s43, 7
  s_add_u32 s76, s76, s45
  s_add_u32 s76, s76, 4096
  s_lshl_b32 s77, s48, 8
  s_add_u32 s77, s77, 49152
  s_lshl_b32 s48, s48, 14
  s_lshl_b32 s43, s43, 8
  s_add_u32 s43, s43, s48
  s_add_u32 s43, s43, 262144
  v_mov_b32 v48, 0
  v_mov_b32 v49, 0
  v_mov_b32 v50, 0
  v_mov_b32 v51, 0
  v_mov_b32 v52, 0
  v_mov_b32 v53, 0
  v_mov_b32 v63, 0
  v_mov_b32 v2, 0
  s_getpc_b64 s[4:5]
attn_kernel_pc10:
  s_add_u32 s4, s4, attn_kernel_tail3-attn_kernel_pc10
  s_addc_u32 s5, s5, 0
  s_and_b32 s5, s5, 0xffff
  s_mov_b32 s6, code_end-attn_kernel_tail3
  s_mov_b32 s7, 0x20000
  s_lshr_b32 s8, s2, 3
  s_lshl_b32 s8, s8, 12
  v_lshlrev_b32 v6, 4, v0
  s_mov_b32 s57, 0x47800000
  s_waitcnt vmcnt(16)
  s_barrier
  ds_read_b64_tr_b16 a[192:193], v12 offset:32768
  ds_read_b64_tr_b16 a[194:195], v12 offset:36864
  ds_read_b64_tr_b16 a[196:197], v12 offset:40960
  ds_read_b64_tr_b16 a[198:199], v12 offset:45056
  ds_read_b64_tr_b16 a[200:201], v13 offset:32768
  ds_read_b64_tr_b16 a[202:203], v13 offset:36864
  ds_read_b64_tr_b16 a[204:205], v13 offset:40960
  ds_read_b64_tr_b16 a[206:207], v13 offset:45056
  s_waitcnt lgkmcnt(4)
  v_mfma_f32_16x16x32_bf16 v[128:131], a[192:195], a[64:67], 0
  ds_read_b64_tr_b16 a[208:209], v14 offset:32768
  ds_read_b64_tr_b16 a[210:211], v14 offset:36864
  v_mfma_f32_16x16x32_bf16 v[128:131], a[196:199], a[80:83], v[128:131]
  buffer_load_dwordx4 a[160:163], v44, s[16:19], s51 offen offset:0 sc1
  v_mfma_f32_16x16x32_bf16 v[132:135], a[192:195], a[68:71], 0
  buffer_load_dwordx4 a[164:167], v44, s[16:19], s51 offen offset:1024 sc1
  v_mfma_f32_16x16x32_bf16 v[132:135], a[196:199], a[84:87], v[132:135]
  v_mfma_f32_16x16x32_bf16 v[136:139], a[192:195], a[72:75], 0
  ds_read_b64_tr_b16 a[212:213], v14 offset:40960
  ds_read_b64_tr_b16 a[214:215], v14 offset:45056
  v_mfma_f32_16x16x32_bf16 v[136:139], a[196:199], a[88:91], v[136:139]
  buffer_load_dwordx4 a[168:171], v44, s[16:19], s51 offen offset:2048 sc1
  v_mfma_f32_16x16x32_bf16 v[140:143], a[192:195], a[76:79], 0
  v_mfma_f32_16x16x32_bf16 v[140:143], a[196:199], a[92:95], v[140:143]
  s_waitcnt lgkmcnt(4)
  v_mfma_f32_16x16x32_bf16 v[144:147], a[200:203], a[64:67], 0
  ds_read_b64_tr_b16 a[216:217], v15 offset:32768
  ds_read_b64_tr_b16 a[218:219], v15 offset:36864
  v_mfma_f32_16x16x32_bf16 v[144:147], a[204:207], a[80:83], v[144:147]
  buffer_load_dwordx4 a[172:175], v44, s[16:19], s51 offen offset:3072 sc1
  v_mfma_f32_16x16x32_bf16 v[148:151], a[200:203], a[68:71], 0
  v_mfma_f32_16x16x32_bf16 v[148:151], a[204:207], a[84:87], v[148:151]
  buffer_load_dwordx4 a[176:179], v45, s[16:19], s51 offen offset:0 sc1
  v_mfma_f32_16x16x32_bf16 v[152:155], a[200:203], a[72:75], 0
  ds_read_b64_tr_b16 a[220:221], v15 offset:40960
  ds_read_b64_tr_b16 a[222:223], v15 offset:45056
  v_mfma_f32_16x16x32_bf16 v[152:155], a[204:207], a[88:91], v[152:155]
  v_mfma_f32_16x16x32_bf16 v[156:159], a[200:203], a[76:79], 0
  buffer_load_dwordx4 a[180:183], v45, s[16:19], s51 offen offset:1024 sc1
  v_mfma_f32_16x16x32_bf16 v[156:159], a[204:207], a[92:95], v[156:159]
  s_waitcnt lgkmcnt(4)
  v_mfma_f32_16x16x32_bf16 v[160:163], a[208:211], a[64:67], 0
  ds_read_b64_tr_b16 a[192:193], v16 offset:32768
  ds_read_b64_tr_b16 a[194:195], v16 offset:36864
  v_mfma_f32_16x16x32_bf16 v[160:163], a[212:215], a[80:83], v[160:163]
  v_mfma_f32_16x16x32_bf16 v[164:167], a[208:211], a[68:71], 0
  buffer_load_dwordx4 a[184:187], v45, s[16:19], s51 offen offset:2048 sc1
  v_mfma_f32_16x16x32_bf16 v[164:167], a[212:215], a[84:87], v[164:167]
  v_mfma_f32_16x16x32_bf16 v[168:171], a[208:211], a[72:75], 0
  ds_read_b64_tr_b16 a[196:197], v16 offset:40960
  ds_read_b64_tr_b16 a[198:199], v16 offset:45056
  v_mfma_f32_16x16x32_bf16 v[168:171], a[212:215], a[88:91], v[168:171]
  buffer_load_dwordx4 a[188:191], v45, s[16:19], s51 offen offset:3072 sc1
  v_mfma_f32_16x16x32_bf16 v[172:175], a[208:211], a[76:79], 0
  s_add_u32 s51, s51, 262144
  v_mfma_f32_16x16x32_bf16 v[172:175], a[212:215], a[92:95], v[172:175]
  s_waitcnt lgkmcnt(4)
  v_mfma_f32_16x16x32_bf16 v[176:179], a[216:219], a[64:67], 0
  ds_read_b64_tr_b16 a[200:201], v17 offset:32768
  ds_read_b64_tr_b16 a[202:203], v17 offset:36864
  v_mfma_f32_16x16x32_bf16 v[176:179], a[220:223], a[80:83], v[176:179]
  buffer_load_dwordx4 a[0:3], v44, s[16:19], s51 offen offset:0 sc1
  v_mfma_f32_16x16x32_bf16 v[180:183], a[216:219], a[68:71], 0
  buffer_load_dwordx4 a[4:7], v44, s[16:19], s51 offen offset:1024 sc1
  v_mfma_f32_16x16x32_bf16 v[180:183], a[220:223], a[84:87], v[180:183]
  v_mfma_f32_16x16x32_bf16 v[184:187], a[216:219], a[72:75], 0
  ds_read_b64_tr_b16 a[204:205], v17 offset:40960
  ds_read_b64_tr_b16 a[206:207], v17 offset:45056
  v_mfma_f32_16x16x32_bf16 v[184:187], a[220:223], a[88:91], v[184:187]
  buffer_load_dwordx4 a[8:11], v44, s[16:19], s51 offen offset:2048 sc1
  v_mfma_f32_16x16x32_bf16 v[188:191], a[216:219], a[76:79], 0
  v_mfma_f32_16x16x32_bf16 v[188:191], a[220:223], a[92:95], v[188:191]
  s_waitcnt lgkmcnt(4)
  v_mfma_f32_16x16x32_bf16 v[192:195], a[192:195], a[64:67], 0
  ds_read_b64_tr_b16 a[208:209], v18 offset:32768
  ds_read_b64_tr_b16 a[210:211], v18 offset:36864
  v_mfma_f32_16x16x32_bf16 v[192:195], a[196:199], a[80:83], v[192:195]
  buffer_load_dwordx4 a[12:15], v44, s[16:19], s51 offen offset:3072 sc1
  v_mfma_f32_16x16x32_bf16 v[196:199], a[192:195], a[68:71], 0
  v_mfma_f32_16x16x32_bf16 v[196:199], a[196:199], a[84:87], v[196:199]
  buffer_load_dwordx4 a[16:19], v45, s[16:19], s51 offen offset:0 sc1
  v_mfma_f32_16x16x32_bf16 v[200:203], a[192:195], a[72:75], 0
  ds_read_b64_tr_b16 a[212:213], v18 offset:40960
  ds_read_b64_tr_b16 a[214:215], v18 offset:45056
  v_mfma_f32_16x16x32_bf16 v[200:203], a[196:199], a[88:91], v[200:203]
  v_mfma_f32_16x16x32_bf16 v[204:207], a[192:195], a[76:79], 0
  buffer_load_dwordx4 a[20:23], v45, s[16:19], s51 offen offset:1024 sc1
  v_mfma_f32_16x16x32_bf16 v[204:207], a[196:199], a[92:95], v[204:207]
  s_waitcnt lgkmcnt(4)
  v_mfma_f32_16x16x32_bf16 v[208:211], a[200:203], a[64:67], 0
  ds_read_b64_tr_b16 a[216:217], v19 offset:32768
  ds_read_b64_tr_b16 a[218:219], v19 offset:36864
  v_mfma_f32_16x16x32_bf16 v[208:211], a[204:207], a[80:83], v[208:211]
  v_mfma_f32_16x16x32_bf16 v[212:215], a[200:203], a[68:71], 0
  buffer_load_dwordx4 a[24:27], v45, s[16:19], s51 offen offset:2048 sc1
  v_mfma_f32_16x16x32_bf16 v[212:215], a[204:207], a[84:87], v[212:215]
  v_mfma_f32_16x16x32_bf16 v[216:219], a[200:203], a[72:75], 0
  ds_read_b64_tr_b16 a[220:221], v19 offset:40960
  ds_read_b64_tr_b16 a[222:223], v19 offset:45056
  v_mfma_f32_16x16x32_bf16 v[216:219], a[204:207], a[88:91], v[216:219]
  buffer_load_dwordx4 a[28:31], v45, s[16:19], s51 offen offset:3072 sc1
  v_mfma_f32_16x16x32_bf16 v[220:223], a[200:203], a[76:79], 0
  s_add_u32 s51, s51, 262144
  v_mfma_f32_16x16x32_bf16 v[220:223], a[204:207], a[92:95], v[220:223]
  s_waitcnt vmcnt(24) lgkmcnt(4)
  s_barrier
  v_mfma_f32_16x16x32_bf16 v[224:227], a[208:211], a[64:67], 0
  ds_read_b64_tr_b16 a[192:193], v12 offset:49152
  ds_read_b64_tr_b16 a[194:195], v12 offset:53248
  v_mfma_f32_16x16x32_bf16 v[224:227], a[212:215], a[80:83], v[224:227]
  buffer_load_dwordx4 a[32:35], v44, s[16:19], s51 offen offset:0 sc1
  v_mfma_f32_16x16x32_bf16 v[228:231], a[208:211], a[68:71], 0
  s_add_u32 m0, s52, 81920
  v_mfma_f32_16x16x32_bf16 v[228:231], a[212:215], a[84:87], v[228:231]
  v_mfma_f32_16x16x32_bf16 v[232:235], a[208:211], a[72:75], 0
  ds_read_b64_tr_b16 a[196:197], v12 offset:57344
  ds_read_b64_tr_b16 a[198:199], v12 offset:61440
  v_mfma_f32_16x16x32_bf16 v[232:235], a[212:215], a[88:91], v[232:235]
  buffer_load_dwordx4 a[36:39], v44, s[16:19], s51 offen offset:1024 sc1
  v_mfma_f32_16x16x32_bf16 v[236:239], a[208:211], a[76:79], 0
  v_mfma_f32_16x16x32_bf16 v[236:239], a[212:215], a[92:95], v[236:239]
  s_waitcnt lgkmcnt(4)
  v_mfma_f32_16x16x32_bf16 v[240:243], a[216:219], a[64:67], 0
  ds_read_b64_tr_b16 a[200:201], v13 offset:49152
  ds_read_b64_tr_b16 a[202:203], v13 offset:53248
  v_mfma_f32_16x16x32_bf16 v[240:243], a[220:223], a[80:83], v[240:243]
  v_mfma_f32_16x16x32_bf16 v[244:247], a[216:219], a[68:71], 0
  buffer_load_dwordx4 v40, s[12:15], s50 offen offset:0 lds
  v_mfma_f32_16x16x32_bf16 v[244:247], a[220:223], a[84:87], v[244:247]
  v_mfma_f32_16x16x32_bf16 v[248:251], a[216:219], a[72:75], 0
  ds_read_b64_tr_b16 a[204:205], v13 offset:57344
  ds_read_b64_tr_b16 a[206:207], v13 offset:61440
  v_mfma_f32_16x16x32_bf16 v[248:251], a[220:223], a[88:91], v[248:251]
  v_mfma_f32_16x16x32_bf16 v[252:255], a[216:219], a[76:79], 0
  v_mfma_f32_16x16x32_bf16 v[252:255], a[220:223], a[92:95], v[252:255]
  s_waitcnt lgkmcnt(4)
  v_mfma_f32_16x16x32_bf16 v[128:131], a[192:195], a[96:99], v[128:131]
  ds_read_b64_tr_b16 a[208:209], v14 offset:49152
  ds_read_b64_tr_b16 a[210:211], v14 offset:53248
  v_mfma_f32_16x16x32_bf16 v[128:131], a[196:199], a[112:115], v[128:131]
  buffer_load_dwordx4 v41, s[12:15], s50 offen offset:1024 lds
  v_mfma_f32_16x16x32_bf16 v[132:135], a[192:195], a[100:103], v[132:135]
  v_mfma_f32_16x16x32_bf16 v[132:135], a[196:199], a[116:119], v[132:135]
  v_mfma_f32_16x16x32_bf16 v[136:139], a[192:195], a[104:107], v[136:139]
  ds_read_b64_tr_b16 a[212:213], v14 offset:57344
  ds_read_b64_tr_b16 a[214:215], v14 offset:61440
  v_mfma_f32_16x16x32_bf16 v[136:139], a[196:199], a[120:123], v[136:139]
  buffer_load_dwordx4 v42, s[12:15], s50 offen offset:2048 lds
  v_mfma_f32_16x16x32_bf16 v[140:143], a[192:195], a[108:111], v[140:143]
  v_mfma_f32_16x16x32_bf16 v[140:143], a[196:199], a[124:127], v[140:143]
  s_waitcnt lgkmcnt(4)
  v_mfma_f32_16x16x32_bf16 v[144:147], a[200:203], a[96:99], v[144:147]
  ds_read_b64_tr_b16 a[216:217], v15 offset:49152
  ds_read_b64_tr_b16 a[218:219], v15 offset:53248
  v_mfma_f32_16x16x32_bf16 v[144:147], a[204:207], a[112:115], v[144:147]
  v_mfma_f32_16x16x32_bf16 v[148:151], a[200:203], a[100:103], v[148:151]
  buffer_load_dwordx4 v43, s[12:15], s50 offen offset:3072 lds
  v_mfma_f32_16x16x32_bf16 v[148:151], a[204:207], a[116:119], v[148:151]
  s_add_u32 s50, s50, 524288
  v_mfma_f32_16x16x32_bf16 v[152:155], a[200:203], a[104:107], v[152:155]
  ds_read_b64_tr_b16 a[220:221], v15 offset:57344
  ds_read_b64_tr_b16 a[222:223], v15 offset:61440
  v_mfma_f32_16x16x32_bf16 v[152:155], a[204:207], a[120:123], v[152:155]
  v_mfma_f32_16x16x32_bf16 v[156:159], a[200:203], a[108:111], v[156:159]
  v_mfma_f32_16x16x32_bf16 v[156:159], a[204:207], a[124:127], v[156:159]
  s_waitcnt lgkmcnt(4)
  v_mfma_f32_16x16x32_bf16 v[160:163], a[208:211], a[96:99], v[160:163]
  ds_read_b64_tr_b16 a[192:193], v16 offset:49152
  ds_read_b64_tr_b16 a[194:195], v16 offset:53248
  v_mfma_f32_16x16x32_bf16 v[160:163], a[212:215], a[112:115], v[160:163]
  buffer_load_dwordx4 a[40:43], v44, s[16:19], s51 offen offset:2048 sc1
  v_mfma_f32_16x16x32_bf16 v[164:167], a[208:211], a[100:103], v[164:167]
  v_mfma_f32_16x16x32_bf16 v[164:167], a[212:215], a[116:119], v[164:167]
  v_mfma_f32_16x16x32_bf16 v[168:171], a[208:211], a[104:107], v[168:171]
  ds_read_b64_tr_b16 a[196:197], v16 offset:57344
  ds_read_b64_tr_b16 a[198:199], v16 offset:61440
  v_mfma_f32_16x16x32_bf16 v[168:171], a[212:215], a[120:123], v[168:171]
  buffer_load_dwordx4 a[44:47], v44, s[16:19], s51 offen offset:3072 sc1
  v_mfma_f32_16x16x32_bf16 v[172:175], a[208:211], a[108:111], v[172:175]
  v_mfma_f32_16x16x32_bf16 v[172:175], a[212:215], a[124:127], v[172:175]
  s_waitcnt lgkmcnt(4)
  v_mfma_f32_16x16x32_bf16 v[176:179], a[216:219], a[96:99], v[176:179]
  ds_read_b64_tr_b16 a[200:201], v17 offset:49152
  ds_read_b64_tr_b16 a[202:203], v17 offset:53248
  v_mfma_f32_16x16x32_bf16 v[176:179], a[220:223], a[112:115], v[176:179]
  v_mfma_f32_16x16x32_bf16 v[180:183], a[216:219], a[100:103], v[180:183]
  buffer_load_dwordx4 a[48:51], v45, s[16:19], s51 offen offset:0 sc1
  v_mfma_f32_16x16x32_bf16 v[180:183], a[220:223], a[116:119], v[180:183]
  v_mfma_f32_16x16x32_bf16 v[184:187], a[216:219], a[104:107], v[184:187]
  ds_read_b64_tr_b16 a[204:205], v17 offset:57344
  ds_read_b64_tr_b16 a[206:207], v17 offset:61440
  v_mfma_f32_16x16x32_bf16 v[184:187], a[220:223], a[120:123], v[184:187]
  v_mfma_f32_16x16x32_bf16 v[188:191], a[216:219], a[108:111], v[188:191]
  v_mfma_f32_16x16x32_bf16 v[188:191], a[220:223], a[124:127], v[188:191]
  s_waitcnt lgkmcnt(4)
  v_mfma_f32_16x16x32_bf16 v[192:195], a[192:195], a[96:99], v[192:195]
  ds_read_b64_tr_b16 a[208:209], v18 offset:49152
  ds_read_b64_tr_b16 a[210:211], v18 offset:53248
  v_mfma_f32_16x16x32_bf16 v[192:195], a[196:199], a[112:115], v[192:195]
  buffer_load_dwordx4 a[52:55], v45, s[16:19], s51 offen offset:1024 sc1
  v_mfma_f32_16x16x32_bf16 v[196:199], a[192:195], a[100:103], v[196:199]
  v_mfma_f32_16x16x32_bf16 v[196:199], a[196:199], a[116:119], v[196:199]
  v_mfma_f32_16x16x32_bf16 v[200:203], a[192:195], a[104:107], v[200:203]
  ds_read_b64_tr_b16 a[212:213], v18 offset:57344
  ds_read_b64_tr_b16 a[214:215], v18 offset:61440
  v_mfma_f32_16x16x32_bf16 v[200:203], a[196:199], a[120:123], v[200:203]
  buffer_load_dwordx4 a[56:59], v45, s[16:19], s51 offen offset:2048 sc1
  v_mfma_f32_16x16x32_bf16 v[204:207], a[192:195], a[108:111], v[204:207]
  v_mfma_f32_16x16x32_bf16 v[204:207], a[196:199], a[124:127], v[204:207]
  s_waitcnt lgkmcnt(4)
  v_mfma_f32_16x16x32_bf16 v[208:211], a[200:203], a[96:99], v[208:211]
  ds_read_b64_tr_b16 a[216:217], v19 offset:49152
  ds_read_b64_tr_b16 a[218:219], v19 offset:53248
  v_mfma_f32_16x16x32_bf16 v[208:211], a[204:207], a[112:115], v[208:211]
  v_mfma_f32_16x16x32_bf16 v[212:215], a[200:203], a[100:103], v[212:215]
  buffer_load_dwordx4 a[60:63], v45, s[16:19], s51 offen offset:3072 sc1
  v_mfma_f32_16x16x32_bf16 v[212:215], a[204:207], a[116:119], v[212:215]
  s_add_u32 s51, s51, 262144
  v_mfma_f32_16x16x32_bf16 v[216:219], a[200:203], a[104:107], v[216:219]
  ds_read_b64_tr_b16 a[220:221], v19 offset:57344
  ds_read_b64_tr_b16 a[222:223], v19 offset:61440
  v_mfma_f32_16x16x32_bf16 v[216:219], a[204:207], a[120:123], v[216:219]
  v_mfma_f32_16x16x32_bf16 v[220:223], a[200:203], a[108:111], v[220:223]
  v_mfma_f32_16x16x32_bf16 v[220:223], a[204:207], a[124:127], v[220:223]
  s_waitcnt vmcnt(28) lgkmcnt(4)
  s_barrier
  v_mfma_f32_16x16x32_bf16 v[224:227], a[208:211], a[96:99], v[224:227]
  ds_read_b64_tr_b16 a[192:193], v32 offset:0
  ds_read_b64_tr_b16 a[194:195], v32 offset:4096
  v_mfma_f32_16x16x32_bf16 v[224:227], a[212:215], a[112:115], v[224:227]
  buffer_load_dwordx4 a[64:67], v44, s[16:19], s51 offen offset:0 sc1
  v_mfma_f32_16x16x32_bf16 v[228:231], a[208:211], a[100:103], v[228:231]
  s_add_u32 m0, s52, 98304
  v_mfma_f32_16x16x32_bf16 v[228:231], a[212:215], a[116:119], v[228:231]
  v_mfma_f32_16x16x32_bf16 v[232:235], a[208:211], a[104:107], v[232:235]
  ds_read_b64_tr_b16 a[196:197], v32 offset:8192
  ds_read_b64_tr_b16 a[198:199], v32 offset:12288
  v_mfma_f32_16x16x32_bf16 v[232:235], a[212:215], a[120:123], v[232:235]
  buffer_load_dwordx4 a[68:71], v44, s[16:19], s51 offen offset:1024 sc1
  v_mfma_f32_16x16x32_bf16 v[236:239], a[208:211], a[108:111], v[236:239]
  v_mfma_f32_16x16x32_bf16 v[236:239], a[212:215], a[124:127], v[236:239]
  s_waitcnt lgkmcnt(4)
  v_mfma_f32_16x16x32_bf16 v[240:243], a[216:219], a[96:99], v[240:243]
  ds_read_b64_tr_b16 a[200:201], v33 offset:0
  ds_read_b64_tr_b16 a[202:203], v33 offset:4096
  v_mfma_f32_16x16x32_bf16 v[240:243], a[220:223], a[112:115], v[240:243]
  v_mfma_f32_16x16x32_bf16 v[244:247], a[216:219], a[100:103], v[244:247]
  buffer_load_dwordx4 v40, s[12:15], s50 offen offset:0 lds
  v_mfma_f32_16x16x32_bf16 v[244:247], a[220:223], a[116:119], v[244:247]
  v_mfma_f32_16x16x32_bf16 v[248:251], a[216:219], a[104:107], v[248:251]
  ds_read_b64_tr_b16 a[204:205], v33 offset:8192
  ds_read_b64_tr_b16 a[206:207], v33 offset:12288
  v_mfma_f32_16x16x32_bf16 v[248:251], a[220:223], a[120:123], v[248:251]
  v_mfma_f32_16x16x32_bf16 v[252:255], a[216:219], a[108:111], v[252:255]
  v_mfma_f32_16x16x32_bf16 v[252:255], a[220:223], a[124:127], v[252:255]
  s_waitcnt lgkmcnt(4)
  v_mfma_f32_16x16x32_bf16 v[128:131], a[192:195], a[128:131], v[128:131]
  ds_read_b64_tr_b16 a[208:209], v34 offset:0
  ds_read_b64_tr_b16 a[210:211], v34 offset:4096
  v_mfma_f32_16x16x32_bf16 v[128:131], a[196:199], a[144:147], v[128:131]
  buffer_load_dwordx4 v41, s[12:15], s50 offen offset:1024 lds
  v_mfma_f32_16x16x32_bf16 v[132:135], a[192:195], a[132:135], v[132:135]
  v_mfma_f32_16x16x32_bf16 v[132:135], a[196:199], a[148:151], v[132:135]
  v_mfma_f32_16x16x32_bf16 v[136:139], a[192:195], a[136:139], v[136:139]
  ds_read_b64_tr_b16 a[212:213], v34 offset:8192
  ds_read_b64_tr_b16 a[214:215], v34 offset:12288
  v_mfma_f32_16x16x32_bf16 v[136:139], a[196:199], a[152:155], v[136:139]
  buffer_load_dwordx4 v42, s[12:15], s50 offen offset:2048 lds
  v_mfma_f32_16x16x32_bf16 v[140:143], a[192:195], a[140:143], v[140:143]
  v_mfma_f32_16x16x32_bf16 v[140:143], a[196:199], a[156:159], v[140:143]
  s_waitcnt lgkmcnt(4)
  v_mfma_f32_16x16x32_bf16 v[144:147], a[200:203], a[128:131], v[144:147]
  ds_read_b64_tr_b16 a[216:217], v35 offset:0
  ds_read_b64_tr_b16 a[218:219], v35 offset:4096
  v_mfma_f32_16x16x32_bf16 v[144:147], a[204:207], a[144:147], v[144:147]
  v_mfma_f32_16x16x32_bf16 v[148:151], a[200:203], a[132:135], v[148:151]
  buffer_load_dwordx4 v43, s[12:15], s50 offen offset:3072 lds
  v_mfma_f32_16x16x32_bf16 v[148:151], a[204:207], a[148:151], v[148:151]
  s_add_u32 s50, s50, 524288
  v_mfma_f32_16x16x32_bf16 v[152:155], a[200:203], a[136:139], v[152:155]
  ds_read_b64_tr_b16 a[220:221], v35 offset:8192
  ds_read_b64_tr_b16 a[222:223], v35 offset:12288
  v_mfma_f32_16x16x32_bf16 v[152:155], a[204:207], a[152:155], v[152:155]
  v_mfma_f32_16x16x32_bf16 v[156:159], a[200:203], a[140:143], v[156:159]
  v_mfma_f32_16x16x32_bf16 v[156:159], a[204:207], a[156:159], v[156:159]
  s_waitcnt lgkmcnt(4)
  v_mfma_f32_16x16x32_bf16 v[160:163], a[208:211], a[128:131], v[160:163]
  ds_read_b64_tr_b16 a[192:193], v36 offset:0
  ds_read_b64_tr_b16 a[194:195], v36 offset:4096
  v_mfma_f32_16x16x32_bf16 v[160:163], a[212:215], a[144:147], v[160:163]
  buffer_load_dwordx4 a[72:75], v44, s[16:19], s51 offen offset:2048 sc1
  v_mfma_f32_16x16x32_bf16 v[164:167], a[208:211], a[132:135], v[164:167]
  v_mfma_f32_16x16x32_bf16 v[164:167], a[212:215], a[148:151], v[164:167]
  v_mfma_f32_16x16x32_bf16 v[168:171], a[208:211], a[136:139], v[168:171]
  ds_read_b64_tr_b16 a[196:197], v36 offset:8192
  ds_read_b64_tr_b16 a[198:199], v36 offset:12288
  v_mfma_f32_16x16x32_bf16 v[168:171], a[212:215], a[152:155], v[168:171]
  buffer_load_dwordx4 a[76:79], v44, s[16:19], s51 offen offset:3072 sc1
  v_mfma_f32_16x16x32_bf16 v[172:175], a[208:211], a[140:143], v[172:175]
  v_mfma_f32_16x16x32_bf16 v[172:175], a[212:215], a[156:159], v[172:175]
  s_waitcnt lgkmcnt(4)
  v_mfma_f32_16x16x32_bf16 v[176:179], a[216:219], a[128:131], v[176:179]
  ds_read_b64_tr_b16 a[200:201], v37 offset:0
  ds_read_b64_tr_b16 a[202:203], v37 offset:4096
  v_mfma_f32_16x16x32_bf16 v[176:179], a[220:223], a[144:147], v[176:179]
  v_mfma_f32_16x16x32_bf16 v[180:183], a[216:219], a[132:135], v[180:183]
  buffer_load_dwordx4 a[80:83], v45, s[16:19], s51 offen offset:0 sc1
  v_mfma_f32_16x16x32_bf16 v[180:183], a[220:223], a[148:151], v[180:183]
  v_mfma_f32_16x16x32_bf16 v[184:187], a[216:219], a[136:139], v[184:187]
  ds_read_b64_tr_b16 a[204:205], v37 offset:8192
  ds_read_b64_tr_b16 a[206:207], v37 offset:12288
  v_mfma_f32_16x16x32_bf16 v[184:187], a[220:223], a[152:155], v[184:187]
  v_mfma_f32_16x16x32_bf16 v[188:191], a[216:219], a[140:143], v[188:191]
  v_mfma_f32_16x16x32_bf16 v[188:191], a[220:223], a[156:159], v[188:191]
  s_waitcnt lgkmcnt(4)
  v_mfma_f32_16x16x32_bf16 v[192:195], a[192:195], a[128:131], v[192:195]
  ds_read_b64_tr_b16 a[208:209], v38 offset:0
  ds_read_b64_tr_b16 a[210:211], v38 offset:4096
  v_mfma_f32_16x16x32_bf16 v[192:195], a[196:199], a[144:147], v[192:195]
  buffer_load_dwordx4 a[84:87], v45, s[16:19], s51 offen offset:1024 sc1
  v_mfma_f32_16x16x32_bf16 v[196:199], a[192:195], a[132:135], v[196:199]
  v_mfma_f32_16x16x32_bf16 v[196:199], a[196:199], a[148:151], v[196:199]
  v_mfma_f32_16x16x32_bf16 v[200:203], a[192:195], a[136:139], v[200:203]
  ds_read_b64_tr_b16 a[212:213], v38 offset:8192
  ds_read_b64_tr_b16 a[214:215], v38 offset:12288
  v_mfma_f32_16x16x32_bf16 v[200:203], a[196:199], a[152:155], v[200:203]
  buffer_load_dwordx4 a[88:91], v45, s[16:19], s51 offen offset:2048 sc1
  v_mfma_f32_16x16x32_bf16 v[204:207], a[192:195], a[140:143], v[204:207]
  v_mfma_f32_16x16x32_bf16 v[204:207], a[196:199], a[156:159], v[204:207]
  s_waitcnt lgkmcnt(4)
  v_mfma_f32_16x16x32_bf16 v[208:211], a[200:203], a[128:131], v[208:211]
  ds_read_b64_tr_b16 a[216:217], v39 offset:0
  ds_read_b64_tr_b16 a[218:219], v39 offset:4096
  v_mfma_f32_16x16x32_bf16 v[208:211], a[204:207], a[144:147], v[208:211]
  v_mfma_f32_16x16x32_bf16 v[212:215], a[200:203], a[132:135], v[212:215]
  buffer_load_dwordx4 a[92:95], v45, s[16:19], s51 offen offset:3072 sc1
  v_mfma_f32_16x16x32_bf16 v[212:215], a[204:207], a[148:151], v[212:215]
  s_add_u32 s51, s51, 262144
  v_mfma_f32_16x16x32_bf16 v[216:219], a[200:203], a[136:139], v[216:219]
  ds_read_b64_tr_b16 a[220:221], v39 offset:8192
  ds_read_b64_tr_b16 a[222:223], v39 offset:12288
  v_mfma_f32_16x16x32_bf16 v[216:219], a[204:207], a[152:155], v[216:219]
  v_mfma_f32_16x16x32_bf16 v[220:223], a[200:203], a[140:143], v[220:223]
  v_mfma_f32_16x16x32_bf16 v[220:223], a[204:207], a[156:159], v[220:223]
  s_waitcnt vmcnt(32) lgkmcnt(4)
  s_barrier
  v_mfma_f32_16x16x32_bf16 v[224:227], a[208:211], a[128:131], v[224:227]
  ds_read_b64_tr_b16 a[192:193], v32 offset:16384
  ds_read_b64_tr_b16 a[194:195], v32 offset:20480
  v_mfma_f32_16x16x32_bf16 v[224:227], a[212:215], a[144:147], v[224:227]
  buffer_load_dwordx4 a[96:99], v44, s[16:19], s51 offen offset:0 sc1
  v_mfma_f32_16x16x32_bf16 v[228:231], a[208:211], a[132:135], v[228:231]
  s_add_u32 m0, s52, 114688
  v_mfma_f32_16x16x32_bf16 v[228:231], a[212:215], a[148:151], v[228:231]
  v_mfma_f32_16x16x32_bf16 v[232:235], a[208:211], a[136:139], v[232:235]
  ds_read_b64_tr_b16 a[196:197], v32 offset:24576
  ds_read_b64_tr_b16 a[198:199], v32 offset:28672
  v_mfma_f32_16x16x32_bf16 v[232:235], a[212:215], a[152:155], v[232:235]
  buffer_load_dwordx4 a[100:103], v44, s[16:19], s51 offen offset:1024 sc1
  v_mfma_f32_16x16x32_bf16 v[236:239], a[208:211], a[140:143], v[236:239]
  v_mfma_f32_16x16x32_bf16 v[236:239], a[212:215], a[156:159], v[236:239]
  s_waitcnt lgkmcnt(4)
  v_mfma_f32_16x16x32_bf16 v[240:243], a[216:219], a[128:131], v[240:243]
  ds_read_b64_tr_b16 a[200:201], v33 offset:16384
  ds_read_b64_tr_b16 a[202:203], v33 offset:20480
  v_mfma_f32_16x16x32_bf16 v[240:243], a[220:223], a[144:147], v[240:243]
  v_mfma_f32_16x16x32_bf16 v[244:247], a[216:219], a[132:135], v[244:247]
  buffer_load_dwordx4 v40, s[12:15], s50 offen offset:0 lds
  v_mfma_f32_16x16x32_bf16 v[244:247], a[220:223], a[148:151], v[244:247]
  v_mfma_f32_16x16x32_bf16 v[248:251], a[216:219], a[136:139], v[248:251]
  ds_read_b64_tr_b16 a[204:205], v33 offset:24576
  ds_read_b64_tr_b16 a[206:207], v33 offset:28672
  v_mfma_f32_16x16x32_bf16 v[248:251], a[220:223], a[152:155], v[248:251]
  v_mfma_f32_16x16x32_bf16 v[252:255], a[216:219], a[140:143], v[252:255]
  v_mfma_f32_16x16x32_bf16 v[252:255], a[220:223], a[156:159], v[252:255]
  s_waitcnt lgkmcnt(4)
  v_mfma_f32_16x16x32_bf16 v[128:131], a[192:195], a[160:163], v[128:131]
  ds_read_b64_tr_b16 a[208:209], v34 offset:16384
  ds_read_b64_tr_b16 a[210:211], v34 offset:20480
  v_mfma_f32_16x16x32_bf16 v[128:131], a[196:199], a[176:179], v[128:131]
  buffer_load_dwordx4 v41, s[12:15], s50 offen offset:1024 lds
  v_mfma_f32_16x16x32_bf16 v[132:135], a[192:195], a[164:167], v[132:135]
  v_mfma_f32_16x16x32_bf16 v[132:135], a[196:199], a[180:183], v[132:135]
  v_mfma_f32_16x16x32_bf16 v[136:139], a[192:195], a[168:171], v[136:139]
  ds_read_b64_tr_b16 a[212:213], v34 offset:24576
  ds_read_b64_tr_b16 a[214:215], v34 offset:28672
  v_mfma_f32_16x16x32_bf16 v[136:139], a[196:199], a[184:187], v[136:139]
  buffer_load_dwordx4 v42, s[12:15], s50 offen offset:2048 lds
  v_mfma_f32_16x16x32_bf16 v[140:143], a[192:195], a[172:175], v[140:143]
  v_mfma_f32_16x16x32_bf16 v[140:143], a[196:199], a[188:191], v[140:143]
  s_waitcnt lgkmcnt(4)
  v_mfma_f32_16x16x32_bf16 v[144:147], a[200:203], a[160:163], v[144:147]
  ds_read_b64_tr_b16 a[216:217], v35 offset:16384
  ds_read_b64_tr_b16 a[218:219], v35 offset:20480
  v_mfma_f32_16x16x32_bf16 v[144:147], a[204:207], a[176:179], v[144:147]
  v_mfma_f32_16x16x32_bf16 v[148:151], a[200:203], a[164:167], v[148:151]
  buffer_load_dwordx4 v43, s[12:15], s50 offen offset:3072 lds
  v_mfma_f32_16x16x32_bf16 v[148:151], a[204:207], a[180:183], v[148:151]
  s_add_u32 s50, s50, 524288
  v_mfma_f32_16x16x32_bf16 v[152:155], a[200:203], a[168:171], v[152:155]
  ds_read_b64_tr_b16 a[220:221], v35 offset:24576
  ds_read_b64_tr_b16 a[222:223], v35 offset:28672
  v_mfma_f32_16x16x32_bf16 v[152:155], a[204:207], a[184:187], v[152:155]
  v_mfma_f32_16x16x32_bf16 v[156:159], a[200:203], a[172:175], v[156:159]
  v_mfma_f32_16x16x32_bf16 v[156:159], a[204:207], a[188:191], v[156:159]
  s_waitcnt lgkmcnt(4)
  v_mfma_f32_16x16x32_bf16 v[160:163], a[208:211], a[160:163], v[160:163]
  ds_read_b64_tr_b16 a[192:193], v36 offset:16384
  ds_read_b64_tr_b16 a[194:195], v36 offset:20480
  v_mfma_f32_16x16x32_bf16 v[160:163], a[212:215], a[176:179], v[160:163]
  buffer_load_dwordx4 a[104:107], v44, s[16:19], s51 offen offset:2048 sc1
  v_mfma_f32_16x16x32_bf16 v[164:167], a[208:211], a[164:167], v[164:167]
  v_mfma_f32_16x16x32_bf16 v[164:167], a[212:215], a[180:183], v[164:167]
  v_mfma_f32_16x16x32_bf16 v[168:171], a[208:211], a[168:171], v[168:171]
  ds_read_b64_tr_b16 a[196:197], v36 offset:24576
  ds_read_b64_tr_b16 a[198:199], v36 offset:28672
  v_mfma_f32_16x16x32_bf16 v[168:171], a[212:215], a[184:187], v[168:171]
  buffer_load_dwordx4 a[108:111], v44, s[16:19], s51 offen offset:3072 sc1
  v_mfma_f32_16x16x32_bf16 v[172:175], a[208:211], a[172:175], v[172:175]
  v_mfma_f32_16x16x32_bf16 v[172:175], a[212:215], a[188:191], v[172:175]
  s_waitcnt lgkmcnt(4)
  v_mfma_f32_16x16x32_bf16 v[176:179], a[216:219], a[160:163], v[176:179]
  ds_read_b64_tr_b16 a[200:201], v37 offset:16384
  ds_read_b64_tr_b16 a[202:203], v37 offset:20480
  v_mfma_f32_16x16x32_bf16 v[176:179], a[220:223], a[176:179], v[176:179]
  v_mfma_f32_16x16x32_bf16 v[180:183], a[216:219], a[164:167], v[180:183]
  buffer_load_dwordx4 a[112:115], v45, s[16:19], s51 offen offset:0 sc1
  v_mfma_f32_16x16x32_bf16 v[180:183], a[220:223], a[180:183], v[180:183]
  v_mfma_f32_16x16x32_bf16 v[184:187], a[216:219], a[168:171], v[184:187]
  ds_read_b64_tr_b16 a[204:205], v37 offset:24576
  ds_read_b64_tr_b16 a[206:207], v37 offset:28672
  v_mfma_f32_16x16x32_bf16 v[184:187], a[220:223], a[184:187], v[184:187]
  v_mfma_f32_16x16x32_bf16 v[188:191], a[216:219], a[172:175], v[188:191]
  v_mfma_f32_16x16x32_bf16 v[188:191], a[220:223], a[188:191], v[188:191]
  s_waitcnt lgkmcnt(4)
  v_mfma_f32_16x16x32_bf16 v[192:195], a[192:195], a[160:163], v[192:195]
  ds_read_b64_tr_b16 a[208:209], v38 offset:16384
  ds_read_b64_tr_b16 a[210:211], v38 offset:20480
  v_mfma_f32_16x16x32_bf16 v[192:195], a[196:199], a[176:179], v[192:195]
  buffer_load_dwordx4 a[116:119], v45, s[16:19], s51 offen offset:1024 sc1
  v_mfma_f32_16x16x32_bf16 v[196:199], a[192:195], a[164:167], v[196:199]
  v_mfma_f32_16x16x32_bf16 v[196:199], a[196:199], a[180:183], v[196:199]
  v_mfma_f32_16x16x32_bf16 v[200:203], a[192:195], a[168:171], v[200:203]
  ds_read_b64_tr_b16 a[212:213], v38 offset:24576
  ds_read_b64_tr_b16 a[214:215], v38 offset:28672
  v_mfma_f32_16x16x32_bf16 v[200:203], a[196:199], a[184:187], v[200:203]
  buffer_load_dwordx4 a[120:123], v45, s[16:19], s51 offen offset:2048 sc1
  v_mfma_f32_16x16x32_bf16 v[204:207], a[192:195], a[172:175], v[204:207]
  v_mfma_f32_16x16x32_bf16 v[204:207], a[196:199], a[188:191], v[204:207]
  s_waitcnt lgkmcnt(4)
  v_mfma_f32_16x16x32_bf16 v[208:211], a[200:203], a[160:163], v[208:211]
  ds_read_b64_tr_b16 a[216:217], v39 offset:16384
  ds_read_b64_tr_b16 a[218:219], v39 offset:20480
  v_mfma_f32_16x16x32_bf16 v[208:211], a[204:207], a[176:179], v[208:211]
  v_mfma_f32_16x16x32_bf16 v[212:215], a[200:203], a[164:167], v[212:215]
  buffer_load_dwordx4 a[124:127], v45, s[16:19], s51 offen offset:3072 sc1
  v_mfma_f32_16x16x32_bf16 v[212:215], a[204:207], a[180:183], v[212:215]
  s_add_u32 s51, s51, 262144
  v_mfma_f32_16x16x32_bf16 v[216:219], a[200:203], a[168:171], v[216:219]
  ds_read_b64_tr_b16 a[220:221], v39 offset:24576
  ds_read_b64_tr_b16 a[222:223], v39 offset:28672
  v_mfma_f32_16x16x32_bf16 v[216:219], a[204:207], a[184:187], v[216:219]
  v_mfma_f32_16x16x32_bf16 v[220:223], a[200:203], a[172:175], v[220:223]
  v_mfma_f32_16x16x32_bf16 v[220:223], a[204:207], a[188:191], v[220:223]
  s_waitcnt vmcnt(36) lgkmcnt(4)
  s_barrier
  v_mfma_f32_16x16x32_bf16 v[224:227], a[208:211], a[160:163], v[224:227]
  ds_read_b64_tr_b16 a[192:193], v12 offset:0
  ds_read_b64_tr_b16 a[194:195], v12 offset:4096
  v_mfma_f32_16x16x32_bf16 v[224:227], a[212:215], a[176:179], v[224:227]
  buffer_load_dwordx4 a[128:131], v44, s[16:19], s51 offen offset:0 sc1
  v_mfma_f32_16x16x32_bf16 v[228:231], a[208:211], a[164:167], v[228:231]
  s_add_u32 m0, s52, 131072
  v_mfma_f32_16x16x32_bf16 v[228:231], a[212:215], a[180:183], v[228:231]
  v_mfma_f32_16x16x32_bf16 v[232:235], a[208:211], a[168:171], v[232:235]
  ds_read_b64_tr_b16 a[196:197], v12 offset:8192
  ds_read_b64_tr_b16 a[198:199], v12 offset:12288
  v_mfma_f32_16x16x32_bf16 v[232:235], a[212:215], a[184:187], v[232:235]
  buffer_load_dwordx4 a[132:135], v44, s[16:19], s51 offen offset:1024 sc1
  v_mfma_f32_16x16x32_bf16 v[236:239], a[208:211], a[172:175], v[236:239]
  v_mfma_f32_16x16x32_bf16 v[236:239], a[212:215], a[188:191], v[236:239]
  s_waitcnt lgkmcnt(4)
  v_mfma_f32_16x16x32_bf16 v[240:243], a[216:219], a[160:163], v[240:243]
  ds_read_b64_tr_b16 a[200:201], v13 offset:0
  ds_read_b64_tr_b16 a[202:203], v13 offset:4096
  v_mfma_f32_16x16x32_bf16 v[240:243], a[220:223], a[176:179], v[240:243]
  v_mfma_f32_16x16x32_bf16 v[244:247], a[216:219], a[164:167], v[244:247]
  buffer_load_dwordx4 v40, s[12:15], s50 offen offset:0 lds
  v_mfma_f32_16x16x32_bf16 v[244:247], a[220:223], a[180:183], v[244:247]
  v_mfma_f32_16x16x32_bf16 v[248:251], a[216:219], a[168:171], v[248:251]
  ds_read_b64_tr_b16 a[204:205], v13 offset:8192
  ds_read_b64_tr_b16 a[206:207], v13 offset:12288
  v_mfma_f32_16x16x32_bf16 v[248:251], a[220:223], a[184:187], v[248:251]
  v_mfma_f32_16x16x32_bf16 v[252:255], a[216:219], a[172:175], v[252:255]
  v_mfma_f32_16x16x32_bf16 v[252:255], a[220:223], a[188:191], v[252:255]
  s_waitcnt lgkmcnt(4)
  v_mfma_f32_16x16x32_bf16 v[128:131], a[192:195], a[0:3], v[128:131]
  ds_read_b64_tr_b16 a[208:209], v14 offset:0
  ds_read_b64_tr_b16 a[210:211], v14 offset:4096
  v_mfma_f32_16x16x32_bf16 v[128:131], a[196:199], a[16:19], v[128:131]
  buffer_load_dwordx4 v41, s[12:15], s50 offen offset:1024 lds
  v_mfma_f32_16x16x32_bf16 v[132:135], a[192:195], a[4:7], v[132:135]
  v_mfma_f32_16x16x32_bf16 v[132:135], a[196:199], a[20:23], v[132:135]
  v_mfma_f32_16x16x32_bf16 v[136:139], a[192:195], a[8:11], v[136:139]
  ds_read_b64_tr_b16 a[212:213], v14 offset:8192
  ds_read_b64_tr_b16 a[214:215], v14 offset:12288
  v_mfma_f32_16x16x32_bf16 v[136:139], a[196:199], a[24:27], v[136:139]
  buffer_load_dwordx4 v42, s[12:15], s50 offen offset:2048 lds
  v_mfma_f32_16x16x32_bf16 v[140:143], a[192:195], a[12:15], v[140:143]
  v_mfma_f32_16x16x32_bf16 v[140:143], a[196:199], a[28:31], v[140:143]
  s_waitcnt lgkmcnt(4)
  v_mfma_f32_16x16x32_bf16 v[144:147], a[200:203], a[0:3], v[144:147]
  ds_read_b64_tr_b16 a[216:217], v15 offset:0
  ds_read_b64_tr_b16 a[218:219], v15 offset:4096
  v_mfma_f32_16x16x32_bf16 v[144:147], a[204:207], a[16:19], v[144:147]
  v_mfma_f32_16x16x32_bf16 v[148:151], a[200:203], a[4:7], v[148:151]
  buffer_load_dwordx4 v43, s[12:15], s50 offen offset:3072 lds
  v_mfma_f32_16x16x32_bf16 v[148:151], a[204:207], a[20:23], v[148:151]
  s_add_u32 s50, s50, 524288
  v_mfma_f32_16x16x32_bf16 v[152:155], a[200:203], a[8:11], v[152:155]
  ds_read_b64_tr_b16 a[220:221], v15 offset:8192
  ds_read_b64_tr_b16 a[222:223], v15 offset:12288
  v_mfma_f32_16x16x32_bf16 v[152:155], a[204:207], a[24:27], v[152:155]
  v_mfma_f32_16x16x32_bf16 v[156:159], a[200:203], a[12:15], v[156:159]
  v_mfma_f32_16x16x32_bf16 v[156:159], a[204:207], a[28:31], v[156:159]
  s_waitcnt lgkmcnt(4)
  v_mfma_f32_16x16x32_bf16 v[160:163], a[208:211], a[0:3], v[160:163]
  ds_read_b64_tr_b16 a[192:193], v16 offset:0
  ds_read_b64_tr_b16 a[194:195], v16 offset:4096
  v_mfma_f32_16x16x32_bf16 v[160:163], a[212:215], a[16:19], v[160:163]
  buffer_load_dwordx4 a[136:139], v44, s[16:19], s51 offen offset:2048 sc1
  v_mfma_f32_16x16x32_bf16 v[164:167], a[208:211], a[4:7], v[164:167]
  v_mfma_f32_16x16x32_bf16 v[164:167], a[212:215], a[20:23], v[164:167]
  v_mfma_f32_16x16x32_bf16 v[168:171], a[208:211], a[8:11], v[168:171]
  ds_read_b64_tr_b16 a[196:197], v16 offset:8192
  ds_read_b64_tr_b16 a[198:199], v16 offset:12288
  v_mfma_f32_16x16x32_bf16 v[168:171], a[212:215], a[24:27], v[168:171]
  buffer_load_dwordx4 a[140:143], v44, s[16:19], s51 offen offset:3072 sc1
  v_mfma_f32_16x16x32_bf16 v[172:175], a[208:211], a[12:15], v[172:175]
  v_mfma_f32_16x16x32_bf16 v[172:175], a[212:215], a[28:31], v[172:175]
  s_waitcnt lgkmcnt(4)
  v_mfma_f32_16x16x32_bf16 v[176:179], a[216:219], a[0:3], v[176:179]
  ds_read_b64_tr_b16 a[200:201], v17 offset:0
  ds_read_b64_tr_b16 a[202:203], v17 offset:4096
  v_mfma_f32_16x16x32_bf16 v[176:179], a[220:223], a[16:19], v[176:179]
  v_mfma_f32_16x16x32_bf16 v[180:183], a[216:219], a[4:7], v[180:183]
  buffer_load_dwordx4 a[144:147], v45, s[16:19], s51 offen offset:0 sc1
  v_mfma_f32_16x16x32_bf16 v[180:183], a[220:223], a[20:23], v[180:183]
  v_mfma_f32_16x16x32_bf16 v[184:187], a[216:219], a[8:11], v[184:187]
  ds_read_b64_tr_b16 a[204:205], v17 offset:8192
  ds_read_b64_tr_b16 a[206:207], v17 offset:12288
  v_mfma_f32_16x16x32_bf16 v[184:187], a[220:223], a[24:27], v[184:187]
  v_mfma_f32_16x16x32_bf16 v[188:191], a[216:219], a[12:15], v[188:191]
  v_mfma_f32_16x16x32_bf16 v[188:191], a[220:223], a[28:31], v[188:191]
  s_waitcnt lgkmcnt(4)
  v_mfma_f32_16x16x32_bf16 v[192:195], a[192:195], a[0:3], v[192:195]
  ds_read_b64_tr_b16 a[208:209], v18 offset:0
  ds_read_b64_tr_b16 a[210:211], v18 offset:4096
  v_mfma_f32_16x16x32_bf16 v[192:195], a[196:199], a[16:19], v[192:195]
  buffer_load_dwordx4 a[148:151], v45, s[16:19], s51 offen offset:1024 sc1
  v_mfma_f32_16x16x32_bf16 v[196:199], a[192:195], a[4:7], v[196:199]
  v_mfma_f32_16x16x32_bf16 v[196:199], a[196:199], a[20:23], v[196:199]
  v_mfma_f32_16x16x32_bf16 v[200:203], a[192:195], a[8:11], v[200:203]
  ds_read_b64_tr_b16 a[212:213], v18 offset:8192
  ds_read_b64_tr_b16 a[214:215], v18 offset:12288
  v_mfma_f32_16x16x32_bf16 v[200:203], a[196:199], a[24:27], v[200:203]
  buffer_load_dwordx4 a[152:155], v45, s[16:19], s51 offen offset:2048 sc1
  v_mfma_f32_16x16x32_bf16 v[204:207], a[192:195], a[12:15], v[204:207]
  v_mfma_f32_16x16x32_bf16 v[204:207], a[196:199], a[28:31], v[204:207]
  s_waitcnt lgkmcnt(4)
  v_mfma_f32_16x16x32_bf16 v[208:211], a[200:203], a[0:3], v[208:211]
  ds_read_b64_tr_b16 a[216:217], v19 offset:0
  ds_read_b64_tr_b16 a[218:219], v19 offset:4096
  v_mfma_f32_16x16x32_bf16 v[208:211], a[204:207], a[16:19], v[208:211]
  v_mfma_f32_16x16x32_bf16 v[212:215], a[200:203], a[4:7], v[212:215]
  buffer_load_dwordx4 a[156:159], v45, s[16:19], s51 offen offset:3072 sc1
  v_mfma_f32_16x16x32_bf16 v[212:215], a[204:207], a[20:23], v[212:215]
  s_add_u32 s51, s51, 262144
  v_mfma_f32_16x16x32_bf16 v[216:219], a[200:203], a[8:11], v[216:219]
  ds_read_b64_tr_b16 a[220:221], v19 offset:8192
  ds_read_b64_tr_b16 a[222:223], v19 offset:12288
  v_mfma_f32_16x16x32_bf16 v[216:219], a[204:207], a[24:27], v[216:219]
  v_mfma_f32_16x16x32_bf16 v[220:223], a[200:203], a[12:15], v[220:223]
  v_mfma_f32_16x16x32_bf16 v[220:223], a[204:207], a[28:31], v[220:223]
  s_waitcnt vmcnt(36) lgkmcnt(4)
  s_barrier
  v_mfma_f32_16x16x32_bf16 v[224:227], a[208:211], a[0:3], v[224:227]
  ds_read_b64_tr_b16 a[192:193], v12 offset:16384
  ds_read_b64_tr_b16 a[194:195], v12 offset:20480
  v_mfma_f32_16x16x32_bf16 v[224:227], a[212:215], a[16:19], v[224:227]
  buffer_load_dwordx4 a[160:163], v44, s[16:19], s51 offen offset:0 sc1
  v_mfma_f32_16x16x32_bf16 v[228:231], a[208:211], a[4:7], v[228:231]
  s_add_u32 m0, s52, 147456
  v_mfma_f32_16x16x32_bf16 v[228:231], a[212:215], a[20:23], v[228:231]
  v_mfma_f32_16x16x32_bf16 v[232:235], a[208:211], a[8:11], v[232:235]
  ds_read_b64_tr_b16 a[196:197], v12 offset:24576
  ds_read_b64_tr_b16 a[198:199], v12 offset:28672
  v_mfma_f32_16x16x32_bf16 v[232:235], a[212:215], a[24:27], v[232:235]
  buffer_load_dwordx4 a[164:167], v44, s[16:19], s51 offen offset:1024 sc1
  v_mfma_f32_16x16x32_bf16 v[236:239], a[208:211], a[12:15], v[236:239]
  v_mfma_f32_16x16x32_bf16 v[236:239], a[212:215], a[28:31], v[236:239]
  s_waitcnt lgkmcnt(4)
  v_mfma_f32_16x16x32_bf16 v[240:243], a[216:219], a[0:3], v[240:243]
  ds_read_b64_tr_b16 a[200:201], v13 offset:16384
  ds_read_b64_tr_b16 a[202:203], v13 offset:20480
  v_mfma_f32_16x16x32_bf16 v[240:243], a[220:223], a[16:19], v[240:243]
  v_mfma_f32_16x16x32_bf16 v[244:247], a[216:219], a[4:7], v[244:247]
  buffer_load_dwordx4 v40, s[12:15], s50 offen offset:0 lds
  v_mfma_f32_16x16x32_bf16 v[244:247], a[220:223], a[20:23], v[244:247]
  v_mfma_f32_16x16x32_bf16 v[248:251], a[216:219], a[8:11], v[248:251]
  ds_read_b64_tr_b16 a[204:205], v13 offset:24576
  ds_read_b64_tr_b16 a[206:207], v13 offset:28672
  v_mfma_f32_16x16x32_bf16 v[248:251], a[220:223], a[24:27], v[248:251]
  v_mfma_f32_16x16x32_bf16 v[252:255], a[216:219], a[12:15], v[252:255]
  v_mfma_f32_16x16x32_bf16 v[252:255], a[220:223], a[28:31], v[252:255]
  s_waitcnt lgkmcnt(4)
  v_mfma_f32_16x16x32_bf16 v[128:131], a[192:195], a[32:35], v[128:131]
  ds_read_b64_tr_b16 a[208:209], v14 offset:16384
  ds_read_b64_tr_b16 a[210:211], v14 offset:20480
  v_mfma_f32_16x16x32_bf16 v[128:131], a[196:199], a[48:51], v[128:131]
  buffer_load_dwordx4 v41, s[12:15], s50 offen offset:1024 lds
  v_mfma_f32_16x16x32_bf16 v[132:135], a[192:195], a[36:39], v[132:135]
  v_mfma_f32_16x16x32_bf16 v[132:135], a[196:199], a[52:55], v[132:135]
  v_mfma_f32_16x16x32_bf16 v[136:139], a[192:195], a[40:43], v[136:139]
  ds_read_b64_tr_b16 a[212:213], v14 offset:24576
  ds_read_b64_tr_b16 a[214:215], v14 offset:28672
  v_mfma_f32_16x16x32_bf16 v[136:139], a[196:199], a[56:59], v[136:139]
  buffer_load_dwordx4 v42, s[12:15], s50 offen offset:2048 lds
  v_mfma_f32_16x16x32_bf16 v[140:143], a[192:195], a[44:47], v[140:143]
  v_mfma_f32_16x16x32_bf16 v[140:143], a[196:199], a[60:63], v[140:143]
  s_waitcnt lgkmcnt(4)
  v_mfma_f32_16x16x32_bf16 v[144:147], a[200:203], a[32:35], v[144:147]
  ds_read_b64_tr_b16 a[216:217], v15 offset:16384
  ds_read_b64_tr_b16 a[218:219], v15 offset:20480
  v_mfma_f32_16x16x32_bf16 v[144:147], a[204:207], a[48:51], v[144:147]
  v_mfma_f32_16x16x32_bf16 v[148:151], a[200:203], a[36:39], v[148:151]
  buffer_load_dwordx4 v43, s[12:15], s50 offen offset:3072 lds
  v_mfma_f32_16x16x32_bf16 v[148:151], a[204:207], a[52:55], v[148:151]
  s_add_u32 s50, s50, 524288
  v_mfma_f32_16x16x32_bf16 v[152:155], a[200:203], a[40:43], v[152:155]
  ds_read_b64_tr_b16 a[220:221], v15 offset:24576
  ds_read_b64_tr_b16 a[222:223], v15 offset:28672
  v_mfma_f32_16x16x32_bf16 v[152:155], a[204:207], a[56:59], v[152:155]
  v_mfma_f32_16x16x32_bf16 v[156:159], a[200:203], a[44:47], v[156:159]
  v_mfma_f32_16x16x32_bf16 v[156:159], a[204:207], a[60:63], v[156:159]
  s_waitcnt lgkmcnt(4)
  v_mfma_f32_16x16x32_bf16 v[160:163], a[208:211], a[32:35], v[160:163]
  ds_read_b64_tr_b16 a[192:193], v16 offset:16384
  ds_read_b64_tr_b16 a[194:195], v16 offset:20480
  v_mfma_f32_16x16x32_bf16 v[160:163], a[212:215], a[48:51], v[160:163]
  buffer_load_dwordx4 a[168:171], v44, s[16:19], s51 offen offset:2048 sc1
  v_mfma_f32_16x16x32_bf16 v[164:167], a[208:211], a[36:39], v[164:167]
  v_mfma_f32_16x16x32_bf16 v[164:167], a[212:215], a[52:55], v[164:167]
  v_mfma_f32_16x16x32_bf16 v[168:171], a[208:211], a[40:43], v[168:171]
  ds_read_b64_tr_b16 a[196:197], v16 offset:24576
  ds_read_b64_tr_b16 a[198:199], v16 offset:28672
  v_mfma_f32_16x16x32_bf16 v[168:171], a[212:215], a[56:59], v[168:171]
  buffer_load_dwordx4 a[172:175], v44, s[16:19], s51 offen offset:3072 sc1
  v_mfma_f32_16x16x32_bf16 v[172:175], a[208:211], a[44:47], v[172:175]
  v_mfma_f32_16x16x32_bf16 v[172:175], a[212:215], a[60:63], v[172:175]
  s_waitcnt lgkmcnt(4)
  v_mfma_f32_16x16x32_bf16 v[176:179], a[216:219], a[32:35], v[176:179]
  ds_read_b64_tr_b16 a[200:201], v17 offset:16384
  ds_read_b64_tr_b16 a[202:203], v17 offset:20480
  v_mfma_f32_16x16x32_bf16 v[176:179], a[220:223], a[48:51], v[176:179]
  v_mfma_f32_16x16x32_bf16 v[180:183], a[216:219], a[36:39], v[180:183]
  buffer_load_dwordx4 a[176:179], v45, s[16:19], s51 offen offset:0 sc1
  v_mfma_f32_16x16x32_bf16 v[180:183], a[220:223], a[52:55], v[180:183]
  v_mfma_f32_16x16x32_bf16 v[184:187], a[216:219], a[40:43], v[184:187]
  ds_read_b64_tr_b16 a[204:205], v17 offset:24576
  ds_read_b64_tr_b16 a[206:207], v17 offset:28672
  v_mfma_f32_16x16x32_bf16 v[184:187], a[220:223], a[56:59], v[184:187]
  v_mfma_f32_16x16x32_bf16 v[188:191], a[216:219], a[44:47], v[188:191]
  v_mfma_f32_16x16x32_bf16 v[188:191], a[220:223], a[60:63], v[188:191]
  s_waitcnt lgkmcnt(4)
  v_mfma_f32_16x16x32_bf16 v[192:195], a[192:195], a[32:35], v[192:195]
  ds_read_b64_tr_b16 a[208:209], v18 offset:16384
  ds_read_b64_tr_b16 a[210:211], v18 offset:20480
  v_mfma_f32_16x16x32_bf16 v[192:195], a[196:199], a[48:51], v[192:195]
  buffer_load_dwordx4 a[180:183], v45, s[16:19], s51 offen offset:1024 sc1
  v_mfma_f32_16x16x32_bf16 v[196:199], a[192:195], a[36:39], v[196:199]
  v_mfma_f32_16x16x32_bf16 v[196:199], a[196:199], a[52:55], v[196:199]
  v_mfma_f32_16x16x32_bf16 v[200:203], a[192:195], a[40:43], v[200:203]
  ds_read_b64_tr_b16 a[212:213], v18 offset:24576
  ds_read_b64_tr_b16 a[214:215], v18 offset:28672
  v_mfma_f32_16x16x32_bf16 v[200:203], a[196:199], a[56:59], v[200:203]
  buffer_load_dwordx4 a[184:187], v45, s[16:19], s51 offen offset:2048 sc1
  v_mfma_f32_16x16x32_bf16 v[204:207], a[192:195], a[44:47], v[204:207]
  v_mfma_f32_16x16x32_bf16 v[204:207], a[196:199], a[60:63], v[204:207]
  s_waitcnt lgkmcnt(4)
  v_mfma_f32_16x16x32_bf16 v[208:211], a[200:203], a[32:35], v[208:211]
  ds_read_b64_tr_b16 a[216:217], v19 offset:16384
  ds_read_b64_tr_b16 a[218:219], v19 offset:20480
  v_mfma_f32_16x16x32_bf16 v[208:211], a[204:207], a[48:51], v[208:211]
  v_mfma_f32_16x16x32_bf16 v[212:215], a[200:203], a[36:39], v[212:215]
  buffer_load_dwordx4 a[188:191], v45, s[16:19], s51 offen offset:3072 sc1
  v_mfma_f32_16x16x32_bf16 v[212:215], a[204:207], a[52:55], v[212:215]
  s_add_u32 s51, s51, 262144
  v_mfma_f32_16x16x32_bf16 v[216:219], a[200:203], a[40:43], v[216:219]
  ds_read_b64_tr_b16 a[220:221], v19 offset:24576
  ds_read_b64_tr_b16 a[222:223], v19 offset:28672
  v_mfma_f32_16x16x32_bf16 v[216:219], a[204:207], a[56:59], v[216:219]
  v_mfma_f32_16x16x32_bf16 v[220:223], a[200:203], a[44:47], v[220:223]
  v_mfma_f32_16x16x32_bf16 v[220:223], a[204:207], a[60:63], v[220:223]
  s_waitcnt vmcnt(36) lgkmcnt(4)
  s_barrier
  v_mfma_f32_16x16x32_bf16 v[224:227], a[208:211], a[32:35], v[224:227]
  ds_read_b64_tr_b16 a[192:193], v12 offset:32768
  ds_read_b64_tr_b16 a[194:195], v12 offset:36864
  v_mfma_f32_16x16x32_bf16 v[224:227], a[212:215], a[48:51], v[224:227]
  buffer_load_dwordx4 a[0:3], v44, s[16:19], s51 offen offset:0 sc1
  v_mfma_f32_16x16x32_bf16 v[228:231], a[208:211], a[36:39], v[228:231]
  s_add_u32 m0, s52, 65536
  v_mfma_f32_16x16x32_bf16 v[228:231], a[212:215], a[52:55], v[228:231]
  v_mfma_f32_16x16x32_bf16 v[232:235], a[208:211], a[40:43], v[232:235]
  ds_read_b64_tr_b16 a[196:197], v12 offset:40960
  ds_read_b64_tr_b16 a[198:199], v12 offset:45056
  v_mfma_f32_16x16x32_bf16 v[232:235], a[212:215], a[56:59], v[232:235]
  buffer_load_dwordx4 a[4:7], v44, s[16:19], s51 offen offset:1024 sc1
  v_mfma_f32_16x16x32_bf16 v[236:239], a[208:211], a[44:47], v[236:239]
  v_mfma_f32_16x16x32_bf16 v[236:239], a[212:215], a[60:63], v[236:239]
  s_waitcnt lgkmcnt(4)
  v_mfma_f32_16x16x32_bf16 v[240:243], a[216:219], a[32:35], v[240:243]
  ds_read_b64_tr_b16 a[200:201], v13 offset:32768
  ds_read_b64_tr_b16 a[202:203], v13 offset:36864
  v_mfma_f32_16x16x32_bf16 v[240:243], a[220:223], a[48:51], v[240:243]
  v_mfma_f32_16x16x32_bf16 v[244:247], a[216:219], a[36:39], v[244:247]
  buffer_load_dwordx4 v40, s[12:15], s50 offen offset:0 lds
  v_mfma_f32_16x16x32_bf16 v[244:247], a[220:223], a[52:55], v[244:247]
  v_mfma_f32_16x16x32_bf16 v[248:251], a[216:219], a[40:43], v[248:251]
  ds_read_b64_tr_b16 a[204:205], v13 offset:40960
  ds_read_b64_tr_b16 a[206:207], v13 offset:45056
  v_mfma_f32_16x16x32_bf16 v[248:251], a[220:223], a[56:59], v[248:251]
  v_mfma_f32_16x16x32_bf16 v[252:255], a[216:219], a[44:47], v[252:255]
  v_mfma_f32_16x16x32_bf16 v[252:255], a[220:223], a[60:63], v[252:255]
  s_waitcnt lgkmcnt(4)
  v_mfma_f32_16x16x32_bf16 v[128:131], a[192:195], a[64:67], v[128:131]
  ds_read_b64_tr_b16 a[208:209], v14 offset:32768
  ds_read_b64_tr_b16 a[210:211], v14 offset:36864
  v_mfma_f32_16x16x32_bf16 v[128:131], a[196:199], a[80:83], v[128:131]
  buffer_load_dwordx4 v41, s[12:15], s50 offen offset:1024 lds
  v_mfma_f32_16x16x32_bf16 v[132:135], a[192:195], a[68:71], v[132:135]
  v_mfma_f32_16x16x32_bf16 v[132:135], a[196:199], a[84:87], v[132:135]
  v_mfma_f32_16x16x32_bf16 v[136:139], a[192:195], a[72:75], v[136:139]
  ds_read_b64_tr_b16 a[212:213], v14 offset:40960
  ds_read_b64_tr_b16 a[214:215], v14 offset:45056
  v_mfma_f32_16x16x32_bf16 v[136:139], a[196:199], a[88:91], v[136:139]
  buffer_load_dwordx4 v42, s[12:15], s50 offen offset:2048 lds
  v_mfma_f32_16x16x32_bf16 v[140:143], a[192:195], a[76:79], v[140:143]
  v_mfma_f32_16x16x32_bf16 v[140:143], a[196:199], a[92:95], v[140:143]
  s_waitcnt lgkmcnt(4)
  v_mfma_f32_16x16x32_bf16 v[144:147], a[200:203], a[64:67], v[144:147]
  ds_read_b64_tr_b16 a[216:217], v15 offset:32768
  ds_read_b64_tr_b16 a[218:219], v15 offset:36864
  v_mfma_f32_16x16x32_bf16 v[144:147], a[204:207], a[80:83], v[144:147]
  v_mfma_f32_16x16x32_bf16 v[148:151], a[200:203], a[68:71], v[148:151]
  buffer_load_dwordx4 v43, s[12:15], s50 offen offset:3072 lds
  v_mfma_f32_16x16x32_bf16 v[148:151], a[204:207], a[84:87], v[148:151]
  s_add_u32 s50, s50, 524288
  v_mfma_f32_16x16x32_bf16 v[152:155], a[200:203], a[72:75], v[152:155]
  ds_read_b64_tr_b16 a[220:221], v15 offset:40960
  ds_read_b64_tr_b16 a[222:223], v15 offset:45056
  v_mfma_f32_16x16x32_bf16 v[152:155], a[204:207], a[88:91], v[152:155]
  v_mfma_f32_16x16x32_bf16 v[156:159], a[200:203], a[76:79], v[156:159]
  v_mfma_f32_16x16x32_bf16 v[156:159], a[204:207], a[92:95], v[156:159]
  s_waitcnt lgkmcnt(4)
  v_mfma_f32_16x16x32_bf16 v[160:163], a[208:211], a[64:67], v[160:163]
  ds_read_b64_tr_b16 a[192:193], v16 offset:32768
  ds_read_b64_tr_b16 a[194:195], v16 offset:36864
  v_mfma_f32_16x16x32_bf16 v[160:163], a[212:215], a[80:83], v[160:163]
  buffer_load_dwordx4 a[8:11], v44, s[16:19], s51 offen offset:2048 sc1
  v_mfma_f32_16x16x32_bf16 v[164:167], a[208:211], a[68:71], v[164:167]
  v_mfma_f32_16x16x32_bf16 v[164:167], a[212:215], a[84:87], v[164:167]
  v_mfma_f32_16x16x32_bf16 v[168:171], a[208:211], a[72:75], v[168:171]
  ds_read_b64_tr_b16 a[196:197], v16 offset:40960
  ds_read_b64_tr_b16 a[198:199], v16 offset:45056
  v_mfma_f32_16x16x32_bf16 v[168:171], a[212:215], a[88:91], v[168:171]
  buffer_load_dwordx4 a[12:15], v44, s[16:19], s51 offen offset:3072 sc1
  v_mfma_f32_16x16x32_bf16 v[172:175], a[208:211], a[76:79], v[172:175]
  v_mfma_f32_16x16x32_bf16 v[172:175], a[212:215], a[92:95], v[172:175]
  s_waitcnt lgkmcnt(4)
  v_mfma_f32_16x16x32_bf16 v[176:179], a[216:219], a[64:67], v[176:179]
  ds_read_b64_tr_b16 a[200:201], v17 offset:32768
  ds_read_b64_tr_b16 a[202:203], v17 offset:36864
  v_mfma_f32_16x16x32_bf16 v[176:179], a[220:223], a[80:83], v[176:179]
  v_mfma_f32_16x16x32_bf16 v[180:183], a[216:219], a[68:71], v[180:183]
  buffer_load_dwordx4 a[16:19], v45, s[16:19], s51 offen offset:0 sc1
  v_mfma_f32_16x16x32_bf16 v[180:183], a[220:223], a[84:87], v[180:183]
  v_mfma_f32_16x16x32_bf16 v[184:187], a[216:219], a[72:75], v[184:187]
  ds_read_b64_tr_b16 a[204:205], v17 offset:40960
  ds_read_b64_tr_b16 a[206:207], v17 offset:45056
  v_mfma_f32_16x16x32_bf16 v[184:187], a[220:223], a[88:91], v[184:187]
  v_mfma_f32_16x16x32_bf16 v[188:191], a[216:219], a[76:79], v[188:191]
  v_mfma_f32_16x16x32_bf16 v[188:191], a[220:223], a[92:95], v[188:191]
  s_waitcnt lgkmcnt(4)
  v_mfma_f32_16x16x32_bf16 v[192:195], a[192:195], a[64:67], v[192:195]
  ds_read_b64_tr_b16 a[208:209], v18 offset:32768
  ds_read_b64_tr_b16 a[210:211], v18 offset:36864
  v_mfma_f32_16x16x32_bf16 v[192:195], a[196:199], a[80:83], v[192:195]
  buffer_load_dwordx4 a[20:23], v45, s[16:19], s51 offen offset:1024 sc1
  v_mfma_f32_16x16x32_bf16 v[196:199], a[192:195], a[68:71], v[196:199]
  v_mfma_f32_16x16x32_bf16 v[196:199], a[196:199], a[84:87], v[196:199]
  v_mfma_f32_16x16x32_bf16 v[200:203], a[192:195], a[72:75], v[200:203]
  ds_read_b64_tr_b16 a[212:213], v18 offset:40960
  ds_read_b64_tr_b16 a[214:215], v18 offset:45056
  v_mfma_f32_16x16x32_bf16 v[200:203], a[196:199], a[88:91], v[200:203]
  buffer_load_dwordx4 a[24:27], v45, s[16:19], s51 offen offset:2048 sc1
  v_mfma_f32_16x16x32_bf16 v[204:207], a[192:195], a[76:79], v[204:207]
  v_mfma_f32_16x16x32_bf16 v[204:207], a[196:199], a[92:95], v[204:207]
  s_waitcnt lgkmcnt(4)
  v_mfma_f32_16x16x32_bf16 v[208:211], a[200:203], a[64:67], v[208:211]
  ds_read_b64_tr_b16 a[216:217], v19 offset:32768
  ds_read_b64_tr_b16 a[218:219], v19 offset:36864
  v_mfma_f32_16x16x32_bf16 v[208:211], a[204:207], a[80:83], v[208:211]
  v_mfma_f32_16x16x32_bf16 v[212:215], a[200:203], a[68:71], v[212:215]
  buffer_load_dwordx4 a[28:31], v45, s[16:19], s51 offen offset:3072 sc1
  v_mfma_f32_16x16x32_bf16 v[212:215], a[204:207], a[84:87], v[212:215]
  s_add_u32 s51, s51, 262144
  v_mfma_f32_16x16x32_bf16 v[216:219], a[200:203], a[72:75], v[216:219]
  ds_read_b64_tr_b16 a[220:221], v19 offset:40960
  ds_read_b64_tr_b16 a[222:223], v19 offset:45056
  v_mfma_f32_16x16x32_bf16 v[216:219], a[204:207], a[88:91], v[216:219]
  v_mfma_f32_16x16x32_bf16 v[220:223], a[200:203], a[76:79], v[220:223]
  v_mfma_f32_16x16x32_bf16 v[220:223], a[204:207], a[92:95], v[220:223]
  s_waitcnt vmcnt(36) lgkmcnt(4)
  s_barrier
  v_mfma_f32_16x16x32_bf16 v[224:227], a[208:211], a[64:67], v[224:227]
  ds_read_b64_tr_b16 a[192:193], v12 offset:49152
  ds_read_b64_tr_b16 a[194:195], v12 offset:53248
  v_mfma_f32_16x16x32_bf16 v[224:227], a[212:215], a[80:83], v[224:227]
  buffer_load_dwordx4 a[32:35], v44, s[16:19], s51 offen offset:0 sc1
  v_mfma_f32_16x16x32_bf16 v[228:231], a[208:211], a[68:71], v[228:231]
  s_add_u32 m0, s52, 81920
  v_mfma_f32_16x16x32_bf16 v[228:231], a[212:215], a[84:87], v[228:231]
  v_mfma_f32_16x16x32_bf16 v[232:235], a[208:211], a[72:75], v[232:235]
  ds_read_b64_tr_b16 a[196:197], v12 offset:57344
  ds_read_b64_tr_b16 a[198:199], v12 offset:61440
  v_mfma_f32_16x16x32_bf16 v[232:235], a[212:215], a[88:91], v[232:235]
  buffer_load_dwordx4 a[36:39], v44, s[16:19], s51 offen offset:1024 sc1
  v_mfma_f32_16x16x32_bf16 v[236:239], a[208:211], a[76:79], v[236:239]
  v_mfma_f32_16x16x32_bf16 v[236:239], a[212:215], a[92:95], v[236:239]
  s_waitcnt lgkmcnt(4)
  v_mfma_f32_16x16x32_bf16 v[240:243], a[216:219], a[64:67], v[240:243]
  ds_read_b64_tr_b16 a[200:201], v13 offset:49152
  ds_read_b64_tr_b16 a[202:203], v13 offset:53248
  v_mfma_f32_16x16x32_bf16 v[240:243], a[220:223], a[80:83], v[240:243]
  v_mfma_f32_16x16x32_bf16 v[244:247], a[216:219], a[68:71], v[244:247]
  buffer_load_dwordx4 v40, s[12:15], s50 offen offset:0 lds
  v_mfma_f32_16x16x32_bf16 v[244:247], a[220:223], a[84:87], v[244:247]
  v_mfma_f32_16x16x32_bf16 v[248:251], a[216:219], a[72:75], v[248:251]
  ds_read_b64_tr_b16 a[204:205], v13 offset:57344
  ds_read_b64_tr_b16 a[206:207], v13 offset:61440
  v_mfma_f32_16x16x32_bf16 v[248:251], a[220:223], a[88:91], v[248:251]
  v_mfma_f32_16x16x32_bf16 v[252:255], a[216:219], a[76:79], v[252:255]
  v_mfma_f32_16x16x32_bf16 v[252:255], a[220:223], a[92:95], v[252:255]
  s_waitcnt lgkmcnt(4)
  v_mfma_f32_16x16x32_bf16 v[128:131], a[192:195], a[96:99], v[128:131]
  ds_read_b64_tr_b16 a[208:209], v14 offset:49152
  ds_read_b64_tr_b16 a[210:211], v14 offset:53248
  v_mfma_f32_16x16x32_bf16 v[128:131], a[196:199], a[112:115], v[128:131]
  buffer_load_dwordx4 v41, s[12:15], s50 offen offset:1024 lds
  v_mfma_f32_16x16x32_bf16 v[132:135], a[192:195], a[100:103], v[132:135]
  v_mfma_f32_16x16x32_bf16 v[132:135], a[196:199], a[116:119], v[132:135]
  v_mfma_f32_16x16x32_bf16 v[136:139], a[192:195], a[104:107], v[136:139]
  ds_read_b64_tr_b16 a[212:213], v14 offset:57344
  ds_read_b64_tr_b16 a[214:215], v14 offset:61440
  v_mfma_f32_16x16x32_bf16 v[136:139], a[196:199], a[120:123], v[136:139]
  buffer_load_dwordx4 v42, s[12:15], s50 offen offset:2048 lds
  v_mfma_f32_16x16x32_bf16 v[140:143], a[192:195], a[108:111], v[140:143]
  v_mfma_f32_16x16x32_bf16 v[140:143], a[196:199], a[124:127], v[140:143]
  s_waitcnt lgkmcnt(4)
  v_mfma_f32_16x16x32_bf16 v[144:147], a[200:203], a[96:99], v[144:147]
  ds_read_b64_tr_b16 a[216:217], v15 offset:49152
  ds_read_b64_tr_b16 a[218:219], v15 offset:53248
  v_mfma_f32_16x16x32_bf16 v[144:147], a[204:207], a[112:115], v[144:147]
  v_mfma_f32_16x16x32_bf16 v[148:151], a[200:203], a[100:103], v[148:151]
  buffer_load_dwordx4 v43, s[12:15], s50 offen offset:3072 lds
  v_mfma_f32_16x16x32_bf16 v[148:151], a[204:207], a[116:119], v[148:151]
  s_add_u32 s50, s50, 524288
  v_mfma_f32_16x16x32_bf16 v[152:155], a[200:203], a[104:107], v[152:155]
  ds_read_b64_tr_b16 a[220:221], v15 offset:57344
  ds_read_b64_tr_b16 a[222:223], v15 offset:61440
  v_mfma_f32_16x16x32_bf16 v[152:155], a[204:207], a[120:123], v[152:155]
  v_mfma_f32_16x16x32_bf16 v[156:159], a[200:203], a[108:111], v[156:159]
  v_mfma_f32_16x16x32_bf16 v[156:159], a[204:207], a[124:127], v[156:159]
  s_waitcnt lgkmcnt(4)
  v_mfma_f32_16x16x32_bf16 v[160:163], a[208:211], a[96:99], v[160:163]
  ds_read_b64_tr_b16 a[192:193], v16 offset:49152
  ds_read_b64_tr_b16 a[194:195], v16 offset:53248
  v_mfma_f32_16x16x32_bf16 v[160:163], a[212:215], a[112:115], v[160:163]
  buffer_load_dwordx4 a[40:43], v44, s[16:19], s51 offen offset:2048 sc1
  v_mfma_f32_16x16x32_bf16 v[164:167], a[208:211], a[100:103], v[164:167]
  v_mfma_f32_16x16x32_bf16 v[164:167], a[212:215], a[116:119], v[164:167]
  v_mfma_f32_16x16x32_bf16 v[168:171], a[208:211], a[104:107], v[168:171]
  ds_read_b64_tr_b16 a[196:197], v16 offset:57344
  ds_read_b64_tr_b16 a[198:199], v16 offset:61440
  v_mfma_f32_16x16x32_bf16 v[168:171], a[212:215], a[120:123], v[168:171]
  buffer_load_dwordx4 a[44:47], v44, s[16:19], s51 offen offset:3072 sc1
  v_mfma_f32_16x16x32_bf16 v[172:175], a[208:211], a[108:111], v[172:175]
  v_mfma_f32_16x16x32_bf16 v[172:175], a[212:215], a[124:127], v[172:175]
  s_waitcnt lgkmcnt(4)
  v_mfma_f32_16x16x32_bf16 v[176:179], a[216:219], a[96:99], v[176:179]
  ds_read_b64_tr_b16 a[200:201], v17 offset:49152
  ds_read_b64_tr_b16 a[202:203], v17 offset:53248
  v_mfma_f32_16x16x32_bf16 v[176:179], a[220:223], a[112:115], v[176:179]
  v_mfma_f32_16x16x32_bf16 v[180:183], a[216:219], a[100:103], v[180:183]
  buffer_load_dwordx4 a[48:51], v45, s[16:19], s51 offen offset:0 sc1
  v_mfma_f32_16x16x32_bf16 v[180:183], a[220:223], a[116:119], v[180:183]
  v_mfma_f32_16x16x32_bf16 v[184:187], a[216:219], a[104:107], v[184:187]
  ds_read_b64_tr_b16 a[204:205], v17 offset:57344
  ds_read_b64_tr_b16 a[206:207], v17 offset:61440
  v_mfma_f32_16x16x32_bf16 v[184:187], a[220:223], a[120:123], v[184:187]
  v_mfma_f32_16x16x32_bf16 v[188:191], a[216:219], a[108:111], v[188:191]
  v_mfma_f32_16x16x32_bf16 v[188:191], a[220:223], a[124:127], v[188:191]
  s_waitcnt lgkmcnt(4)
  v_mfma_f32_16x16x32_bf16 v[192:195], a[192:195], a[96:99], v[192:195]
  ds_read_b64_tr_b16 a[208:209], v18 offset:49152
  ds_read_b64_tr_b16 a[210:211], v18 offset:53248
  v_mfma_f32_16x16x32_bf16 v[192:195], a[196:199], a[112:115], v[192:195]
  buffer_load_dwordx4 a[52:55], v45, s[16:19], s51 offen offset:1024 sc1
  v_mfma_f32_16x16x32_bf16 v[196:199], a[192:195], a[100:103], v[196:199]
  v_mfma_f32_16x16x32_bf16 v[196:199], a[196:199], a[116:119], v[196:199]
  v_mfma_f32_16x16x32_bf16 v[200:203], a[192:195], a[104:107], v[200:203]
  ds_read_b64_tr_b16 a[212:213], v18 offset:57344
  ds_read_b64_tr_b16 a[214:215], v18 offset:61440
  v_mfma_f32_16x16x32_bf16 v[200:203], a[196:199], a[120:123], v[200:203]
  buffer_load_dwordx4 a[56:59], v45, s[16:19], s51 offen offset:2048 sc1
  v_mfma_f32_16x16x32_bf16 v[204:207], a[192:195], a[108:111], v[204:207]
  v_mfma_f32_16x16x32_bf16 v[204:207], a[196:199], a[124:127], v[204:207]
  s_waitcnt lgkmcnt(4)
  v_mfma_f32_16x16x32_bf16 v[208:211], a[200:203], a[96:99], v[208:211]
  ds_read_b64_tr_b16 a[216:217], v19 offset:49152
  ds_read_b64_tr_b16 a[218:219], v19 offset:53248
  v_mfma_f32_16x16x32_bf16 v[208:211], a[204:207], a[112:115], v[208:211]
  v_mfma_f32_16x16x32_bf16 v[212:215], a[200:203], a[100:103], v[212:215]
  buffer_load_dwordx4 a[60:63], v45, s[16:19], s51 offen offset:3072 sc1
  v_mfma_f32_16x16x32_bf16 v[212:215], a[204:207], a[116:119], v[212:215]
  s_add_u32 s51, s51, 262144
  v_mfma_f32_16x16x32_bf16 v[216:219], a[200:203], a[104:107], v[216:219]
  ds_read_b64_tr_b16 a[220:221], v19 offset:57344
  ds_read_b64_tr_b16 a[222:223], v19 offset:61440
  v_mfma_f32_16x16x32_bf16 v[216:219], a[204:207], a[120:123], v[216:219]
  v_mfma_f32_16x16x32_bf16 v[220:223], a[200:203], a[108:111], v[220:223]
  v_mfma_f32_16x16x32_bf16 v[220:223], a[204:207], a[124:127], v[220:223]
  s_waitcnt vmcnt(36) lgkmcnt(4)
  s_barrier
  v_mfma_f32_16x16x32_bf16 v[224:227], a[208:211], a[96:99], v[224:227]
  ds_read_b64_tr_b16 a[192:193], v32 offset:0
  ds_read_b64_tr_b16 a[194:195], v32 offset:4096
  v_mfma_f32_16x16x32_bf16 v[224:227], a[212:215], a[112:115], v[224:227]
  buffer_load_dwordx4 a[64:67], v44, s[16:19], s51 offen offset:0 sc1
  v_mfma_f32_16x16x32_bf16 v[228:231], a[208:211], a[100:103], v[228:231]
  s_add_u32 m0, s52, 98304
  v_mfma_f32_16x16x32_bf16 v[228:231], a[212:215], a[116:119], v[228:231]
  v_mfma_f32_16x16x32_bf16 v[232:235], a[208:211], a[104:107], v[232:235]
  ds_read_b64_tr_b16 a[196:197], v32 offset:8192
  ds_read_b64_tr_b16 a[198:199], v32 offset:12288
  v_mfma_f32_16x16x32_bf16 v[232:235], a[212:215], a[120:123], v[232:235]
  buffer_load_dwordx4 a[68:71], v44, s[16:19], s51 offen offset:1024 sc1
  v_mfma_f32_16x16x32_bf16 v[236:239], a[208:211], a[108:111], v[236:239]
  v_mfma_f32_16x16x32_bf16 v[236:239], a[212:215], a[124:127], v[236:239]
  s_waitcnt lgkmcnt(4)
  v_mfma_f32_16x16x32_bf16 v[240:243], a[216:219], a[96:99], v[240:243]
  ds_read_b64_tr_b16 a[200:201], v33 offset:0
  ds_read_b64_tr_b16 a[202:203], v33 offset:4096
  v_mfma_f32_16x16x32_bf16 v[240:243], a[220:223], a[112:115], v[240:243]
  v_mfma_f32_16x16x32_bf16 v[244:247], a[216:219], a[100:103], v[244:247]
  buffer_load_dwordx4 v40, s[12:15], s50 offen offset:0 lds
  v_mfma_f32_16x16x32_bf16 v[244:247], a[220:223], a[116:119], v[244:247]
  v_mfma_f32_16x16x32_bf16 v[248:251], a[216:219], a[104:107], v[248:251]
  ds_read_b64_tr_b16 a[204:205], v33 offset:8192
  ds_read_b64_tr_b16 a[206:207], v33 offset:12288
  v_mfma_f32_16x16x32_bf16 v[248:251], a[220:223], a[120:123], v[248:251]
  v_mfma_f32_16x16x32_bf16 v[252:255], a[216:219], a[108:111], v[252:255]
  v_mfma_f32_16x16x32_bf16 v[252:255], a[220:223], a[124:127], v[252:255]
  s_waitcnt lgkmcnt(4)
  v_mfma_f32_16x16x32_bf16 v[128:131], a[192:195], a[128:131], v[128:131]
  ds_read_b64_tr_b16 a[208:209], v34 offset:0
  ds_read_b64_tr_b16 a[210:211], v34 offset:4096
  v_mfma_f32_16x16x32_bf16 v[128:131], a[196:199], a[144:147], v[128:131]
  buffer_load_dwordx4 v41, s[12:15], s50 offen offset:1024 lds
  v_mfma_f32_16x16x32_bf16 v[132:135], a[192:195], a[132:135], v[132:135]
  v_mfma_f32_16x16x32_bf16 v[132:135], a[196:199], a[148:151], v[132:135]
  v_mfma_f32_16x16x32_bf16 v[136:139], a[192:195], a[136:139], v[136:139]
  ds_read_b64_tr_b16 a[212:213], v34 offset:8192
  ds_read_b64_tr_b16 a[214:215], v34 offset:12288
  v_mfma_f32_16x16x32_bf16 v[136:139], a[196:199], a[152:155], v[136:139]
  buffer_load_dwordx4 v42, s[12:15], s50 offen offset:2048 lds
  v_mfma_f32_16x16x32_bf16 v[140:143], a[192:195], a[140:143], v[140:143]
  v_mfma_f32_16x16x32_bf16 v[140:143], a[196:199], a[156:159], v[140:143]
  s_waitcnt lgkmcnt(4)
  v_mfma_f32_16x16x32_bf16 v[144:147], a[200:203], a[128:131], v[144:147]
  ds_read_b64_tr_b16 a[216:217], v35 offset:0
  ds_read_b64_tr_b16 a[218:219], v35 offset:4096
  v_mfma_f32_16x16x32_bf16 v[144:147], a[204:207], a[144:147], v[144:147]
  v_mfma_f32_16x16x32_bf16 v[148:151], a[200:203], a[132:135], v[148:151]
  buffer_load_dwordx4 v43, s[12:15], s50 offen offset:3072 lds
  v_mfma_f32_16x16x32_bf16 v[148:151], a[204:207], a[148:151], v[148:151]
  s_add_u32 s50, s50, 524288
  v_mfma_f32_16x16x32_bf16 v[152:155], a[200:203], a[136:139], v[152:155]
  ds_read_b64_tr_b16 a[220:221], v35 offset:8192
  ds_read_b64_tr_b16 a[222:223], v35 offset:12288
  v_mfma_f32_16x16x32_bf16 v[152:155], a[204:207], a[152:155], v[152:155]
  v_mfma_f32_16x16x32_bf16 v[156:159], a[200:203], a[140:143], v[156:159]
  v_mfma_f32_16x16x32_bf16 v[156:159], a[204:207], a[156:159], v[156:159]
  s_waitcnt lgkmcnt(4)
  v_mfma_f32_16x16x32_bf16 v[160:163], a[208:211], a[128:131], v[160:163]
  ds_read_b64_tr_b16 a[192:193], v36 offset:0
  ds_read_b64_tr_b16 a[194:195], v36 offset:4096
  v_mfma_f32_16x16x32_bf16 v[160:163], a[212:215], a[144:147], v[160:163]
  buffer_load_dwordx4 a[72:75], v44, s[16:19], s51 offen offset:2048 sc1
  v_mfma_f32_16x16x32_bf16 v[164:167], a[208:211], a[132:135], v[164:167]
  v_mfma_f32_16x16x32_bf16 v[164:167], a[212:215], a[148:151], v[164:167]
  v_mfma_f32_16x16x32_bf16 v[168:171], a[208:211], a[136:139], v[168:171]
  ds_read_b64_tr_b16 a[196:197], v36 offset:8192
  ds_read_b64_tr_b16 a[198:199], v36 offset:12288
  v_mfma_f32_16x16x32_bf16 v[168:171], a[212:215], a[152:155], v[168:171]
  buffer_load_dwordx4 a[76:79], v44, s[16:19], s51 offen offset:3072 sc1
  v_mfma_f32_16x16x32_bf16 v[172:175], a[208:211], a[140:143], v[172:175]
  v_mfma_f32_16x16x32_bf16 v[172:175], a[212:215], a[156:159], v[172:175]
  s_waitcnt lgkmcnt(4)
  v_mfma_f32_16x16x32_bf16 v[176:179], a[216:219], a[128:131], v[176:179]
  ds_read_b64_tr_b16 a[200:201], v37 offset:0
  ds_read_b64_tr_b16 a[202:203], v37 offset:4096
  v_mfma_f32_16x16x32_bf16 v[176:179], a[220:223], a[144:147], v[176:179]
  v_mfma_f32_16x16x32_bf16 v[180:183], a[216:219], a[132:135], v[180:183]
  buffer_load_dwordx4 a[80:83], v45, s[16:19], s51 offen offset:0 sc1
  v_mfma_f32_16x16x32_bf16 v[180:183], a[220:223], a[148:151], v[180:183]
  v_mfma_f32_16x16x32_bf16 v[184:187], a[216:219], a[136:139], v[184:187]
  ds_read_b64_tr_b16 a[204:205], v37 offset:8192
  ds_read_b64_tr_b16 a[206:207], v37 offset:12288
  v_mfma_f32_16x16x32_bf16 v[184:187], a[220:223], a[152:155], v[184:187]
  v_mfma_f32_16x16x32_bf16 v[188:191], a[216:219], a[140:143], v[188:191]
  v_mfma_f32_16x16x32_bf16 v[188:191], a[220:223], a[156:159], v[188:191]
  s_waitcnt lgkmcnt(4)
  v_mfma_f32_16x16x32_bf16 v[192:195], a[192:195], a[128:131], v[192:195]
  ds_read_b64_tr_b16 a[208:209], v38 offset:0
  ds_read_b64_tr_b16 a[210:211], v38 offset:4096
  v_mfma_f32_16x16x32_bf16 v[192:195], a[196:199], a[144:147], v[192:195]
  buffer_load_dwordx4 a[84:87], v45, s[16:19], s51 offen offset:1024 sc1
  v_mfma_f32_16x16x32_bf16 v[196:199], a[192:195], a[132:135], v[196:199]
  v_mfma_f32_16x16x32_bf16 v[196:199], a[196:199], a[148:151], v[196:199]
  v_mfma_f32_16x16x32_bf16 v[200:203], a[192:195], a[136:139], v[200:203]
  ds_read_b64_tr_b16 a[212:213], v38 offset:8192
  ds_read_b64_tr_b16 a[214:215], v38 offset:12288
  v_mfma_f32_16x16x32_bf16 v[200:203], a[196:199], a[152:155], v[200:203]
  buffer_load_dwordx4 a[88:91], v45, s[16:19], s51 offen offset:2048 sc1
  v_mfma_f32_16x16x32_bf16 v[204:207], a[192:195], a[140:143], v[204:207]
  v_mfma_f32_16x16x32_bf16 v[204:207], a[196:199], a[156:159], v[204:207]
  s_waitcnt lgkmcnt(4)
  v_mfma_f32_16x16x32_bf16 v[208:211], a[200:203], a[128:131], v[208:211]
  ds_read_b64_tr_b16 a[216:217], v39 offset:0
  ds_read_b64_tr_b16 a[218:219], v39 offset:4096
  v_mfma_f32_16x16x32_bf16 v[208:211], a[204:207], a[144:147], v[208:211]
  v_mfma_f32_16x16x32_bf16 v[212:215], a[200:203], a[132:135], v[212:215]
  buffer_load_dwordx4 a[92:95], v45, s[16:19], s51 offen offset:3072 sc1
  v_mfma_f32_16x16x32_bf16 v[212:215], a[204:207], a[148:151], v[212:215]
  s_add_u32 s51, s51, 262144
  v_mfma_f32_16x16x32_bf16 v[216:219], a[200:203], a[136:139], v[216:219]
  ds_read_b64_tr_b16 a[220:221], v39 offset:8192
  ds_read_b64_tr_b16 a[222:223], v39 offset:12288
  v_mfma_f32_16x16x32_bf16 v[216:219], a[204:207], a[152:155], v[216:219]
  v_mfma_f32_16x16x32_bf16 v[220:223], a[200:203], a[140:143], v[220:223]
  v_mfma_f32_16x16x32_bf16 v[220:223], a[204:207], a[156:159], v[220:223]
  s_waitcnt vmcnt(36) lgkmcnt(4)
  s_barrier
  v_mfma_f32_16x16x32_bf16 v[224:227], a[208:211], a[128:131], v[224:227]
  ds_read_b64_tr_b16 a[192:193], v32 offset:16384
  ds_read_b64_tr_b16 a[194:195], v32 offset:20480
  v_mfma_f32_16x16x32_bf16 v[224:227], a[212:215], a[144:147], v[224:227]
  buffer_load_dwordx4 a[96:99], v44, s[16:19], s51 offen offset:0 sc1
  v_mfma_f32_16x16x32_bf16 v[228:231], a[208:211], a[132:135], v[228:231]
  s_add_u32 m0, s52, 114688
  v_mfma_f32_16x16x32_bf16 v[228:231], a[212:215], a[148:151], v[228:231]
  v_mfma_f32_16x16x32_bf16 v[232:235], a[208:211], a[136:139], v[232:235]
  ds_read_b64_tr_b16 a[196:197], v32 offset:24576
  ds_read_b64_tr_b16 a[198:199], v32 offset:28672
  v_mfma_f32_16x16x32_bf16 v[232:235], a[212:215], a[152:155], v[232:235]
  buffer_load_dwordx4 a[100:103], v44, s[16:19], s51 offen offset:1024 sc1
  v_mfma_f32_16x16x32_bf16 v[236:239], a[208:211], a[140:143], v[236:239]
  v_mfma_f32_16x16x32_bf16 v[236:239], a[212:215], a[156:159], v[236:239]
  s_waitcnt lgkmcnt(4)
  v_mfma_f32_16x16x32_bf16 v[240:243], a[216:219], a[128:131], v[240:243]
  ds_read_b64_tr_b16 a[200:201], v33 offset:16384
  ds_read_b64_tr_b16 a[202:203], v33 offset:20480
  v_mfma_f32_16x16x32_bf16 v[240:243], a[220:223], a[144:147], v[240:243]
  v_mfma_f32_16x16x32_bf16 v[244:247], a[216:219], a[132:135], v[244:247]
  buffer_load_dwordx4 v40, s[12:15], s50 offen offset:0 lds
  v_mfma_f32_16x16x32_bf16 v[244:247], a[220:223], a[148:151], v[244:247]
  v_mfma_f32_16x16x32_bf16 v[248:251], a[216:219], a[136:139], v[248:251]
  ds_read_b64_tr_b16 a[204:205], v33 offset:24576
  ds_read_b64_tr_b16 a[206:207], v33 offset:28672
  v_mfma_f32_16x16x32_bf16 v[248:251], a[220:223], a[152:155], v[248:251]
  v_mfma_f32_16x16x32_bf16 v[252:255], a[216:219], a[140:143], v[252:255]
  v_mfma_f32_16x16x32_bf16 v[252:255], a[220:223], a[156:159], v[252:255]
  s_waitcnt lgkmcnt(4)
  v_mfma_f32_16x16x32_bf16 v[128:131], a[192:195], a[160:163], v[128:131]
  ds_read_b64_tr_b16 a[208:209], v34 offset:16384
  ds_read_b64_tr_b16 a[210:211], v34 offset:20480
  v_mfma_f32_16x16x32_bf16 v[128:131], a[196:199], a[176:179], v[128:131]
  buffer_load_dwordx4 v41, s[12:15], s50 offen offset:1024 lds
  v_mfma_f32_16x16x32_bf16 v[132:135], a[192:195], a[164:167], v[132:135]
  v_mfma_f32_16x16x32_bf16 v[132:135], a[196:199], a[180:183], v[132:135]
  v_mfma_f32_16x16x32_bf16 v[136:139], a[192:195], a[168:171], v[136:139]
  ds_read_b64_tr_b16 a[212:213], v34 offset:24576
  ds_read_b64_tr_b16 a[214:215], v34 offset:28672
  v_mfma_f32_16x16x32_bf16 v[136:139], a[196:199], a[184:187], v[136:139]
  buffer_load_dwordx4 v42, s[12:15], s50 offen offset:2048 lds
  v_mfma_f32_16x16x32_bf16 v[140:143], a[192:195], a[172:175], v[140:143]
  v_mfma_f32_16x16x32_bf16 v[140:143], a[196:199], a[188:191], v[140:143]
  s_waitcnt lgkmcnt(4)
  v_mfma_f32_16x16x32_bf16 v[144:147], a[200:203], a[160:163], v[144:147]
  ds_read_b64_tr_b16 a[216:217], v35 offset:16384
  ds_read_b64_tr_b16 a[218:219], v35 offset:20480
  v_mfma_f32_16x16x32_bf16 v[144:147], a[204:207], a[176:179], v[144:147]
  v_mfma_f32_16x16x32_bf16 v[148:151], a[200:203], a[164:167], v[148:151]
  buffer_load_dwordx4 v43, s[12:15], s50 offen offset:3072 lds
  v_mfma_f32_16x16x32_bf16 v[148:151], a[204:207], a[180:183], v[148:151]
  s_add_u32 s50, s50, 524288
  v_mfma_f32_16x16x32_bf16 v[152:155], a[200:203], a[168:171], v[152:155]
  ds_read_b64_tr_b16 a[220:221], v35 offset:24576
  ds_read_b64_tr_b16 a[222:223], v35 offset:28672
  v_mfma_f32_16x16x32_bf16 v[152:155], a[204:207], a[184:187], v[152:155]
  v_mfma_f32_16x16x32_bf16 v[156:159], a[200:203], a[172:175], v[156:159]
  v_mfma_f32_16x16x32_bf16 v[156:159], a[204:207], a[188:191], v[156:159]
  s_waitcnt lgkmcnt(4)
  v_mfma_f32_16x16x32_bf16 v[160:163], a[208:211], a[160:163], v[160:163]
  ds_read_b64_tr_b16 a[192:193], v36 offset:16384
  ds_read_b64_tr_b16 a[194:195], v36 offset:20480
  v_mfma_f32_16x16x32_bf16 v[160:163], a[212:215], a[176:179], v[160:163]
  buffer_load_dwordx4 a[104:107], v44, s[16:19], s51 offen offset:2048 sc1
  v_mfma_f32_16x16x32_bf16 v[164:167], a[208:211], a[164:167], v[164:167]
  v_mfma_f32_16x16x32_bf16 v[164:167], a[212:215], a[180:183], v[164:167]
  v_mfma_f32_16x16x32_bf16 v[168:171], a[208:211], a[168:171], v[168:171]
  ds_read_b64_tr_b16 a[196:197], v36 offset:24576
  ds_read_b64_tr_b16 a[198:199], v36 offset:28672
  v_mfma_f32_16x16x32_bf16 v[168:171], a[212:215], a[184:187], v[168:171]
  buffer_load_dwordx4 a[108:111], v44, s[16:19], s51 offen offset:3072 sc1
  v_mfma_f32_16x16x32_bf16 v[172:175], a[208:211], a[172:175], v[172:175]
  v_mfma_f32_16x16x32_bf16 v[172:175], a[212:215], a[188:191], v[172:175]
  s_waitcnt lgkmcnt(4)
  v_mfma_f32_16x16x32_bf16 v[176:179], a[216:219], a[160:163], v[176:179]
  ds_read_b64_tr_b16 a[200:201], v37 offset:16384
  ds_read_b64_tr_b16 a[202:203], v37 offset:20480
  v_mfma_f32_16x16x32_bf16 v[176:179], a[220:223], a[176:179], v[176:179]
  v_mfma_f32_16x16x32_bf16 v[180:183], a[216:219], a[164:167], v[180:183]
  buffer_load_dwordx4 a[112:115], v45, s[16:19], s51 offen offset:0 sc1
  v_mfma_f32_16x16x32_bf16 v[180:183], a[220:223], a[180:183], v[180:183]
  v_mfma_f32_16x16x32_bf16 v[184:187], a[216:219], a[168:171], v[184:187]
  ds_read_b64_tr_b16 a[204:205], v37 offset:24576
  ds_read_b64_tr_b16 a[206:207], v37 offset:28672
  v_mfma_f32_16x16x32_bf16 v[184:187], a[220:223], a[184:187], v[184:187]
  v_mfma_f32_16x16x32_bf16 v[188:191], a[216:219], a[172:175], v[188:191]
  v_mfma_f32_16x16x32_bf16 v[188:191], a[220:223], a[188:191], v[188:191]
  s_waitcnt lgkmcnt(4)
  v_mfma_f32_16x16x32_bf16 v[192:195], a[192:195], a[160:163], v[192:195]
  ds_read_b64_tr_b16 a[208:209], v38 offset:16384
  ds_read_b64_tr_b16 a[210:211], v38 offset:20480
  v_mfma_f32_16x16x32_bf16 v[192:195], a[196:199], a[176:179], v[192:195]
  buffer_load_dwordx4 a[116:119], v45, s[16:19], s51 offen offset:1024 sc1
  v_mfma_f32_16x16x32_bf16 v[196:199], a[192:195], a[164:167], v[196:199]
  v_mfma_f32_16x16x32_bf16 v[196:199], a[196:199], a[180:183], v[196:199]
  v_mfma_f32_16x16x32_bf16 v[200:203], a[192:195], a[168:171], v[200:203]
  ds_read_b64_tr_b16 a[212:213], v38 offset:24576
  ds_read_b64_tr_b16 a[214:215], v38 offset:28672
  v_mfma_f32_16x16x32_bf16 v[200:203], a[196:199], a[184:187], v[200:203]
  buffer_load_dwordx4 a[120:123], v45, s[16:19], s51 offen offset:2048 sc1
  v_mfma_f32_16x16x32_bf16 v[204:207], a[192:195], a[172:175], v[204:207]
  v_mfma_f32_16x16x32_bf16 v[204:207], a[196:199], a[188:191], v[204:207]
  s_waitcnt lgkmcnt(4)
  v_mfma_f32_16x16x32_bf16 v[208:211], a[200:203], a[160:163], v[208:211]
  ds_read_b64_tr_b16 a[216:217], v39 offset:16384
  ds_read_b64_tr_b16 a[218:219], v39 offset:20480
  v_mfma_f32_16x16x32_bf16 v[208:211], a[204:207], a[176:179], v[208:211]
  v_mfma_f32_16x16x32_bf16 v[212:215], a[200:203], a[164:167], v[212:215]
  buffer_load_dwordx4 a[124:127], v45, s[16:19], s51 offen offset:3072 sc1
  v_mfma_f32_16x16x32_bf16 v[212:215], a[204:207], a[180:183], v[212:215]
  s_add_u32 s51, s51, 262144
  v_mfma_f32_16x16x32_bf16 v[216:219], a[200:203], a[168:171], v[216:219]
  ds_read_b64_tr_b16 a[220:221], v39 offset:24576
  ds_read_b64_tr_b16 a[222:223], v39 offset:28672
  v_mfma_f32_16x16x32_bf16 v[216:219], a[204:207], a[184:187], v[216:219]
  v_mfma_f32_16x16x32_bf16 v[220:223], a[200:203], a[172:175], v[220:223]
  v_mfma_f32_16x16x32_bf16 v[220:223], a[204:207], a[188:191], v[220:223]
  s_waitcnt vmcnt(36) lgkmcnt(4)
  s_barrier
  v_mfma_f32_16x16x32_bf16 v[224:227], a[208:211], a[160:163], v[224:227]
  ds_read_b64_tr_b16 a[192:193], v12 offset:0
  ds_read_b64_tr_b16 a[194:195], v12 offset:4096
  v_mfma_f32_16x16x32_bf16 v[224:227], a[212:215], a[176:179], v[224:227]
  buffer_load_dwordx4 a[128:131], v44, s[16:19], s51 offen offset:0 sc1
  v_mfma_f32_16x16x32_bf16 v[228:231], a[208:211], a[164:167], v[228:231]
  s_add_u32 m0, s52, 131072
  v_mfma_f32_16x16x32_bf16 v[228:231], a[212:215], a[180:183], v[228:231]
  v_mfma_f32_16x16x32_bf16 v[232:235], a[208:211], a[168:171], v[232:235]
  ds_read_b64_tr_b16 a[196:197], v12 offset:8192
  ds_read_b64_tr_b16 a[198:199], v12 offset:12288
  v_mfma_f32_16x16x32_bf16 v[232:235], a[212:215], a[184:187], v[232:235]
  buffer_load_dwordx4 a[132:135], v44, s[16:19], s51 offen offset:1024 sc1
  v_mfma_f32_16x16x32_bf16 v[236:239], a[208:211], a[172:175], v[236:239]
  v_mfma_f32_16x16x32_bf16 v[236:239], a[212:215], a[188:191], v[236:239]
  s_waitcnt lgkmcnt(4)
  v_mfma_f32_16x16x32_bf16 v[240:243], a[216:219], a[160:163], v[240:243]
  ds_read_b64_tr_b16 a[200:201], v13 offset:0
  ds_read_b64_tr_b16 a[202:203], v13 offset:4096
  v_mfma_f32_16x16x32_bf16 v[240:243], a[220:223], a[176:179], v[240:243]
  v_mfma_f32_16x16x32_bf16 v[244:247], a[216:219], a[164:167], v[244:247]
  buffer_load_dwordx4 v40, s[12:15], s50 offen offset:0 lds
  v_mfma_f32_16x16x32_bf16 v[244:247], a[220:223], a[180:183], v[244:247]
  v_mfma_f32_16x16x32_bf16 v[248:251], a[216:219], a[168:171], v[248:251]
  ds_read_b64_tr_b16 a[204:205], v13 offset:8192
  ds_read_b64_tr_b16 a[206:207], v13 offset:12288
  v_mfma_f32_16x16x32_bf16 v[248:251], a[220:223], a[184:187], v[248:251]
  v_mfma_f32_16x16x32_bf16 v[252:255], a[216:219], a[172:175], v[252:255]
  v_mfma_f32_16x16x32_bf16 v[252:255], a[220:223], a[188:191], v[252:255]
  s_waitcnt lgkmcnt(4)
  v_mfma_f32_16x16x32_bf16 v[128:131], a[192:195], a[0:3], v[128:131]
  ds_read_b64_tr_b16 a[208:209], v14 offset:0
  ds_read_b64_tr_b16 a[210:211], v14 offset:4096
  v_mfma_f32_16x16x32_bf16 v[128:131], a[196:199], a[16:19], v[128:131]
  buffer_load_dwordx4 v41, s[12:15], s50 offen offset:1024 lds
  v_mfma_f32_16x16x32_bf16 v[132:135], a[192:195], a[4:7], v[132:135]
  v_mfma_f32_16x16x32_bf16 v[132:135], a[196:199], a[20:23], v[132:135]
  v_mfma_f32_16x16x32_bf16 v[136:139], a[192:195], a[8:11], v[136:139]
  ds_read_b64_tr_b16 a[212:213], v14 offset:8192
  ds_read_b64_tr_b16 a[214:215], v14 offset:12288
  v_mfma_f32_16x16x32_bf16 v[136:139], a[196:199], a[24:27], v[136:139]
  buffer_load_dwordx4 v42, s[12:15], s50 offen offset:2048 lds
  v_mfma_f32_16x16x32_bf16 v[140:143], a[192:195], a[12:15], v[140:143]
  v_mfma_f32_16x16x32_bf16 v[140:143], a[196:199], a[28:31], v[140:143]
  s_waitcnt lgkmcnt(4)
  v_mfma_f32_16x16x32_bf16 v[144:147], a[200:203], a[0:3], v[144:147]
  ds_read_b64_tr_b16 a[216:217], v15 offset:0
  ds_read_b64_tr_b16 a[218:219], v15 offset:4096
  v_mfma_f32_16x16x32_bf16 v[144:147], a[204:207], a[16:19], v[144:147]
  v_mfma_f32_16x16x32_bf16 v[148:151], a[200:203], a[4:7], v[148:151]
  buffer_load_dwordx4 v43, s[12:15], s50 offen offset:3072 lds
  v_mfma_f32_16x16x32_bf16 v[148:151], a[204:207], a[20:23], v[148:151]
  s_add_u32 s50, s50, 524288
  v_mfma_f32_16x16x32_bf16 v[152:155], a[200:203], a[8:11], v[152:155]
  ds_read_b64_tr_b16 a[220:221], v15 offset:8192
  ds_read_b64_tr_b16 a[222:223], v15 offset:12288
  v_mfma_f32_16x16x32_bf16 v[152:155], a[204:207], a[24:27], v[152:155]
  v_mfma_f32_16x16x32_bf16 v[156:159], a[200:203], a[12:15], v[156:159]
  v_mfma_f32_16x16x32_bf16 v[156:159], a[204:207], a[28:31], v[156:159]
  s_waitcnt lgkmcnt(4)
  v_mfma_f32_16x16x32_bf16 v[160:163], a[208:211], a[0:3], v[160:163]
  ds_read_b64_tr_b16 a[192:193], v16 offset:0
  ds_read_b64_tr_b16 a[194:195], v16 offset:4096
  v_mfma_f32_16x16x32_bf16 v[160:163], a[212:215], a[16:19], v[160:163]
  buffer_load_dwordx4 a[136:139], v44, s[16:19], s51 offen offset:2048 sc1
  v_mfma_f32_16x16x32_bf16 v[164:167], a[208:211], a[4:7], v[164:167]
  v_mfma_f32_16x16x32_bf16 v[164:167], a[212:215], a[20:23], v[164:167]
  v_mfma_f32_16x16x32_bf16 v[168:171], a[208:211], a[8:11], v[168:171]
  ds_read_b64_tr_b16 a[196:197], v16 offset:8192
  ds_read_b64_tr_b16 a[198:199], v16 offset:12288
  v_mfma_f32_16x16x32_bf16 v[168:171], a[212:215], a[24:27], v[168:171]
  buffer_load_dwordx4 a[140:143], v44, s[16:19], s51 offen offset:3072 sc1
  v_mfma_f32_16x16x32_bf16 v[172:175], a[208:211], a[12:15], v[172:175]
  v_mfma_f32_16x16x32_bf16 v[172:175], a[212:215], a[28:31], v[172:175]
  s_waitcnt lgkmcnt(4)
  v_mfma_f32_16x16x32_bf16 v[176:179], a[216:219], a[0:3], v[176:179]
  ds_read_b64_tr_b16 a[200:201], v17 offset:0
  ds_read_b64_tr_b16 a[202:203], v17 offset:4096
  v_mfma_f32_16x16x32_bf16 v[176:179], a[220:223], a[16:19], v[176:179]
  v_mfma_f32_16x16x32_bf16 v[180:183], a[216:219], a[4:7], v[180:183]
  buffer_load_dwordx4 a[144:147], v45, s[16:19], s51 offen offset:0 sc1
  v_mfma_f32_16x16x32_bf16 v[180:183], a[220:223], a[20:23], v[180:183]
  v_mfma_f32_16x16x32_bf16 v[184:187], a[216:219], a[8:11], v[184:187]
  ds_read_b64_tr_b16 a[204:205], v17 offset:8192
  ds_read_b64_tr_b16 a[206:207], v17 offset:12288
  v_mfma_f32_16x16x32_bf16 v[184:187], a[220:223], a[24:27], v[184:187]
  v_mfma_f32_16x16x32_bf16 v[188:191], a[216:219], a[12:15], v[188:191]
  v_mfma_f32_16x16x32_bf16 v[188:191], a[220:223], a[28:31], v[188:191]
  s_waitcnt lgkmcnt(4)
  v_mfma_f32_16x16x32_bf16 v[192:195], a[192:195], a[0:3], v[192:195]
  ds_read_b64_tr_b16 a[208:209], v18 offset:0
  ds_read_b64_tr_b16 a[210:211], v18 offset:4096
  v_mfma_f32_16x16x32_bf16 v[192:195], a[196:199], a[16:19], v[192:195]
  buffer_load_dwordx4 a[148:151], v45, s[16:19], s51 offen offset:1024 sc1
  v_mfma_f32_16x16x32_bf16 v[196:199], a[192:195], a[4:7], v[196:199]
  v_mfma_f32_16x16x32_bf16 v[196:199], a[196:199], a[20:23], v[196:199]
  v_mfma_f32_16x16x32_bf16 v[200:203], a[192:195], a[8:11], v[200:203]
  ds_read_b64_tr_b16 a[212:213], v18 offset:8192
  ds_read_b64_tr_b16 a[214:215], v18 offset:12288
  v_mfma_f32_16x16x32_bf16 v[200:203], a[196:199], a[24:27], v[200:203]
  buffer_load_dwordx4 a[152:155], v45, s[16:19], s51 offen offset:2048 sc1
  v_mfma_f32_16x16x32_bf16 v[204:207], a[192:195], a[12:15], v[204:207]
  v_mfma_f32_16x16x32_bf16 v[204:207], a[196:199], a[28:31], v[204:207]
  s_waitcnt lgkmcnt(4)
  v_mfma_f32_16x16x32_bf16 v[208:211], a[200:203], a[0:3], v[208:211]
  ds_read_b64_tr_b16 a[216:217], v19 offset:0
  ds_read_b64_tr_b16 a[218:219], v19 offset:4096
  v_mfma_f32_16x16x32_bf16 v[208:211], a[204:207], a[16:19], v[208:211]
  v_mfma_f32_16x16x32_bf16 v[212:215], a[200:203], a[4:7], v[212:215]
  buffer_load_dwordx4 a[156:159], v45, s[16:19], s51 offen offset:3072 sc1
  v_mfma_f32_16x16x32_bf16 v[212:215], a[204:207], a[20:23], v[212:215]
  s_add_u32 s51, s51, 262144
  v_mfma_f32_16x16x32_bf16 v[216:219], a[200:203], a[8:11], v[216:219]
  ds_read_b64_tr_b16 a[220:221], v19 offset:8192
  ds_read_b64_tr_b16 a[222:223], v19 offset:12288
  v_mfma_f32_16x16x32_bf16 v[216:219], a[204:207], a[24:27], v[216:219]
  v_mfma_f32_16x16x32_bf16 v[220:223], a[200:203], a[12:15], v[220:223]
  v_mfma_f32_16x16x32_bf16 v[220:223], a[204:207], a[28:31], v[220:223]
  s_waitcnt vmcnt(36) lgkmcnt(4)
  s_barrier
  v_mfma_f32_16x16x32_bf16 v[224:227], a[208:211], a[0:3], v[224:227]
  ds_read_b64_tr_b16 a[192:193], v12 offset:16384
  ds_read_b64_tr_b16 a[194:195], v12 offset:20480
  v_mfma_f32_16x16x32_bf16 v[224:227], a[212:215], a[16:19], v[224:227]
  buffer_load_dwordx4 a[160:163], v44, s[16:19], s51 offen offset:0 sc1
  v_mfma_f32_16x16x32_bf16 v[228:231], a[208:211], a[4:7], v[228:231]
  s_add_u32 m0, s52, 147456
  v_mfma_f32_16x16x32_bf16 v[228:231], a[212:215], a[20:23], v[228:231]
  buffer_load_dwordx4 a[164:167], v44, s[16:19], s51 offen offset:1024 sc1
  v_mfma_f32_16x16x32_bf16 v[232:235], a[208:211], a[8:11], v[232:235]
  ds_read_b64_tr_b16 a[196:197], v12 offset:24576
  ds_read_b64_tr_b16 a[198:199], v12 offset:28672
  v_mfma_f32_16x16x32_bf16 v[232:235], a[212:215], a[24:27], v[232:235]
  v_mfma_f32_16x16x32_bf16 v[236:239], a[208:211], a[12:15], v[236:239]
  v_mfma_f32_16x16x32_bf16 v[236:239], a[212:215], a[28:31], v[236:239]
  s_waitcnt lgkmcnt(4)
  v_mfma_f32_16x16x32_bf16 v[240:243], a[216:219], a[0:3], v[240:243]
  ds_read_b64_tr_b16 a[200:201], v13 offset:16384
  ds_read_b64_tr_b16 a[202:203], v13 offset:20480
  v_mfma_f32_16x16x32_bf16 v[240:243], a[220:223], a[16:19], v[240:243]
  buffer_load_dwordx4 v40, s[12:15], s50 offen offset:0 lds
  v_mfma_f32_16x16x32_bf16 v[244:247], a[216:219], a[4:7], v[244:247]
  v_mfma_f32_16x16x32_bf16 v[244:247], a[220:223], a[20:23], v[244:247]
  v_mfma_f32_16x16x32_bf16 v[248:251], a[216:219], a[8:11], v[248:251]
  ds_read_b64_tr_b16 a[204:205], v13 offset:24576
  ds_read_b64_tr_b16 a[206:207], v13 offset:28672
  v_mfma_f32_16x16x32_bf16 v[248:251], a[220:223], a[24:27], v[248:251]
  buffer_load_dwordx4 v41, s[12:15], s50 offen offset:1024 lds
  v_mfma_f32_16x16x32_bf16 v[252:255], a[216:219], a[12:15], v[252:255]
  v_mfma_f32_16x16x32_bf16 v[252:255], a[220:223], a[28:31], v[252:255]
  s_waitcnt lgkmcnt(4)
  v_mfma_f32_16x16x32_bf16 v[128:131], a[192:195], a[32:35], v[128:131]
  ds_read_b64_tr_b16 a[208:209], v14 offset:16384
  ds_read_b64_tr_b16 a[210:211], v14 offset:20480
  v_mfma_f32_16x16x32_bf16 v[128:131], a[196:199], a[48:51], v[128:131]
  v_mfma_f32_16x16x32_bf16 v[132:135], a[192:195], a[36:39], v[132:135]
  buffer_load_dwordx4 v42, s[12:15], s50 offen offset:2048 lds
  v_mfma_f32_16x16x32_bf16 v[132:135], a[196:199], a[52:55], v[132:135]
  v_mfma_f32_16x16x32_bf16 v[136:139], a[192:195], a[40:43], v[136:139]
  ds_read_b64_tr_b16 a[212:213], v14 offset:24576
  ds_read_b64_tr_b16 a[214:215], v14 offset:28672
  v_mfma_f32_16x16x32_bf16 v[136:139], a[196:199], a[56:59], v[136:139]
  v_mfma_f32_16x16x32_bf16 v[140:143], a[192:195], a[44:47], v[140:143]
  buffer_load_dwordx4 v43, s[12:15], s50 offen offset:3072 lds
  v_mfma_f32_16x16x32_bf16 v[140:143], a[196:199], a[60:63], v[140:143]
  s_add_u32 s50, s50, 524288
  s_waitcnt lgkmcnt(4)
  v_mfma_f32_16x16x32_bf16 v[144:147], a[200:203], a[32:35], v[144:147]
  ds_read_b64_tr_b16 a[216:217], v15 offset:16384
  ds_read_b64_tr_b16 a[218:219], v15 offset:20480
  v_mfma_f32_16x16x32_bf16 v[144:147], a[204:207], a[48:51], v[144:147]
  v_mfma_f32_16x16x32_bf16 v[148:151], a[200:203], a[36:39], v[148:151]
  v_mfma_f32_16x16x32_bf16 v[148:151], a[204:207], a[52:55], v[148:151]
  buffer_load_dwordx4 a[168:171], v44, s[16:19], s51 offen offset:2048 sc1
  v_mfma_f32_16x16x32_bf16 v[152:155], a[200:203], a[40:43], v[152:155]
  ds_read_b64_tr_b16 a[220:221], v15 offset:24576
  ds_read_b64_tr_b16 a[222:223], v15 offset:28672
  v_mfma_f32_16x16x32_bf16 v[152:155], a[204:207], a[56:59], v[152:155]
  v_mfma_f32_16x16x32_bf16 v[156:159], a[200:203], a[44:47], v[156:159]
  v_mfma_f32_16x16x32_bf16 v[156:159], a[204:207], a[60:63], v[156:159]
  s_waitcnt lgkmcnt(4)
  v_mfma_f32_16x16x32_bf16 v[160:163], a[208:211], a[32:35], v[160:163]
  ds_read_b64_tr_b16 a[192:193], v16 offset:16384
  ds_read_b64_tr_b16 a[194:195], v16 offset:20480
  v_mfma_f32_16x16x32_bf16 v[160:163], a[212:215], a[48:51], v[160:163]
  buffer_load_dwordx4 a[172:175], v44, s[16:19], s51 offen offset:3072 sc1
  v_mfma_f32_16x16x32_bf16 v[164:167], a[208:211], a[36:39], v[164:167]
  v_mfma_f32_16x16x32_bf16 v[164:167], a[212:215], a[52:55], v[164:167]
  buffer_load_dwordx4 a[176:179], v45, s[16:19], s51 offen offset:0 sc1
  v_mfma_f32_16x16x32_bf16 v[168:171], a[208:211], a[40:43], v[168:171]
  ds_read_b64_tr_b16 a[196:197], v16 offset:24576
  ds_read_b64_tr_b16 a[198:199], v16 offset:28672
  v_mfma_f32_16x16x32_bf16 v[168:171], a[212:215], a[56:59], v[168:171]
  v_mfma_f32_16x16x32_bf16 v[172:175], a[208:211], a[44:47], v[172:175]
  v_mfma_f32_16x16x32_bf16 v[172:175], a[212:215], a[60:63], v[172:175]
  s_waitcnt lgkmcnt(4)
  v_mfma_f32_16x16x32_bf16 v[176:179], a[216:219], a[32:35], v[176:179]
  ds_read_b64_tr_b16 a[200:201], v17 offset:16384
  ds_read_b64_tr_b16 a[202:203], v17 offset:20480
  v_mfma_f32_16x16x32_bf16 v[176:179], a[220:223], a[48:51], v[176:179]
  buffer_load_dwordx4 a[180:183], v45, s[16:19], s51 offen offset:1024 sc1
  v_mfma_f32_16x16x32_bf16 v[180:183], a[216:219], a[36:39], v[180:183]
  v_mfma_f32_16x16x32_bf16 v[180:183], a[220:223], a[52:55], v[180:183]
  v_mfma_f32_16x16x32_bf16 v[184:187], a[216:219], a[40:43], v[184:187]
  ds_read_b64_tr_b16 a[204:205], v17 offset:24576
  ds_read_b64_tr_b16 a[206:207], v17 offset:28672
  v_mfma_f32_16x16x32_bf16 v[184:187], a[220:223], a[56:59], v[184:187]
  buffer_load_dwordx4 a[184:187], v45, s[16:19], s51 offen offset:2048 sc1
  v_mfma_f32_16x16x32_bf16 v[188:191], a[216:219], a[44:47], v[188:191]
  v_mfma_f32_16x16x32_bf16 v[188:191], a[220:223], a[60:63], v[188:191]
  s_waitcnt lgkmcnt(4)
  v_mfma_f32_16x16x32_bf16 v[192:195], a[192:195], a[32:35], v[192:195]
  ds_read_b64_tr_b16 a[208:209], v18 offset:16384
  ds_read_b64_tr_b16 a[210:211], v18 offset:20480
  v_mfma_f32_16x16x32_bf16 v[192:195], a[196:199], a[48:51], v[192:195]
  v_mfma_f32_16x16x32_bf16 v[196:199], a[192:195], a[36:39], v[196:199]
  buffer_load_dwordx4 a[188:191], v45, s[16:19], s51 offen offset:3072 sc1
  v_mfma_f32_16x16x32_bf16 v[196:199], a[196:199], a[52:55], v[196:199]
  s_add_u32 s51, s51, 262144
  v_mfma_f32_16x16x32_bf16 v[200:203], a[192:195], a[40:43], v[200:203]
  ds_read_b64_tr_b16 a[212:213], v18 offset:24576
  ds_read_b64_tr_b16 a[214:215], v18 offset:28672
  v_mfma_f32_16x16x32_bf16 v[200:203], a[196:199], a[56:59], v[200:203]
  v_mfma_f32_16x16x32_bf16 v[204:207], a[192:195], a[44:47], v[204:207]
  buffer_load_dwordx4 v[28:31], v4, s[64:67], s76 offen
  v_mfma_f32_16x16x32_bf16 v[204:207], a[196:199], a[60:63], v[204:207]
  s_waitcnt lgkmcnt(4)
  v_mfma_f32_16x16x32_bf16 v[208:211], a[200:203], a[32:35], v[208:211]
  ds_read_b64_tr_b16 a[216:217], v19 offset:16384
  ds_read_b64_tr_b16 a[218:219], v19 offset:20480
  v_mfma_f32_16x16x32_bf16 v[208:211], a[204:207], a[48:51], v[208:211]
  v_mfma_f32_16x16x32_bf16 v[212:215], a[200:203], a[36:39], v[212:215]
  v_mfma_f32_16x16x32_bf16 v[212:215], a[204:207], a[52:55], v[212:215]
  buffer_load_dword v27, v5, s[68:71], s77 offen
  v_mfma_f32_16x16x32_bf16 v[216:219], a[200:203], a[40:43], v[216:219]
  ds_read_b64_tr_b16 a[220:221], v19 offset:24576
  ds_read_b64_tr_b16 a[222:223], v19 offset:28672
  v_mfma_f32_16x16x32_bf16 v[216:219], a[204:207], a[56:59], v[216:219]
  s_add_u32 s76, s76, 98304
  s_add_u32 s77, s77, 32
  v_mfma_f32_16x16x32_bf16 v[220:223], a[200:203], a[44:47], v[220:223]
  v_mfma_f32_16x16x32_bf16 v[220:223], a[204:207], a[60:63], v[220:223]
  s_waitcnt vmcnt(38) lgkmcnt(4)
  s_barrier
  v_mfma_f32_16x16x32_bf16 v[224:227], a[208:211], a[32:35], v[224:227]
  ds_read_b64_tr_b16 a[192:193], v12 offset:32768
  ds_read_b64_tr_b16 a[194:195], v12 offset:36864
  v_mfma_f32_16x16x32_bf16 v[224:227], a[212:215], a[48:51], v[224:227]
  s_add_u32 m0, s52, 0
  s_nop 0
  v_mfma_f32_16x16x32_bf16 v[228:231], a[208:211], a[36:39], v[228:231]
  buffer_load_dwordx4 v20, s[20:23], s53 offen offset:0 lds
  v_mfma_f32_16x16x32_bf16 v[228:231], a[212:215], a[52:55], v[228:231]
  v_mfma_f32_16x16x32_bf16 v[232:235], a[208:211], a[40:43], v[232:235]
  ds_read_b64_tr_b16 a[196:197], v12 offset:40960
  ds_read_b64_tr_b16 a[198:199], v12 offset:45056
  v_mfma_f32_16x16x32_bf16 v[232:235], a[212:215], a[56:59], v[232:235]
  buffer_load_dwordx4 v21, s[20:23], s53 offen offset:1024 lds
  v_mfma_f32_16x16x32_bf16 v[236:239], a[208:211], a[44:47], v[236:239]
  v_mfma_f32_16x16x32_bf16 v[236:239], a[212:215], a[60:63], v[236:239]
  s_waitcnt lgkmcnt(4)
  v_mfma_f32_16x16x32_bf16 v[240:243], a[216:219], a[32:35], v[240:243]
  ds_read_b64_tr_b16 a[200:201], v13 offset:32768
  ds_read_b64_tr_b16 a[202:203], v13 offset:36864
  v_mfma_f32_16x16x32_bf16 v[240:243], a[220:223], a[48:51], v[240:243]
  v_mfma_f32_16x16x32_bf16 v[244:247], a[216:219], a[36:39], v[244:247]
  buffer_load_dwordx4 v22, s[20:23], s53 offen offset:2048 lds
  v_mfma_f32_16x16x32_bf16 v[244:247], a[220:223], a[52:55], v[244:247]
  v_mfma_f32_16x16x32_bf16 v[248:251], a[216:219], a[40:43], v[248:251]
  ds_read_b64_tr_b16 a[204:205], v13 offset:40960
  ds_read_b64_tr_b16 a[206:207], v13 offset:45056
  v_mfma_f32_16x16x32_bf16 v[248:251], a[220:223], a[56:59], v[248:251]
  v_mfma_f32_16x16x32_bf16 v[252:255], a[216:219], a[44:47], v[252:255]
  v_mfma_f32_16x16x32_bf16 v[252:255], a[220:223], a[60:63], v[252:255]
  s_waitcnt lgkmcnt(4)
  v_mfma_f32_16x16x32_bf16 v[128:131], a[192:195], a[64:67], v[128:131]
  ds_read_b64_tr_b16 a[208:209], v14 offset:32768
  ds_read_b64_tr_b16 a[210:211], v14 offset:36864
  v_mfma_f32_16x16x32_bf16 v[128:131], a[196:199], a[80:83], v[128:131]
  buffer_load_dwordx4 v23, s[20:23], s53 offen offset:3072 lds
  v_mfma_f32_16x16x32_bf16 v[132:135], a[192:195], a[68:71], v[132:135]
  s_add_u32 s53, s53, 16384
  s_add_u32 m0, s52, 16384
  v_mfma_f32_16x16x32_bf16 v[132:135], a[196:199], a[84:87], v[132:135]
  s_nop 0
  v_mfma_f32_16x16x32_bf16 v[136:139], a[192:195], a[72:75], v[136:139]
  ds_read_b64_tr_b16 a[212:213], v14 offset:40960
  ds_read_b64_tr_b16 a[214:215], v14 offset:45056
  v_mfma_f32_16x16x32_bf16 v[136:139], a[196:199], a[88:91], v[136:139]
  buffer_load_dwordx4 v20, s[20:23], s53 offen offset:0 lds
  v_mfma_f32_16x16x32_bf16 v[140:143], a[192:195], a[76:79], v[140:143]
  v_mfma_f32_16x16x32_bf16 v[140:143], a[196:199], a[92:95], v[140:143]
  s_waitcnt lgkmcnt(4)
  v_mfma_f32_16x16x32_bf16 v[144:147], a[200:203], a[64:67], v[144:147]
  ds_read_b64_tr_b16 a[216:217], v15 offset:32768
  ds_read_b64_tr_b16 a[218:219], v15 offset:36864
  v_mfma_f32_16x16x32_bf16 v[144:147], a[204:207], a[80:83], v[144:147]
  v_mfma_f32_16x16x32_bf16 v[148:151], a[200:203], a[68:71], v[148:151]
  buffer_load_dwordx4 v21, s[20:23], s53 offen offset:1024 lds
  v_mfma_f32_16x16x32_bf16 v[148:151], a[204:207], a[84:87], v[148:151]
  v_mfma_f32_16x16x32_bf16 v[152:155], a[200:203], a[72:75], v[152:155]
  ds_read_b64_tr_b16 a[220:221], v15 offset:40960
  ds_read_b64_tr_b16 a[222:223], v15 offset:45056
  v_mfma_f32_16x16x32_bf16 v[152:155], a[204:207], a[88:91], v[152:155]
  v_mfma_f32_16x16x32_bf16 v[156:159], a[200:203], a[76:79], v[156:159]
  v_mfma_f32_16x16x32_bf16 v[156:159], a[204:207], a[92:95], v[156:159]
  s_waitcnt lgkmcnt(4)
  v_mfma_f32_16x16x32_bf16 v[160:163], a[208:211], a[64:67], v[160:163]
  ds_read_b64_tr_b16 a[192:193], v16 offset:32768
  ds_read_b64_tr_b16 a[194:195], v16 offset:36864
  v_mfma_f32_16x16x32_bf16 v[160:163], a[212:215], a[80:83], v[160:163]
  buffer_load_dwordx4 v22, s[20:23], s53 offen offset:2048 lds
  v_mfma_f32_16x16x32_bf16 v[164:167], a[208:211], a[68:71], v[164:167]
  v_mfma_f32_16x16x32_bf16 v[164:167], a[212:215], a[84:87], v[164:167]
  v_mfma_f32_16x16x32_bf16 v[168:171], a[208:211], a[72:75], v[168:171]
  ds_read_b64_tr_b16 a[196:197], v16 offset:40960
  ds_read_b64_tr_b16 a[198:199], v16 offset:45056
  v_mfma_f32_16x16x32_bf16 v[168:171], a[212:215], a[88:91], v[168:171]
  buffer_load_dwordx4 v23, s[20:23], s53 offen offset:3072 lds
  v_mfma_f32_16x16x32_bf16 v[172:175], a[208:211], a[76:79], v[172:175]
  s_add_u32 s53, s53, 16384
  s_add_u32 m0, s52, 65536
  v_mfma_f32_16x16x32_bf16 v[172:175], a[212:215], a[92:95], v[172:175]
  s_nop 0
  s_waitcnt lgkmcnt(4)
  v_mfma_f32_16x16x32_bf16 v[176:179], a[216:219], a[64:67], v[176:179]
  ds_read_b64_tr_b16 a[200:201], v17 offset:32768
  ds_read_b64_tr_b16 a[202:203], v17 offset:36864
  v_mfma_f32_16x16x32_bf16 v[176:179], a[220:223], a[80:83], v[176:179]
  v_mfma_f32_16x16x32_bf16 v[180:183], a[216:219], a[68:71], v[180:183]
  buffer_load_dwordx4 v24, s[24:27], s54 offen offset:0 lds
  v_mfma_f32_16x16x32_bf16 v[180:183], a[220:223], a[84:87], v[180:183]
  v_mfma_f32_16x16x32_bf16 v[184:187], a[216:219], a[72:75], v[184:187]
  ds_read_b64_tr_b16 a[204:205], v17 offset:40960
  ds_read_b64_tr_b16 a[206:207], v17 offset:45056
  v_mfma_f32_16x16x32_bf16 v[184:187], a[220:223], a[88:91], v[184:187]
  v_mfma_f32_16x16x32_bf16 v[188:191], a[216:219], a[76:79], v[188:191]
  v_mfma_f32_16x16x32_bf16 v[188:191], a[220:223], a[92:95], v[188:191]
  s_waitcnt lgkmcnt(4)
  v_mfma_f32_16x16x32_bf16 v[192:195], a[192:195], a[64:67], v[192:195]
  ds_read_b64_tr_b16 a[208:209], v18 offset:32768
  ds_read_b64_tr_b16 a[210:211], v18 offset:36864
  v_mfma_f32_16x16x32_bf16 v[192:195], a[196:199], a[80:83], v[192:195]
  buffer_load_dwordx4 v25, s[24:27], s54 offen offset:1024 lds
  v_mfma_f32_16x16x32_bf16 v[196:199], a[192:195], a[68:71], v[196:199]
  v_mfma_f32_16x16x32_bf16 v[196:199], a[196:199], a[84:87], v[196:199]
  v_mfma_f32_16x16x32_bf16 v[200:203], a[192:195], a[72:75], v[200:203]
  ds_read_b64_tr_b16 a[212:213], v18 offset:40960
  ds_read_b64_tr_b16 a[214:215], v18 offset:45056
  v_mfma_f32_16x16x32_bf16 v[200:203], a[196:199], a[88:91], v[200:203]
  buffer_load_dwordx4 v24, s[24:27], s54 offen offset:2048 lds
  v_mfma_f32_16x16x32_bf16 v[204:207], a[192:195], a[76:79], v[204:207]
  v_mfma_f32_16x16x32_bf16 v[204:207], a[196:199], a[92:95], v[204:207]
  s_waitcnt lgkmcnt(4)
  v_mfma_f32_16x16x32_bf16 v[208:211], a[200:203], a[64:67], v[208:211]
  ds_read_b64_tr_b16 a[216:217], v19 offset:32768
  ds_read_b64_tr_b16 a[218:219], v19 offset:36864
  v_mfma_f32_16x16x32_bf16 v[208:211], a[204:207], a[80:83], v[208:211]
  v_mfma_f32_16x16x32_bf16 v[212:215], a[200:203], a[68:71], v[212:215]
  buffer_load_dwordx4 v25, s[24:27], s54 offen offset:3072 lds
  v_mfma_f32_16x16x32_bf16 v[212:215], a[204:207], a[84:87], v[212:215]
  s_add_u32 s54, s54, 16384
  v_accvgpr_write_b32 a0, 0
  v_mfma_f32_16x16x32_bf16 v[216:219], a[200:203], a[72:75], v[216:219]
  ds_read_b64_tr_b16 a[220:221], v19 offset:40960
  ds_read_b64_tr_b16 a[222:223], v19 offset:45056
  v_mfma_f32_16x16x32_bf16 v[216:219], a[204:207], a[88:91], v[216:219]
  v_accvgpr_write_b32 a1, 0
  v_accvgpr_write_b32 a2, 0
  v_mfma_f32_16x16x32_bf16 v[220:223], a[200:203], a[76:79], v[220:223]
  v_accvgpr_write_b32 a3, 0
  v_accvgpr_write_b32 a4, 0
  v_mfma_f32_16x16x32_bf16 v[220:223], a[204:207], a[92:95], v[220:223]
  v_accvgpr_write_b32 a5, 0
  v_accvgpr_write_b32 a6, 0
  v_accvgpr_write_b32 a7, 0
  v_accvgpr_write_b32 a8, 0
  v_accvgpr_write_b32 a9, 0
  v_accvgpr_write_b32 a10, 0
  v_accvgpr_write_b32 a11, 0
  v_accvgpr_write_b32 a12, 0
  v_accvgpr_write_b32 a13, 0
  v_accvgpr_write_b32 a14, 0
  v_accvgpr_write_b32 a15, 0
  v_accvgpr_write_b32 a16, 0
  v_accvgpr_write_b32 a17, 0
  v_accvgpr_write_b32 a18, 0
  v_accvgpr_write_b32 a19, 0
  v_accvgpr_write_b32 a20, 0
  v_accvgpr_write_b32 a21, 0
  v_accvgpr_write_b32 a22, 0
  v_accvgpr_write_b32 a23, 0
  v_accvgpr_write_b32 a24, 0
  v_accvgpr_write_b32 a25, 0
  v_accvgpr_write_b32 a26, 0
  v_accvgpr_write_b32 a27, 0
  v_accvgpr_write_b32 a28, 0
  v_accvgpr_write_b32 a29, 0
  v_accvgpr_write_b32 a30, 0
  v_accvgpr_write_b32 a31, 0
  s_waitcnt vmcnt(38) lgkmcnt(4)
  s_barrier
  v_mfma_f32_16x16x32_bf16 v[224:227], a[208:211], a[64:67], v[224:227]
  ds_read_b64_tr_b16 a[192:193], v12 offset:49152
  ds_read_b64_tr_b16 a[194:195], v12 offset:53248
  v_mfma_f32_16x16x32_bf16 v[224:227], a[212:215], a[80:83], v[224:227]
  s_add_u32 m0, s52, 32768
  s_nop 0
  v_mfma_f32_16x16x32_bf16 v[228:231], a[208:211], a[68:71], v[228:231]
  buffer_load_dwordx4 v20, s[20:23], s53 offen offset:0 lds
  v_mfma_f32_16x16x32_bf16 v[228:231], a[212:215], a[84:87], v[228:231]
  v_mfma_f32_16x16x32_bf16 v[232:235], a[208:211], a[72:75], v[232:235]
  ds_read_b64_tr_b16 a[196:197], v12 offset:57344
  ds_read_b64_tr_b16 a[198:199], v12 offset:61440
  v_mfma_f32_16x16x32_bf16 v[232:235], a[212:215], a[88:91], v[232:235]
  buffer_load_dwordx4 v21, s[20:23], s53 offen offset:1024 lds
  v_mfma_f32_16x16x32_bf16 v[236:239], a[208:211], a[76:79], v[236:239]
  v_mfma_f32_16x16x32_bf16 v[236:239], a[212:215], a[92:95], v[236:239]
  s_waitcnt lgkmcnt(4)
  v_mfma_f32_16x16x32_bf16 v[240:243], a[216:219], a[64:67], v[240:243]
  ds_read_b64_tr_b16 a[200:201], v13 offset:49152
  ds_read_b64_tr_b16 a[202:203], v13 offset:53248
  v_mfma_f32_16x16x32_bf16 v[240:243], a[220:223], a[80:83], v[240:243]
  v_mfma_f32_16x16x32_bf16 v[244:247], a[216:219], a[68:71], v[244:247]
  v_mfma_f32_16x16x32_bf16 v[244:247], a[220:223], a[84:87], v[244:247]
  buffer_load_dwordx4 v22, s[20:23], s53 offen offset:2048 lds
  v_mfma_f32_16x16x32_bf16 v[248:251], a[216:219], a[72:75], v[248:251]
  ds_read_b64_tr_b16 a[204:205], v13 offset:57344
  ds_read_b64_tr_b16 a[206:207], v13 offset:61440
  v_mfma_f32_16x16x32_bf16 v[248:251], a[220:223], a[88:91], v[248:251]
  v_mfma_f32_16x16x32_bf16 v[252:255], a[216:219], a[76:79], v[252:255]
  v_mfma_f32_16x16x32_bf16 v[252:255], a[220:223], a[92:95], v[252:255]
  s_waitcnt lgkmcnt(4)
  v_mfma_f32_16x16x32_bf16 v[128:131], a[192:195], a[96:99], v[128:131]
  ds_read_b64_tr_b16 a[208:209], v14 offset:49152
  ds_read_b64_tr_b16 a[210:211], v14 offset:53248
  v_mfma_f32_16x16x32_bf16 v[128:131], a[196:199], a[112:115], v[128:131]
  buffer_load_dwordx4 v23, s[20:23], s53 offen offset:3072 lds
  v_mfma_f32_16x16x32_bf16 v[132:135], a[192:195], a[100:103], v[132:135]
  s_add_u32 s53, s53, 16384
  s_add_u32 m0, s52, 81920
  v_mfma_f32_16x16x32_bf16 v[132:135], a[196:199], a[116:119], v[132:135]
  s_nop 0
  v_mfma_f32_16x16x32_bf16 v[136:139], a[192:195], a[104:107], v[136:139]
  ds_read_b64_tr_b16 a[212:213], v14 offset:57344
  ds_read_b64_tr_b16 a[214:215], v14 offset:61440
  v_mfma_f32_16x16x32_bf16 v[136:139], a[196:199], a[120:123], v[136:139]
  v_mfma_f32_16x16x32_bf16 v[140:143], a[192:195], a[108:111], v[140:143]
  buffer_load_dwordx4 v24, s[24:27], s54 offen offset:0 lds
  v_mfma_f32_16x16x32_bf16 v[140:143], a[196:199], a[124:127], v[140:143]
  s_waitcnt lgkmcnt(4)
  v_mfma_f32_16x16x32_bf16 v[144:147], a[200:203], a[96:99], v[144:147]
  ds_read_b64_tr_b16 a[216:217], v15 offset:49152
  ds_read_b64_tr_b16 a[218:219], v15 offset:53248
  v_mfma_f32_16x16x32_bf16 v[144:147], a[204:207], a[112:115], v[144:147]
  v_mfma_f32_16x16x32_bf16 v[148:151], a[200:203], a[100:103], v[148:151]
  v_mfma_f32_16x16x32_bf16 v[148:151], a[204:207], a[116:119], v[148:151]
  v_mfma_f32_16x16x32_bf16 v[152:155], a[200:203], a[104:107], v[152:155]
  ds_read_b64_tr_b16 a[220:221], v15 offset:57344
  ds_read_b64_tr_b16 a[222:223], v15 offset:61440
  v_mfma_f32_16x16x32_bf16 v[152:155], a[204:207], a[120:123], v[152:155]
  buffer_load_dwordx4 v25, s[24:27], s54 offen offset:1024 lds
  v_mfma_f32_16x16x32_bf16 v[156:159], a[200:203], a[108:111], v[156:159]
  v_mfma_f32_16x16x32_bf16 v[156:159], a[204:207], a[124:127], v[156:159]
  s_waitcnt lgkmcnt(4)
  v_mfma_f32_16x16x32_bf16 v[160:163], a[208:211], a[96:99], v[160:163]
  ds_read_b64_tr_b16 a[192:193], v16 offset:49152
  ds_read_b64_tr_b16 a[194:195], v16 offset:53248
  v_mfma_f32_16x16x32_bf16 v[160:163], a[212:215], a[112:115], v[160:163]
  v_mfma_f32_16x16x32_bf16 v[164:167], a[208:211], a[100:103], v[164:167]
  buffer_load_dwordx4 v24, s[24:27], s54 offen offset:2048 lds
  v_mfma_f32_16x16x32_bf16 v[164:167], a[212:215], a[116:119], v[164:167]
  v_mfma_f32_16x16x32_bf16 v[168:171], a[208:211], a[104:107], v[168:171]
  ds_read_b64_tr_b16 a[196:197], v16 offset:57344
  ds_read_b64_tr_b16 a[198:199], v16 offset:61440
  v_mfma_f32_16x16x32_bf16 v[168:171], a[212:215], a[120:123], v[168:171]
  v_mfma_f32_16x16x32_bf16 v[172:175], a[208:211], a[108:111], v[172:175]
  v_mfma_f32_16x16x32_bf16 v[172:175], a[212:215], a[124:127], v[172:175]
  s_waitcnt lgkmcnt(4)
  v_mfma_f32_16x16x32_bf16 v[176:179], a[216:219], a[96:99], v[176:179]
  ds_read_b64_tr_b16 a[200:201], v17 offset:49152
  ds_read_b64_tr_b16 a[202:203], v17 offset:53248
  v_mfma_f32_16x16x32_bf16 v[176:179], a[220:223], a[112:115], v[176:179]
  buffer_load_dwordx4 v25, s[24:27], s54 offen offset:3072 lds
  v_mfma_f32_16x16x32_bf16 v[180:183], a[216:219], a[100:103], v[180:183]
  s_add_u32 s54, s54, 16384
  v_mfma_f32_16x16x32_bf16 v[180:183], a[220:223], a[116:119], v[180:183]
  v_mfma_f32_16x16x32_bf16 v[184:187], a[216:219], a[104:107], v[184:187]
  ds_read_b64_tr_b16 a[204:205], v17 offset:57344
  ds_read_b64_tr_b16 a[206:207], v17 offset:61440
  v_mfma_f32_16x16x32_bf16 v[184:187], a[220:223], a[120:123], v[184:187]
  v_mfma_f32_16x16x32_bf16 v[188:191], a[216:219], a[108:111], v[188:191]
  buffer_store_dwordx4 v[68:71], v7, s[72:75], s41 offen sc1
  v_mfma_f32_16x16x32_bf16 v[188:191], a[220:223], a[124:127], v[188:191]
  s_add_u32 s41, s41, 0x100000
  s_waitcnt lgkmcnt(4)
  v_mfma_f32_16x16x32_bf16 v[192:195], a[192:195], a[96:99], v[192:195]
  ds_read_b64_tr_b16 a[208:209], v18 offset:49152
  ds_read_b64_tr_b16 a[210:211], v18 offset:53248
  v_mfma_f32_16x16x32_bf16 v[192:195], a[196:199], a[112:115], v[192:195]
  v_mfma_f32_16x16x32_bf16 v[196:199], a[192:195], a[100:103], v[196:199]
  v_mfma_f32_16x16x32_bf16 v[196:199], a[196:199], a[116:119], v[196:199]
  buffer_store_dwordx4 v[68:71], v7, s[72:75], s41 offen sc1
  v_mfma_f32_16x16x32_bf16 v[200:203], a[192:195], a[104:107], v[200:203]
  ds_read_b64_tr_b16 a[212:213], v18 offset:57344
  ds_read_b64_tr_b16 a[214:215], v18 offset:61440
  v_mfma_f32_16x16x32_bf16 v[200:203], a[196:199], a[120:123], v[200:203]
  s_add_u32 s41, s41, 0x100000
  v_mfma_f32_16x16x32_bf16 v[204:207], a[192:195], a[108:111], v[204:207]
  v_mfma_f32_16x16x32_bf16 v[204:207], a[196:199], a[124:127], v[204:207]
  s_waitcnt lgkmcnt(4)
  v_mfma_f32_16x16x32_bf16 v[208:211], a[200:203], a[96:99], v[208:211]
  ds_read_b64_tr_b16 a[216:217], v19 offset:49152
  ds_read_b64_tr_b16 a[218:219], v19 offset:53248
  v_mfma_f32_16x16x32_bf16 v[208:211], a[204:207], a[112:115], v[208:211]
  v_mfma_f32_16x16x32_bf16 v[212:215], a[200:203], a[100:103], v[212:215]
  buffer_store_dwordx4 v[68:71], v7, s[72:75], s41 offen sc1
  v_mfma_f32_16x16x32_bf16 v[212:215], a[204:207], a[116:119], v[212:215]
  s_add_u32 s41, s41, 0x100000
  v_accvgpr_write_b32 a32, 0
  v_mfma_f32_16x16x32_bf16 v[216:219], a[200:203], a[104:107], v[216:219]
  ds_read_b64_tr_b16 a[220:221], v19 offset:57344
  ds_read_b64_tr_b16 a[222:223], v19 offset:61440
  v_mfma_f32_16x16x32_bf16 v[216:219], a[204:207], a[120:123], v[216:219]
  v_accvgpr_write_b32 a33, 0
  v_accvgpr_write_b32 a34, 0
  v_mfma_f32_16x16x32_bf16 v[220:223], a[200:203], a[108:111], v[220:223]
  v_accvgpr_write_b32 a35, 0
  v_accvgpr_write_b32 a36, 0
  v_mfma_f32_16x16x32_bf16 v[220:223], a[204:207], a[124:127], v[220:223]
  v_accvgpr_write_b32 a37, 0
  v_accvgpr_write_b32 a38, 0
  v_accvgpr_write_b32 a39, 0
  v_accvgpr_write_b32 a40, 0
  v_accvgpr_write_b32 a41, 0
  v_accvgpr_write_b32 a42, 0
  v_accvgpr_write_b32 a43, 0
  v_accvgpr_write_b32 a44, 0
  v_accvgpr_write_b32 a45, 0
  v_accvgpr_write_b32 a46, 0
  v_accvgpr_write_b32 a47, 0
  v_accvgpr_write_b32 a48, 0
  v_accvgpr_write_b32 a49, 0
  v_accvgpr_write_b32 a50, 0
  v_accvgpr_write_b32 a51, 0
  v_accvgpr_write_b32 a52, 0
  v_accvgpr_write_b32 a53, 0
  v_accvgpr_write_b32 a54, 0
  v_accvgpr_write_b32 a55, 0
  v_accvgpr_write_b32 a56, 0
  v_accvgpr_write_b32 a57, 0
  v_accvgpr_write_b32 a58, 0
  v_accvgpr_write_b32 a59, 0
  v_accvgpr_write_b32 a60, 0
  v_accvgpr_write_b32 a61, 0
  v_accvgpr_write_b32 a62, 0
  v_accvgpr_write_b32 a63, 0
  s_waitcnt vmcnt(37) lgkmcnt(4)
  s_barrier
  v_mfma_f32_16x16x32_bf16 v[224:227], a[208:211], a[96:99], v[224:227]
  ds_read_b64_tr_b16 a[192:193], v32 offset:0
  ds_read_b64_tr_b16 a[194:195], v32 offset:4096
  v_mfma_f32_16x16x32_bf16 v[224:227], a[212:215], a[112:115], v[224:227]
  s_add_u32 m0, s52, 49152
  s_nop 0
  v_mfma_f32_16x16x32_bf16 v[228:231], a[208:211], a[100:103], v[228:231]
  buffer_load_dwordx4 v20, s[20:23], s53 offen offset:0 lds
  v_mfma_f32_16x16x32_bf16 v[228:231], a[212:215], a[116:119], v[228:231]
  v_mfma_f32_16x16x32_bf16 v[232:235], a[208:211], a[104:107], v[232:235]
  ds_read_b64_tr_b16 a[196:197], v32 offset:8192
  ds_read_b64_tr_b16 a[198:199], v32 offset:12288
  v_mfma_f32_16x16x32_bf16 v[232:235], a[212:215], a[120:123], v[232:235]
  v_mfma_f32_16x16x32_bf16 v[236:239], a[208:211], a[108:111], v[236:239]
  buffer_load_dwordx4 v21, s[20:23], s53 offen offset:1024 lds
  v_mfma_f32_16x16x32_bf16 v[236:239], a[212:215], a[124:127], v[236:239]
  s_waitcnt lgkmcnt(4)
  v_mfma_f32_16x16x32_bf16 v[240:243], a[216:219], a[96:99], v[240:243]
  ds_read_b64_tr_b16 a[200:201], v33 offset:0
  ds_read_b64_tr_b16 a[202:203], v33 offset:4096
  v_mfma_f32_16x16x32_bf16 v[240:243], a[220:223], a[112:115], v[240:243]
  v_mfma_f32_16x16x32_bf16 v[244:247], a[216:219], a[100:103], v[244:247]
  v_mfma_f32_16x16x32_bf16 v[244:247], a[220:223], a[116:119], v[244:247]
  v_mfma_f32_16x16x32_bf16 v[248:251], a[216:219], a[104:107], v[248:251]
  ds_read_b64_tr_b16 a[204:205], v33 offset:8192
  ds_read_b64_tr_b16 a[206:207], v33 offset:12288
  v_mfma_f32_16x16x32_bf16 v[248:251], a[220:223], a[120:123], v[248:251]
  buffer_load_dwordx4 v22, s[20:23], s53 offen offset:2048 lds
  v_mfma_f32_16x16x32_bf16 v[252:255], a[216:219], a[108:111], v[252:255]
  v_mfma_f32_16x16x32_bf16 v[252:255], a[220:223], a[124:127], v[252:255]
  s_waitcnt lgkmcnt(4)
  v_mfma_f32_16x16x32_bf16 v[128:131], a[192:195], a[128:131], v[128:131]
  ds_read_b64_tr_b16 a[208:209], v34 offset:0
  ds_read_b64_tr_b16 a[210:211], v34 offset:4096
  v_mfma_f32_16x16x32_bf16 v[128:131], a[196:199], a[144:147], v[128:131]
  v_mfma_f32_16x16x32_bf16 v[132:135], a[192:195], a[132:135], v[132:135]
  v_mfma_f32_16x16x32_bf16 v[132:135], a[196:199], a[148:151], v[132:135]
  v_mfma_f32_16x16x32_bf16 v[136:139], a[192:195], a[136:139], v[136:139]
  ds_read_b64_tr_b16 a[212:213], v34 offset:8192
  ds_read_b64_tr_b16 a[214:215], v34 offset:12288
  v_mfma_f32_16x16x32_bf16 v[136:139], a[196:199], a[152:155], v[136:139]
  buffer_load_dwordx4 v23, s[20:23], s53 offen offset:3072 lds
  v_mfma_f32_16x16x32_bf16 v[140:143], a[192:195], a[140:143], v[140:143]
  s_add_u32 s53, s53, 16384
  s_add_u32 m0, s52, 98304
  v_mfma_f32_16x16x32_bf16 v[140:143], a[196:199], a[156:159], v[140:143]
  s_nop 0
  s_waitcnt lgkmcnt(4)
  v_mfma_f32_16x16x32_bf16 v[144:147], a[200:203], a[128:131], v[144:147]
  ds_read_b64_tr_b16 a[216:217], v35 offset:0
  ds_read_b64_tr_b16 a[218:219], v35 offset:4096
  v_mfma_f32_16x16x32_bf16 v[144:147], a[204:207], a[144:147], v[144:147]
  v_mfma_f32_16x16x32_bf16 v[148:151], a[200:203], a[132:135], v[148:151]
  v_mfma_f32_16x16x32_bf16 v[148:151], a[204:207], a[148:151], v[148:151]
  buffer_load_dwordx4 v24, s[24:27], s54 offen offset:0 lds
  v_mfma_f32_16x16x32_bf16 v[152:155], a[200:203], a[136:139], v[152:155]
  ds_read_b64_tr_b16 a[220:221], v35 offset:8192
  ds_read_b64_tr_b16 a[222:223], v35 offset:12288
  v_mfma_f32_16x16x32_bf16 v[152:155], a[204:207], a[152:155], v[152:155]
  v_mfma_f32_16x16x32_bf16 v[156:159], a[200:203], a[140:143], v[156:159]
  v_mfma_f32_16x16x32_bf16 v[156:159], a[204:207], a[156:159], v[156:159]
  s_waitcnt lgkmcnt(4)
  v_mfma_f32_16x16x32_bf16 v[160:163], a[208:211], a[128:131], v[160:163]
  ds_read_b64_tr_b16 a[192:193], v36 offset:0
  ds_read_b64_tr_b16 a[194:195], v36 offset:4096
  v_mfma_f32_16x16x32_bf16 v[160:163], a[212:215], a[144:147], v[160:163]
  v_mfma_f32_16x16x32_bf16 v[164:167], a[208:211], a[132:135], v[164:167]
  v_mfma_f32_16x16x32_bf16 v[164:167], a[212:215], a[148:151], v[164:167]
  buffer_load_dwordx4 v25, s[24:27], s54 offen offset:1024 lds
  v_mfma_f32_16x16x32_bf16 v[168:171], a[208:211], a[136:139], v[168:171]
  ds_read_b64_tr_b16 a[196:197], v36 offset:8192
  ds_read_b64_tr_b16 a[198:199], v36 offset:12288
  v_mfma_f32_16x16x32_bf16 v[168:171], a[212:215], a[152:155], v[168:171]
  v_mfma_f32_16x16x32_bf16 v[172:175], a[208:211], a[140:143], v[172:175]
  v_mfma_f32_16x16x32_bf16 v[172:175], a[212:215], a[156:159], v[172:175]
  s_waitcnt lgkmcnt(4)
  v_mfma_f32_16x16x32_bf16 v[176:179], a[216:219], a[128:131], v[176:179]
  ds_read_b64_tr_b16 a[200:201], v37 offset:0
  ds_read_b64_tr_b16 a[202:203], v37 offset:4096
  v_mfma_f32_16x16x32_bf16 v[176:179], a[220:223], a[144:147], v[176:179]
  v_mfma_f32_16x16x32_bf16 v[180:183], a[216:219], a[132:135], v[180:183]
  buffer_load_dwordx4 v24, s[24:27], s54 offen offset:2048 lds
  v_mfma_f32_16x16x32_bf16 v[180:183], a[220:223], a[148:151], v[180:183]
  v_mfma_f32_16x16x32_bf16 v[184:187], a[216:219], a[136:139], v[184:187]
  ds_read_b64_tr_b16 a[204:205], v37 offset:8192
  ds_read_b64_tr_b16 a[206:207], v37 offset:12288
  v_mfma_f32_16x16x32_bf16 v[184:187], a[220:223], a[152:155], v[184:187]
  v_mfma_f32_16x16x32_bf16 v[188:191], a[216:219], a[140:143], v[188:191]
  v_mfma_f32_16x16x32_bf16 v[188:191], a[220:223], a[156:159], v[188:191]
  s_waitcnt lgkmcnt(4)
  v_mfma_f32_16x16x32_bf16 v[192:195], a[192:195], a[128:131], v[192:195]
  ds_read_b64_tr_b16 a[208:209], v38 offset:0
  ds_read_b64_tr_b16 a[210:211], v38 offset:4096
  v_mfma_f32_16x16x32_bf16 v[192:195], a[196:199], a[144:147], v[192:195]
  v_mfma_f32_16x16x32_bf16 v[196:199], a[192:195], a[132:135], v[196:199]
  buffer_load_dwordx4 v25, s[24:27], s54 offen offset:3072 lds
  v_mfma_f32_16x16x32_bf16 v[196:199], a[196:199], a[148:151], v[196:199]
  s_add_u32 s54, s54, 16384
  v_mfma_f32_16x16x32_bf16 v[200:203], a[192:195], a[136:139], v[200:203]
  ds_read_b64_tr_b16 a[212:213], v38 offset:8192
  ds_read_b64_tr_b16 a[214:215], v38 offset:12288
  v_mfma_f32_16x16x32_bf16 v[200:203], a[196:199], a[152:155], v[200:203]
  v_mfma_f32_16x16x32_bf16 v[204:207], a[192:195], a[140:143], v[204:207]
  v_mfma_f32_16x16x32_bf16 v[204:207], a[196:199], a[156:159], v[204:207]
  s_waitcnt lgkmcnt(4)
  v_mfma_f32_16x16x32_bf16 v[208:211], a[200:203], a[128:131], v[208:211]
  ds_read_b64_tr_b16 a[216:217], v39 offset:0
  ds_read_b64_tr_b16 a[218:219], v39 offset:4096
  v_mfma_f32_16x16x32_bf16 v[208:211], a[204:207], a[144:147], v[208:211]
  buffer_store_dwordx4 v[68:71], v7, s[72:75], s41 offen sc1
  v_mfma_f32_16x16x32_bf16 v[212:215], a[200:203], a[132:135], v[212:215]
  s_add_u32 s41, s41, 0x100000
  v_accvgpr_write_b32 a64, 0
  v_mfma_f32_16x16x32_bf16 v[212:215], a[204:207], a[148:151], v[212:215]
  v_accvgpr_write_b32 a65, 0
  v_accvgpr_write_b32 a66, 0
  v_mfma_f32_16x16x32_bf16 v[216:219], a[200:203], a[136:139], v[216:219]
  ds_read_b64_tr_b16 a[220:221], v39 offset:8192
  ds_read_b64_tr_b16 a[222:223], v39 offset:12288
  v_mfma_f32_16x16x32_bf16 v[216:219], a[204:207], a[152:155], v[216:219]
  v_accvgpr_write_b32 a67, 0
  v_accvgpr_write_b32 a68, 0
  v_mfma_f32_16x16x32_bf16 v[220:223], a[200:203], a[140:143], v[220:223]
  v_accvgpr_write_b32 a69, 0
  v_accvgpr_write_b32 a70, 0
  v_mfma_f32_16x16x32_bf16 v[220:223], a[204:207], a[156:159], v[220:223]
  v_accvgpr_write_b32 a71, 0
  v_accvgpr_write_b32 a72, 0
  v_accvgpr_write_b32 a73, 0
  v_accvgpr_write_b32 a74, 0
  v_accvgpr_write_b32 a75, 0
  v_accvgpr_write_b32 a76, 0
  v_accvgpr_write_b32 a77, 0
  v_accvgpr_write_b32 a78, 0
  v_accvgpr_write_b32 a79, 0
  v_accvgpr_write_b32 a80, 0
  v_accvgpr_write_b32 a81, 0
  v_accvgpr_write_b32 a82, 0
  v_accvgpr_write_b32 a83, 0
  v_accvgpr_write_b32 a84, 0
  v_accvgpr_write_b32 a85, 0
  v_accvgpr_write_b32 a86, 0
  v_accvgpr_write_b32 a87, 0
  v_accvgpr_write_b32 a88, 0
  v_accvgpr_write_b32 a89, 0
  v_accvgpr_write_b32 a90, 0
  v_accvgpr_write_b32 a91, 0
  v_accvgpr_write_b32 a92, 0
  v_accvgpr_write_b32 a93, 0
  v_accvgpr_write_b32 a94, 0
  v_accvgpr_write_b32 a95, 0
  s_waitcnt vmcnt(34) lgkmcnt(4)
  s_barrier
  v_mfma_f32_16x16x32_bf16 v[224:227], a[208:211], a[128:131], v[224:227]
  ds_read_b64_tr_b16 a[192:193], v32 offset:16384
  ds_read_b64_tr_b16 a[194:195], v32 offset:20480
  v_mfma_f32_16x16x32_bf16 v[224:227], a[212:215], a[144:147], v[224:227]
  v_accvgpr_write_b32 a96, 0
  v_mfma_f32_16x16x32_bf16 v[228:231], a[208:211], a[132:135], v[228:231]
  v_accvgpr_write_b32 a97, 0
  v_mfma_f32_16x16x32_bf16 v[228:231], a[212:215], a[148:151], v[228:231]
  v_mfma_f32_16x16x32_bf16 v[232:235], a[208:211], a[136:139], v[232:235]
  ds_read_b64_tr_b16 a[196:197], v32 offset:24576
  ds_read_b64_tr_b16 a[198:199], v32 offset:28672
  v_mfma_f32_16x16x32_bf16 v[232:235], a[212:215], a[152:155], v[232:235]
  v_accvgpr_write_b32 a98, 0
  v_mfma_f32_16x16x32_bf16 v[236:239], a[208:211], a[140:143], v[236:239]
  v_accvgpr_write_b32 a99, 0
  v_mfma_f32_16x16x32_bf16 v[236:239], a[212:215], a[156:159], v[236:239]
  s_waitcnt lgkmcnt(4)
  v_mfma_f32_16x16x32_bf16 v[240:243], a[216:219], a[128:131], v[240:243]
  ds_read_b64_tr_b16 a[200:201], v33 offset:16384
  ds_read_b64_tr_b16 a[202:203], v33 offset:20480
  v_mfma_f32_16x16x32_bf16 v[240:243], a[220:223], a[144:147], v[240:243]
  v_accvgpr_write_b32 a100, 0
  v_mfma_f32_16x16x32_bf16 v[244:247], a[216:219], a[132:135], v[244:247]
  v_accvgpr_write_b32 a101, 0
  v_mfma_f32_16x16x32_bf16 v[244:247], a[220:223], a[148:151], v[244:247]
  v_mfma_f32_16x16x32_bf16 v[248:251], a[216:219], a[136:139], v[248:251]
  ds_read_b64_tr_b16 a[204:205], v33 offset:24576
  ds_read_b64_tr_b16 a[206:207], v33 offset:28672
  v_mfma_f32_16x16x32_bf16 v[248:251], a[220:223], a[152:155], v[248:251]
  v_accvgpr_write_b32 a102, 0
  v_mfma_f32_16x16x32_bf16 v[252:255], a[216:219], a[140:143], v[252:255]
  v_accvgpr_write_b32 a103, 0
  v_mfma_f32_16x16x32_bf16 v[252:255], a[220:223], a[156:159], v[252:255]
  s_waitcnt lgkmcnt(4)
  v_mfma_f32_16x16x32_bf16 v[128:131], a[192:195], a[160:163], v[128:131]
  ds_read_b64_tr_b16 a[208:209], v34 offset:16384
  ds_read_b64_tr_b16 a[210:211], v34 offset:20480
  v_mfma_f32_16x16x32_bf16 v[128:131], a[196:199], a[176:179], v[128:131]
  v_accvgpr_write_b32 a104, 0
  v_mfma_f32_16x16x32_bf16 v[132:135], a[192:195], a[164:167], v[132:135]
  v_accvgpr_write_b32 a105, 0
  v_mfma_f32_16x16x32_bf16 v[132:135], a[196:199], a[180:183], v[132:135]
  v_mfma_f32_16x16x32_bf16 v[136:139], a[192:195], a[168:171], v[136:139]
  ds_read_b64_tr_b16 a[212:213], v34 offset:24576
  ds_read_b64_tr_b16 a[214:215], v34 offset:28672
  v_mfma_f32_16x16x32_bf16 v[136:139], a[196:199], a[184:187], v[136:139]
  v_accvgpr_write_b32 a106, 0
  v_mfma_f32_16x16x32_bf16 v[140:143], a[192:195], a[172:175], v[140:143]
  v_accvgpr_write_b32 a107, 0
  v_mfma_f32_16x16x32_bf16 v[140:143], a[196:199], a[188:191], v[140:143]
  s_waitcnt lgkmcnt(4)
  v_mfma_f32_16x16x32_bf16 v[144:147], a[200:203], a[160:163], v[144:147]
  ds_read_b64_tr_b16 a[216:217], v35 offset:16384
  ds_read_b64_tr_b16 a[218:219], v35 offset:20480
  v_mfma_f32_16x16x32_bf16 v[144:147], a[204:207], a[176:179], v[144:147]
  v_accvgpr_write_b32 a108, 0
  v_mfma_f32_16x16x32_bf16 v[148:151], a[200:203], a[164:167], v[148:151]
  v_accvgpr_write_b32 a109, 0
  v_mfma_f32_16x16x32_bf16 v[148:151], a[204:207], a[180:183], v[148:151]
  v_mfma_f32_16x16x32_bf16 v[152:155], a[200:203], a[168:171], v[152:155]
  ds_read_b64_tr_b16 a[220:221], v35 offset:24576
  ds_read_b64_tr_b16 a[222:223], v35 offset:28672
  v_mfma_f32_16x16x32_bf16 v[152:155], a[204:207], a[184:187], v[152:155]
  v_accvgpr_write_b32 a110, 0
  v_mfma_f32_16x16x32_bf16 v[156:159], a[200:203], a[172:175], v[156:159]
  v_accvgpr_write_b32 a111, 0
  v_mfma_f32_16x16x32_bf16 v[156:159], a[204:207], a[188:191], v[156:159]
  s_waitcnt lgkmcnt(4)
  v_mfma_f32_16x16x32_bf16 v[160:163], a[208:211], a[160:163], v[160:163]
  ds_read_b64_tr_b16 a[192:193], v36 offset:16384
  ds_read_b64_tr_b16 a[194:195], v36 offset:20480
  v_mfma_f32_16x16x32_bf16 v[160:163], a[212:215], a[176:179], v[160:163]
  v_accvgpr_write_b32 a112, 0
  v_mfma_f32_16x16x32_bf16 v[164:167], a[208:211], a[164:167], v[164:167]
  v_accvgpr_write_b32 a113, 0
  v_mfma_f32_16x16x32_bf16 v[164:167], a[212:215], a[180:183], v[164:167]
  v_mfma_f32_16x16x32_bf16 v[168:171], a[208:211], a[168:171], v[168:171]
  ds_read_b64_tr_b16 a[196:197], v36 offset:24576
  ds_read_b64_tr_b16 a[198:199], v36 offset:28672
  v_mfma_f32_16x16x32_bf16 v[168:171], a[212:215], a[184:187], v[168:171]
  v_accvgpr_write_b32 a114, 0
  v_mfma_f32_16x16x32_bf16 v[172:175], a[208:211], a[172:175], v[172:175]
  v_accvgpr_write_b32 a115, 0
  v_mfma_f32_16x16x32_bf16 v[172:175], a[212:215], a[188:191], v[172:175]
  s_waitcnt lgkmcnt(4)
  v_mfma_f32_16x16x32_bf16 v[176:179], a[216:219], a[160:163], v[176:179]
  ds_read_b64_tr_b16 a[200:201], v37 offset:16384
  ds_read_b64_tr_b16 a[202:203], v37 offset:20480
  v_mfma_f32_16x16x32_bf16 v[176:179], a[220:223], a[176:179], v[176:179]
  v_accvgpr_write_b32 a116, 0
  v_mfma_f32_16x16x32_bf16 v[180:183], a[216:219], a[164:167], v[180:183]
  v_accvgpr_write_b32 a117, 0
  v_mfma_f32_16x16x32_bf16 v[180:183], a[220:223], a[180:183], v[180:183]
  v_mfma_f32_16x16x32_bf16 v[184:187], a[216:219], a[168:171], v[184:187]
  ds_read_b64_tr_b16 a[204:205], v37 offset:24576
  ds_read_b64_tr_b16 a[206:207], v37 offset:28672
  v_mfma_f32_16x16x32_bf16 v[184:187], a[220:223], a[184:187], v[184:187]
  v_accvgpr_write_b32 a118, 0
  v_mfma_f32_16x16x32_bf16 v[188:191], a[216:219], a[172:175], v[188:191]
  v_accvgpr_write_b32 a119, 0
  v_mfma_f32_16x16x32_bf16 v[188:191], a[220:223], a[188:191], v[188:191]
  s_waitcnt lgkmcnt(4)
  v_mfma_f32_16x16x32_bf16 v[192:195], a[192:195], a[160:163], v[192:195]
  ds_read_b64_tr_b16 a[208:209], v38 offset:16384
  ds_read_b64_tr_b16 a[210:211], v38 offset:20480
  v_mfma_f32_16x16x32_bf16 v[192:195], a[196:199], a[176:179], v[192:195]
  v_accvgpr_write_b32 a120, 0
  v_mfma_f32_16x16x32_bf16 v[196:199], a[192:195], a[164:167], v[196:199]
  v_accvgpr_write_b32 a121, 0
  v_mfma_f32_16x16x32_bf16 v[196:199], a[196:199], a[180:183], v[196:199]
  v_mfma_f32_16x16x32_bf16 v[200:203], a[192:195], a[168:171], v[200:203]
  ds_read_b64_tr_b16 a[212:213], v38 offset:24576
  ds_read_b64_tr_b16 a[214:215], v38 offset:28672
  v_mfma_f32_16x16x32_bf16 v[200:203], a[196:199], a[184:187], v[200:203]
  v_accvgpr_write_b32 a122, 0
  v_mfma_f32_16x16x32_bf16 v[204:207], a[192:195], a[172:175], v[204:207]
  v_accvgpr_write_b32 a123, 0
  v_mfma_f32_16x16x32_bf16 v[204:207], a[196:199], a[188:191], v[204:207]
  s_waitcnt lgkmcnt(4)
  v_mfma_f32_16x16x32_bf16 v[208:211], a[200:203], a[160:163], v[208:211]
  ds_read_b64_tr_b16 a[216:217], v39 offset:16384
  ds_read_b64_tr_b16 a[218:219], v39 offset:20480
  v_mfma_f32_16x16x32_bf16 v[208:211], a[204:207], a[176:179], v[208:211]
  v_accvgpr_write_b32 a124, 0
  v_mfma_f32_16x16x32_bf16 v[212:215], a[200:203], a[164:167], v[212:215]
  v_accvgpr_write_b32 a125, 0
  v_mfma_f32_16x16x32_bf16 v[212:215], a[204:207], a[180:183], v[212:215]
  v_mfma_f32_16x16x32_bf16 v[216:219], a[200:203], a[168:171], v[216:219]
  ds_read_b64_tr_b16 a[220:221], v39 offset:24576
  ds_read_b64_tr_b16 a[222:223], v39 offset:28672
  v_mfma_f32_16x16x32_bf16 v[216:219], a[204:207], a[184:187], v[216:219]
  v_accvgpr_write_b32 a126, 0
  v_mfma_f32_16x16x32_bf16 v[220:223], a[200:203], a[172:175], v[220:223]
  v_accvgpr_write_b32 a127, 0
  v_mfma_f32_16x16x32_bf16 v[220:223], a[204:207], a[188:191], v[220:223]
  s_waitcnt lgkmcnt(4)
  v_mfma_f32_16x16x32_bf16 v[224:227], a[208:211], a[160:163], v[224:227]
  v_mfma_f32_16x16x32_bf16 v[224:227], a[212:215], a[176:179], v[224:227]
  v_mfma_f32_16x16x32_bf16 v[228:231], a[208:211], a[164:167], v[228:231]
  v_mfma_f32_16x16x32_bf16 v[228:231], a[212:215], a[180:183], v[228:231]
  v_mfma_f32_16x16x32_bf16 v[232:235], a[208:211], a[168:171], v[232:235]
  v_mfma_f32_16x16x32_bf16 v[232:235], a[212:215], a[184:187], v[232:235]
  v_mfma_f32_16x16x32_bf16 v[236:239], a[208:211], a[172:175], v[236:239]
  v_mfma_f32_16x16x32_bf16 v[236:239], a[212:215], a[188:191], v[236:239]
  s_waitcnt lgkmcnt(0)
  v_mfma_f32_16x16x32_bf16 v[240:243], a[216:219], a[160:163], v[240:243]
  v_mfma_f32_16x16x32_bf16 v[240:243], a[220:223], a[176:179], v[240:243]
  v_mfma_f32_16x16x32_bf16 v[244:247], a[216:219], a[164:167], v[244:247]
  v_mfma_f32_16x16x32_bf16 v[244:247], a[220:223], a[180:183], v[244:247]
  v_mfma_f32_16x16x32_bf16 v[248:251], a[216:219], a[168:171], v[248:251]
  v_mfma_f32_16x16x32_bf16 v[248:251], a[220:223], a[184:187], v[248:251]
  v_mfma_f32_16x16x32_bf16 v[252:255], a[216:219], a[172:175], v[252:255]
  v_mfma_f32_16x16x32_bf16 v[252:255], a[220:223], a[188:191], v[252:255]
  s_waitcnt vmcnt(20)
  s_barrier
  ds_read_b128 a[128:131], v8 offset:0
  ds_read_b128 a[132:135], v9 offset:0
  ds_read_b128 a[136:139], v10 offset:0
  ds_read_b128 a[140:143], v11 offset:0
  ds_read_b128 a[144:147], v8 offset:4096
  ds_read_b128 a[148:151], v9 offset:4096
  ds_read_b128 a[152:155], v10 offset:4096
  ds_read_b128 a[156:159], v11 offset:4096
  v_mov_b32 v46, 0x3e0293ee
  v_mov_b32 v47, 0x3e0293ee
  v_pk_mul_f32 v[128:129], v[128:129], v[46:47]
  v_pk_mul_f32 v[130:131], v[130:131], v[46:47]
  v_cvt_pk_bf16_f32 v64, v128, v129
  v_cvt_pk_bf16_f32 v65, v130, v131
  v_pk_mul_f32 v[144:145], v[144:145], v[46:47]
  v_pk_mul_f32 v[146:147], v[146:147], v[46:47]
  v_cvt_pk_bf16_f32 v66, v144, v145
  v_cvt_pk_bf16_f32 v67, v146, v147
  v_pk_mul_f32 v[132:133], v[132:133], v[46:47]
  v_pk_mul_f32 v[134:135], v[134:135], v[46:47]
  v_cvt_pk_bf16_f32 v80, v132, v133
  v_cvt_pk_bf16_f32 v81, v134, v135
  v_pk_mul_f32 v[148:149], v[148:149], v[46:47]
  v_pk_mul_f32 v[150:151], v[150:151], v[46:47]
  v_cvt_pk_bf16_f32 v82, v148, v149
  v_cvt_pk_bf16_f32 v83, v150, v151
  v_pk_mul_f32 v[136:137], v[136:137], v[46:47]
  v_pk_mul_f32 v[138:139], v[138:139], v[46:47]
  v_cvt_pk_bf16_f32 v96, v136, v137
  v_cvt_pk_bf16_f32 v97, v138, v139
  v_pk_mul_f32 v[152:153], v[152:153], v[46:47]
  v_pk_mul_f32 v[154:155], v[154:155], v[46:47]
  v_cvt_pk_bf16_f32 v98, v152, v153
  v_cvt_pk_bf16_f32 v99, v154, v155
  v_pk_mul_f32 v[140:141], v[140:141], v[46:47]
  v_pk_mul_f32 v[142:143], v[142:143], v[46:47]
  v_cvt_pk_bf16_f32 v112, v140, v141
  v_cvt_pk_bf16_f32 v113, v142, v143
  v_pk_mul_f32 v[156:157], v[156:157], v[46:47]
  v_pk_mul_f32 v[158:159], v[158:159], v[46:47]
  v_cvt_pk_bf16_f32 v114, v156, v157
  v_cvt_pk_bf16_f32 v115, v158, v159
  v_permlane32_swap_b32 v64, v66
  v_permlane32_swap_b32 v65, v67
  v_permlane32_swap_b32 v80, v82
  v_permlane32_swap_b32 v81, v83
  v_permlane32_swap_b32 v96, v98
  v_permlane32_swap_b32 v97, v99
  v_permlane32_swap_b32 v112, v114
  v_permlane32_swap_b32 v113, v115
  v_permlane16_swap_b32 v64, v66
  v_permlane16_swap_b32 v65, v67
  v_permlane16_swap_b32 v80, v82
  v_permlane16_swap_b32 v81, v83
  v_permlane16_swap_b32 v96, v98
  v_permlane16_swap_b32 v97, v99
  v_permlane16_swap_b32 v112, v114
  v_permlane16_swap_b32 v113, v115
  v_pk_mul_f32 v[160:161], v[160:161], v[46:47]
  v_pk_mul_f32 v[162:163], v[162:163], v[46:47]
  v_cvt_pk_bf16_f32 v68, v160, v161
  v_cvt_pk_bf16_f32 v69, v162, v163
  v_pk_mul_f32 v[176:177], v[176:177], v[46:47]
  v_pk_mul_f32 v[178:179], v[178:179], v[46:47]
  v_cvt_pk_bf16_f32 v70, v176, v177
  v_cvt_pk_bf16_f32 v71, v178, v179
  v_pk_mul_f32 v[164:165], v[164:165], v[46:47]
  v_pk_mul_f32 v[166:167], v[166:167], v[46:47]
  v_cvt_pk_bf16_f32 v84, v164, v165
  v_cvt_pk_bf16_f32 v85, v166, v167
  v_pk_mul_f32 v[180:181], v[180:181], v[46:47]
  v_pk_mul_f32 v[182:183], v[182:183], v[46:47]
  v_cvt_pk_bf16_f32 v86, v180, v181
  v_cvt_pk_bf16_f32 v87, v182, v183
  v_pk_mul_f32 v[168:169], v[168:169], v[46:47]
  v_pk_mul_f32 v[170:171], v[170:171], v[46:47]
  v_cvt_pk_bf16_f32 v100, v168, v169
  v_cvt_pk_bf16_f32 v101, v170, v171
  v_pk_mul_f32 v[184:185], v[184:185], v[46:47]
  v_pk_mul_f32 v[186:187], v[186:187], v[46:47]
  v_cvt_pk_bf16_f32 v102, v184, v185
  v_cvt_pk_bf16_f32 v103, v186, v187
  v_pk_mul_f32 v[172:173], v[172:173], v[46:47]
  v_pk_mul_f32 v[174:175], v[174:175], v[46:47]
  v_cvt_pk_bf16_f32 v116, v172, v173
  v_cvt_pk_bf16_f32 v117, v174, v175
  v_pk_mul_f32 v[188:189], v[188:189], v[46:47]
  v_pk_mul_f32 v[190:191], v[190:191], v[46:47]
  v_cvt_pk_bf16_f32 v118, v188, v189
  v_cvt_pk_bf16_f32 v119, v190, v191
  v_permlane32_swap_b32 v68, v70
  v_permlane32_swap_b32 v69, v71
  v_permlane32_swap_b32 v84, v86
  v_permlane32_swap_b32 v85, v87
  v_permlane32_swap_b32 v100, v102
  v_permlane32_swap_b32 v101, v103
  v_permlane32_swap_b32 v116, v118
  v_permlane32_swap_b32 v117, v119
  v_permlane16_swap_b32 v68, v70
  v_permlane16_swap_b32 v69, v71
  v_permlane16_swap_b32 v84, v86
  v_permlane16_swap_b32 v85, v87
  v_permlane16_swap_b32 v100, v102
  v_permlane16_swap_b32 v101, v103
  v_permlane16_swap_b32 v116, v118
  v_permlane16_swap_b32 v117, v119
  v_pk_mul_f32 v[192:193], v[192:193], v[46:47]
  v_pk_mul_f32 v[194:195], v[194:195], v[46:47]
  v_cvt_pk_bf16_f32 v72, v192, v193
  v_cvt_pk_bf16_f32 v73, v194, v195
  v_pk_mul_f32 v[208:209], v[208:209], v[46:47]
  v_pk_mul_f32 v[210:211], v[210:211], v[46:47]
  v_cvt_pk_bf16_f32 v74, v208, v209
  v_cvt_pk_bf16_f32 v75, v210, v211
  v_pk_mul_f32 v[196:197], v[196:197], v[46:47]
  v_pk_mul_f32 v[198:199], v[198:199], v[46:47]
  v_cvt_pk_bf16_f32 v88, v196, v197
  v_cvt_pk_bf16_f32 v89, v198, v199
  v_pk_mul_f32 v[212:213], v[212:213], v[46:47]
  v_pk_mul_f32 v[214:215], v[214:215], v[46:47]
  v_cvt_pk_bf16_f32 v90, v212, v213
  v_cvt_pk_bf16_f32 v91, v214, v215
  v_pk_mul_f32 v[200:201], v[200:201], v[46:47]
  v_pk_mul_f32 v[202:203], v[202:203], v[46:47]
  v_cvt_pk_bf16_f32 v104, v200, v201
  v_cvt_pk_bf16_f32 v105, v202, v203
  v_pk_mul_f32 v[216:217], v[216:217], v[46:47]
  v_pk_mul_f32 v[218:219], v[218:219], v[46:47]
  v_cvt_pk_bf16_f32 v106, v216, v217
  v_cvt_pk_bf16_f32 v107, v218, v219
  v_pk_mul_f32 v[204:205], v[204:205], v[46:47]
  v_pk_mul_f32 v[206:207], v[206:207], v[46:47]
  v_cvt_pk_bf16_f32 v120, v204, v205
  v_cvt_pk_bf16_f32 v121, v206, v207
  v_pk_mul_f32 v[220:221], v[220:221], v[46:47]
  v_pk_mul_f32 v[222:223], v[222:223], v[46:47]
  v_cvt_pk_bf16_f32 v122, v220, v221
  v_cvt_pk_bf16_f32 v123, v222, v223
  v_permlane32_swap_b32 v72, v74
  v_permlane32_swap_b32 v73, v75
  v_permlane32_swap_b32 v88, v90
  v_permlane32_swap_b32 v89, v91
  v_permlane32_swap_b32 v104, v106
  v_permlane32_swap_b32 v105, v107
  v_permlane32_swap_b32 v120, v122
  v_permlane32_swap_b32 v121, v123
  v_permlane16_swap_b32 v72, v74
  v_permlane16_swap_b32 v73, v75
  v_permlane16_swap_b32 v88, v90
  v_permlane16_swap_b32 v89, v91
  v_permlane16_swap_b32 v104, v106
  v_permlane16_swap_b32 v105, v107
  v_permlane16_swap_b32 v120, v122
  v_permlane16_swap_b32 v121, v123
  v_pk_mul_f32 v[224:225], v[224:225], v[46:47]
  v_pk_mul_f32 v[226:227], v[226:227], v[46:47]
  v_cvt_pk_bf16_f32 v76, v224, v225
  v_cvt_pk_bf16_f32 v77, v226, v227
  v_pk_mul_f32 v[240:241], v[240:241], v[46:47]
  v_pk_mul_f32 v[242:243], v[242:243], v[46:47]
  v_cvt_pk_bf16_f32 v78, v240, v241
  v_cvt_pk_bf16_f32 v79, v242, v243
  v_pk_mul_f32 v[228:229], v[228:229], v[46:47]
  v_pk_mul_f32 v[230:231], v[230:231], v[46:47]
  v_cvt_pk_bf16_f32 v92, v228, v229
  v_cvt_pk_bf16_f32 v93, v230, v231
  v_pk_mul_f32 v[244:245], v[244:245], v[46:47]
  v_pk_mul_f32 v[246:247], v[246:247], v[46:47]
  v_cvt_pk_bf16_f32 v94, v244, v245
  v_cvt_pk_bf16_f32 v95, v246, v247
  v_pk_mul_f32 v[232:233], v[232:233], v[46:47]
  v_pk_mul_f32 v[234:235], v[234:235], v[46:47]
  v_cvt_pk_bf16_f32 v108, v232, v233
  v_cvt_pk_bf16_f32 v109, v234, v235
  v_pk_mul_f32 v[248:249], v[248:249], v[46:47]
  v_pk_mul_f32 v[250:251], v[250:251], v[46:47]
  v_cvt_pk_bf16_f32 v110, v248, v249
  v_cvt_pk_bf16_f32 v111, v250, v251
  v_pk_mul_f32 v[236:237], v[236:237], v[46:47]
  v_pk_mul_f32 v[238:239], v[238:239], v[46:47]
  v_cvt_pk_bf16_f32 v124, v236, v237
  v_cvt_pk_bf16_f32 v125, v238, v239
  v_pk_mul_f32 v[252:253], v[252:253], v[46:47]
  v_pk_mul_f32 v[254:255], v[254:255], v[46:47]
  v_cvt_pk_bf16_f32 v126, v252, v253
  v_cvt_pk_bf16_f32 v127, v254, v255
  v_permlane32_swap_b32 v76, v78
  v_permlane32_swap_b32 v77, v79
  v_permlane32_swap_b32 v92, v94
  v_permlane32_swap_b32 v93, v95
  v_permlane32_swap_b32 v108, v110
  v_permlane32_swap_b32 v109, v111
  v_permlane32_swap_b32 v124, v126
  v_permlane32_swap_b32 v125, v127
  v_permlane16_swap_b32 v76, v78
  v_permlane16_swap_b32 v77, v79
  v_permlane16_swap_b32 v92, v94
  v_permlane16_swap_b32 v93, v95
  v_permlane16_swap_b32 v108, v110
  v_permlane16_swap_b32 v109, v111
  v_permlane16_swap_b32 v124, v126
  v_permlane16_swap_b32 v125, v127
  s_waitcnt lgkmcnt(0)
  ds_read_b128 a[160:163], v8 offset:8192
  ds_read_b128 a[164:167], v9 offset:8192
  ds_read_b128 a[168:171], v10 offset:8192
  ds_read_b128 a[172:175], v11 offset:8192
  ds_read_b128 a[176:179], v8 offset:12288
  ds_read_b128 a[180:183], v9 offset:12288
  ds_read_b128 a[184:187], v10 offset:12288
  ds_read_b128 a[188:191], v11 offset:12288
  s_mov_b32 s9, 0xc2c80000
  v_mfma_f32_16x16x32_bf16 v[128:131], a[128:131], v[64:67], 0
  v_add_u32 v255, 0x800000, v7
  v_accvgpr_write_b32 a208, -1
  v_mfma_f32_16x16x32_bf16 v[132:135], a[128:131], v[80:83], 0
  v_accvgpr_write_b32 a209, -1
  v_accvgpr_write_b32 a210, -1
  v_mfma_f32_16x16x32_bf16 v[136:139], a[128:131], v[96:99], 0
  v_accvgpr_write_b32 a211, -1
  v_mov_b32 v32, 0
  v_mfma_f32_16x16x32_bf16 v[140:143], a[128:131], v[112:115], 0
  v_mov_b32 v33, 0
  v_mov_b32 v34, 0
  v_mfma_f32_16x16x32_bf16 v[128:131], a[132:135], v[68:71], v[128:131]
  v_mov_b32 v35, 0
  v_mov_b32 v36, 0
  v_mfma_f32_16x16x32_bf16 v[132:135], a[132:135], v[84:87], v[132:135]
  v_mov_b32 v37, 0
  v_mov_b32 v38, 0
  v_mfma_f32_16x16x32_bf16 v[136:139], a[132:135], v[100:103], v[136:139]
  v_mov_b32 v39, 0
  v_mov_b32 v40, 0
  v_mfma_f32_16x16x32_bf16 v[140:143], a[132:135], v[116:119], v[140:143]
  v_mov_b32 v41, 0
  v_mov_b32 v42, 0
  v_mfma_f32_16x16x32_bf16 v[128:131], a[136:139], v[72:75], v[128:131]
  v_mov_b32 v43, 0
  v_mov_b32 v44, 0
  v_mfma_f32_16x16x32_bf16 v[132:135], a[136:139], v[88:91], v[132:135]
  v_mov_b32 v45, 0
  v_mov_b32 v46, 0
  v_mfma_f32_16x16x32_bf16 v[136:139], a[136:139], v[104:107], v[136:139]
  v_mov_b32 v47, 0
  v_mov_b32 v248, 0x3f803f80
  v_mfma_f32_16x16x32_bf16 v[140:143], a[136:139], v[120:123], v[140:143]
  v_mov_b32 v249, 0x3f803f80
  v_mov_b32 v250, 0x3f803f80
  v_mfma_f32_16x16x32_bf16 v[128:131], a[140:143], v[76:79], v[128:131]
  v_mov_b32 v251, 0x3f803f80
  v_mfma_f32_16x16x32_bf16 v[132:135], a[140:143], v[92:95], v[132:135]
  v_mfma_f32_16x16x32_bf16 v[136:139], a[140:143], v[108:111], v[136:139]
  v_mfma_f32_16x16x32_bf16 v[140:143], a[140:143], v[124:127], v[140:143]
  v_mfma_f32_16x16x32_bf16 v[144:147], a[144:147], v[64:67], 0
  v_mfma_f32_16x16x32_bf16 v[148:151], a[144:147], v[80:83], 0
  v_mfma_f32_16x16x32_bf16 v[152:155], a[144:147], v[96:99], 0
  v_mfma_f32_16x16x32_bf16 v[156:159], a[144:147], v[112:115], 0
  v_mfma_f32_16x16x32_bf16 v[144:147], a[148:151], v[68:71], v[144:147]
  v_mfma_f32_16x16x32_bf16 v[148:151], a[148:151], v[84:87], v[148:151]
  v_mfma_f32_16x16x32_bf16 v[152:155], a[148:151], v[100:103], v[152:155]
  v_max3_f32 v240, v128, v129, v130
  v_max3_f32 v241, v132, v133, v134
  v_mfma_f32_16x16x32_bf16 v[156:159], a[148:151], v[116:119], v[156:159]
  v_max3_f32 v242, v136, v137, v138
  v_max3_f32 v243, v140, v141, v142
  v_mfma_f32_16x16x32_bf16 v[144:147], a[152:155], v[72:75], v[144:147]
  v_max_f32 v240, v240, v131
  v_max_f32 v241, v241, v135
  v_mfma_f32_16x16x32_bf16 v[148:151], a[152:155], v[88:91], v[148:151]
  v_max_f32 v242, v242, v139
  v_max_f32 v243, v243, v143
  v_mfma_f32_16x16x32_bf16 v[152:155], a[152:155], v[104:107], v[152:155]
  v_mfma_f32_16x16x32_bf16 v[156:159], a[152:155], v[120:123], v[156:159]
  v_mfma_f32_16x16x32_bf16 v[144:147], a[156:159], v[76:79], v[144:147]
  v_mfma_f32_16x16x32_bf16 v[148:151], a[156:159], v[92:95], v[148:151]
  v_mfma_f32_16x16x32_bf16 v[152:155], a[156:159], v[108:111], v[152:155]
  v_mfma_f32_16x16x32_bf16 v[156:159], a[156:159], v[124:127], v[156:159]
  s_waitcnt lgkmcnt(0)
  v_mfma_f32_16x16x32_bf16 v[160:163], a[160:163], v[64:67], 0
  ds_read_b64_tr_b16 a[128:129], v12 offset:0
  ds_read_b64_tr_b16 a[130:131], v12 offset:4096
  v_mfma_f32_16x16x32_bf16 v[164:167], a[160:163], v[80:83], 0
  ds_read_b64_tr_b16 a[132:133], v13 offset:0
  ds_read_b64_tr_b16 a[134:135], v13 offset:4096
  v_mfma_f32_16x16x32_bf16 v[168:171], a[160:163], v[96:99], 0
  ds_read_b64_tr_b16 a[136:137], v14 offset:0
  ds_read_b64_tr_b16 a[138:139], v14 offset:4096
  v_mfma_f32_16x16x32_bf16 v[172:175], a[160:163], v[112:115], 0
  ds_read_b64_tr_b16 a[140:141], v15 offset:0
  ds_read_b64_tr_b16 a[142:143], v15 offset:4096
  v_mfma_f32_16x16x32_bf16 v[160:163], a[164:167], v[68:71], v[160:163]
  ds_read_b64_tr_b16 a[144:145], v16 offset:0
  ds_read_b64_tr_b16 a[146:147], v16 offset:4096
  v_mfma_f32_16x16x32_bf16 v[164:167], a[164:167], v[84:87], v[164:167]
  ds_read_b64_tr_b16 a[148:149], v17 offset:0
  ds_read_b64_tr_b16 a[150:151], v17 offset:4096
  v_mfma_f32_16x16x32_bf16 v[168:171], a[164:167], v[100:103], v[168:171]
  ds_read_b64_tr_b16 a[152:153], v18 offset:0
  ds_read_b64_tr_b16 a[154:155], v18 offset:4096
  v_mfma_f32_16x16x32_bf16 v[172:175], a[164:167], v[116:119], v[172:175]
  v_mfma_f32_16x16x32_bf16 v[160:163], a[168:171], v[72:75], v[160:163]
  v_max3_f32 v240, v240, v144, v145
  v_max3_f32 v241, v241, v148, v149
  v_mfma_f32_16x16x32_bf16 v[164:167], a[168:171], v[88:91], v[164:167]
  v_max3_f32 v242, v242, v152, v153
  v_max3_f32 v243, v243, v156, v157
  v_mfma_f32_16x16x32_bf16 v[168:171], a[168:171], v[104:107], v[168:171]
  v_max3_f32 v240, v240, v146, v147
  v_max3_f32 v241, v241, v150, v151
  v_mfma_f32_16x16x32_bf16 v[172:175], a[168:171], v[120:123], v[172:175]
  v_max3_f32 v242, v242, v154, v155
  v_max3_f32 v243, v243, v158, v159
  v_mfma_f32_16x16x32_bf16 v[160:163], a[172:175], v[76:79], v[160:163]
  v_mfma_f32_16x16x32_bf16 v[164:167], a[172:175], v[92:95], v[164:167]
  v_mfma_f32_16x16x32_bf16 v[168:171], a[172:175], v[108:111], v[168:171]
  v_mfma_f32_16x16x32_bf16 v[172:175], a[172:175], v[124:127], v[172:175]
  v_mfma_f32_16x16x32_bf16 v[176:179], a[176:179], v[64:67], 0
  v_mfma_f32_16x16x32_bf16 v[180:183], a[176:179], v[80:83], 0
  v_mfma_f32_16x16x32_bf16 v[184:187], a[176:179], v[96:99], 0
  v_mfma_f32_16x16x32_bf16 v[188:191], a[176:179], v[112:115], 0
  v_mfma_f32_16x16x32_bf16 v[176:179], a[180:183], v[68:71], v[176:179]
  v_max3_f32 v240, v240, v160, v161
  v_max3_f32 v241, v241, v164, v165
  v_mfma_f32_16x16x32_bf16 v[180:183], a[180:183], v[84:87], v[180:183]
  v_max3_f32 v242, v242, v168, v169
  v_max3_f32 v243, v243, v172, v173
  v_mfma_f32_16x16x32_bf16 v[184:187], a[180:183], v[100:103], v[184:187]
  v_max3_f32 v240, v240, v162, v163
  v_max3_f32 v241, v241, v166, v167
  v_mfma_f32_16x16x32_bf16 v[188:191], a[180:183], v[116:119], v[188:191]
  v_max3_f32 v242, v242, v170, v171
  v_max3_f32 v243, v243, v174, v175
  v_mfma_f32_16x16x32_bf16 v[176:179], a[184:187], v[72:75], v[176:179]
  v_mov_b32 v244, v240
  v_mov_b32 v245, v241
  v_mfma_f32_16x16x32_bf16 v[180:183], a[184:187], v[88:91], v[180:183]
  v_mov_b32 v246, v242
  v_mov_b32 v247, v243
  v_mfma_f32_16x16x32_bf16 v[184:187], a[184:187], v[104:107], v[184:187]
  v_permlane16_swap_b32 v240, v244
  v_permlane16_swap_b32 v241, v245
  v_mfma_f32_16x16x32_bf16 v[188:191], a[184:187], v[120:123], v[188:191]
  v_permlane16_swap_b32 v242, v246
  v_permlane16_swap_b32 v243, v247
  v_mfma_f32_16x16x32_bf16 v[176:179], a[188:191], v[76:79], v[176:179]
  v_max_f32 v240, v240, v244
  v_max_f32 v241, v241, v245
  v_mfma_f32_16x16x32_bf16 v[180:183], a[188:191], v[92:95], v[180:183]
  v_max_f32 v242, v242, v246
  v_max_f32 v243, v243, v247
  v_mfma_f32_16x16x32_bf16 v[184:187], a[188:191], v[108:111], v[184:187]
  v_mov_b32 v244, v240
  v_mov_b32 v245, v241
  v_mfma_f32_16x16x32_bf16 v[188:191], a[188:191], v[124:127], v[188:191]
  v_mov_b32 v246, v242
  v_mov_b32 v247, v243
  v_permlane32_swap_b32 v240, v244
  v_permlane32_swap_b32 v241, v245
  v_permlane32_swap_b32 v242, v246
  v_permlane32_swap_b32 v243, v247
  v_max_f32 v240, v240, v244
  v_max_f32 v241, v241, v245
  v_max_f32 v242, v242, v246
  v_max_f32 v243, v243, v247
  v_sub_f32 v224, s9, v240
  v_sub_f32 v228, s9, v241
  v_sub_f32 v232, s9, v242
  v_sub_f32 v236, s9, v243
  v_sub_f32 v225, s9, v240
  v_sub_f32 v229, s9, v241
  v_sub_f32 v233, s9, v242
  v_sub_f32 v237, s9, v243
  v_sub_f32 v226, s9, v240
  v_sub_f32 v230, s9, v241
  v_sub_f32 v234, s9, v242
  v_sub_f32 v238, s9, v243
  v_sub_f32 v227, s9, v240
  v_sub_f32 v231, s9, v241
  v_sub_f32 v235, s9, v242
  v_sub_f32 v239, s9, v243
  v_pk_add_f32 v[128:129], v[128:129], v[224:225]
  v_pk_add_f32 v[130:131], v[130:131], v[224:225]
  v_pk_add_f32 v[132:133], v[132:133], v[228:229]
  v_pk_add_f32 v[134:135], v[134:135], v[228:229]
  v_pk_add_f32 v[136:137], v[136:137], v[232:233]
  v_pk_add_f32 v[138:139], v[138:139], v[232:233]
  v_pk_add_f32 v[140:141], v[140:141], v[236:237]
  v_pk_add_f32 v[142:143], v[142:143], v[236:237]
  v_pk_add_f32 v[144:145], v[144:145], v[224:225]
  v_pk_add_f32 v[146:147], v[146:147], v[224:225]
  v_pk_add_f32 v[148:149], v[148:149], v[228:229]
  v_pk_add_f32 v[150:151], v[150:151], v[228:229]
  v_pk_add_f32 v[152:153], v[152:153], v[232:233]
  v_pk_add_f32 v[154:155], v[154:155], v[232:233]
  v_pk_add_f32 v[156:157], v[156:157], v[236:237]
  v_pk_add_f32 v[158:159], v[158:159], v[236:237]
  v_pk_add_f32 v[160:161], v[160:161], v[224:225]
  v_pk_add_f32 v[162:163], v[162:163], v[224:225]
  v_pk_add_f32 v[164:165], v[164:165], v[228:229]
  v_pk_add_f32 v[166:167], v[166:167], v[228:229]
  v_pk_add_f32 v[168:169], v[168:169], v[232:233]
  v_pk_add_f32 v[170:171], v[170:171], v[232:233]
  v_pk_add_f32 v[172:173], v[172:173], v[236:237]
  v_pk_add_f32 v[174:175], v[174:175], v[236:237]
  v_pk_add_f32 v[176:177], v[176:177], v[224:225]
  v_pk_add_f32 v[178:179], v[178:179], v[224:225]
  v_pk_add_f32 v[180:181], v[180:181], v[228:229]
  v_pk_add_f32 v[182:183], v[182:183], v[228:229]
  v_pk_add_f32 v[184:185], v[184:185], v[232:233]
  v_pk_add_f32 v[186:187], v[186:187], v[232:233]
  v_pk_add_f32 v[188:189], v[188:189], v[236:237]
  v_pk_add_f32 v[190:191], v[190:191], v[236:237]
  v_exp_f32 v240, v128
  v_exp_f32 v241, v129
  v_exp_f32 v242, v130
  v_exp_f32 v243, v131
  v_cvt_pk_bf16_f32 v192, v240, v241
  v_exp_f32 v244, v132
  v_exp_f32 v245, v133
  v_cvt_pk_bf16_f32 v193, v242, v243
  v_exp_f32 v246, v134
  v_exp_f32 v247, v135
  v_cvt_pk_bf16_f32 v196, v244, v245
  v_exp_f32 v240, v136
  v_exp_f32 v241, v137
  v_cvt_pk_bf16_f32 v197, v246, v247
  v_exp_f32 v242, v138
  v_exp_f32 v243, v139
  v_cvt_pk_bf16_f32 v200, v240, v241
  v_exp_f32 v244, v140
  v_exp_f32 v245, v141
  v_cvt_pk_bf16_f32 v201, v242, v243
  v_exp_f32 v246, v142
  v_exp_f32 v247, v143
  v_cvt_pk_bf16_f32 v204, v244, v245
  v_exp_f32 v240, v144
  v_exp_f32 v241, v145
  v_cvt_pk_bf16_f32 v205, v246, v247
  v_exp_f32 v242, v146
  v_exp_f32 v243, v147
  v_cvt_pk_bf16_f32 v194, v240, v241
  v_exp_f32 v244, v148
  v_exp_f32 v245, v149
  v_cvt_pk_bf16_f32 v195, v242, v243
  v_exp_f32 v246, v150
  v_exp_f32 v247, v151
  v_cvt_pk_bf16_f32 v198, v244, v245
  v_exp_f32 v240, v152
  v_exp_f32 v241, v153
  v_cvt_pk_bf16_f32 v199, v246, v247
  v_exp_f32 v242, v154
  v_exp_f32 v243, v155
  v_cvt_pk_bf16_f32 v202, v240, v241
  v_exp_f32 v244, v156
  v_exp_f32 v245, v157
  v_cvt_pk_bf16_f32 v203, v242, v243
  v_exp_f32 v246, v158
  v_exp_f32 v247, v159
  v_cvt_pk_bf16_f32 v206, v244, v245
  s_nop 0
  v_cvt_pk_bf16_f32 v207, v246, v247
  v_exp_f32 v240, v160
  s_nop 0
  v_exp_f32 v241, v161
  s_nop 0
  v_cvt_pk_bf16_f32 v208, v240, v241
  v_exp_f32 v242, v162
  s_nop 0
  v_exp_f32 v243, v163
  s_nop 0
  v_cvt_pk_bf16_f32 v209, v242, v243
  v_exp_f32 v244, v164
  s_nop 0
  s_mov_b32 s55, 7
  s_barrier
  s_add_u32 m0, s52, 0
  s_nop 0
  buffer_load_dwordx4 v20, s[20:23], s53 offen offset:0 lds
  buffer_load_dwordx4 v21, s[20:23], s53 offen offset:1024 lds
  s_waitcnt lgkmcnt(6)
attn_kernel_loop2:
  v_mfma_f32_16x16x32_bf16 a[0:3], a[128:131], v[192:195], a[0:3]
  v_exp_f32 v245, v165
  v_mfma_f32_16x16x32_bf16 a[4:7], a[128:131], v[196:199], a[4:7]
  ds_read_b64_tr_b16 a[156:157], v19 offset:0
  v_cvt_pk_bf16_f32 v212, v244, v245
  v_mfma_f32_16x16x32_bf16 a[8:11], a[128:131], v[200:203], a[8:11]
  v_exp_f32 v246, v166
  v_mfma_f32_16x16x32_bf16 a[12:15], a[128:131], v[204:207], a[12:15]
  ds_read_b64_tr_b16 a[158:159], v19 offset:4096
  v_mfma_f32_16x16x32_bf16 a[16:19], a[132:135], v[192:195], a[16:19]
  v_exp_f32 v247, v167
  v_mfma_f32_16x16x32_bf16 a[20:23], a[132:135], v[196:199], a[20:23]
  ds_read_b128 a[160:163], v8 offset:16384
  v_cvt_pk_bf16_f32 v213, v246, v247
  v_mfma_f32_16x16x32_bf16 a[24:27], a[132:135], v[200:203], a[24:27]
  v_exp_f32 v240, v168
  v_mfma_f32_16x16x32_bf16 a[28:31], a[132:135], v[204:207], a[28:31]
  buffer_load_dwordx4 v22, s[20:23], s53 offen offset:2048 lds
  v_mfma_f32_16x16x32_bf16 a[32:35], a[136:139], v[192:195], a[32:35]
  v_exp_f32 v241, v169
  v_mfma_f32_16x16x32_bf16 a[36:39], a[136:139], v[196:199], a[36:39]
  ds_read_b128 a[164:167], v9 offset:16384
  v_cvt_pk_bf16_f32 v216, v240, v241
  v_mfma_f32_16x16x32_bf16 a[40:43], a[136:139], v[200:203], a[40:43]
  v_exp_f32 v242, v170
  v_mfma_f32_16x16x32_bf16 a[44:47], a[136:139], v[204:207], a[44:47]
  buffer_load_dwordx4 v23, s[20:23], s53 offen offset:3072 lds
  s_add_u32 m0, s52, 114688
  v_mfma_f32_16x16x32_bf16 a[48:51], a[140:143], v[192:195], a[48:51]
  v_exp_f32 v243, v171
  v_mfma_f32_16x16x32_bf16 a[52:55], a[140:143], v[196:199], a[52:55]
  ds_read_b128 a[168:171], v10 offset:16384
  v_cvt_pk_bf16_f32 v217, v242, v243
  v_mfma_f32_16x16x32_bf16 a[56:59], a[140:143], v[200:203], a[56:59]
  v_exp_f32 v244, v172
  v_mfma_f32_16x16x32_bf16 a[60:63], a[140:143], v[204:207], a[60:63]
  ds_read_b128 a[172:175], v11 offset:16384
  s_waitcnt lgkmcnt(4)
  v_mfma_f32_16x16x32_bf16 a[64:67], a[144:147], v[192:195], a[64:67]
  v_exp_f32 v245, v173
  v_mfma_f32_16x16x32_bf16 a[68:71], a[144:147], v[196:199], a[68:71]
  ds_read_b128 a[176:179], v8 offset:20480
  v_cvt_pk_bf16_f32 v220, v244, v245
  v_mfma_f32_16x16x32_bf16 a[72:75], a[144:147], v[200:203], a[72:75]
  v_exp_f32 v246, v174
  v_mfma_f32_16x16x32_bf16 a[76:79], a[144:147], v[204:207], a[76:79]
  buffer_load_dwordx4 v24, s[24:27], s54 offen offset:0 lds
  v_mfma_f32_16x16x32_bf16 a[80:83], a[148:151], v[192:195], a[80:83]
  v_exp_f32 v247, v175
  v_mfma_f32_16x16x32_bf16 a[84:87], a[148:151], v[196:199], a[84:87]
  ds_read_b128 a[180:183], v9 offset:20480
  v_cvt_pk_bf16_f32 v221, v246, v247
  v_mfma_f32_16x16x32_bf16 a[88:91], a[148:151], v[200:203], a[88:91]
  v_exp_f32 v240, v176
  v_mfma_f32_16x16x32_bf16 a[92:95], a[148:151], v[204:207], a[92:95]
  buffer_load_dwordx4 v25, s[24:27], s54 offen offset:1024 lds
  v_mfma_f32_16x16x32_bf16 a[96:99], a[152:155], v[192:195], a[96:99]
  v_exp_f32 v241, v177
  v_mfma_f32_16x16x32_bf16 a[100:103], a[152:155], v[196:199], a[100:103]
  ds_read_b128 a[184:187], v10 offset:20480
  v_cvt_pk_bf16_f32 v210, v240, v241
  v_mfma_f32_16x16x32_bf16 a[104:107], a[152:155], v[200:203], a[104:107]
  v_exp_f32 v242, v178
  v_mfma_f32_16x16x32_bf16 a[108:111], a[152:155], v[204:207], a[108:111]
  buffer_load_dwordx4 v24, s[24:27], s54 offen offset:2048 lds
  v_mfma_f32_16x16x32_bf16 a[112:115], a[156:159], v[192:195], a[112:115]
  v_exp_f32 v243, v179
  v_mfma_f32_16x16x32_bf16 a[116:119], a[156:159], v[196:199], a[116:119]
  ds_read_b128 a[188:191], v11 offset:20480
  v_cvt_pk_bf16_f32 v211, v242, v243
  v_mfma_f32_16x16x32_bf16 a[120:123], a[156:159], v[200:203], a[120:123]
  v_exp_f32 v244, v180
  v_mfma_f32_16x16x32_bf16 a[124:127], a[156:159], v[204:207], a[124:127]
  buffer_load_dwordx4 v25, s[24:27], s54 offen offset:3072 lds
  v_mfma_f32_16x16x32_bf16 v[32:35], v[248:251], v[192:195], v[32:35]
  v_exp_f32 v245, v181
  v_mfma_f32_16x16x32_bf16 v[36:39], v[248:251], v[196:199], v[36:39]
  v_cvt_pk_bf16_f32 v214, v244, v245
  v_mfma_f32_16x16x32_bf16 v[40:43], v[248:251], v[200:203], v[40:43]
  v_exp_f32 v246, v182
  v_mfma_f32_16x16x32_bf16 v[44:47], v[248:251], v[204:207], v[44:47]
  s_waitcnt lgkmcnt(0)
  v_mfma_f32_16x16x32_bf16 v[128:131], a[160:163], v[64:67], v[224:227]
  v_exp_f32 v247, v183
  v_mfma_f32_16x16x32_bf16 v[128:131], a[164:167], v[68:71], v[128:131]
  v_cvt_pk_bf16_f32 v215, v246, v247
  v_mfma_f32_16x16x32_bf16 v[128:131], a[168:171], v[72:75], v[128:131]
  v_exp_f32 v240, v184
  v_mfma_f32_16x16x32_bf16 v[128:131], a[172:175], v[76:79], v[128:131]
  buffer_load_dwordx4 a[192:195], v7, s[32:35], s59 offen
  v_mfma_f32_16x16x32_bf16 v[132:135], a[160:163], v[80:83], v[228:231]
  v_exp_f32 v241, v185
  v_mfma_f32_16x16x32_bf16 v[132:135], a[164:167], v[84:87], v[132:135]
  ds_read_b64_tr_b16 a[128:129], v12 offset:8192
  v_cvt_pk_bf16_f32 v218, v240, v241
  v_mfma_f32_16x16x32_bf16 v[132:135], a[168:171], v[88:91], v[132:135]
  v_exp_f32 v242, v186
  v_mfma_f32_16x16x32_bf16 v[132:135], a[172:175], v[92:95], v[132:135]
  ds_read_b64_tr_b16 a[130:131], v12 offset:12288
  s_add_u32 s53, s53, 16384
  v_mfma_f32_16x16x32_bf16 v[136:139], a[160:163], v[96:99], v[232:235]
  v_exp_f32 v243, v187
  v_mfma_f32_16x16x32_bf16 v[136:139], a[164:167], v[100:103], v[136:139]
  ds_read_b64_tr_b16 a[132:133], v13 offset:8192
  v_cvt_pk_bf16_f32 v219, v242, v243
  v_mfma_f32_16x16x32_bf16 v[136:139], a[168:171], v[104:107], v[136:139]
  v_exp_f32 v244, v188
  v_mfma_f32_16x16x32_bf16 v[136:139], a[172:175], v[108:111], v[136:139]
  ds_read_b64_tr_b16 a[134:135], v13 offset:12288
  s_add_u32 s54, s54, 16384
  v_mfma_f32_16x16x32_bf16 v[140:143], a[160:163], v[112:115], v[236:239]
  v_exp_f32 v245, v189
  v_mfma_f32_16x16x32_bf16 v[140:143], a[164:167], v[116:119], v[140:143]
  ds_read_b64_tr_b16 a[136:137], v14 offset:8192
  v_cvt_pk_bf16_f32 v222, v244, v245
  v_mfma_f32_16x16x32_bf16 v[140:143], a[168:171], v[120:123], v[140:143]
  v_exp_f32 v246, v190
  v_mfma_f32_16x16x32_bf16 v[140:143], a[172:175], v[124:127], v[140:143]
  ds_read_b64_tr_b16 a[138:139], v14 offset:12288
  v_mfma_f32_16x16x32_bf16 v[144:147], a[176:179], v[64:67], v[224:227]
  v_exp_f32 v247, v191
  v_mfma_f32_16x16x32_bf16 v[144:147], a[180:183], v[68:71], v[144:147]
  ds_read_b64_tr_b16 a[140:141], v15 offset:8192
  v_cvt_pk_bf16_f32 v223, v246, v247
  v_mfma_f32_16x16x32_bf16 v[144:147], a[184:187], v[72:75], v[144:147]
  v_mfma_f32_16x16x32_bf16 v[144:147], a[188:191], v[76:79], v[144:147]
  ds_read_b64_tr_b16 a[142:143], v15 offset:12288
  v_mfma_f32_16x16x32_bf16 v[148:151], a[176:179], v[80:83], v[228:231]
  v_mfma_f32_16x16x32_bf16 v[148:151], a[180:183], v[84:87], v[148:151]
  ds_read_b64_tr_b16 a[144:145], v16 offset:8192
  v_mfma_f32_16x16x32_bf16 v[148:151], a[184:187], v[88:91], v[148:151]
  v_exp_f32 v240, v128
  v_mfma_f32_16x16x32_bf16 v[148:151], a[188:191], v[92:95], v[148:151]
  ds_read_b64_tr_b16 a[146:147], v16 offset:12288
  v_mfma_f32_16x16x32_bf16 v[152:155], a[176:179], v[96:99], v[232:235]
  v_exp_f32 v241, v129
  v_mfma_f32_16x16x32_bf16 v[152:155], a[180:183], v[100:103], v[152:155]
  ds_read_b64_tr_b16 a[148:149], v17 offset:8192
  v_cvt_pk_bf16_f32 v192, v240, v241
  v_mfma_f32_16x16x32_bf16 v[152:155], a[184:187], v[104:107], v[152:155]
  v_exp_f32 v242, v130
  v_mfma_f32_16x16x32_bf16 v[152:155], a[188:191], v[108:111], v[152:155]
  ds_read_b64_tr_b16 a[150:151], v17 offset:12288
  v_mfma_f32_16x16x32_bf16 v[156:159], a[176:179], v[112:115], v[236:239]
  v_exp_f32 v243, v131
  v_mfma_f32_16x16x32_bf16 v[156:159], a[180:183], v[116:119], v[156:159]
  ds_read_b64_tr_b16 a[152:153], v18 offset:8192
  v_cvt_pk_bf16_f32 v193, v242, v243
  v_mfma_f32_16x16x32_bf16 v[156:159], a[184:187], v[120:123], v[156:159]
  v_exp_f32 v244, v132
  v_mfma_f32_16x16x32_bf16 v[156:159], a[188:191], v[124:127], v[156:159]
  ds_read_b64_tr_b16 a[154:155], v18 offset:12288
  s_waitcnt lgkmcnt(6)
  v_mfma_f32_16x16x32_bf16 a[0:3], a[128:131], v[208:211], a[0:3]
  v_exp_f32 v245, v133
  v_mfma_f32_16x16x32_bf16 a[4:7], a[128:131], v[212:215], a[4:7]
  ds_read_b64_tr_b16 a[156:157], v19 offset:8192
  v_cvt_pk_bf16_f32 v196, v244, v245
  v_mfma_f32_16x16x32_bf16 a[8:11], a[128:131], v[216:219], a[8:11]
  v_exp_f32 v246, v134
  v_mfma_f32_16x16x32_bf16 a[12:15], a[128:131], v[220:223], a[12:15]
  ds_read_b64_tr_b16 a[158:159], v19 offset:12288
  v_mfma_f32_16x16x32_bf16 a[16:19], a[132:135], v[208:211], a[16:19]
  v_exp_f32 v247, v135
  v_mfma_f32_16x16x32_bf16 a[20:23], a[132:135], v[212:215], a[20:23]
  ds_read_b128 a[160:163], v8 offset:24576
  v_cvt_pk_bf16_f32 v197, v246, v247
  v_mfma_f32_16x16x32_bf16 a[24:27], a[132:135], v[216:219], a[24:27]
  v_exp_f32 v240, v136
  v_mfma_f32_16x16x32_bf16 a[28:31], a[132:135], v[220:223], a[28:31]
  v_mfma_f32_16x16x32_bf16 a[32:35], a[136:139], v[208:211], a[32:35]
  v_exp_f32 v241, v137
  v_mfma_f32_16x16x32_bf16 a[36:39], a[136:139], v[212:215], a[36:39]
  ds_read_b128 a[164:167], v9 offset:24576
  v_cvt_pk_bf16_f32 v200, v240, v241
  v_mfma_f32_16x16x32_bf16 a[40:43], a[136:139], v[216:219], a[40:43]
  v_exp_f32 v242, v138
  v_mfma_f32_16x16x32_bf16 a[44:47], a[136:139], v[220:223], a[44:47]
  v_mfma_f32_16x16x32_bf16 a[48:51], a[140:143], v[208:211], a[48:51]
  v_exp_f32 v243, v139
  v_mfma_f32_16x16x32_bf16 a[52:55], a[140:143], v[212:215], a[52:55]
  ds_read_b128 a[168:171], v10 offset:24576
  v_cvt_pk_bf16_f32 v201, v242, v243
  v_mfma_f32_16x16x32_bf16 a[56:59], a[140:143], v[216:219], a[56:59]
  v_exp_f32 v244, v140
  v_mfma_f32_16x16x32_bf16 a[60:63], a[140:143], v[220:223], a[60:63]
  ds_read_b128 a[172:175], v11 offset:24576
  s_waitcnt lgkmcnt(4)
  v_mfma_f32_16x16x32_bf16 a[64:67], a[144:147], v[208:211], a[64:67]
  v_exp_f32 v245, v141
  v_mfma_f32_16x16x32_bf16 a[68:71], a[144:147], v[212:215], a[68:71]
  ds_read_b128 a[176:179], v8 offset:28672
  v_cvt_pk_bf16_f32 v204, v244, v245
  v_mfma_f32_16x16x32_bf16 a[72:75], a[144:147], v[216:219], a[72:75]
  v_exp_f32 v246, v142
  v_mfma_f32_16x16x32_bf16 a[76:79], a[144:147], v[220:223], a[76:79]
  v_mfma_f32_16x16x32_bf16 a[80:83], a[148:151], v[208:211], a[80:83]
  v_exp_f32 v247, v143
  v_mfma_f32_16x16x32_bf16 a[84:87], a[148:151], v[212:215], a[84:87]
  ds_read_b128 a[180:183], v9 offset:28672
  v_cvt_pk_bf16_f32 v205, v246, v247
  v_mfma_f32_16x16x32_bf16 a[88:91], a[148:151], v[216:219], a[88:91]
  v_exp_f32 v240, v144
  v_mfma_f32_16x16x32_bf16 a[92:95], a[148:151], v[220:223], a[92:95]
  v_mfma_f32_16x16x32_bf16 a[96:99], a[152:155], v[208:211], a[96:99]
  v_exp_f32 v241, v145
  v_mfma_f32_16x16x32_bf16 a[100:103], a[152:155], v[212:215], a[100:103]
  ds_read_b128 a[184:187], v10 offset:28672
  v_cvt_pk_bf16_f32 v194, v240, v241
  v_mfma_f32_16x16x32_bf16 a[104:107], a[152:155], v[216:219], a[104:107]
  v_exp_f32 v242, v146
  v_mfma_f32_16x16x32_bf16 a[108:111], a[152:155], v[220:223], a[108:111]
  v_mfma_f32_16x16x32_bf16 a[112:115], a[156:159], v[208:211], a[112:115]
  v_exp_f32 v243, v147
  v_mfma_f32_16x16x32_bf16 a[116:119], a[156:159], v[212:215], a[116:119]
  ds_read_b128 a[188:191], v11 offset:28672
  v_cvt_pk_bf16_f32 v195, v242, v243
  v_mfma_f32_16x16x32_bf16 a[120:123], a[156:159], v[216:219], a[120:123]
  v_exp_f32 v244, v148
  v_mfma_f32_16x16x32_bf16 a[124:127], a[156:159], v[220:223], a[124:127]
  v_mfma_f32_16x16x32_bf16 v[32:35], v[248:251], v[208:211], v[32:35]
  v_exp_f32 v245, v149
  v_mfma_f32_16x16x32_bf16 v[36:39], v[248:251], v[212:215], v[36:39]
  v_cvt_pk_bf16_f32 v198, v244, v245
  v_mfma_f32_16x16x32_bf16 v[40:43], v[248:251], v[216:219], v[40:43]
  v_exp_f32 v246, v150
  v_mfma_f32_16x16x32_bf16 v[44:47], v[248:251], v[220:223], v[44:47]
  s_waitcnt lgkmcnt(0)
  v_mfma_f32_16x16x32_bf16 v[160:163], a[160:163], v[64:67], v[224:227]
  v_exp_f32 v247, v151
  v_mfma_f32_16x16x32_bf16 v[160:163], a[164:167], v[68:71], v[160:163]
  v_cvt_pk_bf16_f32 v199, v246, v247
  v_mfma_f32_16x16x32_bf16 v[160:163], a[168:171], v[72:75], v[160:163]
  v_exp_f32 v240, v152
  v_mfma_f32_16x16x32_bf16 v[160:163], a[172:175], v[76:79], v[160:163]
  s_waitcnt vmcnt(20)
  s_barrier
  v_mfma_f32_16x16x32_bf16 v[164:167], a[160:163], v[80:83], v[228:231]
  v_exp_f32 v241, v153
  v_mfma_f32_16x16x32_bf16 v[164:167], a[164:167], v[84:87], v[164:167]
  ds_read_b64_tr_b16 a[128:129], v12 offset:16384
  v_cvt_pk_bf16_f32 v202, v240, v241
  v_mfma_f32_16x16x32_bf16 v[164:167], a[168:171], v[88:91], v[164:167]
  v_exp_f32 v242, v154
  v_mfma_f32_16x16x32_bf16 v[164:167], a[172:175], v[92:95], v[164:167]
  ds_read_b64_tr_b16 a[130:131], v12 offset:20480
  s_add_u32 m0, s52, 16384
  v_mfma_f32_16x16x32_bf16 v[168:171], a[160:163], v[96:99], v[232:235]
  v_exp_f32 v243, v155
  v_mfma_f32_16x16x32_bf16 v[168:171], a[164:167], v[100:103], v[168:171]
  ds_read_b64_tr_b16 a[132:133], v13 offset:16384
  v_cvt_pk_bf16_f32 v203, v242, v243
  v_mfma_f32_16x16x32_bf16 v[168:171], a[168:171], v[104:107], v[168:171]
  v_exp_f32 v244, v156
  v_mfma_f32_16x16x32_bf16 v[168:171], a[172:175], v[108:111], v[168:171]
  ds_read_b64_tr_b16 a[134:135], v13 offset:20480
  v_lshlrev_b32 v26, 16, v28
  v_mfma_f32_16x16x32_bf16 v[172:175], a[160:163], v[112:115], v[236:239]
  v_exp_f32 v245, v157
  v_mfma_f32_16x16x32_bf16 v[172:175], a[164:167], v[116:119], v[172:175]
  ds_read_b64_tr_b16 a[136:137], v14 offset:16384
  v_cvt_pk_bf16_f32 v206, v244, v245
  v_mfma_f32_16x16x32_bf16 v[172:175], a[168:171], v[120:123], v[172:175]
  v_exp_f32 v246, v158
  v_mfma_f32_16x16x32_bf16 v[172:175], a[172:175], v[124:127], v[172:175]
  ds_read_b64_tr_b16 a[138:139], v14 offset:20480
  v_and_b32 v3, 0xffff0000, v28
  v_mfma_f32_16x16x32_bf16 v[176:179], a[176:179], v[64:67], v[224:227]
  v_exp_f32 v247, v159
  v_mfma_f32_16x16x32_bf16 v[176:179], a[180:183], v[68:71], v[176:179]
  ds_read_b64_tr_b16 a[140:141], v15 offset:16384
  v_cvt_pk_bf16_f32 v207, v246, v247
  v_mfma_f32_16x16x32_bf16 v[176:179], a[184:187], v[72:75], v[176:179]
  buffer_load_dwordx4 v20, s[20:23], s53 offen offset:0 lds
  v_mfma_f32_16x16x32_bf16 v[176:179], a[188:191], v[76:79], v[176:179]
  ds_read_b64_tr_b16 a[142:143], v15 offset:20480
  v_fmac_f32 v48, v26, v27
  v_mfma_f32_16x16x32_bf16 v[180:183], a[176:179], v[80:83], v[228:231]
  buffer_load_dwordx4 v21, s[20:23], s53 offen offset:1024 lds
  v_mfma_f32_16x16x32_bf16 v[180:183], a[180:183], v[84:87], v[180:183]
  ds_read_b64_tr_b16 a[144:145], v16 offset:16384
  v_fmac_f32 v49, v3, v27
  v_mfma_f32_16x16x32_bf16 v[180:183], a[184:187], v[88:91], v[180:183]
  v_exp_f32 v240, v160
  v_mfma_f32_16x16x32_bf16 v[180:183], a[188:191], v[92:95], v[180:183]
  ds_read_b64_tr_b16 a[146:147], v16 offset:20480
  v_lshlrev_b32 v26, 16, v29
  v_mfma_f32_16x16x32_bf16 v[184:187], a[176:179], v[96:99], v[232:235]
  v_exp_f32 v241, v161
  v_mfma_f32_16x16x32_bf16 v[184:187], a[180:183], v[100:103], v[184:187]
  ds_read_b64_tr_b16 a[148:149], v17 offset:16384
  v_cvt_pk_bf16_f32 v208, v240, v241
  v_mfma_f32_16x16x32_bf16 v[184:187], a[184:187], v[104:107], v[184:187]
  v_exp_f32 v242, v162
  v_mfma_f32_16x16x32_bf16 v[184:187], a[188:191], v[108:111], v[184:187]
  ds_read_b64_tr_b16 a[150:151], v17 offset:20480
  v_and_b32 v3, 0xffff0000, v29
  v_mfma_f32_16x16x32_bf16 v[188:191], a[176:179], v[112:115], v[236:239]
  v_exp_f32 v243, v163
  v_mfma_f32_16x16x32_bf16 v[188:191], a[180:183], v[116:119], v[188:191]
  ds_read_b64_tr_b16 a[152:153], v18 offset:16384
  v_cvt_pk_bf16_f32 v209, v242, v243
  v_mfma_f32_16x16x32_bf16 v[188:191], a[184:187], v[120:123], v[188:191]
  v_exp_f32 v244, v164
  v_mfma_f32_16x16x32_bf16 v[188:191], a[188:191], v[124:127], v[188:191]
  ds_read_b64_tr_b16 a[154:155], v18 offset:20480
  s_waitcnt lgkmcnt(6)
  v_mfma_f32_16x16x32_bf16 a[0:3], a[128:131], v[192:195], a[0:3]
  v_exp_f32 v245, v165
  v_mfma_f32_16x16x32_bf16 a[4:7], a[128:131], v[196:199], a[4:7]
  ds_read_b64_tr_b16 a[156:157], v19 offset:16384
  v_cvt_pk_bf16_f32 v212, v244, v245
  v_mfma_f32_16x16x32_bf16 a[8:11], a[128:131], v[200:203], a[8:11]
  v_exp_f32 v246, v166
  v_mfma_f32_16x16x32_bf16 a[12:15], a[128:131], v[204:207], a[12:15]
  ds_read_b64_tr_b16 a[158:159], v19 offset:20480
  v_mfma_f32_16x16x32_bf16 a[16:19], a[132:135], v[192:195], a[16:19]
  v_exp_f32 v247, v167
  v_mfma_f32_16x16x32_bf16 a[20:23], a[132:135], v[196:199], a[20:23]
  ds_read_b128 a[160:163], v8 offset:32768
  v_cvt_pk_bf16_f32 v213, v246, v247
  v_mfma_f32_16x16x32_bf16 a[24:27], a[132:135], v[200:203], a[24:27]
  v_exp_f32 v240, v168
  v_mfma_f32_16x16x32_bf16 a[28:31], a[132:135], v[204:207], a[28:31]
  buffer_load_dwordx4 v22, s[20:23], s53 offen offset:2048 lds
  v_mfma_f32_16x16x32_bf16 a[32:35], a[136:139], v[192:195], a[32:35]
  v_exp_f32 v241, v169
  v_mfma_f32_16x16x32_bf16 a[36:39], a[136:139], v[196:199], a[36:39]
  ds_read_b128 a[164:167], v9 offset:32768
  v_cvt_pk_bf16_f32 v216, v240, v241
  v_mfma_f32_16x16x32_bf16 a[40:43], a[136:139], v[200:203], a[40:43]
  v_exp_f32 v242, v170
  v_mfma_f32_16x16x32_bf16 a[44:47], a[136:139], v[204:207], a[44:47]
  buffer_load_dwordx4 v23, s[20:23], s53 offen offset:3072 lds
  s_add_u32 m0, s52, 65536
  v_mfma_f32_16x16x32_bf16 a[48:51], a[140:143], v[192:195], a[48:51]
  v_exp_f32 v243, v171
  v_mfma_f32_16x16x32_bf16 a[52:55], a[140:143], v[196:199], a[52:55]
  ds_read_b128 a[168:171], v10 offset:32768
  v_cvt_pk_bf16_f32 v217, v242, v243
  v_mfma_f32_16x16x32_bf16 a[56:59], a[140:143], v[200:203], a[56:59]
  v_exp_f32 v244, v172
  v_mfma_f32_16x16x32_bf16 a[60:63], a[140:143], v[204:207], a[60:63]
  ds_read_b128 a[172:175], v11 offset:32768
  s_waitcnt lgkmcnt(4)
  v_mfma_f32_16x16x32_bf16 a[64:67], a[144:147], v[192:195], a[64:67]
  v_exp_f32 v245, v173
  v_mfma_f32_16x16x32_bf16 a[68:71], a[144:147], v[196:199], a[68:71]
  ds_read_b128 a[176:179], v8 offset:36864
  v_cvt_pk_bf16_f32 v220, v244, v245
  v_mfma_f32_16x16x32_bf16 a[72:75], a[144:147], v[200:203], a[72:75]
  v_exp_f32 v246, v174
  v_mfma_f32_16x16x32_bf16 a[76:79], a[144:147], v[204:207], a[76:79]
  buffer_load_dwordx4 v24, s[24:27], s54 offen offset:0 lds
  v_mfma_f32_16x16x32_bf16 a[80:83], a[148:151], v[192:195], a[80:83]
  v_exp_f32 v247, v175
  v_mfma_f32_16x16x32_bf16 a[84:87], a[148:151], v[196:199], a[84:87]
  ds_read_b128 a[180:183], v9 offset:36864
  v_cvt_pk_bf16_f32 v221, v246, v247
  v_mfma_f32_16x16x32_bf16 a[88:91], a[148:151], v[200:203], a[88:91]
  v_exp_f32 v240, v176
  v_mfma_f32_16x16x32_bf16 a[92:95], a[148:151], v[204:207], a[92:95]
  buffer_load_dwordx4 v25, s[24:27], s54 offen offset:1024 lds
  v_mfma_f32_16x16x32_bf16 a[96:99], a[152:155], v[192:195], a[96:99]
  v_exp_f32 v241, v177
  v_mfma_f32_16x16x32_bf16 a[100:103], a[152:155], v[196:199], a[100:103]
  ds_read_b128 a[184:187], v10 offset:36864
  v_cvt_pk_bf16_f32 v210, v240, v241
  v_mfma_f32_16x16x32_bf16 a[104:107], a[152:155], v[200:203], a[104:107]
  v_exp_f32 v242, v178
  v_mfma_f32_16x16x32_bf16 a[108:111], a[152:155], v[204:207], a[108:111]
  buffer_load_dwordx4 v24, s[24:27], s54 offen offset:2048 lds
  v_mfma_f32_16x16x32_bf16 a[112:115], a[156:159], v[192:195], a[112:115]
  v_exp_f32 v243, v179
  v_mfma_f32_16x16x32_bf16 a[116:119], a[156:159], v[196:199], a[116:119]
  ds_read_b128 a[188:191], v11 offset:36864
  v_cvt_pk_bf16_f32 v211, v242, v243
  v_mfma_f32_16x16x32_bf16 a[120:123], a[156:159], v[200:203], a[120:123]
  v_exp_f32 v244, v180
  v_mfma_f32_16x16x32_bf16 a[124:127], a[156:159], v[204:207], a[124:127]
  buffer_load_dwordx4 v25, s[24:27], s54 offen offset:3072 lds
  v_mfma_f32_16x16x32_bf16 v[32:35], v[248:251], v[192:195], v[32:35]
  v_exp_f32 v245, v181
  v_mfma_f32_16x16x32_bf16 v[36:39], v[248:251], v[196:199], v[36:39]
  v_cvt_pk_bf16_f32 v214, v244, v245
  v_fmac_f32 v50, v26, v27
  v_mfma_f32_16x16x32_bf16 v[40:43], v[248:251], v[200:203], v[40:43]
  v_exp_f32 v246, v182
  v_mfma_f32_16x16x32_bf16 v[44:47], v[248:251], v[204:207], v[44:47]
  s_waitcnt lgkmcnt(0)
  v_fmac_f32 v51, v3, v27
  v_mfma_f32_16x16x32_bf16 v[128:131], a[160:163], v[64:67], v[224:227]
  v_exp_f32 v247, v183
  v_mfma_f32_16x16x32_bf16 v[128:131], a[164:167], v[68:71], v[128:131]
  v_cvt_pk_bf16_f32 v215, v246, v247
  v_mfma_f32_16x16x32_bf16 v[128:131], a[168:171], v[72:75], v[128:131]
  v_exp_f32 v240, v184
  v_mfma_f32_16x16x32_bf16 v[128:131], a[172:175], v[76:79], v[128:131]
  buffer_load_dwordx4 a[196:199], v7, s[36:39], s59 offen
  v_mfma_f32_16x16x32_bf16 v[132:135], a[160:163], v[80:83], v[228:231]
  v_exp_f32 v241, v185
  v_mfma_f32_16x16x32_bf16 v[132:135], a[164:167], v[84:87], v[132:135]
  ds_read_b64_tr_b16 a[128:129], v12 offset:24576
  v_cvt_pk_bf16_f32 v218, v240, v241
  v_mfma_f32_16x16x32_bf16 v[132:135], a[168:171], v[88:91], v[132:135]
  v_exp_f32 v242, v186
  v_mfma_f32_16x16x32_bf16 v[132:135], a[172:175], v[92:95], v[132:135]
  ds_read_b64_tr_b16 a[130:131], v12 offset:28672
  s_add_u32 s53, s53, 16384
  v_mfma_f32_16x16x32_bf16 v[136:139], a[160:163], v[96:99], v[232:235]
  v_exp_f32 v243, v187
  v_mfma_f32_16x16x32_bf16 v[136:139], a[164:167], v[100:103], v[136:139]
  ds_read_b64_tr_b16 a[132:133], v13 offset:24576
  v_cvt_pk_bf16_f32 v219, v242, v243
  v_mfma_f32_16x16x32_bf16 v[136:139], a[168:171], v[104:107], v[136:139]
  v_exp_f32 v244, v188
  v_mfma_f32_16x16x32_bf16 v[136:139], a[172:175], v[108:111], v[136:139]
  ds_read_b64_tr_b16 a[134:135], v13 offset:28672
  s_add_u32 s54, s54, 16384
  v_mfma_f32_16x16x32_bf16 v[140:143], a[160:163], v[112:115], v[236:239]
  v_exp_f32 v245, v189
  v_mfma_f32_16x16x32_bf16 v[140:143], a[164:167], v[116:119], v[140:143]
  ds_read_b64_tr_b16 a[136:137], v14 offset:24576
  v_cvt_pk_bf16_f32 v222, v244, v245
  v_mfma_f32_16x16x32_bf16 v[140:143], a[168:171], v[120:123], v[140:143]
  v_exp_f32 v246, v190
  v_mfma_f32_16x16x32_bf16 v[140:143], a[172:175], v[124:127], v[140:143]
  ds_read_b64_tr_b16 a[138:139], v14 offset:28672
  v_mfma_f32_16x16x32_bf16 v[144:147], a[176:179], v[64:67], v[224:227]
  v_exp_f32 v247, v191
  v_mfma_f32_16x16x32_bf16 v[144:147], a[180:183], v[68:71], v[144:147]
  ds_read_b64_tr_b16 a[140:141], v15 offset:24576
  v_cvt_pk_bf16_f32 v223, v246, v247
  v_mfma_f32_16x16x32_bf16 v[144:147], a[184:187], v[72:75], v[144:147]
  v_mfma_f32_16x16x32_bf16 v[144:147], a[188:191], v[76:79], v[144:147]
  ds_read_b64_tr_b16 a[142:143], v15 offset:28672
  v_mfma_f32_16x16x32_bf16 v[148:151], a[176:179], v[80:83], v[228:231]
  v_mfma_f32_16x16x32_bf16 v[148:151], a[180:183], v[84:87], v[148:151]
  ds_read_b64_tr_b16 a[144:145], v16 offset:24576
  v_mfma_f32_16x16x32_bf16 v[148:151], a[184:187], v[88:91], v[148:151]
  v_exp_f32 v240, v128
  v_mfma_f32_16x16x32_bf16 v[148:151], a[188:191], v[92:95], v[148:151]
  ds_read_b64_tr_b16 a[146:147], v16 offset:28672
  v_mfma_f32_16x16x32_bf16 v[152:155], a[176:179], v[96:99], v[232:235]
  v_exp_f32 v241, v129
  v_mfma_f32_16x16x32_bf16 v[152:155], a[180:183], v[100:103], v[152:155]
  ds_read_b64_tr_b16 a[148:149], v17 offset:24576
  v_cvt_pk_bf16_f32 v192, v240, v241
  v_mfma_f32_16x16x32_bf16 v[152:155], a[184:187], v[104:107], v[152:155]
  v_exp_f32 v242, v130
  v_mfma_f32_16x16x32_bf16 v[152:155], a[188:191], v[108:111], v[152:155]
  ds_read_b64_tr_b16 a[150:151], v17 offset:28672
  v_mfma_f32_16x16x32_bf16 v[156:159], a[176:179], v[112:115], v[236:239]
  v_exp_f32 v243, v131
  v_mfma_f32_16x16x32_bf16 v[156:159], a[180:183], v[116:119], v[156:159]
  ds_read_b64_tr_b16 a[152:153], v18 offset:24576
  v_cvt_pk_bf16_f32 v193, v242, v243
  v_mfma_f32_16x16x32_bf16 v[156:159], a[184:187], v[120:123], v[156:159]
  v_exp_f32 v244, v132
  v_mfma_f32_16x16x32_bf16 v[156:159], a[188:191], v[124:127], v[156:159]
  ds_read_b64_tr_b16 a[154:155], v18 offset:28672
  s_waitcnt lgkmcnt(6)
  v_mfma_f32_16x16x32_bf16 a[0:3], a[128:131], v[208:211], a[0:3]
  v_exp_f32 v245, v133
  v_mfma_f32_16x16x32_bf16 a[4:7], a[128:131], v[212:215], a[4:7]
  ds_read_b64_tr_b16 a[156:157], v19 offset:24576
  v_cvt_pk_bf16_f32 v196, v244, v245
  v_mfma_f32_16x16x32_bf16 a[8:11], a[128:131], v[216:219], a[8:11]
  v_exp_f32 v246, v134
  v_mfma_f32_16x16x32_bf16 a[12:15], a[128:131], v[220:223], a[12:15]
  ds_read_b64_tr_b16 a[158:159], v19 offset:28672
  v_lshlrev_b32 v26, 16, v30
  v_mfma_f32_16x16x32_bf16 a[16:19], a[132:135], v[208:211], a[16:19]
  v_exp_f32 v247, v135
  v_mfma_f32_16x16x32_bf16 a[20:23], a[132:135], v[212:215], a[20:23]
  ds_read_b128 a[160:163], v8 offset:40960
  v_cvt_pk_bf16_f32 v197, v246, v247
  v_mfma_f32_16x16x32_bf16 a[24:27], a[132:135], v[216:219], a[24:27]
  v_exp_f32 v240, v136
  v_mfma_f32_16x16x32_bf16 a[28:31], a[132:135], v[220:223], a[28:31]
  v_and_b32 v3, 0xffff0000, v30
  v_fmac_f32 v52, v26, v27
  v_mfma_f32_16x16x32_bf16 a[32:35], a[136:139], v[208:211], a[32:35]
  v_exp_f32 v241, v137
  v_mfma_f32_16x16x32_bf16 a[36:39], a[136:139], v[212:215], a[36:39]
  ds_read_b128 a[164:167], v9 offset:40960
  v_cvt_pk_bf16_f32 v200, v240, v241
  v_mfma_f32_16x16x32_bf16 a[40:43], a[136:139], v[216:219], a[40:43]
  v_exp_f32 v242, v138
  v_mfma_f32_16x16x32_bf16 a[44:47], a[136:139], v[220:223], a[44:47]
  v_fmac_f32 v53, v3, v27
  v_lshlrev_b32 v26, 16, v31
  v_mfma_f32_16x16x32_bf16 a[48:51], a[140:143], v[208:211], a[48:51]
  v_exp_f32 v243, v139
  v_mfma_f32_16x16x32_bf16 a[52:55], a[140:143], v[212:215], a[52:55]
  ds_read_b128 a[168:171], v10 offset:40960
  v_cvt_pk_bf16_f32 v201, v242, v243
  v_mfma_f32_16x16x32_bf16 a[56:59], a[140:143], v[216:219], a[56:59]
  v_exp_f32 v244, v140
  v_mfma_f32_16x16x32_bf16 a[60:63], a[140:143], v[220:223], a[60:63]
  ds_read_b128 a[172:175], v11 offset:40960
  s_waitcnt lgkmcnt(4)
  v_mfma_f32_16x16x32_bf16 a[64:67], a[144:147], v[208:211], a[64:67]
  v_exp_f32 v245, v141
  v_mfma_f32_16x16x32_bf16 a[68:71], a[144:147], v[212:215], a[68:71]
  ds_read_b128 a[176:179], v8 offset:45056
  v_cvt_pk_bf16_f32 v204, v244, v245
  v_mfma_f32_16x16x32_bf16 a[72:75], a[144:147], v[216:219], a[72:75]
  v_exp_f32 v246, v142
  v_mfma_f32_16x16x32_bf16 a[76:79], a[144:147], v[220:223], a[76:79]
  v_and_b32 v3, 0xffff0000, v31
  v_fmac_f32 v63, v26, v27
  v_mfma_f32_16x16x32_bf16 a[80:83], a[148:151], v[208:211], a[80:83]
  v_exp_f32 v247, v143
  v_mfma_f32_16x16x32_bf16 a[84:87], a[148:151], v[212:215], a[84:87]
  ds_read_b128 a[180:183], v9 offset:45056
  v_cvt_pk_bf16_f32 v205, v246, v247
  v_mfma_f32_16x16x32_bf16 a[88:91], a[148:151], v[216:219], a[88:91]
  v_exp_f32 v240, v144
  v_mfma_f32_16x16x32_bf16 a[92:95], a[148:151], v[220:223], a[92:95]
  v_fmac_f32 v2, v3, v27
  v_mfma_f32_16x16x32_bf16 a[96:99], a[152:155], v[208:211], a[96:99]
  v_exp_f32 v241, v145
  v_mfma_f32_16x16x32_bf16 a[100:103], a[152:155], v[212:215], a[100:103]
  ds_read_b128 a[184:187], v10 offset:45056
  v_cvt_pk_bf16_f32 v194, v240, v241
  v_mfma_f32_16x16x32_bf16 a[104:107], a[152:155], v[216:219], a[104:107]
  v_exp_f32 v242, v146
  v_mfma_f32_16x16x32_bf16 a[108:111], a[152:155], v[220:223], a[108:111]
  buffer_load_dwordx4 v[28:31], v4, s[64:67], s76 offen
  v_mfma_f32_16x16x32_bf16 a[112:115], a[156:159], v[208:211], a[112:115]
  v_exp_f32 v243, v147
  v_mfma_f32_16x16x32_bf16 a[116:119], a[156:159], v[212:215], a[116:119]
  ds_read_b128 a[188:191], v11 offset:45056
  v_cvt_pk_bf16_f32 v195, v242, v243
  v_mfma_f32_16x16x32_bf16 a[120:123], a[156:159], v[216:219], a[120:123]
  v_exp_f32 v244, v148
  v_mfma_f32_16x16x32_bf16 a[124:127], a[156:159], v[220:223], a[124:127]
  buffer_load_dword v27, v5, s[68:71], s77 offen
  v_mfma_f32_16x16x32_bf16 v[32:35], v[248:251], v[208:211], v[32:35]
  v_exp_f32 v245, v149
  v_mfma_f32_16x16x32_bf16 v[36:39], v[248:251], v[212:215], v[36:39]
  v_cvt_pk_bf16_f32 v198, v244, v245
  s_add_u32 s76, s76, 98304
  v_mfma_f32_16x16x32_bf16 v[40:43], v[248:251], v[216:219], v[40:43]
  v_exp_f32 v246, v150
  v_mfma_f32_16x16x32_bf16 v[44:47], v[248:251], v[220:223], v[44:47]
  s_waitcnt lgkmcnt(0)
  s_add_u32 s77, s77, 32
  v_mfma_f32_16x16x32_bf16 v[160:163], a[160:163], v[64:67], v[224:227]
  v_exp_f32 v247, v151
  v_mfma_f32_16x16x32_bf16 v[160:163], a[164:167], v[68:71], v[160:163]
  v_cvt_pk_bf16_f32 v199, v246, v247
  s_mul_i32 s56, s59, 7
  v_mfma_f32_16x16x32_bf16 v[160:163], a[168:171], v[72:75], v[160:163]
  v_exp_f32 v240, v152
  v_mfma_f32_16x16x32_bf16 v[160:163], a[172:175], v[76:79], v[160:163]
  s_waitcnt vmcnt(21)
  s_barrier
  v_mfma_f32_16x16x32_bf16 v[164:167], a[160:163], v[80:83], v[228:231]
  v_exp_f32 v241, v153
  v_mfma_f32_16x16x32_bf16 v[164:167], a[164:167], v[84:87], v[164:167]
  ds_read_b64_tr_b16 a[128:129], v12 offset:32768
  v_cvt_pk_bf16_f32 v202, v240, v241
  v_mfma_f32_16x16x32_bf16 v[164:167], a[168:171], v[88:91], v[164:167]
  v_exp_f32 v242, v154
  v_mfma_f32_16x16x32_bf16 v[164:167], a[172:175], v[92:95], v[164:167]
  ds_read_b64_tr_b16 a[130:131], v12 offset:36864
  s_add_u32 m0, s52, 32768
  v_mfma_f32_16x16x32_bf16 v[168:171], a[160:163], v[96:99], v[232:235]
  v_exp_f32 v243, v155
  v_mfma_f32_16x16x32_bf16 v[168:171], a[164:167], v[100:103], v[168:171]
  ds_read_b64_tr_b16 a[132:133], v13 offset:32768
  v_cvt_pk_bf16_f32 v203, v242, v243
  v_mfma_f32_16x16x32_bf16 v[168:171], a[168:171], v[104:107], v[168:171]
  v_exp_f32 v244, v156
  v_mfma_f32_16x16x32_bf16 v[168:171], a[172:175], v[108:111], v[168:171]
  ds_read_b64_tr_b16 a[134:135], v13 offset:36864
  s_lshr_b32 s56, s56, 8
  v_mfma_f32_16x16x32_bf16 v[172:175], a[160:163], v[112:115], v[236:239]
  v_exp_f32 v245, v157
  v_mfma_f32_16x16x32_bf16 v[172:175], a[164:167], v[116:119], v[172:175]
  ds_read_b64_tr_b16 a[136:137], v14 offset:32768
  v_cvt_pk_bf16_f32 v206, v244, v245
  v_mfma_f32_16x16x32_bf16 v[172:175], a[168:171], v[120:123], v[172:175]
  v_exp_f32 v246, v158
  v_mfma_f32_16x16x32_bf16 v[172:175], a[172:175], v[124:127], v[172:175]
  ds_read_b64_tr_b16 a[138:139], v14 offset:36864
  s_add_u32 s46, s46, 917504
  v_mfma_f32_16x16x32_bf16 v[176:179], a[176:179], v[64:67], v[224:227]
  v_exp_f32 v247, v159
  v_mfma_f32_16x16x32_bf16 v[176:179], a[180:183], v[68:71], v[176:179]
  ds_read_b64_tr_b16 a[140:141], v15 offset:32768
  v_cvt_pk_bf16_f32 v207, v246, v247
  v_mfma_f32_16x16x32_bf16 v[176:179], a[184:187], v[72:75], v[176:179]
  buffer_load_dwordx4 v20, s[20:23], s53 offen offset:0 lds
  v_mfma_f32_16x16x32_bf16 v[176:179], a[188:191], v[76:79], v[176:179]
  ds_read_b64_tr_b16 a[142:143], v15 offset:36864
  v_mfma_f32_16x16x32_bf16 v[180:183], a[176:179], v[80:83], v[228:231]
  buffer_load_dwordx4 v21, s[20:23], s53 offen offset:1024 lds
  v_mfma_f32_16x16x32_bf16 v[180:183], a[180:183], v[84:87], v[180:183]
  ds_read_b64_tr_b16 a[144:145], v16 offset:32768
  v_mfma_f32_16x16x32_bf16 v[180:183], a[184:187], v[88:91], v[180:183]
  v_exp_f32 v240, v160
  v_mfma_f32_16x16x32_bf16 v[180:183], a[188:191], v[92:95], v[180:183]
  ds_read_b64_tr_b16 a[146:147], v16 offset:36864
  v_mfma_f32_16x16x32_bf16 v[184:187], a[176:179], v[96:99], v[232:235]
  v_exp_f32 v241, v161
  v_mfma_f32_16x16x32_bf16 v[184:187], a[180:183], v[100:103], v[184:187]
  ds_read_b64_tr_b16 a[148:149], v17 offset:32768
  v_cvt_pk_bf16_f32 v208, v240, v241
  v_mfma_f32_16x16x32_bf16 v[184:187], a[184:187], v[104:107], v[184:187]
  v_exp_f32 v242, v162
  v_mfma_f32_16x16x32_bf16 v[184:187], a[188:191], v[108:111], v[184:187]
  ds_read_b64_tr_b16 a[150:151], v17 offset:36864
  v_mfma_f32_16x16x32_bf16 v[188:191], a[176:179], v[112:115], v[236:239]
  v_exp_f32 v243, v163
  v_mfma_f32_16x16x32_bf16 v[188:191], a[180:183], v[116:119], v[188:191]
  ds_read_b64_tr_b16 a[152:153], v18 offset:32768
  v_cvt_pk_bf16_f32 v209, v242, v243
  v_mfma_f32_16x16x32_bf16 v[188:191], a[184:187], v[120:123], v[188:191]
  v_exp_f32 v244, v164
  v_mfma_f32_16x16x32_bf16 v[188:191], a[188:191], v[124:127], v[188:191]
  ds_read_b64_tr_b16 a[154:155], v18 offset:36864
  s_waitcnt lgkmcnt(6)
  v_mfma_f32_16x16x32_bf16 a[0:3], a[128:131], v[192:195], a[0:3]
  v_exp_f32 v245, v165
  v_mfma_f32_16x16x32_bf16 a[4:7], a[128:131], v[196:199], a[4:7]
  ds_read_b64_tr_b16 a[156:157], v19 offset:32768
  v_cvt_pk_bf16_f32 v212, v244, v245
  v_mfma_f32_16x16x32_bf16 a[8:11], a[128:131], v[200:203], a[8:11]
  v_exp_f32 v246, v166
  v_mfma_f32_16x16x32_bf16 a[12:15], a[128:131], v[204:207], a[12:15]
  ds_read_b64_tr_b16 a[158:159], v19 offset:36864
  v_mfma_f32_16x16x32_bf16 a[16:19], a[132:135], v[192:195], a[16:19]
  v_exp_f32 v247, v167
  v_mfma_f32_16x16x32_bf16 a[20:23], a[132:135], v[196:199], a[20:23]
  ds_read_b128 a[160:163], v8 offset:49152
  v_cvt_pk_bf16_f32 v213, v246, v247
  v_mfma_f32_16x16x32_bf16 a[24:27], a[132:135], v[200:203], a[24:27]
  v_exp_f32 v240, v168
  v_mfma_f32_16x16x32_bf16 a[28:31], a[132:135], v[204:207], a[28:31]
  buffer_load_dwordx4 v22, s[20:23], s53 offen offset:2048 lds
  v_mfma_f32_16x16x32_bf16 a[32:35], a[136:139], v[192:195], a[32:35]
  v_exp_f32 v241, v169
  v_mfma_f32_16x16x32_bf16 a[36:39], a[136:139], v[196:199], a[36:39]
  ds_read_b128 a[164:167], v9 offset:49152
  v_cvt_pk_bf16_f32 v216, v240, v241
  v_mfma_f32_16x16x32_bf16 a[40:43], a[136:139], v[200:203], a[40:43]
  v_exp_f32 v242, v170
  v_mfma_f32_16x16x32_bf16 a[44:47], a[136:139], v[204:207], a[44:47]
  buffer_load_dwordx4 v23, s[20:23], s53 offen offset:3072 lds
  s_add_u32 m0, s52, 81920
  v_mfma_f32_16x16x32_bf16 a[48:51], a[140:143], v[192:195], a[48:51]
  v_exp_f32 v243, v171
  v_mfma_f32_16x16x32_bf16 a[52:55], a[140:143], v[196:199], a[52:55]
  ds_read_b128 a[168:171], v10 offset:49152
  v_cvt_pk_bf16_f32 v217, v242, v243
  v_mfma_f32_16x16x32_bf16 a[56:59], a[140:143], v[200:203], a[56:59]
  v_exp_f32 v244, v172
  v_mfma_f32_16x16x32_bf16 a[60:63], a[140:143], v[204:207], a[60:63]
  ds_read_b128 a[172:175], v11 offset:49152
  s_waitcnt lgkmcnt(4)
  v_mfma_f32_16x16x32_bf16 a[64:67], a[144:147], v[192:195], a[64:67]
  v_exp_f32 v245, v173
  v_mfma_f32_16x16x32_bf16 a[68:71], a[144:147], v[196:199], a[68:71]
  ds_read_b128 a[176:179], v8 offset:53248
  v_cvt_pk_bf16_f32 v220, v244, v245
  v_mfma_f32_16x16x32_bf16 a[72:75], a[144:147], v[200:203], a[72:75]
  v_exp_f32 v246, v174
  v_mfma_f32_16x16x32_bf16 a[76:79], a[144:147], v[204:207], a[76:79]
  buffer_load_dwordx4 v24, s[24:27], s54 offen offset:0 lds
  v_mfma_f32_16x16x32_bf16 a[80:83], a[148:151], v[192:195], a[80:83]
  v_exp_f32 v247, v175
  v_mfma_f32_16x16x32_bf16 a[84:87], a[148:151], v[196:199], a[84:87]
  ds_read_b128 a[180:183], v9 offset:53248
  v_cvt_pk_bf16_f32 v221, v246, v247
  v_mfma_f32_16x16x32_bf16 a[88:91], a[148:151], v[200:203], a[88:91]
  v_exp_f32 v240, v176
  v_mfma_f32_16x16x32_bf16 a[92:95], a[148:151], v[204:207], a[92:95]
  buffer_load_dwordx4 v25, s[24:27], s54 offen offset:1024 lds
  v_mfma_f32_16x16x32_bf16 a[96:99], a[152:155], v[192:195], a[96:99]
  v_exp_f32 v241, v177
  v_mfma_f32_16x16x32_bf16 a[100:103], a[152:155], v[196:199], a[100:103]
  ds_read_b128 a[184:187], v10 offset:53248
  v_cvt_pk_bf16_f32 v210, v240, v241
  v_mfma_f32_16x16x32_bf16 a[104:107], a[152:155], v[200:203], a[104:107]
  v_exp_f32 v242, v178
  v_mfma_f32_16x16x32_bf16 a[108:111], a[152:155], v[204:207], a[108:111]
  buffer_load_dwordx4 v24, s[24:27], s54 offen offset:2048 lds
  v_mfma_f32_16x16x32_bf16 a[112:115], a[156:159], v[192:195], a[112:115]
  v_exp_f32 v243, v179
  v_mfma_f32_16x16x32_bf16 a[116:119], a[156:159], v[196:199], a[116:119]
  ds_read_b128 a[188:191], v11 offset:53248
  v_cvt_pk_bf16_f32 v211, v242, v243
  v_mfma_f32_16x16x32_bf16 a[120:123], a[156:159], v[200:203], a[120:123]
  v_exp_f32 v244, v180
  v_mfma_f32_16x16x32_bf16 a[124:127], a[156:159], v[204:207], a[124:127]
  buffer_load_dwordx4 v25, s[24:27], s54 offen offset:3072 lds
  v_mfma_f32_16x16x32_bf16 v[32:35], v[248:251], v[192:195], v[32:35]
  v_exp_f32 v245, v181
  v_mfma_f32_16x16x32_bf16 v[36:39], v[248:251], v[196:199], v[36:39]
  v_cvt_pk_bf16_f32 v214, v244, v245
  v_mfma_f32_16x16x32_bf16 v[40:43], v[248:251], v[200:203], v[40:43]
  v_exp_f32 v246, v182
  v_mfma_f32_16x16x32_bf16 v[44:47], v[248:251], v[204:207], v[44:47]
  s_waitcnt lgkmcnt(0)
  v_mfma_f32_16x16x32_bf16 v[128:131], a[160:163], v[64:67], v[224:227]
  v_exp_f32 v247, v183
  v_mfma_f32_16x16x32_bf16 v[128:131], a[164:167], v[68:71], v[128:131]
  v_cvt_pk_bf16_f32 v215, v246, v247
  v_mfma_f32_16x16x32_bf16 v[128:131], a[168:171], v[72:75], v[128:131]
  v_exp_f32 v240, v184
  v_mfma_f32_16x16x32_bf16 v[128:131], a[172:175], v[76:79], v[128:131]
  buffer_load_dwordx4 a[200:203], v7, s[60:63], s59 offen
  v_mfma_f32_16x16x32_bf16 v[132:135], a[160:163], v[80:83], v[228:231]
  v_exp_f32 v241, v185
  v_mfma_f32_16x16x32_bf16 v[132:135], a[164:167], v[84:87], v[132:135]
  ds_read_b64_tr_b16 a[128:129], v12 offset:40960
  v_cvt_pk_bf16_f32 v218, v240, v241
  v_mfma_f32_16x16x32_bf16 v[132:135], a[168:171], v[88:91], v[132:135]
  v_exp_f32 v242, v186
  v_mfma_f32_16x16x32_bf16 v[132:135], a[172:175], v[92:95], v[132:135]
  ds_read_b64_tr_b16 a[130:131], v12 offset:45056
  s_add_u32 s53, s53, 16384
  v_mfma_f32_16x16x32_bf16 v[136:139], a[160:163], v[96:99], v[232:235]
  v_exp_f32 v243, v187
  v_mfma_f32_16x16x32_bf16 v[136:139], a[164:167], v[100:103], v[136:139]
  ds_read_b64_tr_b16 a[132:133], v13 offset:40960
  v_cvt_pk_bf16_f32 v219, v242, v243
  v_mfma_f32_16x16x32_bf16 v[136:139], a[168:171], v[104:107], v[136:139]
  v_exp_f32 v244, v188
  v_mfma_f32_16x16x32_bf16 v[136:139], a[172:175], v[108:111], v[136:139]
  ds_read_b64_tr_b16 a[134:135], v13 offset:45056
  s_add_u32 s54, s54, 16384
  v_mfma_f32_16x16x32_bf16 v[140:143], a[160:163], v[112:115], v[236:239]
  v_exp_f32 v245, v189
  v_mfma_f32_16x16x32_bf16 v[140:143], a[164:167], v[116:119], v[140:143]
  ds_read_b64_tr_b16 a[136:137], v14 offset:40960
  v_cvt_pk_bf16_f32 v222, v244, v245
  v_mfma_f32_16x16x32_bf16 v[140:143], a[168:171], v[120:123], v[140:143]
  v_exp_f32 v246, v190
  v_mfma_f32_16x16x32_bf16 v[140:143], a[172:175], v[124:127], v[140:143]
  ds_read_b64_tr_b16 a[138:139], v14 offset:45056
  v_mfma_f32_16x16x32_bf16 v[144:147], a[176:179], v[64:67], v[224:227]
  v_exp_f32 v247, v191
  v_mfma_f32_16x16x32_bf16 v[144:147], a[180:183], v[68:71], v[144:147]
  ds_read_b64_tr_b16 a[140:141], v15 offset:40960
  v_cvt_pk_bf16_f32 v223, v246, v247
  v_mfma_f32_16x16x32_bf16 v[144:147], a[184:187], v[72:75], v[144:147]
  v_mfma_f32_16x16x32_bf16 v[144:147], a[188:191], v[76:79], v[144:147]
  ds_read_b64_tr_b16 a[142:143], v15 offset:45056
  v_mfma_f32_16x16x32_bf16 v[148:151], a[176:179], v[80:83], v[228:231]
  v_mfma_f32_16x16x32_bf16 v[148:151], a[180:183], v[84:87], v[148:151]
  ds_read_b64_tr_b16 a[144:145], v16 offset:40960
  v_mfma_f32_16x16x32_bf16 v[148:151], a[184:187], v[88:91], v[148:151]
  v_exp_f32 v240, v128
  v_mfma_f32_16x16x32_bf16 v[148:151], a[188:191], v[92:95], v[148:151]
  ds_read_b64_tr_b16 a[146:147], v16 offset:45056
  v_mfma_f32_16x16x32_bf16 v[152:155], a[176:179], v[96:99], v[232:235]
  v_exp_f32 v241, v129
  v_mfma_f32_16x16x32_bf16 v[152:155], a[180:183], v[100:103], v[152:155]
  ds_read_b64_tr_b16 a[148:149], v17 offset:40960
  v_cvt_pk_bf16_f32 v192, v240, v241
  v_mfma_f32_16x16x32_bf16 v[152:155], a[184:187], v[104:107], v[152:155]
  v_exp_f32 v242, v130
  v_mfma_f32_16x16x32_bf16 v[152:155], a[188:191], v[108:111], v[152:155]
  ds_read_b64_tr_b16 a[150:151], v17 offset:45056
  v_mfma_f32_16x16x32_bf16 v[156:159], a[176:179], v[112:115], v[236:239]
  v_exp_f32 v243, v131
  v_mfma_f32_16x16x32_bf16 v[156:159], a[180:183], v[116:119], v[156:159]
  ds_read_b64_tr_b16 a[152:153], v18 offset:40960
  v_cvt_pk_bf16_f32 v193, v242, v243
  v_mfma_f32_16x16x32_bf16 v[156:159], a[184:187], v[120:123], v[156:159]
  v_exp_f32 v244, v132
  v_mfma_f32_16x16x32_bf16 v[156:159], a[188:191], v[124:127], v[156:159]
  ds_read_b64_tr_b16 a[154:155], v18 offset:45056
  s_waitcnt lgkmcnt(6)
  v_mfma_f32_16x16x32_bf16 a[0:3], a[128:131], v[208:211], a[0:3]
  v_exp_f32 v245, v133
  v_mfma_f32_16x16x32_bf16 a[4:7], a[128:131], v[212:215], a[4:7]
  ds_read_b64_tr_b16 a[156:157], v19 offset:40960
  v_cvt_pk_bf16_f32 v196, v244, v245
  v_mfma_f32_16x16x32_bf16 a[8:11], a[128:131], v[216:219], a[8:11]
  v_exp_f32 v246, v134
  v_mfma_f32_16x16x32_bf16 a[12:15], a[128:131], v[220:223], a[12:15]
  ds_read_b64_tr_b16 a[158:159], v19 offset:45056
  v_mfma_f32_16x16x32_bf16 a[16:19], a[132:135], v[208:211], a[16:19]
  v_exp_f32 v247, v135
  v_mfma_f32_16x16x32_bf16 a[20:23], a[132:135], v[212:215], a[20:23]
  ds_read_b128 a[160:163], v8 offset:57344
  v_cvt_pk_bf16_f32 v197, v246, v247
  v_mfma_f32_16x16x32_bf16 a[24:27], a[132:135], v[216:219], a[24:27]
  v_exp_f32 v240, v136
  v_mfma_f32_16x16x32_bf16 a[28:31], a[132:135], v[220:223], a[28:31]
  buffer_store_dwordx4 a[208:211], v7, s[72:75], s41 offen sc1
  v_mfma_f32_16x16x32_bf16 a[32:35], a[136:139], v[208:211], a[32:35]
  v_exp_f32 v241, v137
  v_mfma_f32_16x16x32_bf16 a[36:39], a[136:139], v[212:215], a[36:39]
  ds_read_b128 a[164:167], v9 offset:57344
  v_cvt_pk_bf16_f32 v200, v240, v241
  v_mfma_f32_16x16x32_bf16 a[40:43], a[136:139], v[216:219], a[40:43]
  v_exp_f32 v242, v138
  v_mfma_f32_16x16x32_bf16 a[44:47], a[136:139], v[220:223], a[44:47]
  v_mfma_f32_16x16x32_bf16 a[48:51], a[140:143], v[208:211], a[48:51]
  v_exp_f32 v243, v139
  v_mfma_f32_16x16x32_bf16 a[52:55], a[140:143], v[212:215], a[52:55]
  ds_read_b128 a[168:171], v10 offset:57344
  v_cvt_pk_bf16_f32 v201, v242, v243
  v_mfma_f32_16x16x32_bf16 a[56:59], a[140:143], v[216:219], a[56:59]
  v_exp_f32 v244, v140
  v_mfma_f32_16x16x32_bf16 a[60:63], a[140:143], v[220:223], a[60:63]
  ds_read_b128 a[172:175], v11 offset:57344
  s_waitcnt lgkmcnt(4)
  v_mfma_f32_16x16x32_bf16 a[64:67], a[144:147], v[208:211], a[64:67]
  v_exp_f32 v245, v141
  v_mfma_f32_16x16x32_bf16 a[68:71], a[144:147], v[212:215], a[68:71]
  ds_read_b128 a[176:179], v8 offset:61440
  v_cvt_pk_bf16_f32 v204, v244, v245
  v_mfma_f32_16x16x32_bf16 a[72:75], a[144:147], v[216:219], a[72:75]
  v_exp_f32 v246, v142
  v_mfma_f32_16x16x32_bf16 a[76:79], a[144:147], v[220:223], a[76:79]
  s_add_u32 s41, s41, 0x100000
  s_lshr_b32 s49, s59, 3
  v_mfma_f32_16x16x32_bf16 a[80:83], a[148:151], v[208:211], a[80:83]
  v_exp_f32 v247, v143
  v_mfma_f32_16x16x32_bf16 a[84:87], a[148:151], v[212:215], a[84:87]
  ds_read_b128 a[180:183], v9 offset:61440
  v_cvt_pk_bf16_f32 v205, v246, v247
  v_mfma_f32_16x16x32_bf16 a[88:91], a[148:151], v[216:219], a[88:91]
  v_exp_f32 v240, v144
  v_mfma_f32_16x16x32_bf16 a[92:95], a[148:151], v[220:223], a[92:95]
  s_add_u32 s59, s59, 0x100000
  v_mfma_f32_16x16x32_bf16 a[96:99], a[152:155], v[208:211], a[96:99]
  v_exp_f32 v241, v145
  v_mfma_f32_16x16x32_bf16 a[100:103], a[152:155], v[212:215], a[100:103]
  ds_read_b128 a[184:187], v10 offset:61440
  v_cvt_pk_bf16_f32 v194, v240, v241
  v_mfma_f32_16x16x32_bf16 a[104:107], a[152:155], v[216:219], a[104:107]
  v_exp_f32 v242, v146
  v_mfma_f32_16x16x32_bf16 a[108:111], a[152:155], v[220:223], a[108:111]
  v_mfma_f32_16x16x32_bf16 a[112:115], a[156:159], v[208:211], a[112:115]
  v_exp_f32 v243, v147
  v_mfma_f32_16x16x32_bf16 a[116:119], a[156:159], v[212:215], a[116:119]
  ds_read_b128 a[188:191], v11 offset:61440
  v_cvt_pk_bf16_f32 v195, v242, v243
  v_mfma_f32_16x16x32_bf16 a[120:123], a[156:159], v[216:219], a[120:123]
  v_exp_f32 v244, v148
  v_mfma_f32_16x16x32_bf16 a[124:127], a[156:159], v[220:223], a[124:127]
  v_mfma_f32_16x16x32_bf16 v[32:35], v[248:251], v[208:211], v[32:35]
  v_exp_f32 v245, v149
  v_mfma_f32_16x16x32_bf16 v[36:39], v[248:251], v[212:215], v[36:39]
  v_cvt_pk_bf16_f32 v198, v244, v245
  v_mfma_f32_16x16x32_bf16 v[40:43], v[248:251], v[216:219], v[40:43]
  v_exp_f32 v246, v150
  v_mfma_f32_16x16x32_bf16 v[44:47], v[248:251], v[220:223], v[44:47]
  s_waitcnt lgkmcnt(0)
  v_mfma_f32_16x16x32_bf16 v[160:163], a[160:163], v[64:67], v[224:227]
  v_exp_f32 v247, v151
  v_mfma_f32_16x16x32_bf16 v[160:163], a[164:167], v[68:71], v[160:163]
  v_cvt_pk_bf16_f32 v199, v246, v247
  v_mfma_f32_16x16x32_bf16 v[160:163], a[168:171], v[72:75], v[160:163]
  v_exp_f32 v240, v152
  v_mfma_f32_16x16x32_bf16 v[160:163], a[172:175], v[76:79], v[160:163]
  s_waitcnt vmcnt(22)
  s_barrier
  v_mfma_f32_16x16x32_bf16 v[164:167], a[160:163], v[80:83], v[228:231]
  v_exp_f32 v241, v153
  v_mfma_f32_16x16x32_bf16 v[164:167], a[164:167], v[84:87], v[164:167]
  ds_read_b64_tr_b16 a[128:129], v12 offset:49152
  v_cvt_pk_bf16_f32 v202, v240, v241
  v_mfma_f32_16x16x32_bf16 v[164:167], a[168:171], v[88:91], v[164:167]
  v_exp_f32 v242, v154
  v_mfma_f32_16x16x32_bf16 v[164:167], a[172:175], v[92:95], v[164:167]
  ds_read_b64_tr_b16 a[130:131], v12 offset:53248
  s_add_u32 m0, s52, 49152
  v_mfma_f32_16x16x32_bf16 v[168:171], a[160:163], v[96:99], v[232:235]
  v_exp_f32 v243, v155
  v_mfma_f32_16x16x32_bf16 v[168:171], a[164:167], v[100:103], v[168:171]
  ds_read_b64_tr_b16 a[132:133], v13 offset:49152
  v_cvt_pk_bf16_f32 v203, v242, v243
  v_mfma_f32_16x16x32_bf16 v[168:171], a[168:171], v[104:107], v[168:171]
  v_exp_f32 v244, v156
  v_mfma_f32_16x16x32_bf16 v[168:171], a[172:175], v[108:111], v[168:171]
  ds_read_b64_tr_b16 a[134:135], v13 offset:53248
  v_mfma_f32_16x16x32_bf16 v[172:175], a[160:163], v[112:115], v[236:239]
  v_exp_f32 v245, v157
  v_mfma_f32_16x16x32_bf16 v[172:175], a[164:167], v[116:119], v[172:175]
  ds_read_b64_tr_b16 a[136:137], v14 offset:49152
  v_cvt_pk_bf16_f32 v206, v244, v245
  v_mfma_f32_16x16x32_bf16 v[172:175], a[168:171], v[120:123], v[172:175]
  v_exp_f32 v246, v158
  v_mfma_f32_16x16x32_bf16 v[172:175], a[172:175], v[124:127], v[172:175]
  ds_read_b64_tr_b16 a[138:139], v14 offset:53248
  v_mfma_f32_16x16x32_bf16 v[176:179], a[176:179], v[64:67], v[224:227]
  v_exp_f32 v247, v159
  v_mfma_f32_16x16x32_bf16 v[176:179], a[180:183], v[68:71], v[176:179]
  ds_read_b64_tr_b16 a[140:141], v15 offset:49152
  v_cvt_pk_bf16_f32 v207, v246, v247
  v_mfma_f32_16x16x32_bf16 v[176:179], a[184:187], v[72:75], v[176:179]
  buffer_load_dwordx4 v20, s[20:23], s53 offen offset:0 lds
  v_mfma_f32_16x16x32_bf16 v[176:179], a[188:191], v[76:79], v[176:179]
  ds_read_b64_tr_b16 a[142:143], v15 offset:53248
  v_mfma_f32_16x16x32_bf16 v[180:183], a[176:179], v[80:83], v[228:231]
  buffer_load_dwordx4 v21, s[20:23], s53 offen offset:1024 lds
  v_mfma_f32_16x16x32_bf16 v[180:183], a[180:183], v[84:87], v[180:183]
  ds_read_b64_tr_b16 a[144:145], v16 offset:49152
  v_mfma_f32_16x16x32_bf16 v[180:183], a[184:187], v[88:91], v[180:183]
  v_exp_f32 v240, v160
  v_mfma_f32_16x16x32_bf16 v[180:183], a[188:191], v[92:95], v[180:183]
  ds_read_b64_tr_b16 a[146:147], v16 offset:53248
  v_mfma_f32_16x16x32_bf16 v[184:187], a[176:179], v[96:99], v[232:235]
  v_exp_f32 v241, v161
  v_mfma_f32_16x16x32_bf16 v[184:187], a[180:183], v[100:103], v[184:187]
  ds_read_b64_tr_b16 a[148:149], v17 offset:49152
  v_cvt_pk_bf16_f32 v208, v240, v241
  v_mfma_f32_16x16x32_bf16 v[184:187], a[184:187], v[104:107], v[184:187]
  v_exp_f32 v242, v162
  v_mfma_f32_16x16x32_bf16 v[184:187], a[188:191], v[108:111], v[184:187]
  ds_read_b64_tr_b16 a[150:151], v17 offset:53248
  v_mfma_f32_16x16x32_bf16 v[188:191], a[176:179], v[112:115], v[236:239]
  v_exp_f32 v243, v163
  v_mfma_f32_16x16x32_bf16 v[188:191], a[180:183], v[116:119], v[188:191]
  ds_read_b64_tr_b16 a[152:153], v18 offset:49152
  v_cvt_pk_bf16_f32 v209, v242, v243
  v_mfma_f32_16x16x32_bf16 v[188:191], a[184:187], v[120:123], v[188:191]
  v_exp_f32 v244, v164
  v_mfma_f32_16x16x32_bf16 v[188:191], a[188:191], v[124:127], v[188:191]
  ds_read_b64_tr_b16 a[154:155], v18 offset:53248
  s_waitcnt lgkmcnt(6)
  v_mfma_f32_16x16x32_bf16 a[0:3], a[128:131], v[192:195], a[0:3]
  v_exp_f32 v245, v165
  v_mfma_f32_16x16x32_bf16 a[4:7], a[128:131], v[196:199], a[4:7]
  ds_read_b64_tr_b16 a[156:157], v19 offset:49152
  v_cvt_pk_bf16_f32 v212, v244, v245
  v_mfma_f32_16x16x32_bf16 a[8:11], a[128:131], v[200:203], a[8:11]
  v_exp_f32 v246, v166
  v_mfma_f32_16x16x32_bf16 a[12:15], a[128:131], v[204:207], a[12:15]
  ds_read_b64_tr_b16 a[158:159], v19 offset:53248
  v_mfma_f32_16x16x32_bf16 a[16:19], a[132:135], v[192:195], a[16:19]
  v_exp_f32 v247, v167
  v_mfma_f32_16x16x32_bf16 a[20:23], a[132:135], v[196:199], a[20:23]
  ds_read_b128 a[160:163], v8 offset:0
  v_cvt_pk_bf16_f32 v213, v246, v247
  v_mfma_f32_16x16x32_bf16 a[24:27], a[132:135], v[200:203], a[24:27]
  v_exp_f32 v240, v168
  v_mfma_f32_16x16x32_bf16 a[28:31], a[132:135], v[204:207], a[28:31]
  buffer_load_dwordx4 v22, s[20:23], s53 offen offset:2048 lds
  v_mfma_f32_16x16x32_bf16 a[32:35], a[136:139], v[192:195], a[32:35]
  v_exp_f32 v241, v169
  v_mfma_f32_16x16x32_bf16 a[36:39], a[136:139], v[196:199], a[36:39]
  ds_read_b128 a[164:167], v9 offset:0
  v_cvt_pk_bf16_f32 v216, v240, v241
  v_mfma_f32_16x16x32_bf16 a[40:43], a[136:139], v[200:203], a[40:43]
  v_exp_f32 v242, v170
  v_mfma_f32_16x16x32_bf16 a[44:47], a[136:139], v[204:207], a[44:47]
  buffer_load_dwordx4 v23, s[20:23], s53 offen offset:3072 lds
  s_add_u32 m0, s52, 98304
  v_mfma_f32_16x16x32_bf16 a[48:51], a[140:143], v[192:195], a[48:51]
  v_exp_f32 v243, v171
  v_mfma_f32_16x16x32_bf16 a[52:55], a[140:143], v[196:199], a[52:55]
  ds_read_b128 a[168:171], v10 offset:0
  v_cvt_pk_bf16_f32 v217, v242, v243
  v_mfma_f32_16x16x32_bf16 a[56:59], a[140:143], v[200:203], a[56:59]
  v_exp_f32 v244, v172
  v_mfma_f32_16x16x32_bf16 a[60:63], a[140:143], v[204:207], a[60:63]
  ds_read_b128 a[172:175], v11 offset:0
  s_waitcnt lgkmcnt(4)
  v_mfma_f32_16x16x32_bf16 a[64:67], a[144:147], v[192:195], a[64:67]
  v_exp_f32 v245, v173
  v_mfma_f32_16x16x32_bf16 a[68:71], a[144:147], v[196:199], a[68:71]
  ds_read_b128 a[176:179], v8 offset:4096
  v_cvt_pk_bf16_f32 v220, v244, v245
  v_mfma_f32_16x16x32_bf16 a[72:75], a[144:147], v[200:203], a[72:75]
  v_exp_f32 v246, v174
  v_mfma_f32_16x16x32_bf16 a[76:79], a[144:147], v[204:207], a[76:79]
  buffer_load_dwordx4 v24, s[24:27], s54 offen offset:0 lds
  v_mfma_f32_16x16x32_bf16 a[80:83], a[148:151], v[192:195], a[80:83]
  v_exp_f32 v247, v175
  v_mfma_f32_16x16x32_bf16 a[84:87], a[148:151], v[196:199], a[84:87]
  ds_read_b128 a[180:183], v9 offset:4096
  v_cvt_pk_bf16_f32 v221, v246, v247
  v_mfma_f32_16x16x32_bf16 a[88:91], a[148:151], v[200:203], a[88:91]
  v_exp_f32 v240, v176
  v_mfma_f32_16x16x32_bf16 a[92:95], a[148:151], v[204:207], a[92:95]
  buffer_load_dwordx4 v25, s[24:27], s54 offen offset:1024 lds
  v_mfma_f32_16x16x32_bf16 a[96:99], a[152:155], v[192:195], a[96:99]
  v_exp_f32 v241, v177
  v_mfma_f32_16x16x32_bf16 a[100:103], a[152:155], v[196:199], a[100:103]
  ds_read_b128 a[184:187], v10 offset:4096
  v_cvt_pk_bf16_f32 v210, v240, v241
  v_mfma_f32_16x16x32_bf16 a[104:107], a[152:155], v[200:203], a[104:107]
  v_exp_f32 v242, v178
  v_mfma_f32_16x16x32_bf16 a[108:111], a[152:155], v[204:207], a[108:111]
  buffer_load_dwordx4 v24, s[24:27], s54 offen offset:2048 lds
  v_mfma_f32_16x16x32_bf16 a[112:115], a[156:159], v[192:195], a[112:115]
  v_exp_f32 v243, v179
  v_mfma_f32_16x16x32_bf16 a[116:119], a[156:159], v[196:199], a[116:119]
  ds_read_b128 a[188:191], v11 offset:4096
  v_cvt_pk_bf16_f32 v211, v242, v243
  v_mfma_f32_16x16x32_bf16 a[120:123], a[156:159], v[200:203], a[120:123]
  v_exp_f32 v244, v180
  v_mfma_f32_16x16x32_bf16 a[124:127], a[156:159], v[204:207], a[124:127]
  buffer_load_dwordx4 v25, s[24:27], s54 offen offset:3072 lds
  v_mfma_f32_16x16x32_bf16 v[32:35], v[248:251], v[192:195], v[32:35]
  v_exp_f32 v245, v181
  v_mfma_f32_16x16x32_bf16 v[36:39], v[248:251], v[196:199], v[36:39]
  v_cvt_pk_bf16_f32 v214, v244, v245
  s_sub_u32 s55, s55, 1
  v_mfma_f32_16x16x32_bf16 v[40:43], v[248:251], v[200:203], v[40:43]
  v_exp_f32 v246, v182
  v_mfma_f32_16x16x32_bf16 v[44:47], v[248:251], v[204:207], v[44:47]
  s_waitcnt lgkmcnt(0)
  s_cbranch_scc1 attn_kernel_tail3
  v_mfma_f32_16x16x32_bf16 v[128:131], a[160:163], v[64:67], v[224:227]
  v_exp_f32 v247, v183
  v_mfma_f32_16x16x32_bf16 v[128:131], a[164:167], v[68:71], v[128:131]
  v_cvt_pk_bf16_f32 v215, v246, v247
  v_mfma_f32_16x16x32_bf16 v[128:131], a[168:171], v[72:75], v[128:131]
  v_exp_f32 v240, v184
  v_mfma_f32_16x16x32_bf16 v[128:131], a[172:175], v[76:79], v[128:131]
  buffer_load_dwordx4 a[204:207], v6, s[4:7], s8 offen
  v_mfma_f32_16x16x32_bf16 v[132:135], a[160:163], v[80:83], v[228:231]
  v_exp_f32 v241, v185
  v_mfma_f32_16x16x32_bf16 v[132:135], a[164:167], v[84:87], v[132:135]
  ds_read_b64_tr_b16 a[128:129], v12 offset:57344
  v_cvt_pk_bf16_f32 v218, v240, v241
  v_mfma_f32_16x16x32_bf16 v[132:135], a[168:171], v[88:91], v[132:135]
  v_exp_f32 v242, v186
  v_mfma_f32_16x16x32_bf16 v[132:135], a[172:175], v[92:95], v[132:135]
  ds_read_b64_tr_b16 a[130:131], v12 offset:61440
  s_add_u32 s53, s53, 16384
  v_mfma_f32_16x16x32_bf16 v[136:139], a[160:163], v[96:99], v[232:235]
  v_exp_f32 v243, v187
  v_mfma_f32_16x16x32_bf16 v[136:139], a[164:167], v[100:103], v[136:139]
  ds_read_b64_tr_b16 a[132:133], v13 offset:57344
  v_cvt_pk_bf16_f32 v219, v242, v243
  v_mfma_f32_16x16x32_bf16 v[136:139], a[168:171], v[104:107], v[136:139]
  v_exp_f32 v244, v188
  v_mfma_f32_16x16x32_bf16 v[136:139], a[172:175], v[108:111], v[136:139]
  ds_read_b64_tr_b16 a[134:135], v13 offset:61440
  s_add_u32 s54, s54, 16384
  v_mfma_f32_16x16x32_bf16 v[140:143], a[160:163], v[112:115], v[236:239]
  v_exp_f32 v245, v189
  v_mfma_f32_16x16x32_bf16 v[140:143], a[164:167], v[116:119], v[140:143]
  ds_read_b64_tr_b16 a[136:137], v14 offset:57344
  v_cvt_pk_bf16_f32 v222, v244, v245
  v_mfma_f32_16x16x32_bf16 v[140:143], a[168:171], v[120:123], v[140:143]
  v_exp_f32 v246, v190
  v_mfma_f32_16x16x32_bf16 v[140:143], a[172:175], v[124:127], v[140:143]
  ds_read_b64_tr_b16 a[138:139], v14 offset:61440
  v_mfma_f32_16x16x32_bf16 v[144:147], a[176:179], v[64:67], v[224:227]
  v_exp_f32 v247, v191
  v_mfma_f32_16x16x32_bf16 v[144:147], a[180:183], v[68:71], v[144:147]
  ds_read_b64_tr_b16 a[140:141], v15 offset:57344
  v_cvt_pk_bf16_f32 v223, v246, v247
  v_mfma_f32_16x16x32_bf16 v[144:147], a[184:187], v[72:75], v[144:147]
  v_mfma_f32_16x16x32_bf16 v[144:147], a[188:191], v[76:79], v[144:147]
  ds_read_b64_tr_b16 a[142:143], v15 offset:61440
  v_mfma_f32_16x16x32_bf16 v[148:151], a[176:179], v[80:83], v[228:231]
  v_mfma_f32_16x16x32_bf16 v[148:151], a[180:183], v[84:87], v[148:151]
  ds_read_b64_tr_b16 a[144:145], v16 offset:57344
  v_mfma_f32_16x16x32_bf16 v[148:151], a[184:187], v[88:91], v[148:151]
  v_exp_f32 v240, v128
  v_mfma_f32_16x16x32_bf16 v[148:151], a[188:191], v[92:95], v[148:151]
  ds_read_b64_tr_b16 a[146:147], v16 offset:61440
  v_mfma_f32_16x16x32_bf16 v[152:155], a[176:179], v[96:99], v[232:235]
  v_exp_f32 v241, v129
  v_mfma_f32_16x16x32_bf16 v[152:155], a[180:183], v[100:103], v[152:155]
  ds_read_b64_tr_b16 a[148:149], v17 offset:57344
  v_cvt_pk_bf16_f32 v192, v240, v241
  v_mfma_f32_16x16x32_bf16 v[152:155], a[184:187], v[104:107], v[152:155]
  v_exp_f32 v242, v130
  v_mfma_f32_16x16x32_bf16 v[152:155], a[188:191], v[108:111], v[152:155]
  ds_read_b64_tr_b16 a[150:151], v17 offset:61440
  v_mfma_f32_16x16x32_bf16 v[156:159], a[176:179], v[112:115], v[236:239]
  v_exp_f32 v243, v131
  v_mfma_f32_16x16x32_bf16 v[156:159], a[180:183], v[116:119], v[156:159]
  ds_read_b64_tr_b16 a[152:153], v18 offset:57344
  v_cvt_pk_bf16_f32 v193, v242, v243
  v_mfma_f32_16x16x32_bf16 v[156:159], a[184:187], v[120:123], v[156:159]
  v_exp_f32 v244, v132
  v_mfma_f32_16x16x32_bf16 v[156:159], a[188:191], v[124:127], v[156:159]
  ds_read_b64_tr_b16 a[154:155], v18 offset:61440
  s_waitcnt lgkmcnt(6)
  v_mfma_f32_16x16x32_bf16 a[0:3], a[128:131], v[208:211], a[0:3]
  v_exp_f32 v245, v133
  v_mfma_f32_16x16x32_bf16 a[4:7], a[128:131], v[212:215], a[4:7]
  ds_read_b64_tr_b16 a[156:157], v19 offset:57344
  v_cvt_pk_bf16_f32 v196, v244, v245
  v_mfma_f32_16x16x32_bf16 a[8:11], a[128:131], v[216:219], a[8:11]
  v_exp_f32 v246, v134
  v_mfma_f32_16x16x32_bf16 a[12:15], a[128:131], v[220:223], a[12:15]
  ds_read_b64_tr_b16 a[158:159], v19 offset:61440
  v_mfma_f32_16x16x32_bf16 a[16:19], a[132:135], v[208:211], a[16:19]
  v_exp_f32 v247, v135
  v_mfma_f32_16x16x32_bf16 a[20:23], a[132:135], v[212:215], a[20:23]
  ds_read_b128 a[160:163], v8 offset:8192
  v_cvt_pk_bf16_f32 v197, v246, v247
  v_mfma_f32_16x16x32_bf16 a[24:27], a[132:135], v[216:219], a[24:27]
  v_exp_f32 v240, v136
  v_mfma_f32_16x16x32_bf16 a[28:31], a[132:135], v[220:223], a[28:31]
  v_mfma_f32_16x16x32_bf16 a[32:35], a[136:139], v[208:211], a[32:35]
  v_exp_f32 v241, v137
  v_mfma_f32_16x16x32_bf16 a[36:39], a[136:139], v[212:215], a[36:39]
  ds_read_b128 a[164:167], v9 offset:8192
  v_cvt_pk_bf16_f32 v200, v240, v241
  v_mfma_f32_16x16x32_bf16 a[40:43], a[136:139], v[216:219], a[40:43]
  v_exp_f32 v242, v138
  v_mfma_f32_16x16x32_bf16 a[44:47], a[136:139], v[220:223], a[44:47]
  v_mfma_f32_16x16x32_bf16 a[48:51], a[140:143], v[208:211], a[48:51]
  v_exp_f32 v243, v139
  v_mfma_f32_16x16x32_bf16 a[52:55], a[140:143], v[212:215], a[52:55]
  ds_read_b128 a[168:171], v10 offset:8192
  v_cvt_pk_bf16_f32 v201, v242, v243
  v_mfma_f32_16x16x32_bf16 a[56:59], a[140:143], v[216:219], a[56:59]
  v_exp_f32 v244, v140
  v_mfma_f32_16x16x32_bf16 a[60:63], a[140:143], v[220:223], a[60:63]
  ds_read_b128 a[172:175], v11 offset:8192
  s_waitcnt lgkmcnt(4)
  v_mfma_f32_16x16x32_bf16 a[64:67], a[144:147], v[208:211], a[64:67]
  v_exp_f32 v245, v141
  v_mfma_f32_16x16x32_bf16 a[68:71], a[144:147], v[212:215], a[68:71]
  ds_read_b128 a[176:179], v8 offset:12288
  v_cvt_pk_bf16_f32 v204, v244, v245
  v_mfma_f32_16x16x32_bf16 a[72:75], a[144:147], v[216:219], a[72:75]
  v_exp_f32 v246, v142
  v_mfma_f32_16x16x32_bf16 a[76:79], a[144:147], v[220:223], a[76:79]
  v_mfma_f32_16x16x32_bf16 a[80:83], a[148:151], v[208:211], a[80:83]
  v_exp_f32 v247, v143
  v_mfma_f32_16x16x32_bf16 a[84:87], a[148:151], v[212:215], a[84:87]
  ds_read_b128 a[180:183], v9 offset:12288
  v_cvt_pk_bf16_f32 v205, v246, v247
  v_mfma_f32_16x16x32_bf16 a[88:91], a[148:151], v[216:219], a[88:91]
  v_exp_f32 v240, v144
  v_mfma_f32_16x16x32_bf16 a[92:95], a[148:151], v[220:223], a[92:95]
  v_mfma_f32_16x16x32_bf16 a[96:99], a[152:155], v[208:211], a[96:99]
  v_exp_f32 v241, v145
  v_mfma_f32_16x16x32_bf16 a[100:103], a[152:155], v[212:215], a[100:103]
  ds_read_b128 a[184:187], v10 offset:12288
  v_cvt_pk_bf16_f32 v194, v240, v241
  v_mfma_f32_16x16x32_bf16 a[104:107], a[152:155], v[216:219], a[104:107]
  v_exp_f32 v242, v146
  v_mfma_f32_16x16x32_bf16 a[108:111], a[152:155], v[220:223], a[108:111]
  v_mfma_f32_16x16x32_bf16 a[112:115], a[156:159], v[208:211], a[112:115]
  v_exp_f32 v243, v147
  v_mfma_f32_16x16x32_bf16 a[116:119], a[156:159], v[212:215], a[116:119]
  ds_read_b128 a[188:191], v11 offset:12288
  v_cvt_pk_bf16_f32 v195, v242, v243
  v_mfma_f32_16x16x32_bf16 a[120:123], a[156:159], v[216:219], a[120:123]
  v_exp_f32 v244, v148
  v_mfma_f32_16x16x32_bf16 a[124:127], a[156:159], v[220:223], a[124:127]
  v_mfma_f32_16x16x32_bf16 v[32:35], v[248:251], v[208:211], v[32:35]
  v_exp_f32 v245, v149
  v_mfma_f32_16x16x32_bf16 v[36:39], v[248:251], v[212:215], v[36:39]
  v_cvt_pk_bf16_f32 v198, v244, v245
  v_mfma_f32_16x16x32_bf16 v[40:43], v[248:251], v[216:219], v[40:43]
  v_exp_f32 v246, v150
  v_mfma_f32_16x16x32_bf16 v[44:47], v[248:251], v[220:223], v[44:47]
  s_waitcnt lgkmcnt(0)
  v_mfma_f32_16x16x32_bf16 v[160:163], a[160:163], v[64:67], v[224:227]
  v_exp_f32 v247, v151
  v_mfma_f32_16x16x32_bf16 v[160:163], a[164:167], v[68:71], v[160:163]
  v_cvt_pk_bf16_f32 v199, v246, v247
  v_mfma_f32_16x16x32_bf16 v[160:163], a[168:171], v[72:75], v[160:163]
  v_exp_f32 v240, v152
  v_mfma_f32_16x16x32_bf16 v[160:163], a[172:175], v[76:79], v[160:163]
  s_waitcnt vmcnt(22)
  s_barrier
  v_mfma_f32_16x16x32_bf16 v[164:167], a[160:163], v[80:83], v[228:231]
  v_exp_f32 v241, v153
  v_mfma_f32_16x16x32_bf16 v[164:167], a[164:167], v[84:87], v[164:167]
  ds_read_b64_tr_b16 a[128:129], v12 offset:0
  v_cvt_pk_bf16_f32 v202, v240, v241
  v_mfma_f32_16x16x32_bf16 v[164:167], a[168:171], v[88:91], v[164:167]
  v_exp_f32 v242, v154
  v_mfma_f32_16x16x32_bf16 v[164:167], a[172:175], v[92:95], v[164:167]
  ds_read_b64_tr_b16 a[130:131], v12 offset:4096
  s_add_u32 m0, s52, 0
  v_mfma_f32_16x16x32_bf16 v[168:171], a[160:163], v[96:99], v[232:235]
  v_exp_f32 v243, v155
  v_mfma_f32_16x16x32_bf16 v[168:171], a[164:167], v[100:103], v[168:171]
  ds_read_b64_tr_b16 a[132:133], v13 offset:0
  v_cvt_pk_bf16_f32 v203, v242, v243
  v_mfma_f32_16x16x32_bf16 v[168:171], a[168:171], v[104:107], v[168:171]
  v_exp_f32 v244, v156
  v_mfma_f32_16x16x32_bf16 v[168:171], a[172:175], v[108:111], v[168:171]
  ds_read_b64_tr_b16 a[134:135], v13 offset:4096
  v_mfma_f32_16x16x32_bf16 v[172:175], a[160:163], v[112:115], v[236:239]
  v_exp_f32 v245, v157
  v_mfma_f32_16x16x32_bf16 v[172:175], a[164:167], v[116:119], v[172:175]
  ds_read_b64_tr_b16 a[136:137], v14 offset:0
  v_cvt_pk_bf16_f32 v206, v244, v245
  v_mfma_f32_16x16x32_bf16 v[172:175], a[168:171], v[120:123], v[172:175]
  v_exp_f32 v246, v158
  v_mfma_f32_16x16x32_bf16 v[172:175], a[172:175], v[124:127], v[172:175]
  ds_read_b64_tr_b16 a[138:139], v14 offset:4096
  v_mfma_f32_16x16x32_bf16 v[176:179], a[176:179], v[64:67], v[224:227]
  v_exp_f32 v247, v159
  v_mfma_f32_16x16x32_bf16 v[176:179], a[180:183], v[68:71], v[176:179]
  ds_read_b64_tr_b16 a[140:141], v15 offset:0
  v_cvt_pk_bf16_f32 v207, v246, v247
  v_mfma_f32_16x16x32_bf16 v[176:179], a[184:187], v[72:75], v[176:179]
  buffer_load_dwordx4 v20, s[20:23], s53 offen offset:0 lds
  v_mfma_f32_16x16x32_bf16 v[176:179], a[188:191], v[76:79], v[176:179]
  ds_read_b64_tr_b16 a[142:143], v15 offset:4096
  v_mfma_f32_16x16x32_bf16 v[180:183], a[176:179], v[80:83], v[228:231]
  buffer_load_dwordx4 v21, s[20:23], s53 offen offset:1024 lds
  v_mfma_f32_16x16x32_bf16 v[180:183], a[180:183], v[84:87], v[180:183]
  ds_read_b64_tr_b16 a[144:145], v16 offset:0
  v_mfma_f32_16x16x32_bf16 v[180:183], a[184:187], v[88:91], v[180:183]
  v_exp_f32 v240, v160
  v_mfma_f32_16x16x32_bf16 v[180:183], a[188:191], v[92:95], v[180:183]
  ds_read_b64_tr_b16 a[146:147], v16 offset:4096
  v_mfma_f32_16x16x32_bf16 v[184:187], a[176:179], v[96:99], v[232:235]
  v_exp_f32 v241, v161
  v_mfma_f32_16x16x32_bf16 v[184:187], a[180:183], v[100:103], v[184:187]
  ds_read_b64_tr_b16 a[148:149], v17 offset:0
  v_cvt_pk_bf16_f32 v208, v240, v241
  v_mfma_f32_16x16x32_bf16 v[184:187], a[184:187], v[104:107], v[184:187]
  v_exp_f32 v242, v162
  v_mfma_f32_16x16x32_bf16 v[184:187], a[188:191], v[108:111], v[184:187]
  ds_read_b64_tr_b16 a[150:151], v17 offset:4096
  v_mfma_f32_16x16x32_bf16 v[188:191], a[176:179], v[112:115], v[236:239]
  v_exp_f32 v243, v163
  v_mfma_f32_16x16x32_bf16 v[188:191], a[180:183], v[116:119], v[188:191]
  ds_read_b64_tr_b16 a[152:153], v18 offset:0
  v_cvt_pk_bf16_f32 v209, v242, v243
  v_mfma_f32_16x16x32_bf16 v[188:191], a[184:187], v[120:123], v[188:191]
  v_exp_f32 v244, v164
  v_mfma_f32_16x16x32_bf16 v[188:191], a[188:191], v[124:127], v[188:191]
  ds_read_b64_tr_b16 a[154:155], v18 offset:4096
  s_waitcnt lgkmcnt(6)
  s_branch attn_kernel_loop2
attn_kernel_tail3:
  ds_read_b64_tr_b16 a[128:129], v12 offset:57344
  ds_read_b64_tr_b16 a[130:131], v12 offset:61440
  ds_read_b64_tr_b16 a[132:133], v13 offset:57344
  ds_read_b64_tr_b16 a[134:135], v13 offset:61440
  ds_read_b64_tr_b16 a[136:137], v14 offset:57344
  ds_read_b64_tr_b16 a[138:139], v14 offset:61440
  ds_read_b64_tr_b16 a[140:141], v15 offset:57344
  ds_read_b64_tr_b16 a[142:143], v15 offset:61440
  ds_read_b64_tr_b16 a[144:145], v16 offset:57344
  ds_read_b64_tr_b16 a[146:147], v16 offset:61440
  ds_read_b64_tr_b16 a[148:149], v17 offset:57344
  ds_read_b64_tr_b16 a[150:151], v17 offset:61440
  ds_read_b64_tr_b16 a[152:153], v18 offset:57344
  ds_read_b64_tr_b16 a[154:155], v18 offset:61440
  ds_read_b64_tr_b16 a[156:157], v19 offset:57344
  ds_read_b64_tr_b16 a[158:159], v19 offset:61440
  v_exp_f32 v247, v183
  s_nop 0
  v_cvt_pk_bf16_f32 v215, v246, v247
  v_exp_f32 v240, v184
  s_nop 0
  v_exp_f32 v241, v185
  s_nop 0
  v_cvt_pk_bf16_f32 v218, v240, v241
  v_exp_f32 v242, v186
  s_nop 0
  v_exp_f32 v243, v187
  s_nop 0
  v_cvt_pk_bf16_f32 v219, v242, v243
  v_exp_f32 v244, v188
  s_nop 0
  v_exp_f32 v245, v189
  s_nop 0
  v_cvt_pk_bf16_f32 v222, v244, v245
  v_exp_f32 v246, v190
  s_nop 0
  v_exp_f32 v247, v191
  s_nop 0
  v_cvt_pk_bf16_f32 v223, v246, v247
  s_waitcnt lgkmcnt(0)
  s_nop 0
  v_mfma_f32_16x16x32_bf16 v[32:35], v[248:251], v[208:211], v[32:35]
  v_mfma_f32_16x16x32_bf16 v[36:39], v[248:251], v[212:215], v[36:39]
  v_mfma_f32_16x16x32_bf16 v[40:43], v[248:251], v[216:219], v[40:43]
  v_mfma_f32_16x16x32_bf16 v[44:47], v[248:251], v[220:223], v[44:47]
  v_mfma_f32_16x16x32_bf16 a[0:3], a[128:131], v[208:211], a[0:3]
  v_add_f32_dpp v48, v48, v48 row_ror:8 row_mask:0xf bank_mask:0xf
  v_mfma_f32_16x16x32_bf16 a[4:7], a[128:131], v[212:215], a[4:7]
  v_add_f32_dpp v49, v49, v49 row_ror:8 row_mask:0xf bank_mask:0xf
  v_mfma_f32_16x16x32_bf16 a[8:11], a[128:131], v[216:219], a[8:11]
  v_add_f32_dpp v50, v50, v50 row_ror:8 row_mask:0xf bank_mask:0xf
  v_mfma_f32_16x16x32_bf16 a[12:15], a[128:131], v[220:223], a[12:15]
  v_add_f32_dpp v51, v51, v51 row_ror:8 row_mask:0xf bank_mask:0xf
  v_mfma_f32_16x16x32_bf16 a[16:19], a[132:135], v[208:211], a[16:19]
  v_add_f32_dpp v52, v52, v52 row_ror:8 row_mask:0xf bank_mask:0xf
  v_mfma_f32_16x16x32_bf16 a[20:23], a[132:135], v[212:215], a[20:23]
  v_add_f32_dpp v53, v53, v53 row_ror:8 row_mask:0xf bank_mask:0xf
  v_mfma_f32_16x16x32_bf16 a[24:27], a[132:135], v[216:219], a[24:27]
  v_add_f32_dpp v63, v63, v63 row_ror:8 row_mask:0xf bank_mask:0xf
  v_mfma_f32_16x16x32_bf16 a[28:31], a[132:135], v[220:223], a[28:31]
  v_add_f32_dpp v2, v2, v2 row_ror:8 row_mask:0xf bank_mask:0xf
  v_mfma_f32_16x16x32_bf16 a[32:35], a[136:139], v[208:211], a[32:35]
  v_permlane16_swap_b32 v48, v49
  v_mfma_f32_16x16x32_bf16 a[36:39], a[136:139], v[212:215], a[36:39]
  v_permlane16_swap_b32 v50, v51
  v_mfma_f32_16x16x32_bf16 a[40:43], a[136:139], v[216:219], a[40:43]
  v_permlane16_swap_b32 v52, v53
  v_mfma_f32_16x16x32_bf16 a[44:47], a[136:139], v[220:223], a[44:47]
  v_permlane16_swap_b32 v63, v2
  v_mfma_f32_16x16x32_bf16 a[48:51], a[140:143], v[208:211], a[48:51]
  v_add_f32 v48, v48, v49
  v_mfma_f32_16x16x32_bf16 a[52:55], a[140:143], v[212:215], a[52:55]
  v_add_f32 v50, v50, v51
  v_mfma_f32_16x16x32_bf16 a[56:59], a[140:143], v[216:219], a[56:59]
  v_add_f32 v52, v52, v53
  v_mfma_f32_16x16x32_bf16 a[60:63], a[140:143], v[220:223], a[60:63]
  v_add_f32 v63, v63, v2
  v_mfma_f32_16x16x32_bf16 a[64:67], a[144:147], v[208:211], a[64:67]
  v_and_b32 v4, 7, v1
  v_mfma_f32_16x16x32_bf16 a[68:71], a[144:147], v[212:215], a[68:71]
  v_lshrrev_b32 v5, 4, v1
  v_mfma_f32_16x16x32_bf16 a[72:75], a[144:147], v[216:219], a[72:75]
  v_permlane32_swap_b32 v48, v50
  v_mfma_f32_16x16x32_bf16 a[76:79], a[144:147], v[220:223], a[76:79]
  v_permlane32_swap_b32 v52, v63
  v_mfma_f32_16x16x32_bf16 a[80:83], a[148:151], v[208:211], a[80:83]
  v_add_f32 v48, v48, v50
  v_mfma_f32_16x16x32_bf16 a[84:87], a[148:151], v[212:215], a[84:87]
  v_add_f32 v52, v52, v63
  v_mfma_f32_16x16x32_bf16 a[88:91], a[148:151], v[216:219], a[88:91]
  v_lshl_add_u32 v4, v4, 3, v5
  v_mfma_f32_16x16x32_bf16 a[92:95], a[148:151], v[220:223], a[92:95]
  v_lshlrev_b32 v4, 2, v4
  v_mfma_f32_16x16x32_bf16 a[96:99], a[152:155], v[208:211], a[96:99]
  buffer_store_dword v48, v4, s[68:71], s43 offen sc1
  v_mfma_f32_16x16x32_bf16 a[100:103], a[152:155], v[212:215], a[100:103]
  buffer_store_dword v52, v4, s[68:71], s43 offen offset:16 sc1
  v_mfma_f32_16x16x32_bf16 a[104:107], a[152:155], v[216:219], a[104:107]
  v_mfma_f32_16x16x32_bf16 a[108:111], a[152:155], v[220:223], a[108:111]
  v_mfma_f32_16x16x32_bf16 a[112:115], a[156:159], v[208:211], a[112:115]
  v_mfma_f32_16x16x32_bf16 a[116:119], a[156:159], v[212:215], a[116:119]
  v_mfma_f32_16x16x32_bf16 a[120:123], a[156:159], v[216:219], a[120:123]
  v_mfma_f32_16x16x32_bf16 a[124:127], a[156:159], v[220:223], a[124:127]
  v_max3_f32 v252, v32, v36, v40
  v_max_f32 v252, v252, v44
  v_cmp_nge_f32 vcc, s57, v252
  s_cbranch_vccnz attn_kernel_slow4
  s_mov_b64 s[66:67], -1
attn_kernel_epi5:
  s_setreg_imm32_b32 hwreg(HW_REG_MODE, 4, 2), 3
  v_rcp_f32 v240, v32
  s_nop 0
  v_mov_b32 v241, v240
  v_rcp_f32 v242, v36
  s_nop 0
  v_mov_b32 v243, v242
  v_rcp_f32 v244, v40
  s_nop 0
  v_mov_b32 v245, v244
  v_rcp_f32 v246, v44
  s_nop 0
  v_mov_b32 v247, v246
  v_lshlrev_b32 v6, 4, v1
  s_lshl_b32 s48, s40, 9
  s_add_u32 s48, s48, s47
  s_lshl_b32 s48, s48, 10
  v_accvgpr_read_b32 v128, a0
  v_accvgpr_read_b32 v129, a1
  v_accvgpr_read_b32 v130, a2
  v_accvgpr_read_b32 v131, a3
  v_accvgpr_read_b32 v132, a16
  v_accvgpr_read_b32 v133, a17
  v_accvgpr_read_b32 v134, a18
  v_accvgpr_read_b32 v135, a19
  v_max3_f32 v253, abs(v128), abs(v129), abs(v130)
  v_max3_f32 v253, v253, abs(v131), abs(v132)
  v_max3_f32 v253, v253, abs(v133), abs(v134)
  v_mov_b32 v252, v253
  v_pk_mul_f32 v[128:129], v[128:129], v[240:241]
  v_pk_mul_f32 v[130:131], v[130:131], v[240:241]
  v_pk_mul_f32 v[132:133], v[132:133], v[240:241]
  v_pk_mul_f32 v[134:135], v[134:135], v[240:241]
  v_cvt_pk_bf16_f32 v192, v128, v129
  v_cvt_pk_bf16_f32 v193, v130, v131
  v_cvt_pk_bf16_f32 v194, v132, v133
  v_cvt_pk_bf16_f32 v195, v134, v135
  buffer_store_dwordx4 v[192:195], v6, s[28:31], s48 offen offset:0 sc1
  v_accvgpr_read_b32 v136, a4
  v_accvgpr_read_b32 v137, a5
  v_accvgpr_read_b32 v138, a6
  v_accvgpr_read_b32 v139, a7
  v_accvgpr_read_b32 v140, a20
  v_accvgpr_read_b32 v141, a21
  v_accvgpr_read_b32 v142, a22
  v_accvgpr_read_b32 v143, a23
  v_max3_f32 v253, abs(v136), abs(v137), abs(v138)
  v_max3_f32 v253, v253, abs(v139), abs(v140)
  v_max3_f32 v253, v253, abs(v141), abs(v142)
  v_min_f32 v252, v252, v253
  v_pk_mul_f32 v[136:137], v[136:137], v[242:243]
  v_pk_mul_f32 v[138:139], v[138:139], v[242:243]
  v_pk_mul_f32 v[140:141], v[140:141], v[242:243]
  v_pk_mul_f32 v[142:143], v[142:143], v[242:243]
  v_cvt_pk_bf16_f32 v196, v136, v137
  v_cvt_pk_bf16_f32 v197, v138, v139
  v_cvt_pk_bf16_f32 v198, v140, v141
  v_cvt_pk_bf16_f32 v199, v142, v143
  buffer_store_dwordx4 v[196:199], v6, s[28:31], s48 offen offset:1024 sc1
  v_accvgpr_read_b32 v144, a8
  v_accvgpr_read_b32 v145, a9
  v_accvgpr_read_b32 v146, a10
  v_accvgpr_read_b32 v147, a11
  v_accvgpr_read_b32 v148, a24
  v_accvgpr_read_b32 v149, a25
  v_accvgpr_read_b32 v150, a26
  v_accvgpr_read_b32 v151, a27
  v_max3_f32 v253, abs(v144), abs(v145), abs(v146)
  v_max3_f32 v253, v253, abs(v147), abs(v148)
  v_max3_f32 v253, v253, abs(v149), abs(v150)
  v_min_f32 v252, v252, v253
  v_pk_mul_f32 v[144:145], v[144:145], v[244:245]
  v_pk_mul_f32 v[146:147], v[146:147], v[244:245]
  v_pk_mul_f32 v[148:149], v[148:149], v[244:245]
  v_pk_mul_f32 v[150:151], v[150:151], v[244:245]
  v_cvt_pk_bf16_f32 v200, v144, v145
  v_cvt_pk_bf16_f32 v201, v146, v147
  v_cvt_pk_bf16_f32 v202, v148, v149
  v_cvt_pk_bf16_f32 v203, v150, v151
  buffer_store_dwordx4 v[200:203], v6, s[28:31], s48 offen offset:2048 sc1
  v_accvgpr_read_b32 v152, a12
  v_accvgpr_read_b32 v153, a13
  v_accvgpr_read_b32 v154, a14
  v_accvgpr_read_b32 v155, a15
  v_accvgpr_read_b32 v156, a28
  v_accvgpr_read_b32 v157, a29
  v_accvgpr_read_b32 v158, a30
  v_accvgpr_read_b32 v159, a31
  v_max3_f32 v253, abs(v152), abs(v153), abs(v154)
  v_max3_f32 v253, v253, abs(v155), abs(v156)
  v_max3_f32 v253, v253, abs(v157), abs(v158)
  v_min_f32 v252, v252, v253
  v_pk_mul_f32 v[152:153], v[152:153], v[246:247]
  v_pk_mul_f32 v[154:155], v[154:155], v[246:247]
  v_pk_mul_f32 v[156:157], v[156:157], v[246:247]
  v_pk_mul_f32 v[158:159], v[158:159], v[246:247]
  v_cvt_pk_bf16_f32 v204, v152, v153
  v_cvt_pk_bf16_f32 v205, v154, v155
  v_cvt_pk_bf16_f32 v206, v156, v157
  v_cvt_pk_bf16_f32 v207, v158, v159
  buffer_store_dwordx4 v[204:207], v6, s[28:31], s48 offen offset:3072 sc1
  v_cmp_gt_f32 vcc, 0x00004000, v252
  s_and_b64 vcc, vcc, s[66:67]
  s_cbranch_vccnz attn_kernel_slow4
  s_add_u32 s48, s48, 131072
  v_accvgpr_read_b32 v128, a32
  v_accvgpr_read_b32 v129, a33
  v_accvgpr_read_b32 v130, a34
  v_accvgpr_read_b32 v131, a35
  v_accvgpr_read_b32 v132, a48
  v_accvgpr_read_b32 v133, a49
  v_accvgpr_read_b32 v134, a50
  v_accvgpr_read_b32 v135, a51
  v_pk_mul_f32 v[128:129], v[128:129], v[240:241]
  v_pk_mul_f32 v[130:131], v[130:131], v[240:241]
  v_pk_mul_f32 v[132:133], v[132:133], v[240:241]
  v_pk_mul_f32 v[134:135], v[134:135], v[240:241]
  v_cvt_pk_bf16_f32 v192, v128, v129
  v_cvt_pk_bf16_f32 v193, v130, v131
  v_cvt_pk_bf16_f32 v194, v132, v133
  v_cvt_pk_bf16_f32 v195, v134, v135
  buffer_store_dwordx4 v[192:195], v6, s[28:31], s48 offen offset:0 sc1
  v_accvgpr_read_b32 v136, a36
  v_accvgpr_read_b32 v137, a37
  v_accvgpr_read_b32 v138, a38
  v_accvgpr_read_b32 v139, a39
  v_accvgpr_read_b32 v140, a52
  v_accvgpr_read_b32 v141, a53
  v_accvgpr_read_b32 v142, a54
  v_accvgpr_read_b32 v143, a55
  v_pk_mul_f32 v[136:137], v[136:137], v[242:243]
  v_pk_mul_f32 v[138:139], v[138:139], v[242:243]
  v_pk_mul_f32 v[140:141], v[140:141], v[242:243]
  v_pk_mul_f32 v[142:143], v[142:143], v[242:243]
  v_cvt_pk_bf16_f32 v196, v136, v137
  v_cvt_pk_bf16_f32 v197, v138, v139
  v_cvt_pk_bf16_f32 v198, v140, v141
  v_cvt_pk_bf16_f32 v199, v142, v143
  buffer_store_dwordx4 v[196:199], v6, s[28:31], s48 offen offset:1024 sc1
  v_accvgpr_read_b32 v144, a40
  v_accvgpr_read_b32 v145, a41
  v_accvgpr_read_b32 v146, a42
  v_accvgpr_read_b32 v147, a43
  v_accvgpr_read_b32 v148, a56
  v_accvgpr_read_b32 v149, a57
  v_accvgpr_read_b32 v150, a58
  v_accvgpr_read_b32 v151, a59
  v_pk_mul_f32 v[144:145], v[144:145], v[244:245]
  v_pk_mul_f32 v[146:147], v[146:147], v[244:245]
  v_pk_mul_f32 v[148:149], v[148:149], v[244:245]
  v_pk_mul_f32 v[150:151], v[150:151], v[244:245]
  v_cvt_pk_bf16_f32 v200, v144, v145
  v_cvt_pk_bf16_f32 v201, v146, v147
  v_cvt_pk_bf16_f32 v202, v148, v149
  v_cvt_pk_bf16_f32 v203, v150, v151
  buffer_store_dwordx4 v[200:203], v6, s[28:31], s48 offen offset:2048 sc1
  v_accvgpr_read_b32 v152, a44
  v_accvgpr_read_b32 v153, a45
  v_accvgpr_read_b32 v154, a46
  v_accvgpr_read_b32 v155, a47
  v_accvgpr_read_b32 v156, a60
  v_accvgpr_read_b32 v157, a61
  v_accvgpr_read_b32 v158, a62
  v_accvgpr_read_b32 v159, a63
  v_pk_mul_f32 v[152:153], v[152:153], v[246:247]
  v_pk_mul_f32 v[154:155], v[154:155], v[246:247]
  v_pk_mul_f32 v[156:157], v[156:157], v[246:247]
  v_pk_mul_f32 v[158:159], v[158:159], v[246:247]
  v_cvt_pk_bf16_f32 v204, v152, v153
  v_cvt_pk_bf16_f32 v205, v154, v155
  v_cvt_pk_bf16_f32 v206, v156, v157
  v_cvt_pk_bf16_f32 v207, v158, v159
  buffer_store_dwordx4 v[204:207], v6, s[28:31], s48 offen offset:3072 sc1
  s_add_u32 s48, s48, 131072
  v_accvgpr_read_b32 v128, a64
  v_accvgpr_read_b32 v129, a65
  v_accvgpr_read_b32 v130, a66
  v_accvgpr_read_b32 v131, a67
  v_accvgpr_read_b32 v132, a80
  v_accvgpr_read_b32 v133, a81
  v_accvgpr_read_b32 v134, a82
  v_accvgpr_read_b32 v135, a83
  v_pk_mul_f32 v[128:129], v[128:129], v[240:241]
  v_pk_mul_f32 v[130:131], v[130:131], v[240:241]
  v_pk_mul_f32 v[132:133], v[132:133], v[240:241]
  v_pk_mul_f32 v[134:135], v[134:135], v[240:241]
  v_cvt_pk_bf16_f32 v192, v128, v129
  v_cvt_pk_bf16_f32 v193, v130, v131
  v_cvt_pk_bf16_f32 v194, v132, v133
  v_cvt_pk_bf16_f32 v195, v134, v135
  buffer_store_dwordx4 v[192:195], v6, s[28:31], s48 offen offset:0 sc1
  v_accvgpr_read_b32 v136, a68
  v_accvgpr_read_b32 v137, a69
  v_accvgpr_read_b32 v138, a70
  v_accvgpr_read_b32 v139, a71
  v_accvgpr_read_b32 v140, a84
  v_accvgpr_read_b32 v141, a85
  v_accvgpr_read_b32 v142, a86
  v_accvgpr_read_b32 v143, a87
  v_pk_mul_f32 v[136:137], v[136:137], v[242:243]
  v_pk_mul_f32 v[138:139], v[138:139], v[242:243]
  v_pk_mul_f32 v[140:141], v[140:141], v[242:243]
  v_pk_mul_f32 v[142:143], v[142:143], v[242:243]
  v_cvt_pk_bf16_f32 v196, v136, v137
  v_cvt_pk_bf16_f32 v197, v138, v139
  v_cvt_pk_bf16_f32 v198, v140, v141
  v_cvt_pk_bf16_f32 v199, v142, v143
  buffer_store_dwordx4 v[196:199], v6, s[28:31], s48 offen offset:1024 sc1
  v_accvgpr_read_b32 v144, a72
  v_accvgpr_read_b32 v145, a73
  v_accvgpr_read_b32 v146, a74
  v_accvgpr_read_b32 v147, a75
  v_accvgpr_read_b32 v148, a88
  v_accvgpr_read_b32 v149, a89
  v_accvgpr_read_b32 v150, a90
  v_accvgpr_read_b32 v151, a91
  v_pk_mul_f32 v[144:145], v[144:145], v[244:245]
  v_pk_mul_f32 v[146:147], v[146:147], v[244:245]
  v_pk_mul_f32 v[148:149], v[148:149], v[244:245]
  v_pk_mul_f32 v[150:151], v[150:151], v[244:245]
  v_cvt_pk_bf16_f32 v200, v144, v145
  v_cvt_pk_bf16_f32 v201, v146, v147
  v_cvt_pk_bf16_f32 v202, v148, v149
  v_cvt_pk_bf16_f32 v203, v150, v151
  buffer_store_dwordx4 v[200:203], v6, s[28:31], s48 offen offset:2048 sc1
  v_accvgpr_read_b32 v152, a76
  v_accvgpr_read_b32 v153, a77
  v_accvgpr_read_b32 v154, a78
  v_accvgpr_read_b32 v155, a79
  v_accvgpr_read_b32 v156, a92
  v_accvgpr_read_b32 v157, a93
  v_accvgpr_read_b32 v158, a94
  v_accvgpr_read_b32 v159, a95
  v_pk_mul_f32 v[152:153], v[152:153], v[246:247]
  v_pk_mul_f32 v[154:155], v[154:155], v[246:247]
  v_pk_mul_f32 v[156:157], v[156:157], v[246:247]
  v_pk_mul_f32 v[158:159], v[158:159], v[246:247]
  v_cvt_pk_bf16_f32 v204, v152, v153
  v_cvt_pk_bf16_f32 v205, v154, v155
  v_cvt_pk_bf16_f32 v206, v156, v157
  v_cvt_pk_bf16_f32 v207, v158, v159
  buffer_store_dwordx4 v[204:207], v6, s[28:31], s48 offen offset:3072 sc1
  s_add_u32 s48, s48, 131072
  v_accvgpr_read_b32 v128, a96
  v_accvgpr_read_b32 v129, a97
  v_accvgpr_read_b32 v130, a98
  v_accvgpr_read_b32 v131, a99
  v_accvgpr_read_b32 v132, a112
  v_accvgpr_read_b32 v133, a113
  v_accvgpr_read_b32 v134, a114
  v_accvgpr_read_b32 v135, a115
  v_pk_mul_f32 v[128:129], v[128:129], v[240:241]
  v_pk_mul_f32 v[130:131], v[130:131], v[240:241]
  v_pk_mul_f32 v[132:133], v[132:133], v[240:241]
  v_pk_mul_f32 v[134:135], v[134:135], v[240:241]
  v_cvt_pk_bf16_f32 v192, v128, v129
  v_cvt_pk_bf16_f32 v193, v130, v131
  v_cvt_pk_bf16_f32 v194, v132, v133
  v_cvt_pk_bf16_f32 v195, v134, v135
  buffer_store_dwordx4 v[192:195], v6, s[28:31], s48 offen offset:0 sc1
  v_accvgpr_read_b32 v136, a100
  v_accvgpr_read_b32 v137, a101
  v_accvgpr_read_b32 v138, a102
  v_accvgpr_read_b32 v139, a103
  v_accvgpr_read_b32 v140, a116
  v_accvgpr_read_b32 v141, a117
  v_accvgpr_read_b32 v142, a118
  v_accvgpr_read_b32 v143, a119
  v_pk_mul_f32 v[136:137], v[136:137], v[242:243]
  v_pk_mul_f32 v[138:139], v[138:139], v[242:243]
  v_pk_mul_f32 v[140:141], v[140:141], v[242:243]
  v_pk_mul_f32 v[142:143], v[142:143], v[242:243]
  v_cvt_pk_bf16_f32 v196, v136, v137
  v_cvt_pk_bf16_f32 v197, v138, v139
  v_cvt_pk_bf16_f32 v198, v140, v141
  v_cvt_pk_bf16_f32 v199, v142, v143
  buffer_store_dwordx4 v[196:199], v6, s[28:31], s48 offen offset:1024 sc1
  v_accvgpr_read_b32 v144, a104
  v_accvgpr_read_b32 v145, a105
  v_accvgpr_read_b32 v146, a106
  v_accvgpr_read_b32 v147, a107
  v_accvgpr_read_b32 v148, a120
  v_accvgpr_read_b32 v149, a121
  v_accvgpr_read_b32 v150, a122
  v_accvgpr_read_b32 v151, a123
  v_pk_mul_f32 v[144:145], v[144:145], v[244:245]
  v_pk_mul_f32 v[146:147], v[146:147], v[244:245]
  v_pk_mul_f32 v[148:149], v[148:149], v[244:245]
  v_pk_mul_f32 v[150:151], v[150:151], v[244:245]
  v_cvt_pk_bf16_f32 v200, v144, v145
  v_cvt_pk_bf16_f32 v201, v146, v147
  v_cvt_pk_bf16_f32 v202, v148, v149
  v_cvt_pk_bf16_f32 v203, v150, v151
  buffer_store_dwordx4 v[200:203], v6, s[28:31], s48 offen offset:2048 sc1
  v_accvgpr_read_b32 v152, a108
  v_accvgpr_read_b32 v153, a109
  v_accvgpr_read_b32 v154, a110
  v_accvgpr_read_b32 v155, a111
  v_accvgpr_read_b32 v156, a124
  v_accvgpr_read_b32 v157, a125
  v_accvgpr_read_b32 v158, a126
  v_accvgpr_read_b32 v159, a127
  v_pk_mul_f32 v[152:153], v[152:153], v[246:247]
  v_pk_mul_f32 v[154:155], v[154:155], v[246:247]
  v_pk_mul_f32 v[156:157], v[156:157], v[246:247]
  v_pk_mul_f32 v[158:159], v[158:159], v[246:247]
  v_cvt_pk_bf16_f32 v204, v152, v153
  v_cvt_pk_bf16_f32 v205, v154, v155
  v_cvt_pk_bf16_f32 v206, v156, v157
  v_cvt_pk_bf16_f32 v207, v158, v159
  buffer_store_dwordx4 v[204:207], v6, s[28:31], s48 offen offset:3072 sc1
  s_setreg_imm32_b32 hwreg(HW_REG_MODE, 4, 2), 0
  s_branch attn_kernel_next11
attn_kernel_end1:
  s_endpgm
attn_kernel_slow4:
  s_waitcnt vmcnt(0)
  s_mov_b64 s[66:67], 0
  v_and_b32 v26, 15, v1
  v_lshrrev_b32 v27, 4, v1
  v_lshlrev_b32 v52, 8, v26
  v_lshl_add_u32 v52, v27, 4, v52
  v_add_u32 v53, 4096, v52
  s_lshl_b32 s48, s44, 13
  s_add_u32 s48, s48, 131072
  s_sub_u32 s49, s48, 0x10000
  v_add_u32 v54, s49, v12
  v_add_u32 v55, s49, v13
  v_add_u32 v56, s49, v14
  v_add_u32 v57, s49, v15
  v_add_u32 v58, s49, v16
  v_add_u32 v59, s49, v17
  v_add_u32 v60, s49, v18
  v_add_u32 v61, s49, v19
  v_subrev_u32 v62, s52, v24
  v_subrev_u32 v63, s52, v25
  v_mov_b32 v48, 0xff7fffff
  v_mov_b32 v49, 0xff7fffff
  v_mov_b32 v50, 0xff7fffff
  v_mov_b32 v51, 0xff7fffff
  v_mov_b32 v224, 0
  v_mov_b32 v225, 0
  v_mov_b32 v226, 0
  v_mov_b32 v227, 0
  v_mov_b32 v228, 0
  v_mov_b32 v229, 0
  v_mov_b32 v230, 0
  v_mov_b32 v231, 0
  v_mov_b32 v232, 0
  v_mov_b32 v233, 0
  v_mov_b32 v234, 0
  v_mov_b32 v235, 0
  v_mov_b32 v236, 0
  v_mov_b32 v237, 0
  v_mov_b32 v238, 0
  v_mov_b32 v239, 0
  s_mov_b32 s58, 0
attn_kernel_spass12:
  s_mov_b32 s53, 0
attn_kernel_sunit13:
  buffer_load_dwordx4 a[160:163], v52, s[20:23], s53 offen offset:0
  buffer_load_dwordx4 a[164:167], v52, s[20:23], s53 offen offset:64
  buffer_load_dwordx4 a[168:171], v52, s[20:23], s53 offen offset:128
  buffer_load_dwordx4 a[172:175], v52, s[20:23], s53 offen offset:192
  buffer_load_dwordx4 a[176:179], v53, s[20:23], s53 offen offset:0
  buffer_load_dwordx4 a[180:183], v53, s[20:23], s53 offen offset:64
  buffer_load_dwordx4 a[184:187], v53, s[20:23], s53 offen offset:128
  buffer_load_dwordx4 a[188:191], v53, s[20:23], s53 offen offset:192
  s_cmp_eq_u32 s58, 0
  s_cbranch_scc1 attn_kernel_snov16
  s_add_u32 m0, s48, 0
  s_add_u32 s49, s53, 0
  buffer_load_dwordx4 v62, s[24:27], s49 offen offset:0 lds
  buffer_load_dwordx4 v63, s[24:27], s49 offen offset:1024 lds
  buffer_load_dwordx4 v62, s[24:27], s49 offen offset:2048 lds
  buffer_load_dwordx4 v63, s[24:27], s49 offen offset:3072 lds
  s_add_u32 m0, s48, 4096
  s_add_u32 s49, s53, 4096
  buffer_load_dwordx4 v62, s[24:27], s49 offen offset:0 lds
  buffer_load_dwordx4 v63, s[24:27], s49 offen offset:1024 lds
  buffer_load_dwordx4 v62, s[24:27], s49 offen offset:2048 lds
  buffer_load_dwordx4 v63, s[24:27], s49 offen offset:3072 lds
attn_kernel_snov16:
  s_waitcnt vmcnt(0)
  v_mfma_f32_16x16x32_bf16 v[128:131], a[160:163], v[64:67], v[224:227]
  v_mfma_f32_16x16x32_bf16 v[132:135], a[160:163], v[80:83], v[228:231]
  v_mfma_f32_16x16x32_bf16 v[136:139], a[160:163], v[96:99], v[232:235]
  v_mfma_f32_16x16x32_bf16 v[140:143], a[160:163], v[112:115], v[236:239]
  v_mfma_f32_16x16x32_bf16 v[128:131], a[164:167], v[68:71], v[128:131]
  v_mfma_f32_16x16x32_bf16 v[132:135], a[164:167], v[84:87], v[132:135]
  v_mfma_f32_16x16x32_bf16 v[136:139], a[164:167], v[100:103], v[136:139]
  v_mfma_f32_16x16x32_bf16 v[140:143], a[164:167], v[116:119], v[140:143]
  v_mfma_f32_16x16x32_bf16 v[128:131], a[168:171], v[72:75], v[128:131]
  v_mfma_f32_16x16x32_bf16 v[132:135], a[168:171], v[88:91], v[132:135]
  v_mfma_f32_16x16x32_bf16 v[136:139], a[168:171], v[104:107], v[136:139]
  v_mfma_f32_16x16x32_bf16 v[140:143], a[168:171], v[120:123], v[140:143]
  v_mfma_f32_16x16x32_bf16 v[128:131], a[172:175], v[76:79], v[128:131]
  v_mfma_f32_16x16x32_bf16 v[132:135], a[172:175], v[92:95], v[132:135]
  v_mfma_f32_16x16x32_bf16 v[136:139], a[172:175], v[108:111], v[136:139]
  v_mfma_f32_16x16x32_bf16 v[140:143], a[172:175], v[124:127], v[140:143]
  v_mfma_f32_16x16x32_bf16 v[144:147], a[176:179], v[64:67], v[224:227]
  v_mfma_f32_16x16x32_bf16 v[148:151], a[176:179], v[80:83], v[228:231]
  v_mfma_f32_16x16x32_bf16 v[152:155], a[176:179], v[96:99], v[232:235]
  v_mfma_f32_16x16x32_bf16 v[156:159], a[176:179], v[112:115], v[236:239]
  v_mfma_f32_16x16x32_bf16 v[144:147], a[180:183], v[68:71], v[144:147]
  v_mfma_f32_16x16x32_bf16 v[148:151], a[180:183], v[84:87], v[148:151]
  v_mfma_f32_16x16x32_bf16 v[152:155], a[180:183], v[100:103], v[152:155]
  v_mfma_f32_16x16x32_bf16 v[156:159], a[180:183], v[116:119], v[156:159]
  v_mfma_f32_16x16x32_bf16 v[144:147], a[184:187], v[72:75], v[144:147]
  v_mfma_f32_16x16x32_bf16 v[148:151], a[184:187], v[88:91], v[148:151]
  v_mfma_f32_16x16x32_bf16 v[152:155], a[184:187], v[104:107], v[152:155]
  v_mfma_f32_16x16x32_bf16 v[156:159], a[184:187], v[120:123], v[156:159]
  v_mfma_f32_16x16x32_bf16 v[144:147], a[188:191], v[76:79], v[144:147]
  v_mfma_f32_16x16x32_bf16 v[148:151], a[188:191], v[92:95], v[148:151]
  v_mfma_f32_16x16x32_bf16 v[152:155], a[188:191], v[108:111], v[152:155]
  v_mfma_f32_16x16x32_bf16 v[156:159], a[188:191], v[124:127], v[156:159]
  s_nop 7
  s_cmp_eq_u32 s58, 0
  s_cbranch_scc0 attn_kernel_sp114
  v_max3_f32 v48, v48, v128, v129
  v_max3_f32 v48, v48, v130, v131
  v_max3_f32 v48, v48, v144, v145
  v_max3_f32 v48, v48, v146, v147
  v_max3_f32 v49, v49, v132, v133
  v_max3_f32 v49, v49, v134, v135
  v_max3_f32 v49, v49, v148, v149
  v_max3_f32 v49, v49, v150, v151
  v_max3_f32 v50, v50, v136, v137
  v_max3_f32 v50, v50, v138, v139
  v_max3_f32 v50, v50, v152, v153
  v_max3_f32 v50, v50, v154, v155
  v_max3_f32 v51, v51, v140, v141
  v_max3_f32 v51, v51, v142, v143
  v_max3_f32 v51, v51, v156, v157
  v_max3_f32 v51, v51, v158, v159
  s_branch attn_kernel_snext15
attn_kernel_sp114:
  ds_read_b64_tr_b16 a[128:129], v54 offset:0
  ds_read_b64_tr_b16 a[130:131], v54 offset:4096
  ds_read_b64_tr_b16 a[132:133], v55 offset:0
  ds_read_b64_tr_b16 a[134:135], v55 offset:4096
  ds_read_b64_tr_b16 a[136:137], v56 offset:0
  ds_read_b64_tr_b16 a[138:139], v56 offset:4096
  ds_read_b64_tr_b16 a[140:141], v57 offset:0
  ds_read_b64_tr_b16 a[142:143], v57 offset:4096
  ds_read_b64_tr_b16 a[144:145], v58 offset:0
  ds_read_b64_tr_b16 a[146:147], v58 offset:4096
  ds_read_b64_tr_b16 a[148:149], v59 offset:0
  ds_read_b64_tr_b16 a[150:151], v59 offset:4096
  ds_read_b64_tr_b16 a[152:153], v60 offset:0
  ds_read_b64_tr_b16 a[154:155], v60 offset:4096
  ds_read_b64_tr_b16 a[156:157], v61 offset:0
  ds_read_b64_tr_b16 a[158:159], v61 offset:4096
  v_exp_f32 v240, v128
  v_exp_f32 v241, v129
  s_nop 0
  v_cvt_pk_bf16_f32 v192, v240, v241
  v_exp_f32 v242, v130
  v_exp_f32 v243, v131
  s_nop 0
  v_cvt_pk_bf16_f32 v193, v242, v243
  v_exp_f32 v244, v132
  v_exp_f32 v245, v133
  s_nop 0
  v_cvt_pk_bf16_f32 v196, v244, v245
  v_exp_f32 v246, v134
  v_exp_f32 v247, v135
  s_nop 0
  v_cvt_pk_bf16_f32 v197, v246, v247
  v_exp_f32 v240, v136
  v_exp_f32 v241, v137
  s_nop 0
  v_cvt_pk_bf16_f32 v200, v240, v241
  v_exp_f32 v242, v138
  v_exp_f32 v243, v139
  s_nop 0
  v_cvt_pk_bf16_f32 v201, v242, v243
  v_exp_f32 v244, v140
  v_exp_f32 v245, v141
  s_nop 0
  v_cvt_pk_bf16_f32 v204, v244, v245
  v_exp_f32 v246, v142
  v_exp_f32 v247, v143
  s_nop 0
  v_cvt_pk_bf16_f32 v205, v246, v247
  v_exp_f32 v240, v144
  v_exp_f32 v241, v145
  s_nop 0
  v_cvt_pk_bf16_f32 v194, v240, v241
  v_exp_f32 v242, v146
  v_exp_f32 v243, v147
  s_nop 0
  v_cvt_pk_bf16_f32 v195, v242, v243
  v_exp_f32 v244, v148
  v_exp_f32 v245, v149
  s_nop 0
  v_cvt_pk_bf16_f32 v198, v244, v245
  v_exp_f32 v246, v150
  v_exp_f32 v247, v151
  s_nop 0
  v_cvt_pk_bf16_f32 v199, v246, v247
  v_exp_f32 v240, v152
  v_exp_f32 v241, v153
  s_nop 0
  v_cvt_pk_bf16_f32 v202, v240, v241
  v_exp_f32 v242, v154
  v_exp_f32 v243, v155
  s_nop 0
  v_cvt_pk_bf16_f32 v203, v242, v243
  v_exp_f32 v244, v156
  v_exp_f32 v245, v157
  s_nop 0
  v_cvt_pk_bf16_f32 v206, v244, v245
  v_exp_f32 v246, v158
  v_exp_f32 v247, v159
  s_nop 0
  v_cvt_pk_bf16_f32 v207, v246, v247
  s_waitcnt lgkmcnt(0)
  s_nop 0
  v_mfma_f32_16x16x32_bf16 v[32:35], v[248:251], v[192:195], v[32:35]
  v_mfma_f32_16x16x32_bf16 v[36:39], v[248:251], v[196:199], v[36:39]
  v_mfma_f32_16x16x32_bf16 v[40:43], v[248:251], v[200:203], v[40:43]
  v_mfma_f32_16x16x32_bf16 v[44:47], v[248:251], v[204:207], v[44:47]
  v_mfma_f32_16x16x32_bf16 a[0:3], a[128:131], v[192:195], a[0:3]
  v_mfma_f32_16x16x32_bf16 a[4:7], a[128:131], v[196:199], a[4:7]
  v_mfma_f32_16x16x32_bf16 a[8:11], a[128:131], v[200:203], a[8:11]
  v_mfma_f32_16x16x32_bf16 a[12:15], a[128:131], v[204:207], a[12:15]
  v_mfma_f32_16x16x32_bf16 a[16:19], a[132:135], v[192:195], a[16:19]
  v_mfma_f32_16x16x32_bf16 a[20:23], a[132:135], v[196:199], a[20:23]
  v_mfma_f32_16x16x32_bf16 a[24:27], a[132:135], v[200:203], a[24:27]
  v_mfma_f32_16x16x32_bf16 a[28:31], a[132:135], v[204:207], a[28:31]
  v_mfma_f32_16x16x32_bf16 a[32:35], a[136:139], v[192:195], a[32:35]
  v_mfma_f32_16x16x32_bf16 a[36:39], a[136:139], v[196:199], a[36:39]
  v_mfma_f32_16x16x32_bf16 a[40:43], a[136:139], v[200:203], a[40:43]
  v_mfma_f32_16x16x32_bf16 a[44:47], a[136:139], v[204:207], a[44:47]
  v_mfma_f32_16x16x32_bf16 a[48:51], a[140:143], v[192:195], a[48:51]
  v_mfma_f32_16x16x32_bf16 a[52:55], a[140:143], v[196:199], a[52:55]
  v_mfma_f32_16x16x32_bf16 a[56:59], a[140:143], v[200:203], a[56:59]
  v_mfma_f32_16x16x32_bf16 a[60:63], a[140:143], v[204:207], a[60:63]
  v_mfma_f32_16x16x32_bf16 a[64:67], a[144:147], v[192:195], a[64:67]
  v_mfma_f32_16x16x32_bf16 a[68:71], a[144:147], v[196:199], a[68:71]
  v_mfma_f32_16x16x32_bf16 a[72:75], a[144:147], v[200:203], a[72:75]
  v_mfma_f32_16x16x32_bf16 a[76:79], a[144:147], v[204:207], a[76:79]
  v_mfma_f32_16x16x32_bf16 a[80:83], a[148:151], v[192:195], a[80:83]
  v_mfma_f32_16x16x32_bf16 a[84:87], a[148:151], v[196:199], a[84:87]
  v_mfma_f32_16x16x32_bf16 a[88:91], a[148:151], v[200:203], a[88:91]
  v_mfma_f32_16x16x32_bf16 a[92:95], a[148:151], v[204:207], a[92:95]
  v_mfma_f32_16x16x32_bf16 a[96:99], a[152:155], v[192:195], a[96:99]
  v_mfma_f32_16x16x32_bf16 a[100:103], a[152:155], v[196:199], a[100:103]
  v_mfma_f32_16x16x32_bf16 a[104:107], a[152:155], v[200:203], a[104:107]
  v_mfma_f32_16x16x32_bf16 a[108:111], a[152:155], v[204:207], a[108:111]
  v_mfma_f32_16x16x32_bf16 a[112:115], a[156:159], v[192:195], a[112:115]
  v_mfma_f32_16x16x32_bf16 a[116:119], a[156:159], v[196:199], a[116:119]
  v_mfma_f32_16x16x32_bf16 a[120:123], a[156:159], v[200:203], a[120:123]
  v_mfma_f32_16x16x32_bf16 a[124:127], a[156:159], v[204:207], a[124:127]
attn_kernel_snext15:
  s_add_u32 s53, s53, 8192
  s_cmp_lt_u32 s53, 524288
  s_cbranch_scc1 attn_kernel_sunit13
  s_nop 7
  s_cmp_eq_u32 s58, 0
  s_cbranch_scc0 attn_kernel_epi5
  v_mov_b32 v252, v48
  s_nop 1
  v_permlane16_swap_b32 v48, v252
  v_max_f32 v48, v48, v252
  v_mov_b32 v252, v48
  s_nop 1
  v_permlane32_swap_b32 v48, v252
  v_max_f32 v48, v48, v252
  v_sub_f32 v224, 0, v48
  v_sub_f32 v225, 0, v48
  v_sub_f32 v226, 0, v48
  v_sub_f32 v227, 0, v48
  v_mov_b32 v252, v49
  s_nop 1
  v_permlane16_swap_b32 v49, v252
  v_max_f32 v49, v49, v252
  v_mov_b32 v252, v49
  s_nop 1
  v_permlane32_swap_b32 v49, v252
  v_max_f32 v49, v49, v252
  v_sub_f32 v228, 0, v49
  v_sub_f32 v229, 0, v49
  v_sub_f32 v230, 0, v49
  v_sub_f32 v231, 0, v49
  v_mov_b32 v252, v50
  s_nop 1
  v_permlane16_swap_b32 v50, v252
  v_max_f32 v50, v50, v252
  v_mov_b32 v252, v50
  s_nop 1
  v_permlane32_swap_b32 v50, v252
  v_max_f32 v50, v50, v252
  v_sub_f32 v232, 0, v50
  v_sub_f32 v233, 0, v50
  v_sub_f32 v234, 0, v50
  v_sub_f32 v235, 0, v50
  v_mov_b32 v252, v51
  s_nop 1
  v_permlane16_swap_b32 v51, v252
  v_max_f32 v51, v51, v252
  v_mov_b32 v252, v51
  s_nop 1
  v_permlane32_swap_b32 v51, v252
  v_max_f32 v51, v51, v252
  v_sub_f32 v236, 0, v51
  v_sub_f32 v237, 0, v51
  v_sub_f32 v238, 0, v51
  v_sub_f32 v239, 0, v51
  v_mov_b32 v32, 0
  v_mov_b32 v33, 0
  v_mov_b32 v34, 0
  v_mov_b32 v35, 0
  v_mov_b32 v36, 0
  v_mov_b32 v37, 0
  v_mov_b32 v38, 0
  v_mov_b32 v39, 0
  v_mov_b32 v40, 0
  v_mov_b32 v41, 0
  v_mov_b32 v42, 0
  v_mov_b32 v43, 0
  v_mov_b32 v44, 0
  v_mov_b32 v45, 0
  v_mov_b32 v46, 0
  v_mov_b32 v47, 0
  v_accvgpr_write_b32 a0, 0
  v_accvgpr_write_b32 a1, 0
  v_accvgpr_write_b32 a2, 0
  v_accvgpr_write_b32 a3, 0
  v_accvgpr_write_b32 a4, 0
  v_accvgpr_write_b32 a5, 0
  v_accvgpr_write_b32 a6, 0
  v_accvgpr_write_b32 a7, 0
  v_accvgpr_write_b32 a8, 0
  v_accvgpr_write_b32 a9, 0
  v_accvgpr_write_b32 a10, 0
  v_accvgpr_write_b32 a11, 0
  v_accvgpr_write_b32 a12, 0
  v_accvgpr_write_b32 a13, 0
  v_accvgpr_write_b32 a14, 0
  v_accvgpr_write_b32 a15, 0
  v_accvgpr_write_b32 a16, 0
  v_accvgpr_write_b32 a17, 0
  v_accvgpr_write_b32 a18, 0
  v_accvgpr_write_b32 a19, 0
  v_accvgpr_write_b32 a20, 0
  v_accvgpr_write_b32 a21, 0
  v_accvgpr_write_b32 a22, 0
  v_accvgpr_write_b32 a23, 0
  v_accvgpr_write_b32 a24, 0
  v_accvgpr_write_b32 a25, 0
  v_accvgpr_write_b32 a26, 0
  v_accvgpr_write_b32 a27, 0
  v_accvgpr_write_b32 a28, 0
  v_accvgpr_write_b32 a29, 0
  v_accvgpr_write_b32 a30, 0
  v_accvgpr_write_b32 a31, 0
  v_accvgpr_write_b32 a32, 0
  v_accvgpr_write_b32 a33, 0
  v_accvgpr_write_b32 a34, 0
  v_accvgpr_write_b32 a35, 0
  v_accvgpr_write_b32 a36, 0
  v_accvgpr_write_b32 a37, 0
  v_accvgpr_write_b32 a38, 0
  v_accvgpr_write_b32 a39, 0
  v_accvgpr_write_b32 a40, 0
  v_accvgpr_write_b32 a41, 0
  v_accvgpr_write_b32 a42, 0
  v_accvgpr_write_b32 a43, 0
  v_accvgpr_write_b32 a44, 0
  v_accvgpr_write_b32 a45, 0
  v_accvgpr_write_b32 a46, 0
  v_accvgpr_write_b32 a47, 0
  v_accvgpr_write_b32 a48, 0
  v_accvgpr_write_b32 a49, 0
  v_accvgpr_write_b32 a50, 0
  v_accvgpr_write_b32 a51, 0
  v_accvgpr_write_b32 a52, 0
  v_accvgpr_write_b32 a53, 0
  v_accvgpr_write_b32 a54, 0
  v_accvgpr_write_b32 a55, 0
  v_accvgpr_write_b32 a56, 0
  v_accvgpr_write_b32 a57, 0
  v_accvgpr_write_b32 a58, 0
  v_accvgpr_write_b32 a59, 0
  v_accvgpr_write_b32 a60, 0
  v_accvgpr_write_b32 a61, 0
  v_accvgpr_write_b32 a62, 0
  v_accvgpr_write_b32 a63, 0
  v_accvgpr_write_b32 a64, 0
  v_accvgpr_write_b32 a65, 0
  v_accvgpr_write_b32 a66, 0
  v_accvgpr_write_b32 a67, 0
  v_accvgpr_write_b32 a68, 0
  v_accvgpr_write_b32 a69, 0
  v_accvgpr_write_b32 a70, 0
  v_accvgpr_write_b32 a71, 0
  v_accvgpr_write_b32 a72, 0
  v_accvgpr_write_b32 a73, 0
  v_accvgpr_write_b32 a74, 0
  v_accvgpr_write_b32 a75, 0
  v_accvgpr_write_b32 a76, 0
  v_accvgpr_write_b32 a77, 0
  v_accvgpr_write_b32 a78, 0
  v_accvgpr_write_b32 a79, 0
  v_accvgpr_write_b32 a80, 0
  v_accvgpr_write_b32 a81, 0
  v_accvgpr_write_b32 a82, 0
  v_accvgpr_write_b32 a83, 0
  v_accvgpr_write_b32 a84, 0
  v_accvgpr_write_b32 a85, 0
  v_accvgpr_write_b32 a86, 0
  v_accvgpr_write_b32 a87, 0
  v_accvgpr_write_b32 a88, 0
  v_accvgpr_write_b32 a89, 0
  v_accvgpr_write_b32 a90, 0
  v_accvgpr_write_b32 a91, 0
  v_accvgpr_write_b32 a92, 0
  v_accvgpr_write_b32 a93, 0
  v_accvgpr_write_b32 a94, 0
  v_accvgpr_write_b32 a95, 0
  v_accvgpr_write_b32 a96, 0
  v_accvgpr_write_b32 a97, 0
  v_accvgpr_write_b32 a98, 0
  v_accvgpr_write_b32 a99, 0
  v_accvgpr_write_b32 a100, 0
  v_accvgpr_write_b32 a101, 0
  v_accvgpr_write_b32 a102, 0
  v_accvgpr_write_b32 a103, 0
  v_accvgpr_write_b32 a104, 0
  v_accvgpr_write_b32 a105, 0
  v_accvgpr_write_b32 a106, 0
  v_accvgpr_write_b32 a107, 0
  v_accvgpr_write_b32 a108, 0
  v_accvgpr_write_b32 a109, 0
  v_accvgpr_write_b32 a110, 0
  v_accvgpr_write_b32 a111, 0
  v_accvgpr_write_b32 a112, 0
  v_accvgpr_write_b32 a113, 0
  v_accvgpr_write_b32 a114, 0
  v_accvgpr_write_b32 a115, 0
  v_accvgpr_write_b32 a116, 0
  v_accvgpr_write_b32 a117, 0
  v_accvgpr_write_b32 a118, 0
  v_accvgpr_write_b32 a119, 0
  v_accvgpr_write_b32 a120, 0
  v_accvgpr_write_b32 a121, 0
  v_accvgpr_write_b32 a122, 0
  v_accvgpr_write_b32 a123, 0
  v_accvgpr_write_b32 a124, 0
  v_accvgpr_write_b32 a125, 0
  v_accvgpr_write_b32 a126, 0
  v_accvgpr_write_b32 a127, 0
  s_mov_b32 s58, 1
  s_branch attn_kernel_spass12
attn_kernel_next11:
  s_load_dwordx2 s[4:5], s[0:1], 112
  s_load_dwordx2 s[28:29], s[0:1], 0
  s_load_dwordx2 s[6:7], s[0:1], 56
  s_load_dwordx2 s[8:9], s[0:1], 96
  s_load_dwordx2 s[10:11], s[0:1], 72
  s_load_dwordx2 s[12:13], s[0:1], 32
  v_and_b32 v1, 63, v0
  v_lshrrev_b32 v2, 6, v0
  s_nop 0
  v_readfirstlane_b32 s44, v2
  s_bfe_u32 s40, s2, 0x10002
  s_bfe_u32 s42, s2, 0x10001
  s_lshl_b32 s42, s42, 3
  s_lshr_b32 s43, s2, 5
  s_add_u32 s42, s42, s43
  s_and_b32 s43, s2, 1
  s_lshl_b32 s43, s43, 2
  s_bfe_u32 s41, s2, 0x20003
  s_add_u32 s43, s43, s41
  s_lshl_b32 s47, s42, 3
  s_lshl_b32 s48, s44, 1
  s_add_u32 s47, s47, s48
  s_lshl_b32 s52, s44, 12
  v_lshl_add_u32 v8, v1, 4, s52
  v_lshrrev_b32 v32, 4, v1
  v_and_b32 v33, 15, v1
  s_lshl_b32 s45, s44, 4
  s_mov_b32 s46, 2048
  v_add_u32 v34, 0, v32
  v_and_b32 v35, 7, v34
  v_lshlrev_b32 v35, 1, v35
  v_xor_b32 v35, v35, v33
  v_add_u32 v34, s45, v34
  v_mul_lo_u32 v34, v34, s46
  v_lshl_add_u32 v56, v35, 4, v34
  v_add_u32 v34, 4, v32
  v_and_b32 v35, 7, v34
  v_lshlrev_b32 v35, 1, v35
  v_xor_b32 v35, v35, v33
  v_add_u32 v34, s45, v34
  v_mul_lo_u32 v34, v34, s46
  v_lshl_add_u32 v57, v35, 4, v34
  v_subrev_u32 v57, 1024, v57
  v_add_u32 v34, 8, v32
  v_and_b32 v35, 7, v34
  v_lshlrev_b32 v35, 1, v35
  v_xor_b32 v35, v35, v33
  v_add_u32 v34, s45, v34
  v_mul_lo_u32 v34, v34, s46
  v_lshl_add_u32 v58, v35, 4, v34
  v_subrev_u32 v58, 2048, v58
  v_add_u32 v34, 12, v32
  v_and_b32 v35, 7, v34
  v_lshlrev_b32 v35, 1, v35
  v_xor_b32 v35, v35, v33
  v_add_u32 v34, s45, v34
  v_mul_lo_u32 v34, v34, s46
  v_lshl_add_u32 v59, v35, 4, v34
  v_subrev_u32 v59, 3072, v59
  s_lshl_b32 s48, s47, 10
  v_lshl_add_u32 v12, v1, 4, s48
  v_add_u32 v13, 0x20000, v12
  s_lshl_b32 s50, s43, 8
  s_lshl_b32 s48, s40, 22
  s_add_u32 s50, s50, s48
  s_lshl_b32 s51, s40, 23
  s_waitcnt lgkmcnt(0)
  s_and_b32 s13, s13, 0xffff
  s_mov_b32 s14, 8388608
  s_mov_b32 s15, 0x20000
  s_add_u32 s16, s4, 8388608
  s_addc_u32 s17, s5, 0
  s_and_b32 s17, s17, 0xffff
  s_mov_b32 s18, 16777216
  s_mov_b32 s19, 0x20000
  s_add_u32 s68, s4, 655360
  s_addc_u32 s69, s5, 0
  s_and_b32 s69, s69, 0xffff
  s_mov_b32 s70, 98304
  s_mov_b32 s71, 0x20000
  s_lshl_b32 s45, s2, 7
  s_add_u32 s45, s45, 65536
  s_waitcnt vmcnt(0)
  s_barrier
  s_cmp_lg_u32 s44, 0
  s_cbranch_scc1 attn_kernel_pub18
  v_mov_b32 v3, 0
  v_mov_b32 v4, 1
  buffer_store_dword v4, v3, s[68:71], s45 offen sc1
attn_kernel_pub18:
  v_and_b32 v3, 3, v1
  v_bfe_u32 v4, v1, 2, 2
  v_lshl_add_u32 v4, v3, 3, v4
  s_lshr_b32 s45, s42, 1
  s_lshl_b32 s45, s45, 5
  s_lshl_b32 s46, s40, 2
  s_add_u32 s45, s45, s46
  v_add_u32 v4, s45, v4
  s_and_b32 s45, s2, 0xfc
  v_add_u32 v3, s45, v3
  v_cmp_gt_u32 vcc, 16, v1
  s_mov_b32 s45, 65536
  s_nop 0
  v_cndmask_b32 v3, v3, v4, vcc
  v_lshlrev_b32 v3, 7, v3
  s_add_u32 m0, s52, 0
  s_nop 0
  buffer_load_dwordx4 v56, s[12:15], s50 offen offset:0 lds
  buffer_load_dwordx4 v57, s[12:15], s50 offen offset:1024 lds
  buffer_load_dwordx4 v58, s[12:15], s50 offen offset:2048 lds
  buffer_load_dwordx4 v59, s[12:15], s50 offen offset:3072 lds
  s_add_u32 s50, s50, 131072
  s_add_u32 m0, s52, 16384
  s_nop 0
  buffer_load_dwordx4 v56, s[12:15], s50 offen offset:0 lds
  buffer_load_dwordx4 v57, s[12:15], s50 offen offset:1024 lds
  buffer_load_dwordx4 v58, s[12:15], s50 offen offset:2048 lds
  buffer_load_dwordx4 v59, s[12:15], s50 offen offset:3072 lds
  s_add_u32 s50, s50, 131072
  s_add_u32 m0, s52, 32768
  s_nop 0
  buffer_load_dwordx4 v56, s[12:15], s50 offen offset:0 lds
  buffer_load_dwordx4 v57, s[12:15], s50 offen offset:1024 lds
  buffer_load_dwordx4 v58, s[12:15], s50 offen offset:2048 lds
  buffer_load_dwordx4 v59, s[12:15], s50 offen offset:3072 lds
  s_add_u32 s50, s50, 131072
  s_add_u32 m0, s52, 49152
  s_nop 0
  buffer_load_dwordx4 v56, s[12:15], s50 offen offset:0 lds
  buffer_load_dwordx4 v57, s[12:15], s50 offen offset:1024 lds
  buffer_load_dwordx4 v58, s[12:15], s50 offen offset:2048 lds
  buffer_load_dwordx4 v59, s[12:15], s50 offen offset:3072 lds
  s_add_u32 s50, s50, 131072
  s_add_u32 m0, s52, 65536
  s_nop 0
  buffer_load_dwordx4 v56, s[12:15], s50 offen offset:0 lds
  buffer_load_dwordx4 v57, s[12:15], s50 offen offset:1024 lds
  buffer_load_dwordx4 v58, s[12:15], s50 offen offset:2048 lds
  buffer_load_dwordx4 v59, s[12:15], s50 offen offset:3072 lds
  s_add_u32 s50, s50, 131072
  s_add_u32 m0, s52, 81920
  s_nop 0
  buffer_load_dwordx4 v56, s[12:15], s50 offen offset:0 lds
  buffer_load_dwordx4 v57, s[12:15], s50 offen offset:1024 lds
  buffer_load_dwordx4 v58, s[12:15], s50 offen offset:2048 lds
  buffer_load_dwordx4 v59, s[12:15], s50 offen offset:3072 lds
  s_add_u32 s50, s50, 131072
  s_add_u32 m0, s52, 98304
  s_nop 0
  buffer_load_dwordx4 v56, s[12:15], s50 offen offset:0 lds
  buffer_load_dwordx4 v57, s[12:15], s50 offen offset:1024 lds
  buffer_load_dwordx4 v58, s[12:15], s50 offen offset:2048 lds
  buffer_load_dwordx4 v59, s[12:15], s50 offen offset:3072 lds
  s_add_u32 s50, s50, 131072
  s_cmp_lg_u32 s44, 0
  s_cbranch_scc1 attn_kernel_awd20
  s_mov_b32 s53, 0x80000
attn_kernel_aw19:
  buffer_load_dword v4, v3, s[68:71], s45 offen sc1
  s_sub_u32 s53, s53, 1
  s_cselect_b64 s[58:59], 0, -1
  s_waitcnt vmcnt(0)
  v_cmp_eq_u32 vcc, 0, v4
  s_and_b64 vcc, vcc, s[58:59]
  s_cbranch_vccz attn_kernel_awd20
  s_branch attn_kernel_aw19
attn_kernel_awd20:
  s_barrier
  buffer_load_dwordx4 a[0:3], v12, s[16:19], s51 offen offset:0 sc1
  buffer_load_dwordx4 a[4:7], v12, s[16:19], s51 offen offset:1024 sc1
  buffer_load_dwordx4 a[8:11], v13, s[16:19], s51 offen offset:0 sc1
  buffer_load_dwordx4 a[12:15], v13, s[16:19], s51 offen offset:1024 sc1
  s_add_u32 s51, s51, 262144
  buffer_load_dwordx4 a[16:19], v12, s[16:19], s51 offen offset:0 sc1
  buffer_load_dwordx4 a[20:23], v12, s[16:19], s51 offen offset:1024 sc1
  buffer_load_dwordx4 a[24:27], v13, s[16:19], s51 offen offset:0 sc1
  buffer_load_dwordx4 a[28:31], v13, s[16:19], s51 offen offset:1024 sc1
  s_add_u32 s51, s51, 262144
  buffer_load_dwordx4 a[32:35], v12, s[16:19], s51 offen offset:0 sc1
  buffer_load_dwordx4 a[36:39], v12, s[16:19], s51 offen offset:1024 sc1
  buffer_load_dwordx4 a[40:43], v13, s[16:19], s51 offen offset:0 sc1
  buffer_load_dwordx4 a[44:47], v13, s[16:19], s51 offen offset:1024 sc1
  s_add_u32 s51, s51, 262144
  buffer_load_dwordx4 a[48:51], v12, s[16:19], s51 offen offset:0 sc1
  buffer_load_dwordx4 a[52:55], v12, s[16:19], s51 offen offset:1024 sc1
  buffer_load_dwordx4 a[56:59], v13, s[16:19], s51 offen offset:0 sc1
  buffer_load_dwordx4 a[60:63], v13, s[16:19], s51 offen offset:1024 sc1
  s_add_u32 s51, s51, 262144
  buffer_load_dwordx4 a[64:67], v12, s[16:19], s51 offen offset:0 sc1
  buffer_load_dwordx4 a[68:71], v12, s[16:19], s51 offen offset:1024 sc1
  buffer_load_dwordx4 a[72:75], v13, s[16:19], s51 offen offset:0 sc1
  buffer_load_dwordx4 a[76:79], v13, s[16:19], s51 offen offset:1024 sc1
  s_add_u32 s51, s51, 262144
  v_lshrrev_b32 v32, 2, v1
  v_and_b32 v33, 3, v1
  v_and_b32 v34, 7, v32
  v_lshlrev_b32 v32, 8, v32
  v_lshl_add_u32 v32, v33, 3, v32
  v_xor_b32 v33, 0, v34
  v_lshl_add_u32 v16, v33, 5, v32
  v_xor_b32 v33, 1, v34
  v_lshl_add_u32 v17, v33, 5, v32
  v_xor_b32 v33, 2, v34
  v_lshl_add_u32 v18, v33, 5, v32
  v_xor_b32 v33, 3, v34
  v_lshl_add_u32 v19, v33, 5, v32
  v_xor_b32 v33, 4, v34
  v_lshl_add_u32 v20, v33, 5, v32
  v_xor_b32 v33, 5, v34
  v_lshl_add_u32 v21, v33, 5, v32
  v_xor_b32 v33, 6, v34
  v_lshl_add_u32 v22, v33, 5, v32
  v_xor_b32 v33, 7, v34
  v_lshl_add_u32 v23, v33, 5, v32
  v_add_u32 v24, 0x10000, v16
  v_add_u32 v25, 0x10000, v17
  v_add_u32 v26, 0x10000, v18
  v_add_u32 v27, 0x10000, v19
  v_add_u32 v28, 0x10000, v20
  v_add_u32 v29, 0x10000, v21
  v_add_u32 v30, 0x10000, v22
  v_add_u32 v31, 0x10000, v23
  s_add_u32 s56, s4, 0
  s_addc_u32 s57, s5, 0
  s_and_b32 s57, s57, 0xffff
  s_mov_b32 s58, 524288
  s_mov_b32 s59, 0x20000
  v_and_b32 v40, 15, v1
  v_lshlrev_b32 v40, 2, v40
  v_lshrrev_b32 v45, 4, v1
  v_lshl_add_u32 v45, v45, 16, v40
  s_lshl_b32 s60, s2, 6
  s_add_u32 s61, s60, 262144
  buffer_load_dword v41, v45, s[56:59], s61 offen sc1
  s_add_u32 s61, s60, 278528
  buffer_load_dword v42, v45, s[56:59], s61 offen sc1
  s_add_u32 s61, s60, 294912
  buffer_load_dword v43, v45, s[56:59], s61 offen sc1
  s_add_u32 s61, s60, 311296
  buffer_load_dword v44, v45, s[56:59], s61 offen sc1
  s_getpc_b64 s[32:33]
attn_kernel_pc22:
  s_add_u32 s32, s32, attn_kernel_tail21-attn_kernel_pc22
  s_addc_u32 s33, s33, 0
  s_and_b32 s33, s33, 0xffff
  s_mov_b32 s34, code_end-attn_kernel_tail21
  s_mov_b32 s35, 0x20000
  s_lshr_b32 s55, s2, 3
  s_lshl_b32 s55, s55, 12
  v_lshlrev_b32 v52, 4, v0
  s_and_b32 s29, s29, 0xffff
  s_mov_b32 s30, 4194304
  s_mov_b32 s31, 0x20000
  s_mov_b32 s72, s10
  s_and_b32 s73, s11, 0xffff
  s_mov_b32 s74, 2048
  s_mov_b32 s75, 0x20000
  s_add_u32 s24, s4, 96468992
  s_addc_u32 s25, s5, 0
  s_and_b32 s25, s25, 0xffff
  s_mov_b32 s26, 8388608
  s_mov_b32 s27, 0x20000
  s_add_u32 s20, s4, 8192
  s_addc_u32 s21, s5, 0
  s_and_b32 s21, s21, 0xffff
  s_mov_b32 s22, 12288
  s_mov_b32 s23, 0x20000
  s_add_u32 s36, s4, 96468992
  s_addc_u32 s37, s5, 0
  s_and_b32 s37, s37, 0xffff
  s_mov_b32 s38, 4194304
  s_mov_b32 s39, 0x20000
  s_add_u32 s64, s4, 1048576
  s_addc_u32 s65, s5, 0
  s_and_b32 s65, s65, 0xffff
  s_mov_b32 s66, 4194304
  s_mov_b32 s67, 0x20000
  v_and_b32 v4, 15, v1
  v_lshrrev_b32 v5, 4, v1
  v_lshlrev_b32 v6, 11, v4
  v_lshl_add_u32 v7, v5, 4, v6
  v_lshlrev_b32 v3, 4, v1
  v_and_b32 v14, 7, v1
  v_lshlrev_b32 v14, 11, v14
  v_bfe_u32 v15, v1, 3, 1
  v_lshl_add_u32 v14, v15, 6, v14
  v_lshrrev_b32 v15, 4, v1
  v_lshl_add_u32 v14, v15, 4, v14
  v_add_u32 v15, 0x4000, v14
  s_lshl_b32 s48, s47, 15
  s_lshl_b32 s49, s43, 8
  s_add_u32 s48, s48, s49
  s_lshl_b32 s49, s40, 22
  s_add_u32 s48, s48, s49
  s_add_u32 s49, s48, 32768
  s_lshl_b32 s46, s42, 4
  s_lshl_b32 s45, s43, 1
  s_add_u32 s46, s46, s45
  s_add_u32 s46, s46, s40
  s_lshl_b32 s54, s46, 14
  s_add_u32 s45, s54, 4194304
  s_mul_i32 s41, s44, 3072
  v_lshlrev_b32 v53, 7, v1
  v_add_u32 v54, 16384, v53
  s_waitcnt vmcnt(20)
  s_barrier
  ds_read_b64_tr_b16 a[128:129], v16 offset:0
  ds_read_b64_tr_b16 a[130:131], v16 offset:4096
  ds_read_b64_tr_b16 a[132:133], v16 offset:8192
  ds_read_b64_tr_b16 a[134:135], v16 offset:12288
  ds_read_b64_tr_b16 a[136:137], v17 offset:0
  ds_read_b64_tr_b16 a[138:139], v17 offset:4096
  ds_read_b64_tr_b16 a[140:141], v17 offset:8192
  ds_read_b64_tr_b16 a[142:143], v17 offset:12288
  s_waitcnt lgkmcnt(4)
  v_mfma_f32_16x16x32_bf16 v[64:67], a[128:131], a[0:3], 0
  ds_read_b64_tr_b16 a[144:145], v18 offset:0
  ds_read_b64_tr_b16 a[146:147], v18 offset:4096
  v_mfma_f32_16x16x32_bf16 v[64:67], a[132:135], a[8:11], v[64:67]
  buffer_load_dwordx4 a[80:83], v12, s[16:19], s51 offen offset:0 sc1
  v_mfma_f32_16x16x32_bf16 v[68:71], a[128:131], a[4:7], 0
  ds_read_b64_tr_b16 a[148:149], v18 offset:8192
  ds_read_b64_tr_b16 a[150:151], v18 offset:12288
  v_mfma_f32_16x16x32_bf16 v[68:71], a[132:135], a[12:15], v[68:71]
  buffer_load_dwordx4 a[84:87], v12, s[16:19], s51 offen offset:1024 sc1
  s_waitcnt lgkmcnt(4)
  v_mfma_f32_16x16x32_bf16 v[72:75], a[136:139], a[0:3], 0
  ds_read_b64_tr_b16 a[152:153], v19 offset:0
  ds_read_b64_tr_b16 a[154:155], v19 offset:4096
  v_mfma_f32_16x16x32_bf16 v[72:75], a[140:143], a[8:11], v[72:75]
  v_mfma_f32_16x16x32_bf16 v[76:79], a[136:139], a[4:7], 0
  ds_read_b64_tr_b16 a[156:157], v19 offset:8192
  ds_read_b64_tr_b16 a[158:159], v19 offset:12288
  v_mfma_f32_16x16x32_bf16 v[76:79], a[140:143], a[12:15], v[76:79]
  buffer_load_dwordx4 a[88:91], v13, s[16:19], s51 offen offset:0 sc1
  s_waitcnt lgkmcnt(4)
  v_mfma_f32_16x16x32_bf16 v[80:83], a[144:147], a[0:3], 0
  ds_read_b64_tr_b16 a[128:129], v20 offset:0
  ds_read_b64_tr_b16 a[130:131], v20 offset:4096
  v_mfma_f32_16x16x32_bf16 v[80:83], a[148:151], a[8:11], v[80:83]
  buffer_load_dwordx4 a[92:95], v13, s[16:19], s51 offen offset:1024 sc1
  s_add_u32 s51, s51, 262144
  v_mfma_f32_16x16x32_bf16 v[84:87], a[144:147], a[4:7], 0
  ds_read_b64_tr_b16 a[132:133], v20 offset:8192
  ds_read_b64_tr_b16 a[134:135], v20 offset:12288
  v_mfma_f32_16x16x32_bf16 v[84:87], a[148:151], a[12:15], v[84:87]
  s_waitcnt lgkmcnt(4)
  v_mfma_f32_16x16x32_bf16 v[88:91], a[152:155], a[0:3], 0
  ds_read_b64_tr_b16 a[136:137], v21 offset:0
  ds_read_b64_tr_b16 a[138:139], v21 offset:4096
  v_mfma_f32_16x16x32_bf16 v[88:91], a[156:159], a[8:11], v[88:91]
  buffer_load_dwordx4 a[96:99], v12, s[16:19], s51 offen offset:0 sc1
  v_mfma_f32_16x16x32_bf16 v[92:95], a[152:155], a[4:7], 0
  ds_read_b64_tr_b16 a[140:141], v21 offset:8192
  ds_read_b64_tr_b16 a[142:143], v21 offset:12288
  v_mfma_f32_16x16x32_bf16 v[92:95], a[156:159], a[12:15], v[92:95]
  buffer_load_dwordx4 a[100:103], v12, s[16:19], s51 offen offset:1024 sc1
  s_waitcnt lgkmcnt(4)
  v_mfma_f32_16x16x32_bf16 v[96:99], a[128:131], a[0:3], 0
  ds_read_b64_tr_b16 a[144:145], v22 offset:0
  ds_read_b64_tr_b16 a[146:147], v22 offset:4096
  v_mfma_f32_16x16x32_bf16 v[96:99], a[132:135], a[8:11], v[96:99]
  v_mfma_f32_16x16x32_bf16 v[100:103], a[128:131], a[4:7], 0
  ds_read_b64_tr_b16 a[148:149], v22 offset:8192
  ds_read_b64_tr_b16 a[150:151], v22 offset:12288
  v_mfma_f32_16x16x32_bf16 v[100:103], a[132:135], a[12:15], v[100:103]
  buffer_load_dwordx4 a[104:107], v13, s[16:19], s51 offen offset:0 sc1
  s_waitcnt lgkmcnt(4)
  v_mfma_f32_16x16x32_bf16 v[104:107], a[136:139], a[0:3], 0
  ds_read_b64_tr_b16 a[152:153], v23 offset:0
  ds_read_b64_tr_b16 a[154:155], v23 offset:4096
  v_mfma_f32_16x16x32_bf16 v[104:107], a[140:143], a[8:11], v[104:107]
  buffer_load_dwordx4 a[108:111], v13, s[16:19], s51 offen offset:1024 sc1
  s_add_u32 s51, s51, 262144
  v_mfma_f32_16x16x32_bf16 v[108:111], a[136:139], a[4:7], 0
  ds_read_b64_tr_b16 a[156:157], v23 offset:8192
  ds_read_b64_tr_b16 a[158:159], v23 offset:12288
  v_mfma_f32_16x16x32_bf16 v[108:111], a[140:143], a[12:15], v[108:111]
  s_waitcnt vmcnt(24) lgkmcnt(4)
  s_barrier
  v_mfma_f32_16x16x32_bf16 v[112:115], a[144:147], a[0:3], 0
  ds_read_b64_tr_b16 a[128:129], v16 offset:16384
  ds_read_b64_tr_b16 a[130:131], v16 offset:20480
  v_mfma_f32_16x16x32_bf16 v[112:115], a[148:151], a[8:11], v[112:115]
  buffer_load_dwordx4 a[112:115], v12, s[16:19], s51 offen offset:0 sc1
  v_mfma_f32_16x16x32_bf16 v[116:119], a[144:147], a[4:7], 0
  ds_read_b64_tr_b16 a[132:133], v16 offset:24576
  ds_read_b64_tr_b16 a[134:135], v16 offset:28672
  v_mfma_f32_16x16x32_bf16 v[116:119], a[148:151], a[12:15], v[116:119]
  s_add_u32 m0, s52, 114688
  s_waitcnt lgkmcnt(4)
  v_mfma_f32_16x16x32_bf16 v[120:123], a[152:155], a[0:3], 0
  ds_read_b64_tr_b16 a[136:137], v17 offset:16384
  ds_read_b64_tr_b16 a[138:139], v17 offset:20480
  v_mfma_f32_16x16x32_bf16 v[120:123], a[156:159], a[8:11], v[120:123]
  buffer_load_dwordx4 a[116:119], v12, s[16:19], s51 offen offset:1024 sc1
  v_mfma_f32_16x16x32_bf16 v[124:127], a[152:155], a[4:7], 0
  ds_read_b64_tr_b16 a[140:141], v17 offset:24576
  ds_read_b64_tr_b16 a[142:143], v17 offset:28672
  v_mfma_f32_16x16x32_bf16 v[124:127], a[156:159], a[12:15], v[124:127]
  s_waitcnt lgkmcnt(4)
  v_mfma_f32_16x16x32_bf16 v[64:67], a[128:131], a[16:19], v[64:67]
  ds_read_b64_tr_b16 a[144:145], v18 offset:16384
  ds_read_b64_tr_b16 a[146:147], v18 offset:20480
  v_mfma_f32_16x16x32_bf16 v[64:67], a[132:135], a[24:27], v[64:67]
  buffer_load_dwordx4 v56, s[12:15], s50 offen offset:0 lds
  v_mfma_f32_16x16x32_bf16 v[68:71], a[128:131], a[20:23], v[68:71]
  ds_read_b64_tr_b16 a[148:149], v18 offset:24576
  ds_read_b64_tr_b16 a[150:151], v18 offset:28672
  v_mfma_f32_16x16x32_bf16 v[68:71], a[132:135], a[28:31], v[68:71]
  s_waitcnt lgkmcnt(4)
  v_mfma_f32_16x16x32_bf16 v[72:75], a[136:139], a[16:19], v[72:75]
  ds_read_b64_tr_b16 a[152:153], v19 offset:16384
  ds_read_b64_tr_b16 a[154:155], v19 offset:20480
  v_mfma_f32_16x16x32_bf16 v[72:75], a[140:143], a[24:27], v[72:75]
  buffer_load_dwordx4 v57, s[12:15], s50 offen offset:1024 lds
  v_mfma_f32_16x16x32_bf16 v[76:79], a[136:139], a[20:23], v[76:79]
  ds_read_b64_tr_b16 a[156:157], v19 offset:24576
  ds_read_b64_tr_b16 a[158:159], v19 offset:28672
  v_mfma_f32_16x16x32_bf16 v[76:79], a[140:143], a[28:31], v[76:79]
  s_waitcnt lgkmcnt(4)
  v_mfma_f32_16x16x32_bf16 v[80:83], a[144:147], a[16:19], v[80:83]
  ds_read_b64_tr_b16 a[128:129], v20 offset:16384
  ds_read_b64_tr_b16 a[130:131], v20 offset:20480
  v_mfma_f32_16x16x32_bf16 v[80:83], a[148:151], a[24:27], v[80:83]
  buffer_load_dwordx4 v58, s[12:15], s50 offen offset:2048 lds
  v_mfma_f32_16x16x32_bf16 v[84:87], a[144:147], a[20:23], v[84:87]
  ds_read_b64_tr_b16 a[132:133], v20 offset:24576
  ds_read_b64_tr_b16 a[134:135], v20 offset:28672
  v_mfma_f32_16x16x32_bf16 v[84:87], a[148:151], a[28:31], v[84:87]
  s_waitcnt lgkmcnt(4)
  v_mfma_f32_16x16x32_bf16 v[88:91], a[152:155], a[16:19], v[88:91]
  ds_read_b64_tr_b16 a[136:137], v21 offset:16384
  ds_read_b64_tr_b16 a[138:139], v21 offset:20480
  v_mfma_f32_16x16x32_bf16 v[88:91], a[156:159], a[24:27], v[88:91]
  buffer_load_dwordx4 v59, s[12:15], s50 offen offset:3072 lds
  v_mfma_f32_16x16x32_bf16 v[92:95], a[152:155], a[20:23], v[92:95]
  ds_read_b64_tr_b16 a[140:141], v21 offset:24576
  ds_read_b64_tr_b16 a[142:143], v21 offset:28672
  v_mfma_f32_16x16x32_bf16 v[92:95], a[156:159], a[28:31], v[92:95]
  s_add_u32 s50, s50, 131072
  s_waitcnt lgkmcnt(4)
  v_mfma_f32_16x16x32_bf16 v[96:99], a[128:131], a[16:19], v[96:99]
  ds_read_b64_tr_b16 a[144:145], v22 offset:16384
  ds_read_b64_tr_b16 a[146:147], v22 offset:20480
  v_mfma_f32_16x16x32_bf16 v[96:99], a[132:135], a[24:27], v[96:99]
  buffer_load_dwordx4 a[120:123], v13, s[16:19], s51 offen offset:0 sc1
  v_mfma_f32_16x16x32_bf16 v[100:103], a[128:131], a[20:23], v[100:103]
  ds_read_b64_tr_b16 a[148:149], v22 offset:24576
  ds_read_b64_tr_b16 a[150:151], v22 offset:28672
  v_mfma_f32_16x16x32_bf16 v[100:103], a[132:135], a[28:31], v[100:103]
  s_waitcnt lgkmcnt(4)
  v_mfma_f32_16x16x32_bf16 v[104:107], a[136:139], a[16:19], v[104:107]
  ds_read_b64_tr_b16 a[152:153], v23 offset:16384
  ds_read_b64_tr_b16 a[154:155], v23 offset:20480
  v_mfma_f32_16x16x32_bf16 v[104:107], a[140:143], a[24:27], v[104:107]
  buffer_load_dwordx4 a[124:127], v13, s[16:19], s51 offen offset:1024 sc1
  v_mfma_f32_16x16x32_bf16 v[108:111], a[136:139], a[20:23], v[108:111]
  ds_read_b64_tr_b16 a[156:157], v23 offset:24576
  ds_read_b64_tr_b16 a[158:159], v23 offset:28672
  v_mfma_f32_16x16x32_bf16 v[108:111], a[140:143], a[28:31], v[108:111]
  s_add_u32 s51, s51, 262144
  s_waitcnt vmcnt(28) lgkmcnt(4)
  s_barrier
  v_mfma_f32_16x16x32_bf16 v[112:115], a[144:147], a[16:19], v[112:115]
  ds_read_b64_tr_b16 a[128:129], v16 offset:32768
  ds_read_b64_tr_b16 a[130:131], v16 offset:36864
  v_mfma_f32_16x16x32_bf16 v[112:115], a[148:151], a[24:27], v[112:115]
  buffer_load_dwordx4 a[0:3], v12, s[16:19], s51 offen offset:0 sc1
  v_mfma_f32_16x16x32_bf16 v[116:119], a[144:147], a[20:23], v[116:119]
  ds_read_b64_tr_b16 a[132:133], v16 offset:40960
  ds_read_b64_tr_b16 a[134:135], v16 offset:45056
  v_mfma_f32_16x16x32_bf16 v[116:119], a[148:151], a[28:31], v[116:119]
  s_add_u32 m0, s52, 0
  s_waitcnt lgkmcnt(4)
  v_mfma_f32_16x16x32_bf16 v[120:123], a[152:155], a[16:19], v[120:123]
  ds_read_b64_tr_b16 a[136:137], v17 offset:32768
  ds_read_b64_tr_b16 a[138:139], v17 offset:36864
  v_mfma_f32_16x16x32_bf16 v[120:123], a[156:159], a[24:27], v[120:123]
  buffer_load_dwordx4 a[4:7], v12, s[16:19], s51 offen offset:1024 sc1
  v_mfma_f32_16x16x32_bf16 v[124:127], a[152:155], a[20:23], v[124:127]
  ds_read_b64_tr_b16 a[140:141], v17 offset:40960
  ds_read_b64_tr_b16 a[142:143], v17 offset:45056
  v_mfma_f32_16x16x32_bf16 v[124:127], a[156:159], a[28:31], v[124:127]
  s_waitcnt lgkmcnt(4)
  v_mfma_f32_16x16x32_bf16 v[64:67], a[128:131], a[32:35], v[64:67]
  ds_read_b64_tr_b16 a[144:145], v18 offset:32768
  ds_read_b64_tr_b16 a[146:147], v18 offset:36864
  v_mfma_f32_16x16x32_bf16 v[64:67], a[132:135], a[40:43], v[64:67]
  buffer_load_dwordx4 v56, s[12:15], s50 offen offset:0 lds
  v_mfma_f32_16x16x32_bf16 v[68:71], a[128:131], a[36:39], v[68:71]
  ds_read_b64_tr_b16 a[148:149], v18 offset:40960
  ds_read_b64_tr_b16 a[150:151], v18 offset:45056
  v_mfma_f32_16x16x32_bf16 v[68:71], a[132:135], a[44:47], v[68:71]
  s_waitcnt lgkmcnt(4)
  v_mfma_f32_16x16x32_bf16 v[72:75], a[136:139], a[32:35], v[72:75]
  ds_read_b64_tr_b16 a[152:153], v19 offset:32768
  ds_read_b64_tr_b16 a[154:155], v19 offset:36864
  v_mfma_f32_16x16x32_bf16 v[72:75], a[140:143], a[40:43], v[72:75]
  buffer_load_dwordx4 v57, s[12:15], s50 offen offset:1024 lds
  v_mfma_f32_16x16x32_bf16 v[76:79], a[136:139], a[36:39], v[76:79]
  ds_read_b64_tr_b16 a[156:157], v19 offset:40960
  ds_read_b64_tr_b16 a[158:159], v19 offset:45056
  v_mfma_f32_16x16x32_bf16 v[76:79], a[140:143], a[44:47], v[76:79]
  s_waitcnt lgkmcnt(4)
  v_mfma_f32_16x16x32_bf16 v[80:83], a[144:147], a[32:35], v[80:83]
  ds_read_b64_tr_b16 a[128:129], v20 offset:32768
  ds_read_b64_tr_b16 a[130:131], v20 offset:36864
  v_mfma_f32_16x16x32_bf16 v[80:83], a[148:151], a[40:43], v[80:83]
  buffer_load_dwordx4 v58, s[12:15], s50 offen offset:2048 lds
  v_mfma_f32_16x16x32_bf16 v[84:87], a[144:147], a[36:39], v[84:87]
  ds_read_b64_tr_b16 a[132:133], v20 offset:40960
  ds_read_b64_tr_b16 a[134:135], v20 offset:45056
  v_mfma_f32_16x16x32_bf16 v[84:87], a[148:151], a[44:47], v[84:87]
  s_waitcnt lgkmcnt(4)
  v_mfma_f32_16x16x32_bf16 v[88:91], a[152:155], a[32:35], v[88:91]
  ds_read_b64_tr_b16 a[136:137], v21 offset:32768
  ds_read_b64_tr_b16 a[138:139], v21 offset:36864
  v_mfma_f32_16x16x32_bf16 v[88:91], a[156:159], a[40:43], v[88:91]
  buffer_load_dwordx4 v59, s[12:15], s50 offen offset:3072 lds
  v_mfma_f32_16x16x32_bf16 v[92:95], a[152:155], a[36:39], v[92:95]
  ds_read_b64_tr_b16 a[140:141], v21 offset:40960
  ds_read_b64_tr_b16 a[142:143], v21 offset:45056
  v_mfma_f32_16x16x32_bf16 v[92:95], a[156:159], a[44:47], v[92:95]
  s_add_u32 s50, s50, 131072
  s_waitcnt lgkmcnt(4)
  v_mfma_f32_16x16x32_bf16 v[96:99], a[128:131], a[32:35], v[96:99]
  ds_read_b64_tr_b16 a[144:145], v22 offset:32768
  ds_read_b64_tr_b16 a[146:147], v22 offset:36864
  v_mfma_f32_16x16x32_bf16 v[96:99], a[132:135], a[40:43], v[96:99]
  buffer_load_dwordx4 a[8:11], v13, s[16:19], s51 offen offset:0 sc1
  v_mfma_f32_16x16x32_bf16 v[100:103], a[128:131], a[36:39], v[100:103]
  ds_read_b64_tr_b16 a[148:149], v22 offset:40960
  ds_read_b64_tr_b16 a[150:151], v22 offset:45056
  v_mfma_f32_16x16x32_bf16 v[100:103], a[132:135], a[44:47], v[100:103]
  s_waitcnt lgkmcnt(4)
  v_mfma_f32_16x16x32_bf16 v[104:107], a[136:139], a[32:35], v[104:107]
  ds_read_b64_tr_b16 a[152:153], v23 offset:32768
  ds_read_b64_tr_b16 a[154:155], v23 offset:36864
  v_mfma_f32_16x16x32_bf16 v[104:107], a[140:143], a[40:43], v[104:107]
  buffer_load_dwordx4 a[12:15], v13, s[16:19], s51 offen offset:1024 sc1
  v_mfma_f32_16x16x32_bf16 v[108:111], a[136:139], a[36:39], v[108:111]
  ds_read_b64_tr_b16 a[156:157], v23 offset:40960
  ds_read_b64_tr_b16 a[158:159], v23 offset:45056
  v_mfma_f32_16x16x32_bf16 v[108:111], a[140:143], a[44:47], v[108:111]
  s_add_u32 s51, s51, 262144
  s_waitcnt vmcnt(32) lgkmcnt(4)
  s_barrier
  v_mfma_f32_16x16x32_bf16 v[112:115], a[144:147], a[32:35], v[112:115]
  ds_read_b64_tr_b16 a[128:129], v16 offset:49152
  ds_read_b64_tr_b16 a[130:131], v16 offset:53248
  v_mfma_f32_16x16x32_bf16 v[112:115], a[148:151], a[40:43], v[112:115]
  buffer_load_dwordx4 a[16:19], v12, s[16:19], s51 offen offset:0 sc1
  v_mfma_f32_16x16x32_bf16 v[116:119], a[144:147], a[36:39], v[116:119]
  ds_read_b64_tr_b16 a[132:133], v16 offset:57344
  ds_read_b64_tr_b16 a[134:135], v16 offset:61440
  v_mfma_f32_16x16x32_bf16 v[116:119], a[148:151], a[44:47], v[116:119]
  s_add_u32 m0, s52, 16384
  s_waitcnt lgkmcnt(4)
  v_mfma_f32_16x16x32_bf16 v[120:123], a[152:155], a[32:35], v[120:123]
  ds_read_b64_tr_b16 a[136:137], v17 offset:49152
  ds_read_b64_tr_b16 a[138:139], v17 offset:53248
  v_mfma_f32_16x16x32_bf16 v[120:123], a[156:159], a[40:43], v[120:123]
  buffer_load_dwordx4 a[20:23], v12, s[16:19], s51 offen offset:1024 sc1
  v_mfma_f32_16x16x32_bf16 v[124:127], a[152:155], a[36:39], v[124:127]
  ds_read_b64_tr_b16 a[140:141], v17 offset:57344
  ds_read_b64_tr_b16 a[142:143], v17 offset:61440
  v_mfma_f32_16x16x32_bf16 v[124:127], a[156:159], a[44:47], v[124:127]
  s_waitcnt lgkmcnt(4)
  v_mfma_f32_16x16x32_bf16 v[64:67], a[128:131], a[48:51], v[64:67]
  ds_read_b64_tr_b16 a[144:145], v18 offset:49152
  ds_read_b64_tr_b16 a[146:147], v18 offset:53248
  v_mfma_f32_16x16x32_bf16 v[64:67], a[132:135], a[56:59], v[64:67]
  buffer_load_dwordx4 v56, s[12:15], s50 offen offset:0 lds
  v_mfma_f32_16x16x32_bf16 v[68:71], a[128:131], a[52:55], v[68:71]
  ds_read_b64_tr_b16 a[148:149], v18 offset:57344
  ds_read_b64_tr_b16 a[150:151], v18 offset:61440
  v_mfma_f32_16x16x32_bf16 v[68:71], a[132:135], a[60:63], v[68:71]
  s_waitcnt lgkmcnt(4)
  v_mfma_f32_16x16x32_bf16 v[72:75], a[136:139], a[48:51], v[72:75]
  ds_read_b64_tr_b16 a[152:153], v19 offset:49152
  ds_read_b64_tr_b16 a[154:155], v19 offset:53248
  v_mfma_f32_16x16x32_bf16 v[72:75], a[140:143], a[56:59], v[72:75]
  buffer_load_dwordx4 v57, s[12:15], s50 offen offset:1024 lds
  v_mfma_f32_16x16x32_bf16 v[76:79], a[136:139], a[52:55], v[76:79]
  ds_read_b64_tr_b16 a[156:157], v19 offset:57344
  ds_read_b64_tr_b16 a[158:159], v19 offset:61440
  v_mfma_f32_16x16x32_bf16 v[76:79], a[140:143], a[60:63], v[76:79]
  s_waitcnt lgkmcnt(4)
  v_mfma_f32_16x16x32_bf16 v[80:83], a[144:147], a[48:51], v[80:83]
  ds_read_b64_tr_b16 a[128:129], v20 offset:49152
  ds_read_b64_tr_b16 a[130:131], v20 offset:53248
  v_mfma_f32_16x16x32_bf16 v[80:83], a[148:151], a[56:59], v[80:83]
  buffer_load_dwordx4 v58, s[12:15], s50 offen offset:2048 lds
  v_mfma_f32_16x16x32_bf16 v[84:87], a[144:147], a[52:55], v[84:87]
  ds_read_b64_tr_b16 a[132:133], v20 offset:57344
  ds_read_b64_tr_b16 a[134:135], v20 offset:61440
  v_mfma_f32_16x16x32_bf16 v[84:87], a[148:151], a[60:63], v[84:87]
  s_waitcnt lgkmcnt(4)
  v_mfma_f32_16x16x32_bf16 v[88:91], a[152:155], a[48:51], v[88:91]
  ds_read_b64_tr_b16 a[136:137], v21 offset:49152
  ds_read_b64_tr_b16 a[138:139], v21 offset:53248
  v_mfma_f32_16x16x32_bf16 v[88:91], a[156:159], a[56:59], v[88:91]
  buffer_load_dwordx4 v59, s[12:15], s50 offen offset:3072 lds
  v_mfma_f32_16x16x32_bf16 v[92:95], a[152:155], a[52:55], v[92:95]
  ds_read_b64_tr_b16 a[140:141], v21 offset:57344
  ds_read_b64_tr_b16 a[142:143], v21 offset:61440
  v_mfma_f32_16x16x32_bf16 v[92:95], a[156:159], a[60:63], v[92:95]
  s_add_u32 s50, s50, 131072
  s_waitcnt lgkmcnt(4)
  v_mfma_f32_16x16x32_bf16 v[96:99], a[128:131], a[48:51], v[96:99]
  ds_read_b64_tr_b16 a[144:145], v22 offset:49152
  ds_read_b64_tr_b16 a[146:147], v22 offset:53248
  v_mfma_f32_16x16x32_bf16 v[96:99], a[132:135], a[56:59], v[96:99]
  buffer_load_dwordx4 a[24:27], v13, s[16:19], s51 offen offset:0 sc1
  v_mfma_f32_16x16x32_bf16 v[100:103], a[128:131], a[52:55], v[100:103]
  ds_read_b64_tr_b16 a[148:149], v22 offset:57344
  ds_read_b64_tr_b16 a[150:151], v22 offset:61440
  v_mfma_f32_16x16x32_bf16 v[100:103], a[132:135], a[60:63], v[100:103]
  s_waitcnt lgkmcnt(4)
  v_mfma_f32_16x16x32_bf16 v[104:107], a[136:139], a[48:51], v[104:107]
  ds_read_b64_tr_b16 a[152:153], v23 offset:49152
  ds_read_b64_tr_b16 a[154:155], v23 offset:53248
  v_mfma_f32_16x16x32_bf16 v[104:107], a[140:143], a[56:59], v[104:107]
  buffer_load_dwordx4 a[28:31], v13, s[16:19], s51 offen offset:1024 sc1
  v_mfma_f32_16x16x32_bf16 v[108:111], a[136:139], a[52:55], v[108:111]
  ds_read_b64_tr_b16 a[156:157], v23 offset:57344
  ds_read_b64_tr_b16 a[158:159], v23 offset:61440
  v_mfma_f32_16x16x32_bf16 v[108:111], a[140:143], a[60:63], v[108:111]
  s_add_u32 s51, s51, 262144
  s_waitcnt vmcnt(36) lgkmcnt(4)
  s_barrier
  v_mfma_f32_16x16x32_bf16 v[112:115], a[144:147], a[48:51], v[112:115]
  ds_read_b64_tr_b16 a[128:129], v24 offset:0
  ds_read_b64_tr_b16 a[130:131], v24 offset:4096
  v_mfma_f32_16x16x32_bf16 v[112:115], a[148:151], a[56:59], v[112:115]
  buffer_load_dwordx4 a[32:35], v12, s[16:19], s51 offen offset:0 sc1
  v_mfma_f32_16x16x32_bf16 v[116:119], a[144:147], a[52:55], v[116:119]
  ds_read_b64_tr_b16 a[132:133], v24 offset:8192
  ds_read_b64_tr_b16 a[134:135], v24 offset:12288
  v_mfma_f32_16x16x32_bf16 v[116:119], a[148:151], a[60:63], v[116:119]
  s_add_u32 m0, s52, 32768
  s_waitcnt lgkmcnt(4)
  v_mfma_f32_16x16x32_bf16 v[120:123], a[152:155], a[48:51], v[120:123]
  ds_read_b64_tr_b16 a[136:137], v25 offset:0
  ds_read_b64_tr_b16 a[138:139], v25 offset:4096
  v_mfma_f32_16x16x32_bf16 v[120:123], a[156:159], a[56:59], v[120:123]
  buffer_load_dwordx4 a[36:39], v12, s[16:19], s51 offen offset:1024 sc1
  v_mfma_f32_16x16x32_bf16 v[124:127], a[152:155], a[52:55], v[124:127]
  ds_read_b64_tr_b16 a[140:141], v25 offset:8192
  ds_read_b64_tr_b16 a[142:143], v25 offset:12288
  v_mfma_f32_16x16x32_bf16 v[124:127], a[156:159], a[60:63], v[124:127]
  s_waitcnt lgkmcnt(4)
  v_mfma_f32_16x16x32_bf16 v[64:67], a[128:131], a[64:67], v[64:67]
  ds_read_b64_tr_b16 a[144:145], v26 offset:0
  ds_read_b64_tr_b16 a[146:147], v26 offset:4096
  v_mfma_f32_16x16x32_bf16 v[64:67], a[132:135], a[72:75], v[64:67]
  buffer_load_dwordx4 v56, s[12:15], s50 offen offset:0 lds
  v_mfma_f32_16x16x32_bf16 v[68:71], a[128:131], a[68:71], v[68:71]
  ds_read_b64_tr_b16 a[148:149], v26 offset:8192
  ds_read_b64_tr_b16 a[150:151], v26 offset:12288
  v_mfma_f32_16x16x32_bf16 v[68:71], a[132:135], a[76:79], v[68:71]
  s_waitcnt lgkmcnt(4)
  v_mfma_f32_16x16x32_bf16 v[72:75], a[136:139], a[64:67], v[72:75]
  ds_read_b64_tr_b16 a[152:153], v27 offset:0
  ds_read_b64_tr_b16 a[154:155], v27 offset:4096
  v_mfma_f32_16x16x32_bf16 v[72:75], a[140:143], a[72:75], v[72:75]
  buffer_load_dwordx4 v57, s[12:15], s50 offen offset:1024 lds
  v_mfma_f32_16x16x32_bf16 v[76:79], a[136:139], a[68:71], v[76:79]
  ds_read_b64_tr_b16 a[156:157], v27 offset:8192
  ds_read_b64_tr_b16 a[158:159], v27 offset:12288
  v_mfma_f32_16x16x32_bf16 v[76:79], a[140:143], a[76:79], v[76:79]
  s_waitcnt lgkmcnt(4)
  v_mfma_f32_16x16x32_bf16 v[80:83], a[144:147], a[64:67], v[80:83]
  ds_read_b64_tr_b16 a[128:129], v28 offset:0
  ds_read_b64_tr_b16 a[130:131], v28 offset:4096
  v_mfma_f32_16x16x32_bf16 v[80:83], a[148:151], a[72:75], v[80:83]
  buffer_load_dwordx4 v58, s[12:15], s50 offen offset:2048 lds
  v_mfma_f32_16x16x32_bf16 v[84:87], a[144:147], a[68:71], v[84:87]
  ds_read_b64_tr_b16 a[132:133], v28 offset:8192
  ds_read_b64_tr_b16 a[134:135], v28 offset:12288
  v_mfma_f32_16x16x32_bf16 v[84:87], a[148:151], a[76:79], v[84:87]
  s_waitcnt lgkmcnt(4)
  v_mfma_f32_16x16x32_bf16 v[88:91], a[152:155], a[64:67], v[88:91]
  ds_read_b64_tr_b16 a[136:137], v29 offset:0
  ds_read_b64_tr_b16 a[138:139], v29 offset:4096
  v_mfma_f32_16x16x32_bf16 v[88:91], a[156:159], a[72:75], v[88:91]
  buffer_load_dwordx4 v59, s[12:15], s50 offen offset:3072 lds
  v_mfma_f32_16x16x32_bf16 v[92:95], a[152:155], a[68:71], v[92:95]
  ds_read_b64_tr_b16 a[140:141], v29 offset:8192
  ds_read_b64_tr_b16 a[142:143], v29 offset:12288
  v_mfma_f32_16x16x32_bf16 v[92:95], a[156:159], a[76:79], v[92:95]
  s_add_u32 s50, s50, 131072
  s_waitcnt lgkmcnt(4)
  v_mfma_f32_16x16x32_bf16 v[96:99], a[128:131], a[64:67], v[96:99]
  ds_read_b64_tr_b16 a[144:145], v30 offset:0
  ds_read_b64_tr_b16 a[146:147], v30 offset:4096
  v_mfma_f32_16x16x32_bf16 v[96:99], a[132:135], a[72:75], v[96:99]
  buffer_load_dwordx4 a[40:43], v13, s[16:19], s51 offen offset:0 sc1
  v_mfma_f32_16x16x32_bf16 v[100:103], a[128:131], a[68:71], v[100:103]
  ds_read_b64_tr_b16 a[148:149], v30 offset:8192
  ds_read_b64_tr_b16 a[150:151], v30 offset:12288
  v_mfma_f32_16x16x32_bf16 v[100:103], a[132:135], a[76:79], v[100:103]
  s_waitcnt lgkmcnt(4)
  v_mfma_f32_16x16x32_bf16 v[104:107], a[136:139], a[64:67], v[104:107]
  ds_read_b64_tr_b16 a[152:153], v31 offset:0
  ds_read_b64_tr_b16 a[154:155], v31 offset:4096
  v_mfma_f32_16x16x32_bf16 v[104:107], a[140:143], a[72:75], v[104:107]
  buffer_load_dwordx4 a[44:47], v13, s[16:19], s51 offen offset:1024 sc1
  v_mfma_f32_16x16x32_bf16 v[108:111], a[136:139], a[68:71], v[108:111]
  ds_read_b64_tr_b16 a[156:157], v31 offset:8192
  ds_read_b64_tr_b16 a[158:159], v31 offset:12288
  v_mfma_f32_16x16x32_bf16 v[108:111], a[140:143], a[76:79], v[108:111]
  s_add_u32 s51, s51, 262144
  s_waitcnt vmcnt(36) lgkmcnt(4)
  s_barrier
  v_mfma_f32_16x16x32_bf16 v[112:115], a[144:147], a[64:67], v[112:115]
  ds_read_b64_tr_b16 a[128:129], v24 offset:16384
  ds_read_b64_tr_b16 a[130:131], v24 offset:20480
  v_mfma_f32_16x16x32_bf16 v[112:115], a[148:151], a[72:75], v[112:115]
  buffer_load_dwordx4 a[48:51], v12, s[16:19], s51 offen offset:0 sc1
  v_mfma_f32_16x16x32_bf16 v[116:119], a[144:147], a[68:71], v[116:119]
  ds_read_b64_tr_b16 a[132:133], v24 offset:24576
  ds_read_b64_tr_b16 a[134:135], v24 offset:28672
  v_mfma_f32_16x16x32_bf16 v[116:119], a[148:151], a[76:79], v[116:119]
  s_add_u32 m0, s52, 49152
  s_waitcnt lgkmcnt(4)
  v_mfma_f32_16x16x32_bf16 v[120:123], a[152:155], a[64:67], v[120:123]
  ds_read_b64_tr_b16 a[136:137], v25 offset:16384
  ds_read_b64_tr_b16 a[138:139], v25 offset:20480
  v_mfma_f32_16x16x32_bf16 v[120:123], a[156:159], a[72:75], v[120:123]
  buffer_load_dwordx4 a[52:55], v12, s[16:19], s51 offen offset:1024 sc1
  v_mfma_f32_16x16x32_bf16 v[124:127], a[152:155], a[68:71], v[124:127]
  ds_read_b64_tr_b16 a[140:141], v25 offset:24576
  ds_read_b64_tr_b16 a[142:143], v25 offset:28672
  v_mfma_f32_16x16x32_bf16 v[124:127], a[156:159], a[76:79], v[124:127]
  s_waitcnt lgkmcnt(4)
  v_mfma_f32_16x16x32_bf16 v[64:67], a[128:131], a[80:83], v[64:67]
  ds_read_b64_tr_b16 a[144:145], v26 offset:16384
  ds_read_b64_tr_b16 a[146:147], v26 offset:20480
  v_mfma_f32_16x16x32_bf16 v[64:67], a[132:135], a[88:91], v[64:67]
  buffer_load_dwordx4 v56, s[12:15], s50 offen offset:0 lds
  v_mfma_f32_16x16x32_bf16 v[68:71], a[128:131], a[84:87], v[68:71]
  ds_read_b64_tr_b16 a[148:149], v26 offset:24576
  ds_read_b64_tr_b16 a[150:151], v26 offset:28672
  v_mfma_f32_16x16x32_bf16 v[68:71], a[132:135], a[92:95], v[68:71]
  s_waitcnt lgkmcnt(4)
  v_mfma_f32_16x16x32_bf16 v[72:75], a[136:139], a[80:83], v[72:75]
  ds_read_b64_tr_b16 a[152:153], v27 offset:16384
  ds_read_b64_tr_b16 a[154:155], v27 offset:20480
  v_mfma_f32_16x16x32_bf16 v[72:75], a[140:143], a[88:91], v[72:75]
  buffer_load_dwordx4 v57, s[12:15], s50 offen offset:1024 lds
  v_mfma_f32_16x16x32_bf16 v[76:79], a[136:139], a[84:87], v[76:79]
  ds_read_b64_tr_b16 a[156:157], v27 offset:24576
  ds_read_b64_tr_b16 a[158:159], v27 offset:28672
  v_mfma_f32_16x16x32_bf16 v[76:79], a[140:143], a[92:95], v[76:79]
  s_waitcnt lgkmcnt(4)
  v_mfma_f32_16x16x32_bf16 v[80:83], a[144:147], a[80:83], v[80:83]
  ds_read_b64_tr_b16 a[128:129], v28 offset:16384
  ds_read_b64_tr_b16 a[130:131], v28 offset:20480
  v_mfma_f32_16x16x32_bf16 v[80:83], a[148:151], a[88:91], v[80:83]
  buffer_load_dwordx4 v58, s[12:15], s50 offen offset:2048 lds
  v_mfma_f32_16x16x32_bf16 v[84:87], a[144:147], a[84:87], v[84:87]
  ds_read_b64_tr_b16 a[132:133], v28 offset:24576
  ds_read_b64_tr_b16 a[134:135], v28 offset:28672
  v_mfma_f32_16x16x32_bf16 v[84:87], a[148:151], a[92:95], v[84:87]
  s_waitcnt lgkmcnt(4)
  v_mfma_f32_16x16x32_bf16 v[88:91], a[152:155], a[80:83], v[88:91]
  ds_read_b64_tr_b16 a[136:137], v29 offset:16384
  ds_read_b64_tr_b16 a[138:139], v29 offset:20480
  v_mfma_f32_16x16x32_bf16 v[88:91], a[156:159], a[88:91], v[88:91]
  buffer_load_dwordx4 v59, s[12:15], s50 offen offset:3072 lds
  v_mfma_f32_16x16x32_bf16 v[92:95], a[152:155], a[84:87], v[92:95]
  ds_read_b64_tr_b16 a[140:141], v29 offset:24576
  ds_read_b64_tr_b16 a[142:143], v29 offset:28672
  v_mfma_f32_16x16x32_bf16 v[92:95], a[156:159], a[92:95], v[92:95]
  s_add_u32 s50, s50, 131072
  s_waitcnt lgkmcnt(4)
  v_mfma_f32_16x16x32_bf16 v[96:99], a[128:131], a[80:83], v[96:99]
  ds_read_b64_tr_b16 a[144:145], v30 offset:16384
  ds_read_b64_tr_b16 a[146:147], v30 offset:20480
  v_mfma_f32_16x16x32_bf16 v[96:99], a[132:135], a[88:91], v[96:99]
  buffer_load_dwordx4 a[56:59], v13, s[16:19], s51 offen offset:0 sc1
  v_mfma_f32_16x16x32_bf16 v[100:103], a[128:131], a[84:87], v[100:103]
  ds_read_b64_tr_b16 a[148:149], v30 offset:24576
  ds_read_b64_tr_b16 a[150:151], v30 offset:28672
  v_mfma_f32_16x16x32_bf16 v[100:103], a[132:135], a[92:95], v[100:103]
  s_waitcnt lgkmcnt(4)
  v_mfma_f32_16x16x32_bf16 v[104:107], a[136:139], a[80:83], v[104:107]
  ds_read_b64_tr_b16 a[152:153], v31 offset:16384
  ds_read_b64_tr_b16 a[154:155], v31 offset:20480
  v_mfma_f32_16x16x32_bf16 v[104:107], a[140:143], a[88:91], v[104:107]
  buffer_load_dwordx4 a[60:63], v13, s[16:19], s51 offen offset:1024 sc1
  v_mfma_f32_16x16x32_bf16 v[108:111], a[136:139], a[84:87], v[108:111]
  ds_read_b64_tr_b16 a[156:157], v31 offset:24576
  ds_read_b64_tr_b16 a[158:159], v31 offset:28672
  v_mfma_f32_16x16x32_bf16 v[108:111], a[140:143], a[92:95], v[108:111]
  s_add_u32 s51, s51, 262144
  s_waitcnt vmcnt(40) lgkmcnt(4)
  s_barrier
  v_mfma_f32_16x16x32_bf16 v[112:115], a[144:147], a[80:83], v[112:115]
  ds_read_b64_tr_b16 a[128:129], v24 offset:32768
  ds_read_b64_tr_b16 a[130:131], v24 offset:36864
  v_mfma_f32_16x16x32_bf16 v[112:115], a[148:151], a[88:91], v[112:115]
  buffer_load_dwordx4 a[64:67], v12, s[16:19], s51 offen offset:0 sc1
  s_add_u32 m0, s52, 65536
  v_mfma_f32_16x16x32_bf16 v[116:119], a[144:147], a[84:87], v[116:119]
  ds_read_b64_tr_b16 a[132:133], v24 offset:40960
  ds_read_b64_tr_b16 a[134:135], v24 offset:45056
  v_mfma_f32_16x16x32_bf16 v[116:119], a[148:151], a[92:95], v[116:119]
  buffer_load_dwordx4 a[68:71], v12, s[16:19], s51 offen offset:1024 sc1
  s_waitcnt lgkmcnt(4)
  v_mfma_f32_16x16x32_bf16 v[120:123], a[152:155], a[80:83], v[120:123]
  ds_read_b64_tr_b16 a[136:137], v25 offset:32768
  ds_read_b64_tr_b16 a[138:139], v25 offset:36864
  v_mfma_f32_16x16x32_bf16 v[120:123], a[156:159], a[88:91], v[120:123]
  v_mfma_f32_16x16x32_bf16 v[124:127], a[152:155], a[84:87], v[124:127]
  ds_read_b64_tr_b16 a[140:141], v25 offset:40960
  ds_read_b64_tr_b16 a[142:143], v25 offset:45056
  v_mfma_f32_16x16x32_bf16 v[124:127], a[156:159], a[92:95], v[124:127]
  buffer_load_dwordx4 v56, s[12:15], s50 offen offset:0 lds
  s_waitcnt lgkmcnt(4)
  v_mfma_f32_16x16x32_bf16 v[64:67], a[128:131], a[96:99], v[64:67]
  ds_read_b64_tr_b16 a[144:145], v26 offset:32768
  ds_read_b64_tr_b16 a[146:147], v26 offset:36864
  v_mfma_f32_16x16x32_bf16 v[64:67], a[132:135], a[104:107], v[64:67]
  v_mfma_f32_16x16x32_bf16 v[68:71], a[128:131], a[100:103], v[68:71]
  ds_read_b64_tr_b16 a[148:149], v26 offset:40960
  ds_read_b64_tr_b16 a[150:151], v26 offset:45056
  v_mfma_f32_16x16x32_bf16 v[68:71], a[132:135], a[108:111], v[68:71]
  buffer_load_dwordx4 v57, s[12:15], s50 offen offset:1024 lds
  s_waitcnt lgkmcnt(4)
  v_mfma_f32_16x16x32_bf16 v[72:75], a[136:139], a[96:99], v[72:75]
  ds_read_b64_tr_b16 a[152:153], v27 offset:32768
  ds_read_b64_tr_b16 a[154:155], v27 offset:36864
  v_mfma_f32_16x16x32_bf16 v[72:75], a[140:143], a[104:107], v[72:75]
  v_mfma_f32_16x16x32_bf16 v[76:79], a[136:139], a[100:103], v[76:79]
  ds_read_b64_tr_b16 a[156:157], v27 offset:40960
  ds_read_b64_tr_b16 a[158:159], v27 offset:45056
  v_mfma_f32_16x16x32_bf16 v[76:79], a[140:143], a[108:111], v[76:79]
  buffer_load_dwordx4 v58, s[12:15], s50 offen offset:2048 lds
  s_waitcnt lgkmcnt(4)
  v_mfma_f32_16x16x32_bf16 v[80:83], a[144:147], a[96:99], v[80:83]
  ds_read_b64_tr_b16 a[128:129], v28 offset:32768
  ds_read_b64_tr_b16 a[130:131], v28 offset:36864
  v_mfma_f32_16x16x32_bf16 v[80:83], a[148:151], a[104:107], v[80:83]
  buffer_load_dwordx4 v59, s[12:15], s50 offen offset:3072 lds
  s_add_u32 s50, s50, 131072
  v_mfma_f32_16x16x32_bf16 v[84:87], a[144:147], a[100:103], v[84:87]
  ds_read_b64_tr_b16 a[132:133], v28 offset:40960
  ds_read_b64_tr_b16 a[134:135], v28 offset:45056
  v_mfma_f32_16x16x32_bf16 v[84:87], a[148:151], a[108:111], v[84:87]
  s_waitcnt lgkmcnt(4)
  v_mfma_f32_16x16x32_bf16 v[88:91], a[152:155], a[96:99], v[88:91]
  ds_read_b64_tr_b16 a[136:137], v29 offset:32768
  ds_read_b64_tr_b16 a[138:139], v29 offset:36864
  v_mfma_f32_16x16x32_bf16 v[88:91], a[156:159], a[104:107], v[88:91]
  buffer_load_dwordx4 a[72:75], v13, s[16:19], s51 offen offset:0 sc1
  v_mfma_f32_16x16x32_bf16 v[92:95], a[152:155], a[100:103], v[92:95]
  ds_read_b64_tr_b16 a[140:141], v29 offset:40960
  ds_read_b64_tr_b16 a[142:143], v29 offset:45056
  v_mfma_f32_16x16x32_bf16 v[92:95], a[156:159], a[108:111], v[92:95]
  s_waitcnt lgkmcnt(4)
  v_mfma_f32_16x16x32_bf16 v[96:99], a[128:131], a[96:99], v[96:99]
  ds_read_b64_tr_b16 a[144:145], v30 offset:32768
  ds_read_b64_tr_b16 a[146:147], v30 offset:36864
  v_mfma_f32_16x16x32_bf16 v[96:99], a[132:135], a[104:107], v[96:99]
  buffer_load_dwordx4 a[76:79], v13, s[16:19], s51 offen offset:1024 sc1
  s_add_u32 s51, s51, 262144
  v_mfma_f32_16x16x32_bf16 v[100:103], a[128:131], a[100:103], v[100:103]
  ds_read_b64_tr_b16 a[148:149], v30 offset:40960
  ds_read_b64_tr_b16 a[150:151], v30 offset:45056
  v_mfma_f32_16x16x32_bf16 v[100:103], a[132:135], a[108:111], v[100:103]
  v_add_f32 v41, v41, v42
  s_waitcnt lgkmcnt(4)
  v_mfma_f32_16x16x32_bf16 v[104:107], a[136:139], a[96:99], v[104:107]
  ds_read_b64_tr_b16 a[152:153], v31 offset:32768
  ds_read_b64_tr_b16 a[154:155], v31 offset:36864
  v_mfma_f32_16x16x32_bf16 v[104:107], a[140:143], a[104:107], v[104:107]
  v_add_f32 v43, v43, v44
  v_add_f32 v41, v41, v43
  v_mfma_f32_16x16x32_bf16 v[108:111], a[136:139], a[100:103], v[108:111]
  ds_read_b64_tr_b16 a[156:157], v31 offset:40960
  ds_read_b64_tr_b16 a[158:159], v31 offset:45056
  v_mfma_f32_16x16x32_bf16 v[108:111], a[140:143], a[108:111], v[108:111]
  v_mov_b32 v42, v41
  s_nop 1
  v_permlane16_swap_b32 v41, v42
  v_add_f32 v41, v41, v42
  v_mov_b32 v42, v41
  s_nop 1
  v_permlane32_swap_b32 v41, v42
  v_add_f32 v41, v41, v42
  v_cvt_pk_bf16_f32 v43, v41, v42
  v_lshlrev_b32 v41, 16, v43
  v_and_b32 v42, 0xffff0000, v43
  s_lshr_b32 s61, s2, 6
  s_cmp_eq_u32 s61, 2
  s_cselect_b32 s61, 1.0, 0
  v_add_f32 v41, s61, v41
  v_cvt_pk_bf16_f32 v43, v41, v42
  v_lshlrev_b32 v41, 16, v43
  v_and_b32 v42, 0xffff0000, v43
  v_and_b32 v42, 12, v40
  v_bfe_u32 v43, v40, 4, 1
  v_lshl_add_u32 v42, v43, 10, v42
  v_bfe_u32 v43, v40, 5, 1
  v_lshl_add_u32 v42, v43, 4, v42
  s_and_b32 s61, s2, 31
  s_lshl_b32 s61, s61, 5
  s_lshr_b32 s62, s2, 5
  s_lshl_b32 s62, s62, 11
  s_add_u32 s61, s61, s62
  s_cmp_ge_u32 s2, 192
  s_cselect_b32 s60, s60, s61
  s_cselect_b64 vcc, -1, 0
  s_add_u32 s60, s60, 8192
  v_cndmask_b32 v42, v42, v40, vcc
  buffer_store_dword v41, v42, s[56:59], s60 offen sc1
  s_mov_b32 s53, 2
attn_kernel_gloop23:
  s_waitcnt vmcnt(40) lgkmcnt(4)
  s_barrier
  v_mfma_f32_16x16x32_bf16 v[112:115], a[144:147], a[96:99], v[112:115]
  ds_read_b64_tr_b16 a[128:129], v24 offset:49152
  ds_read_b64_tr_b16 a[130:131], v24 offset:53248
  v_mfma_f32_16x16x32_bf16 v[112:115], a[148:151], a[104:107], v[112:115]
  buffer_load_dwordx4 a[80:83], v12, s[16:19], s51 offen offset:0 sc1
  v_mfma_f32_16x16x32_bf16 v[116:119], a[144:147], a[100:103], v[116:119]
  ds_read_b64_tr_b16 a[132:133], v24 offset:57344
  ds_read_b64_tr_b16 a[134:135], v24 offset:61440
  v_mfma_f32_16x16x32_bf16 v[116:119], a[148:151], a[108:111], v[116:119]
  s_add_u32 m0, s52, 81920
  s_waitcnt lgkmcnt(4)
  v_mfma_f32_16x16x32_bf16 v[120:123], a[152:155], a[96:99], v[120:123]
  ds_read_b64_tr_b16 a[136:137], v25 offset:49152
  ds_read_b64_tr_b16 a[138:139], v25 offset:53248
  v_mfma_f32_16x16x32_bf16 v[120:123], a[156:159], a[104:107], v[120:123]
  buffer_load_dwordx4 a[84:87], v12, s[16:19], s51 offen offset:1024 sc1
  v_mfma_f32_16x16x32_bf16 v[124:127], a[152:155], a[100:103], v[124:127]
  ds_read_b64_tr_b16 a[140:141], v25 offset:57344
  ds_read_b64_tr_b16 a[142:143], v25 offset:61440
  v_mfma_f32_16x16x32_bf16 v[124:127], a[156:159], a[108:111], v[124:127]
  s_waitcnt lgkmcnt(4)
  v_mfma_f32_16x16x32_bf16 v[64:67], a[128:131], a[112:115], v[64:67]
  ds_read_b64_tr_b16 a[144:145], v26 offset:49152
  ds_read_b64_tr_b16 a[146:147], v26 offset:53248
  v_mfma_f32_16x16x32_bf16 v[64:67], a[132:135], a[120:123], v[64:67]
  buffer_load_dwordx4 v56, s[12:15], s50 offen offset:0 lds
  v_mfma_f32_16x16x32_bf16 v[68:71], a[128:131], a[116:119], v[68:71]
  ds_read_b64_tr_b16 a[148:149], v26 offset:57344
  ds_read_b64_tr_b16 a[150:151], v26 offset:61440
  v_mfma_f32_16x16x32_bf16 v[68:71], a[132:135], a[124:127], v[68:71]
  s_waitcnt lgkmcnt(4)
  v_mfma_f32_16x16x32_bf16 v[72:75], a[136:139], a[112:115], v[72:75]
  ds_read_b64_tr_b16 a[152:153], v27 offset:49152
  ds_read_b64_tr_b16 a[154:155], v27 offset:53248
  v_mfma_f32_16x16x32_bf16 v[72:75], a[140:143], a[120:123], v[72:75]
  buffer_load_dwordx4 v57, s[12:15], s50 offen offset:1024 lds
  v_mfma_f32_16x16x32_bf16 v[76:79], a[136:139], a[116:119], v[76:79]
  ds_read_b64_tr_b16 a[156:157], v27 offset:57344
  ds_read_b64_tr_b16 a[158:159], v27 offset:61440
  v_mfma_f32_16x16x32_bf16 v[76:79], a[140:143], a[124:127], v[76:79]
  s_waitcnt lgkmcnt(4)
  v_mfma_f32_16x16x32_bf16 v[80:83], a[144:147], a[112:115], v[80:83]
  ds_read_b64_tr_b16 a[128:129], v28 offset:49152
  ds_read_b64_tr_b16 a[130:131], v28 offset:53248
  v_mfma_f32_16x16x32_bf16 v[80:83], a[148:151], a[120:123], v[80:83]
  buffer_load_dwordx4 v58, s[12:15], s50 offen offset:2048 lds
  v_mfma_f32_16x16x32_bf16 v[84:87], a[144:147], a[116:119], v[84:87]
  ds_read_b64_tr_b16 a[132:133], v28 offset:57344
  ds_read_b64_tr_b16 a[134:135], v28 offset:61440
  v_mfma_f32_16x16x32_bf16 v[84:87], a[148:151], a[124:127], v[84:87]
  s_waitcnt lgkmcnt(4)
  v_mfma_f32_16x16x32_bf16 v[88:91], a[152:155], a[112:115], v[88:91]
  ds_read_b64_tr_b16 a[136:137], v29 offset:49152
  ds_read_b64_tr_b16 a[138:139], v29 offset:53248
  v_mfma_f32_16x16x32_bf16 v[88:91], a[156:159], a[120:123], v[88:91]
  buffer_load_dwordx4 v59, s[12:15], s50 offen offset:3072 lds
  v_mfma_f32_16x16x32_bf16 v[92:95], a[152:155], a[116:119], v[92:95]
  ds_read_b64_tr_b16 a[140:141], v29 offset:57344
  ds_read_b64_tr_b16 a[142:143], v29 offset:61440
  v_mfma_f32_16x16x32_bf16 v[92:95], a[156:159], a[124:127], v[92:95]
  s_add_u32 s50, s50, 131072
  s_waitcnt lgkmcnt(4)
  v_mfma_f32_16x16x32_bf16 v[96:99], a[128:131], a[112:115], v[96:99]
  ds_read_b64_tr_b16 a[144:145], v30 offset:49152
  ds_read_b64_tr_b16 a[146:147], v30 offset:53248
  v_mfma_f32_16x16x32_bf16 v[96:99], a[132:135], a[120:123], v[96:99]
  buffer_load_dwordx4 a[88:91], v13, s[16:19], s51 offen offset:0 sc1
  v_mfma_f32_16x16x32_bf16 v[100:103], a[128:131], a[116:119], v[100:103]
  ds_read_b64_tr_b16 a[148:149], v30 offset:57344
  ds_read_b64_tr_b16 a[150:151], v30 offset:61440
  v_mfma_f32_16x16x32_bf16 v[100:103], a[132:135], a[124:127], v[100:103]
  s_waitcnt lgkmcnt(4)
  v_mfma_f32_16x16x32_bf16 v[104:107], a[136:139], a[112:115], v[104:107]
  ds_read_b64_tr_b16 a[152:153], v31 offset:49152
  ds_read_b64_tr_b16 a[154:155], v31 offset:53248
  v_mfma_f32_16x16x32_bf16 v[104:107], a[140:143], a[120:123], v[104:107]
  buffer_load_dwordx4 a[92:95], v13, s[16:19], s51 offen offset:1024 sc1
  v_mfma_f32_16x16x32_bf16 v[108:111], a[136:139], a[116:119], v[108:111]
  ds_read_b64_tr_b16 a[156:157], v31 offset:57344
  ds_read_b64_tr_b16 a[158:159], v31 offset:61440
  v_mfma_f32_16x16x32_bf16 v[108:111], a[140:143], a[124:127], v[108:111]
  s_add_u32 s51, s51, 262144
  s_waitcnt vmcnt(40) lgkmcnt(4)
  s_barrier
  v_mfma_f32_16x16x32_bf16 v[112:115], a[144:147], a[112:115], v[112:115]
  ds_read_b64_tr_b16 a[128:129], v16 offset:0
  ds_read_b64_tr_b16 a[130:131], v16 offset:4096
  v_mfma_f32_16x16x32_bf16 v[112:115], a[148:151], a[120:123], v[112:115]
  buffer_load_dwordx4 a[96:99], v12, s[16:19], s51 offen offset:0 sc1
  v_mfma_f32_16x16x32_bf16 v[116:119], a[144:147], a[116:119], v[116:119]
  ds_read_b64_tr_b16 a[132:133], v16 offset:8192
  ds_read_b64_tr_b16 a[134:135], v16 offset:12288
  v_mfma_f32_16x16x32_bf16 v[116:119], a[148:151], a[124:127], v[116:119]
  s_add_u32 m0, s52, 98304
  s_waitcnt lgkmcnt(4)
  v_mfma_f32_16x16x32_bf16 v[120:123], a[152:155], a[112:115], v[120:123]
  ds_read_b64_tr_b16 a[136:137], v17 offset:0
  ds_read_b64_tr_b16 a[138:139], v17 offset:4096
  v_mfma_f32_16x16x32_bf16 v[120:123], a[156:159], a[120:123], v[120:123]
  buffer_load_dwordx4 a[100:103], v12, s[16:19], s51 offen offset:1024 sc1
  v_mfma_f32_16x16x32_bf16 v[124:127], a[152:155], a[116:119], v[124:127]
  ds_read_b64_tr_b16 a[140:141], v17 offset:8192
  ds_read_b64_tr_b16 a[142:143], v17 offset:12288
  v_mfma_f32_16x16x32_bf16 v[124:127], a[156:159], a[124:127], v[124:127]
  s_waitcnt lgkmcnt(4)
  v_mfma_f32_16x16x32_bf16 v[64:67], a[128:131], a[0:3], v[64:67]
  ds_read_b64_tr_b16 a[144:145], v18 offset:0
  ds_read_b64_tr_b16 a[146:147], v18 offset:4096
  v_mfma_f32_16x16x32_bf16 v[64:67], a[132:135], a[8:11], v[64:67]
  buffer_load_dwordx4 v56, s[12:15], s50 offen offset:0 lds
  v_mfma_f32_16x16x32_bf16 v[68:71], a[128:131], a[4:7], v[68:71]
  ds_read_b64_tr_b16 a[148:149], v18 offset:8192
  ds_read_b64_tr_b16 a[150:151], v18 offset:12288
  v_mfma_f32_16x16x32_bf16 v[68:71], a[132:135], a[12:15], v[68:71]
  s_waitcnt lgkmcnt(4)
  v_mfma_f32_16x16x32_bf16 v[72:75], a[136:139], a[0:3], v[72:75]
  ds_read_b64_tr_b16 a[152:153], v19 offset:0
  ds_read_b64_tr_b16 a[154:155], v19 offset:4096
  v_mfma_f32_16x16x32_bf16 v[72:75], a[140:143], a[8:11], v[72:75]
  buffer_load_dwordx4 v57, s[12:15], s50 offen offset:1024 lds
  v_mfma_f32_16x16x32_bf16 v[76:79], a[136:139], a[4:7], v[76:79]
  ds_read_b64_tr_b16 a[156:157], v19 offset:8192
  ds_read_b64_tr_b16 a[158:159], v19 offset:12288
  v_mfma_f32_16x16x32_bf16 v[76:79], a[140:143], a[12:15], v[76:79]
  s_waitcnt lgkmcnt(4)
  v_mfma_f32_16x16x32_bf16 v[80:83], a[144:147], a[0:3], v[80:83]
  ds_read_b64_tr_b16 a[128:129], v20 offset:0
  ds_read_b64_tr_b16 a[130:131], v20 offset:4096
  v_mfma_f32_16x16x32_bf16 v[80:83], a[148:151], a[8:11], v[80:83]
  buffer_load_dwordx4 v58, s[12:15], s50 offen offset:2048 lds
  v_mfma_f32_16x16x32_bf16 v[84:87], a[144:147], a[4:7], v[84:87]
  ds_read_b64_tr_b16 a[132:133], v20 offset:8192
  ds_read_b64_tr_b16 a[134:135], v20 offset:12288
  v_mfma_f32_16x16x32_bf16 v[84:87], a[148:151], a[12:15], v[84:87]
  s_waitcnt lgkmcnt(4)
  v_mfma_f32_16x16x32_bf16 v[88:91], a[152:155], a[0:3], v[88:91]
  ds_read_b64_tr_b16 a[136:137], v21 offset:0
  ds_read_b64_tr_b16 a[138:139], v21 offset:4096
  v_mfma_f32_16x16x32_bf16 v[88:91], a[156:159], a[8:11], v[88:91]
  buffer_load_dwordx4 v59, s[12:15], s50 offen offset:3072 lds
  v_mfma_f32_16x16x32_bf16 v[92:95], a[152:155], a[4:7], v[92:95]
  ds_read_b64_tr_b16 a[140:141], v21 offset:8192
  ds_read_b64_tr_b16 a[142:143], v21 offset:12288
  v_mfma_f32_16x16x32_bf16 v[92:95], a[156:159], a[12:15], v[92:95]
  s_add_u32 s50, s50, 131072
  s_waitcnt lgkmcnt(4)
  v_mfma_f32_16x16x32_bf16 v[96:99], a[128:131], a[0:3], v[96:99]
  ds_read_b64_tr_b16 a[144:145], v22 offset:0
  ds_read_b64_tr_b16 a[146:147], v22 offset:4096
  v_mfma_f32_16x16x32_bf16 v[96:99], a[132:135], a[8:11], v[96:99]
  buffer_load_dwordx4 a[104:107], v13, s[16:19], s51 offen offset:0 sc1
  v_mfma_f32_16x16x32_bf16 v[100:103], a[128:131], a[4:7], v[100:103]
  ds_read_b64_tr_b16 a[148:149], v22 offset:8192
  ds_read_b64_tr_b16 a[150:151], v22 offset:12288
  v_mfma_f32_16x16x32_bf16 v[100:103], a[132:135], a[12:15], v[100:103]
  s_waitcnt lgkmcnt(4)
  v_mfma_f32_16x16x32_bf16 v[104:107], a[136:139], a[0:3], v[104:107]
  ds_read_b64_tr_b16 a[152:153], v23 offset:0
  ds_read_b64_tr_b16 a[154:155], v23 offset:4096
  v_mfma_f32_16x16x32_bf16 v[104:107], a[140:143], a[8:11], v[104:107]
  buffer_load_dwordx4 a[108:111], v13, s[16:19], s51 offen offset:1024 sc1
  v_mfma_f32_16x16x32_bf16 v[108:111], a[136:139], a[4:7], v[108:111]
  ds_read_b64_tr_b16 a[156:157], v23 offset:8192
  ds_read_b64_tr_b16 a[158:159], v23 offset:12288
  v_mfma_f32_16x16x32_bf16 v[108:111], a[140:143], a[12:15], v[108:111]
  s_add_u32 s51, s51, 262144
  s_waitcnt vmcnt(40) lgkmcnt(4)
  s_barrier
  v_mfma_f32_16x16x32_bf16 v[112:115], a[144:147], a[0:3], v[112:115]
  ds_read_b64_tr_b16 a[128:129], v16 offset:16384
  ds_read_b64_tr_b16 a[130:131], v16 offset:20480
  v_mfma_f32_16x16x32_bf16 v[112:115], a[148:151], a[8:11], v[112:115]
  buffer_load_dwordx4 a[112:115], v12, s[16:19], s51 offen offset:0 sc1
  v_mfma_f32_16x16x32_bf16 v[116:119], a[144:147], a[4:7], v[116:119]
  ds_read_b64_tr_b16 a[132:133], v16 offset:24576
  ds_read_b64_tr_b16 a[134:135], v16 offset:28672
  v_mfma_f32_16x16x32_bf16 v[116:119], a[148:151], a[12:15], v[116:119]
  s_add_u32 m0, s52, 114688
  s_waitcnt lgkmcnt(4)
  v_mfma_f32_16x16x32_bf16 v[120:123], a[152:155], a[0:3], v[120:123]
  ds_read_b64_tr_b16 a[136:137], v17 offset:16384
  ds_read_b64_tr_b16 a[138:139], v17 offset:20480
  v_mfma_f32_16x16x32_bf16 v[120:123], a[156:159], a[8:11], v[120:123]
  buffer_load_dwordx4 a[116:119], v12, s[16:19], s51 offen offset:1024 sc1
  v_mfma_f32_16x16x32_bf16 v[124:127], a[152:155], a[4:7], v[124:127]
  ds_read_b64_tr_b16 a[140:141], v17 offset:24576
  ds_read_b64_tr_b16 a[142:143], v17 offset:28672
  v_mfma_f32_16x16x32_bf16 v[124:127], a[156:159], a[12:15], v[124:127]
  s_waitcnt lgkmcnt(4)
  v_mfma_f32_16x16x32_bf16 v[64:67], a[128:131], a[16:19], v[64:67]
  ds_read_b64_tr_b16 a[144:145], v18 offset:16384
  ds_read_b64_tr_b16 a[146:147], v18 offset:20480
  v_mfma_f32_16x16x32_bf16 v[64:67], a[132:135], a[24:27], v[64:67]
  buffer_load_dwordx4 v56, s[12:15], s50 offen offset:0 lds
  v_mfma_f32_16x16x32_bf16 v[68:71], a[128:131], a[20:23], v[68:71]
  ds_read_b64_tr_b16 a[148:149], v18 offset:24576
  ds_read_b64_tr_b16 a[150:151], v18 offset:28672
  v_mfma_f32_16x16x32_bf16 v[68:71], a[132:135], a[28:31], v[68:71]
  s_waitcnt lgkmcnt(4)
  v_mfma_f32_16x16x32_bf16 v[72:75], a[136:139], a[16:19], v[72:75]
  ds_read_b64_tr_b16 a[152:153], v19 offset:16384
  ds_read_b64_tr_b16 a[154:155], v19 offset:20480
  v_mfma_f32_16x16x32_bf16 v[72:75], a[140:143], a[24:27], v[72:75]
  buffer_load_dwordx4 v57, s[12:15], s50 offen offset:1024 lds
  v_mfma_f32_16x16x32_bf16 v[76:79], a[136:139], a[20:23], v[76:79]
  ds_read_b64_tr_b16 a[156:157], v19 offset:24576
  ds_read_b64_tr_b16 a[158:159], v19 offset:28672
  v_mfma_f32_16x16x32_bf16 v[76:79], a[140:143], a[28:31], v[76:79]
  s_waitcnt lgkmcnt(4)
  v_mfma_f32_16x16x32_bf16 v[80:83], a[144:147], a[16:19], v[80:83]
  ds_read_b64_tr_b16 a[128:129], v20 offset:16384
  ds_read_b64_tr_b16 a[130:131], v20 offset:20480
  v_mfma_f32_16x16x32_bf16 v[80:83], a[148:151], a[24:27], v[80:83]
  buffer_load_dwordx4 v58, s[12:15], s50 offen offset:2048 lds
  v_mfma_f32_16x16x32_bf16 v[84:87], a[144:147], a[20:23], v[84:87]
  ds_read_b64_tr_b16 a[132:133], v20 offset:24576
  ds_read_b64_tr_b16 a[134:135], v20 offset:28672
  v_mfma_f32_16x16x32_bf16 v[84:87], a[148:151], a[28:31], v[84:87]
  s_waitcnt lgkmcnt(4)
  v_mfma_f32_16x16x32_bf16 v[88:91], a[152:155], a[16:19], v[88:91]
  ds_read_b64_tr_b16 a[136:137], v21 offset:16384
  ds_read_b64_tr_b16 a[138:139], v21 offset:20480
  v_mfma_f32_16x16x32_bf16 v[88:91], a[156:159], a[24:27], v[88:91]
  buffer_load_dwordx4 v59, s[12:15], s50 offen offset:3072 lds
  v_mfma_f32_16x16x32_bf16 v[92:95], a[152:155], a[20:23], v[92:95]
  ds_read_b64_tr_b16 a[140:141], v21 offset:24576
  ds_read_b64_tr_b16 a[142:143], v21 offset:28672
  v_mfma_f32_16x16x32_bf16 v[92:95], a[156:159], a[28:31], v[92:95]
  s_add_u32 s50, s50, 131072
  s_waitcnt lgkmcnt(4)
  v_mfma_f32_16x16x32_bf16 v[96:99], a[128:131], a[16:19], v[96:99]
  ds_read_b64_tr_b16 a[144:145], v22 offset:16384
  ds_read_b64_tr_b16 a[146:147], v22 offset:20480
  v_mfma_f32_16x16x32_bf16 v[96:99], a[132:135], a[24:27], v[96:99]
  buffer_load_dwordx4 a[120:123], v13, s[16:19], s51 offen offset:0 sc1
  v_mfma_f32_16x16x32_bf16 v[100:103], a[128:131], a[20:23], v[100:103]
  ds_read_b64_tr_b16 a[148:149], v22 offset:24576
  ds_read_b64_tr_b16 a[150:151], v22 offset:28672
  v_mfma_f32_16x16x32_bf16 v[100:103], a[132:135], a[28:31], v[100:103]
  s_waitcnt lgkmcnt(4)
  v_mfma_f32_16x16x32_bf16 v[104:107], a[136:139], a[16:19], v[104:107]
  ds_read_b64_tr_b16 a[152:153], v23 offset:16384
  ds_read_b64_tr_b16 a[154:155], v23 offset:20480
  v_mfma_f32_16x16x32_bf16 v[104:107], a[140:143], a[24:27], v[104:107]
  buffer_load_dwordx4 a[124:127], v13, s[16:19], s51 offen offset:1024 sc1
  v_mfma_f32_16x16x32_bf16 v[108:111], a[136:139], a[20:23], v[108:111]
  ds_read_b64_tr_b16 a[156:157], v23 offset:24576
  ds_read_b64_tr_b16 a[158:159], v23 offset:28672
  v_mfma_f32_16x16x32_bf16 v[108:111], a[140:143], a[28:31], v[108:111]
  s_add_u32 s51, s51, 262144
  s_waitcnt vmcnt(40) lgkmcnt(4)
  s_barrier
  v_mfma_f32_16x16x32_bf16 v[112:115], a[144:147], a[16:19], v[112:115]
  ds_read_b64_tr_b16 a[128:129], v16 offset:32768
  ds_read_b64_tr_b16 a[130:131], v16 offset:36864
  v_mfma_f32_16x16x32_bf16 v[112:115], a[148:151], a[24:27], v[112:115]
  buffer_load_dwordx4 a[0:3], v12, s[16:19], s51 offen offset:0 sc1
  v_mfma_f32_16x16x32_bf16 v[116:119], a[144:147], a[20:23], v[116:119]
  ds_read_b64_tr_b16 a[132:133], v16 offset:40960
  ds_read_b64_tr_b16 a[134:135], v16 offset:45056
  v_mfma_f32_16x16x32_bf16 v[116:119], a[148:151], a[28:31], v[116:119]
  s_add_u32 m0, s52, 0
  s_waitcnt lgkmcnt(4)
  v_mfma_f32_16x16x32_bf16 v[120:123], a[152:155], a[16:19], v[120:123]
  ds_read_b64_tr_b16 a[136:137], v17 offset:32768
  ds_read_b64_tr_b16 a[138:139], v17 offset:36864
  v_mfma_f32_16x16x32_bf16 v[120:123], a[156:159], a[24:27], v[120:123]
  buffer_load_dwordx4 a[4:7], v12, s[16:19], s51 offen offset:1024 sc1
  v_mfma_f32_16x16x32_bf16 v[124:127], a[152:155], a[20:23], v[124:127]
  ds_read_b64_tr_b16 a[140:141], v17 offset:40960
  ds_read_b64_tr_b16 a[142:143], v17 offset:45056
  v_mfma_f32_16x16x32_bf16 v[124:127], a[156:159], a[28:31], v[124:127]
  s_waitcnt lgkmcnt(4)
  v_mfma_f32_16x16x32_bf16 v[64:67], a[128:131], a[32:35], v[64:67]
  ds_read_b64_tr_b16 a[144:145], v18 offset:32768
  ds_read_b64_tr_b16 a[146:147], v18 offset:36864
  v_mfma_f32_16x16x32_bf16 v[64:67], a[132:135], a[40:43], v[64:67]
  buffer_load_dwordx4 v56, s[12:15], s50 offen offset:0 lds
  v_mfma_f32_16x16x32_bf16 v[68:71], a[128:131], a[36:39], v[68:71]
  ds_read_b64_tr_b16 a[148:149], v18 offset:40960
  ds_read_b64_tr_b16 a[150:151], v18 offset:45056
  v_mfma_f32_16x16x32_bf16 v[68:71], a[132:135], a[44:47], v[68:71]
  s_waitcnt lgkmcnt(4)
  v_mfma_f32_16x16x32_bf16 v[72:75], a[136:139], a[32:35], v[72:75]
  ds_read_b64_tr_b16 a[152:153], v19 offset:32768
  ds_read_b64_tr_b16 a[154:155], v19 offset:36864
  v_mfma_f32_16x16x32_bf16 v[72:75], a[140:143], a[40:43], v[72:75]
  buffer_load_dwordx4 v57, s[12:15], s50 offen offset:1024 lds
  v_mfma_f32_16x16x32_bf16 v[76:79], a[136:139], a[36:39], v[76:79]
  ds_read_b64_tr_b16 a[156:157], v19 offset:40960
  ds_read_b64_tr_b16 a[158:159], v19 offset:45056
  v_mfma_f32_16x16x32_bf16 v[76:79], a[140:143], a[44:47], v[76:79]
  s_waitcnt lgkmcnt(4)
  v_mfma_f32_16x16x32_bf16 v[80:83], a[144:147], a[32:35], v[80:83]
  ds_read_b64_tr_b16 a[128:129], v20 offset:32768
  ds_read_b64_tr_b16 a[130:131], v20 offset:36864
  v_mfma_f32_16x16x32_bf16 v[80:83], a[148:151], a[40:43], v[80:83]
  buffer_load_dwordx4 v58, s[12:15], s50 offen offset:2048 lds
  v_mfma_f32_16x16x32_bf16 v[84:87], a[144:147], a[36:39], v[84:87]
  ds_read_b64_tr_b16 a[132:133], v20 offset:40960
  ds_read_b64_tr_b16 a[134:135], v20 offset:45056
  v_mfma_f32_16x16x32_bf16 v[84:87], a[148:151], a[44:47], v[84:87]
  s_waitcnt lgkmcnt(4)
  v_mfma_f32_16x16x32_bf16 v[88:91], a[152:155], a[32:35], v[88:91]
  ds_read_b64_tr_b16 a[136:137], v21 offset:32768
  ds_read_b64_tr_b16 a[138:139], v21 offset:36864
  v_mfma_f32_16x16x32_bf16 v[88:91], a[156:159], a[40:43], v[88:91]
  buffer_load_dwordx4 v59, s[12:15], s50 offen offset:3072 lds
  v_mfma_f32_16x16x32_bf16 v[92:95], a[152:155], a[36:39], v[92:95]
  ds_read_b64_tr_b16 a[140:141], v21 offset:40960
  ds_read_b64_tr_b16 a[142:143], v21 offset:45056
  v_mfma_f32_16x16x32_bf16 v[92:95], a[156:159], a[44:47], v[92:95]
  s_add_u32 s50, s50, 131072
  s_waitcnt lgkmcnt(4)
  v_mfma_f32_16x16x32_bf16 v[96:99], a[128:131], a[32:35], v[96:99]
  ds_read_b64_tr_b16 a[144:145], v22 offset:32768
  ds_read_b64_tr_b16 a[146:147], v22 offset:36864
  v_mfma_f32_16x16x32_bf16 v[96:99], a[132:135], a[40:43], v[96:99]
  buffer_load_dwordx4 a[8:11], v13, s[16:19], s51 offen offset:0 sc1
  v_mfma_f32_16x16x32_bf16 v[100:103], a[128:131], a[36:39], v[100:103]
  ds_read_b64_tr_b16 a[148:149], v22 offset:40960
  ds_read_b64_tr_b16 a[150:151], v22 offset:45056
  v_mfma_f32_16x16x32_bf16 v[100:103], a[132:135], a[44:47], v[100:103]
  s_waitcnt lgkmcnt(4)
  v_mfma_f32_16x16x32_bf16 v[104:107], a[136:139], a[32:35], v[104:107]
  ds_read_b64_tr_b16 a[152:153], v23 offset:32768
  ds_read_b64_tr_b16 a[154:155], v23 offset:36864
  v_mfma_f32_16x16x32_bf16 v[104:107], a[140:143], a[40:43], v[104:107]
  buffer_load_dwordx4 a[12:15], v13, s[16:19], s51 offen offset:1024 sc1
  v_mfma_f32_16x16x32_bf16 v[108:111], a[136:139], a[36:39], v[108:111]
  ds_read_b64_tr_b16 a[156:157], v23 offset:40960
  ds_read_b64_tr_b16 a[158:159], v23 offset:45056
  v_mfma_f32_16x16x32_bf16 v[108:111], a[140:143], a[44:47], v[108:111]
  s_add_u32 s51, s51, 262144
  s_waitcnt vmcnt(40) lgkmcnt(4)
  s_barrier
  v_mfma_f32_16x16x32_bf16 v[112:115], a[144:147], a[32:35], v[112:115]
  ds_read_b64_tr_b16 a[128:129], v16 offset:49152
  ds_read_b64_tr_b16 a[130:131], v16 offset:53248
  v_mfma_f32_16x16x32_bf16 v[112:115], a[148:151], a[40:43], v[112:115]
  buffer_load_dwordx4 a[16:19], v12, s[16:19], s51 offen offset:0 sc1
  v_mfma_f32_16x16x32_bf16 v[116:119], a[144:147], a[36:39], v[116:119]
  ds_read_b64_tr_b16 a[132:133], v16 offset:57344
  ds_read_b64_tr_b16 a[134:135], v16 offset:61440
  v_mfma_f32_16x16x32_bf16 v[116:119], a[148:151], a[44:47], v[116:119]
  s_add_u32 m0, s52, 16384
  s_waitcnt lgkmcnt(4)
  v_mfma_f32_16x16x32_bf16 v[120:123], a[152:155], a[32:35], v[120:123]
  ds_read_b64_tr_b16 a[136:137], v17 offset:49152
  ds_read_b64_tr_b16 a[138:139], v17 offset:53248
  v_mfma_f32_16x16x32_bf16 v[120:123], a[156:159], a[40:43], v[120:123]
  buffer_load_dwordx4 a[20:23], v12, s[16:19], s51 offen offset:1024 sc1
  v_mfma_f32_16x16x32_bf16 v[124:127], a[152:155], a[36:39], v[124:127]
  ds_read_b64_tr_b16 a[140:141], v17 offset:57344
  ds_read_b64_tr_b16 a[142:143], v17 offset:61440
  v_mfma_f32_16x16x32_bf16 v[124:127], a[156:159], a[44:47], v[124:127]
  s_waitcnt lgkmcnt(4)
  v_mfma_f32_16x16x32_bf16 v[64:67], a[128:131], a[48:51], v[64:67]
  ds_read_b64_tr_b16 a[144:145], v18 offset:49152
  ds_read_b64_tr_b16 a[146:147], v18 offset:53248
  v_mfma_f32_16x16x32_bf16 v[64:67], a[132:135], a[56:59], v[64:67]
  buffer_load_dwordx4 v56, s[12:15], s50 offen offset:0 lds
  v_mfma_f32_16x16x32_bf16 v[68:71], a[128:131], a[52:55], v[68:71]
  ds_read_b64_tr_b16 a[148:149], v18 offset:57344
  ds_read_b64_tr_b16 a[150:151], v18 offset:61440
  v_mfma_f32_16x16x32_bf16 v[68:71], a[132:135], a[60:63], v[68:71]
  s_waitcnt lgkmcnt(4)
  v_mfma_f32_16x16x32_bf16 v[72:75], a[136:139], a[48:51], v[72:75]
  ds_read_b64_tr_b16 a[152:153], v19 offset:49152
  ds_read_b64_tr_b16 a[154:155], v19 offset:53248
  v_mfma_f32_16x16x32_bf16 v[72:75], a[140:143], a[56:59], v[72:75]
  buffer_load_dwordx4 v57, s[12:15], s50 offen offset:1024 lds
  v_mfma_f32_16x16x32_bf16 v[76:79], a[136:139], a[52:55], v[76:79]
  ds_read_b64_tr_b16 a[156:157], v19 offset:57344
  ds_read_b64_tr_b16 a[158:159], v19 offset:61440
  v_mfma_f32_16x16x32_bf16 v[76:79], a[140:143], a[60:63], v[76:79]
  s_waitcnt lgkmcnt(4)
  v_mfma_f32_16x16x32_bf16 v[80:83], a[144:147], a[48:51], v[80:83]
  ds_read_b64_tr_b16 a[128:129], v20 offset:49152
  ds_read_b64_tr_b16 a[130:131], v20 offset:53248
  v_mfma_f32_16x16x32_bf16 v[80:83], a[148:151], a[56:59], v[80:83]
  buffer_load_dwordx4 v58, s[12:15], s50 offen offset:2048 lds
  v_mfma_f32_16x16x32_bf16 v[84:87], a[144:147], a[52:55], v[84:87]
  ds_read_b64_tr_b16 a[132:133], v20 offset:57344
  ds_read_b64_tr_b16 a[134:135], v20 offset:61440
  v_mfma_f32_16x16x32_bf16 v[84:87], a[148:151], a[60:63], v[84:87]
  s_waitcnt lgkmcnt(4)
  v_mfma_f32_16x16x32_bf16 v[88:91], a[152:155], a[48:51], v[88:91]
  ds_read_b64_tr_b16 a[136:137], v21 offset:49152
  ds_read_b64_tr_b16 a[138:139], v21 offset:53248
  v_mfma_f32_16x16x32_bf16 v[88:91], a[156:159], a[56:59], v[88:91]
  buffer_load_dwordx4 v59, s[12:15], s50 offen offset:3072 lds
  v_mfma_f32_16x16x32_bf16 v[92:95], a[152:155], a[52:55], v[92:95]
  ds_read_b64_tr_b16 a[140:141], v21 offset:57344
  ds_read_b64_tr_b16 a[142:143], v21 offset:61440
  v_mfma_f32_16x16x32_bf16 v[92:95], a[156:159], a[60:63], v[92:95]
  s_add_u32 s50, s50, 131072
  s_waitcnt lgkmcnt(4)
  v_mfma_f32_16x16x32_bf16 v[96:99], a[128:131], a[48:51], v[96:99]
  ds_read_b64_tr_b16 a[144:145], v22 offset:49152
  ds_read_b64_tr_b16 a[146:147], v22 offset:53248
  v_mfma_f32_16x16x32_bf16 v[96:99], a[132:135], a[56:59], v[96:99]
  buffer_load_dwordx4 a[24:27], v13, s[16:19], s51 offen offset:0 sc1
  v_mfma_f32_16x16x32_bf16 v[100:103], a[128:131], a[52:55], v[100:103]
  ds_read_b64_tr_b16 a[148:149], v22 offset:57344
  ds_read_b64_tr_b16 a[150:151], v22 offset:61440
  v_mfma_f32_16x16x32_bf16 v[100:103], a[132:135], a[60:63], v[100:103]
  s_waitcnt lgkmcnt(4)
  v_mfma_f32_16x16x32_bf16 v[104:107], a[136:139], a[48:51], v[104:107]
  ds_read_b64_tr_b16 a[152:153], v23 offset:49152
  ds_read_b64_tr_b16 a[154:155], v23 offset:53248
  v_mfma_f32_16x16x32_bf16 v[104:107], a[140:143], a[56:59], v[104:107]
  buffer_load_dwordx4 a[28:31], v13, s[16:19], s51 offen offset:1024 sc1
  v_mfma_f32_16x16x32_bf16 v[108:111], a[136:139], a[52:55], v[108:111]
  ds_read_b64_tr_b16 a[156:157], v23 offset:57344
  ds_read_b64_tr_b16 a[158:159], v23 offset:61440
  v_mfma_f32_16x16x32_bf16 v[108:111], a[140:143], a[60:63], v[108:111]
  s_add_u32 s51, s51, 262144
  s_waitcnt vmcnt(40) lgkmcnt(4)
  s_barrier
  v_mfma_f32_16x16x32_bf16 v[112:115], a[144:147], a[48:51], v[112:115]
  ds_read_b64_tr_b16 a[128:129], v24 offset:0
  ds_read_b64_tr_b16 a[130:131], v24 offset:4096
  v_mfma_f32_16x16x32_bf16 v[112:115], a[148:151], a[56:59], v[112:115]
  buffer_load_dwordx4 a[32:35], v12, s[16:19], s51 offen offset:0 sc1
  v_mfma_f32_16x16x32_bf16 v[116:119], a[144:147], a[52:55], v[116:119]
  ds_read_b64_tr_b16 a[132:133], v24 offset:8192
  ds_read_b64_tr_b16 a[134:135], v24 offset:12288
  v_mfma_f32_16x16x32_bf16 v[116:119], a[148:151], a[60:63], v[116:119]
  s_add_u32 m0, s52, 32768
  s_waitcnt lgkmcnt(4)
  v_mfma_f32_16x16x32_bf16 v[120:123], a[152:155], a[48:51], v[120:123]
  ds_read_b64_tr_b16 a[136:137], v25 offset:0
  ds_read_b64_tr_b16 a[138:139], v25 offset:4096
  v_mfma_f32_16x16x32_bf16 v[120:123], a[156:159], a[56:59], v[120:123]
  buffer_load_dwordx4 a[36:39], v12, s[16:19], s51 offen offset:1024 sc1
  v_mfma_f32_16x16x32_bf16 v[124:127], a[152:155], a[52:55], v[124:127]
  ds_read_b64_tr_b16 a[140:141], v25 offset:8192
  ds_read_b64_tr_b16 a[142:143], v25 offset:12288
  v_mfma_f32_16x16x32_bf16 v[124:127], a[156:159], a[60:63], v[124:127]
  s_waitcnt lgkmcnt(4)
  v_mfma_f32_16x16x32_bf16 v[64:67], a[128:131], a[64:67], v[64:67]
  ds_read_b64_tr_b16 a[144:145], v26 offset:0
  ds_read_b64_tr_b16 a[146:147], v26 offset:4096
  v_mfma_f32_16x16x32_bf16 v[64:67], a[132:135], a[72:75], v[64:67]
  buffer_load_dwordx4 v56, s[12:15], s50 offen offset:0 lds
  v_mfma_f32_16x16x32_bf16 v[68:71], a[128:131], a[68:71], v[68:71]
  ds_read_b64_tr_b16 a[148:149], v26 offset:8192
  ds_read_b64_tr_b16 a[150:151], v26 offset:12288
  v_mfma_f32_16x16x32_bf16 v[68:71], a[132:135], a[76:79], v[68:71]
  s_waitcnt lgkmcnt(4)
  v_mfma_f32_16x16x32_bf16 v[72:75], a[136:139], a[64:67], v[72:75]
  ds_read_b64_tr_b16 a[152:153], v27 offset:0
  ds_read_b64_tr_b16 a[154:155], v27 offset:4096
  v_mfma_f32_16x16x32_bf16 v[72:75], a[140:143], a[72:75], v[72:75]
  buffer_load_dwordx4 v57, s[12:15], s50 offen offset:1024 lds
  v_mfma_f32_16x16x32_bf16 v[76:79], a[136:139], a[68:71], v[76:79]
  ds_read_b64_tr_b16 a[156:157], v27 offset:8192
  ds_read_b64_tr_b16 a[158:159], v27 offset:12288
  v_mfma_f32_16x16x32_bf16 v[76:79], a[140:143], a[76:79], v[76:79]
  s_waitcnt lgkmcnt(4)
  v_mfma_f32_16x16x32_bf16 v[80:83], a[144:147], a[64:67], v[80:83]
  ds_read_b64_tr_b16 a[128:129], v28 offset:0
  ds_read_b64_tr_b16 a[130:131], v28 offset:4096
  v_mfma_f32_16x16x32_bf16 v[80:83], a[148:151], a[72:75], v[80:83]
  buffer_load_dwordx4 v58, s[12:15], s50 offen offset:2048 lds
  v_mfma_f32_16x16x32_bf16 v[84:87], a[144:147], a[68:71], v[84:87]
  ds_read_b64_tr_b16 a[132:133], v28 offset:8192
  ds_read_b64_tr_b16 a[134:135], v28 offset:12288
  v_mfma_f32_16x16x32_bf16 v[84:87], a[148:151], a[76:79], v[84:87]
  s_waitcnt lgkmcnt(4)
  v_mfma_f32_16x16x32_bf16 v[88:91], a[152:155], a[64:67], v[88:91]
  ds_read_b64_tr_b16 a[136:137], v29 offset:0
  ds_read_b64_tr_b16 a[138:139], v29 offset:4096
  v_mfma_f32_16x16x32_bf16 v[88:91], a[156:159], a[72:75], v[88:91]
  buffer_load_dwordx4 v59, s[12:15], s50 offen offset:3072 lds
  v_mfma_f32_16x16x32_bf16 v[92:95], a[152:155], a[68:71], v[92:95]
  ds_read_b64_tr_b16 a[140:141], v29 offset:8192
  ds_read_b64_tr_b16 a[142:143], v29 offset:12288
  v_mfma_f32_16x16x32_bf16 v[92:95], a[156:159], a[76:79], v[92:95]
  s_add_u32 s50, s50, 131072
  s_waitcnt lgkmcnt(4)
  v_mfma_f32_16x16x32_bf16 v[96:99], a[128:131], a[64:67], v[96:99]
  ds_read_b64_tr_b16 a[144:145], v30 offset:0
  ds_read_b64_tr_b16 a[146:147], v30 offset:4096
  v_mfma_f32_16x16x32_bf16 v[96:99], a[132:135], a[72:75], v[96:99]
  buffer_load_dwordx4 a[40:43], v13, s[16:19], s51 offen offset:0 sc1
  v_mfma_f32_16x16x32_bf16 v[100:103], a[128:131], a[68:71], v[100:103]
  ds_read_b64_tr_b16 a[148:149], v30 offset:8192
  ds_read_b64_tr_b16 a[150:151], v30 offset:12288
  v_mfma_f32_16x16x32_bf16 v[100:103], a[132:135], a[76:79], v[100:103]
  s_waitcnt lgkmcnt(4)
  v_mfma_f32_16x16x32_bf16 v[104:107], a[136:139], a[64:67], v[104:107]
  ds_read_b64_tr_b16 a[152:153], v31 offset:0
  ds_read_b64_tr_b16 a[154:155], v31 offset:4096
  v_mfma_f32_16x16x32_bf16 v[104:107], a[140:143], a[72:75], v[104:107]
  buffer_load_dwordx4 a[44:47], v13, s[16:19], s51 offen offset:1024 sc1
  v_mfma_f32_16x16x32_bf16 v[108:111], a[136:139], a[68:71], v[108:111]
  ds_read_b64_tr_b16 a[156:157], v31 offset:8192
  ds_read_b64_tr_b16 a[158:159], v31 offset:12288
  v_mfma_f32_16x16x32_bf16 v[108:111], a[140:143], a[76:79], v[108:111]
  s_add_u32 s51, s51, 262144
  s_waitcnt vmcnt(40) lgkmcnt(4)
  s_barrier
  v_mfma_f32_16x16x32_bf16 v[112:115], a[144:147], a[64:67], v[112:115]
  ds_read_b64_tr_b16 a[128:129], v24 offset:16384
  ds_read_b64_tr_b16 a[130:131], v24 offset:20480
  v_mfma_f32_16x16x32_bf16 v[112:115], a[148:151], a[72:75], v[112:115]
  buffer_load_dwordx4 a[48:51], v12, s[16:19], s51 offen offset:0 sc1
  v_mfma_f32_16x16x32_bf16 v[116:119], a[144:147], a[68:71], v[116:119]
  ds_read_b64_tr_b16 a[132:133], v24 offset:24576
  ds_read_b64_tr_b16 a[134:135], v24 offset:28672
  v_mfma_f32_16x16x32_bf16 v[116:119], a[148:151], a[76:79], v[116:119]
  s_add_u32 m0, s52, 49152
  s_waitcnt lgkmcnt(4)
  v_mfma_f32_16x16x32_bf16 v[120:123], a[152:155], a[64:67], v[120:123]
  ds_read_b64_tr_b16 a[136:137], v25 offset:16384
  ds_read_b64_tr_b16 a[138:139], v25 offset:20480
  v_mfma_f32_16x16x32_bf16 v[120:123], a[156:159], a[72:75], v[120:123]
  buffer_load_dwordx4 a[52:55], v12, s[16:19], s51 offen offset:1024 sc1
  v_mfma_f32_16x16x32_bf16 v[124:127], a[152:155], a[68:71], v[124:127]
  ds_read_b64_tr_b16 a[140:141], v25 offset:24576
  ds_read_b64_tr_b16 a[142:143], v25 offset:28672
  v_mfma_f32_16x16x32_bf16 v[124:127], a[156:159], a[76:79], v[124:127]
  s_waitcnt lgkmcnt(4)
  v_mfma_f32_16x16x32_bf16 v[64:67], a[128:131], a[80:83], v[64:67]
  ds_read_b64_tr_b16 a[144:145], v26 offset:16384
  ds_read_b64_tr_b16 a[146:147], v26 offset:20480
  v_mfma_f32_16x16x32_bf16 v[64:67], a[132:135], a[88:91], v[64:67]
  buffer_load_dwordx4 v56, s[12:15], s50 offen offset:0 lds
  v_mfma_f32_16x16x32_bf16 v[68:71], a[128:131], a[84:87], v[68:71]
  ds_read_b64_tr_b16 a[148:149], v26 offset:24576
  ds_read_b64_tr_b16 a[150:151], v26 offset:28672
  v_mfma_f32_16x16x32_bf16 v[68:71], a[132:135], a[92:95], v[68:71]
  s_waitcnt lgkmcnt(4)
  v_mfma_f32_16x16x32_bf16 v[72:75], a[136:139], a[80:83], v[72:75]
  ds_read_b64_tr_b16 a[152:153], v27 offset:16384
  ds_read_b64_tr_b16 a[154:155], v27 offset:20480
  v_mfma_f32_16x16x32_bf16 v[72:75], a[140:143], a[88:91], v[72:75]
  buffer_load_dwordx4 v57, s[12:15], s50 offen offset:1024 lds
  v_mfma_f32_16x16x32_bf16 v[76:79], a[136:139], a[84:87], v[76:79]
  ds_read_b64_tr_b16 a[156:157], v27 offset:24576
  ds_read_b64_tr_b16 a[158:159], v27 offset:28672
  v_mfma_f32_16x16x32_bf16 v[76:79], a[140:143], a[92:95], v[76:79]
  s_waitcnt lgkmcnt(4)
  v_mfma_f32_16x16x32_bf16 v[80:83], a[144:147], a[80:83], v[80:83]
  ds_read_b64_tr_b16 a[128:129], v28 offset:16384
  ds_read_b64_tr_b16 a[130:131], v28 offset:20480
  v_mfma_f32_16x16x32_bf16 v[80:83], a[148:151], a[88:91], v[80:83]
  buffer_load_dwordx4 v58, s[12:15], s50 offen offset:2048 lds
  v_mfma_f32_16x16x32_bf16 v[84:87], a[144:147], a[84:87], v[84:87]
  ds_read_b64_tr_b16 a[132:133], v28 offset:24576
  ds_read_b64_tr_b16 a[134:135], v28 offset:28672
  v_mfma_f32_16x16x32_bf16 v[84:87], a[148:151], a[92:95], v[84:87]
  s_waitcnt lgkmcnt(4)
  v_mfma_f32_16x16x32_bf16 v[88:91], a[152:155], a[80:83], v[88:91]
  ds_read_b64_tr_b16 a[136:137], v29 offset:16384
  ds_read_b64_tr_b16 a[138:139], v29 offset:20480
  v_mfma_f32_16x16x32_bf16 v[88:91], a[156:159], a[88:91], v[88:91]
  buffer_load_dwordx4 v59, s[12:15], s50 offen offset:3072 lds
  v_mfma_f32_16x16x32_bf16 v[92:95], a[152:155], a[84:87], v[92:95]
  ds_read_b64_tr_b16 a[140:141], v29 offset:24576
  ds_read_b64_tr_b16 a[142:143], v29 offset:28672
  v_mfma_f32_16x16x32_bf16 v[92:95], a[156:159], a[92:95], v[92:95]
  s_add_u32 s50, s50, 131072
  s_waitcnt lgkmcnt(4)
  v_mfma_f32_16x16x32_bf16 v[96:99], a[128:131], a[80:83], v[96:99]
  ds_read_b64_tr_b16 a[144:145], v30 offset:16384
  ds_read_b64_tr_b16 a[146:147], v30 offset:20480
  v_mfma_f32_16x16x32_bf16 v[96:99], a[132:135], a[88:91], v[96:99]
  buffer_load_dwordx4 a[56:59], v13, s[16:19], s51 offen offset:0 sc1
  v_mfma_f32_16x16x32_bf16 v[100:103], a[128:131], a[84:87], v[100:103]
  ds_read_b64_tr_b16 a[148:149], v30 offset:24576
  ds_read_b64_tr_b16 a[150:151], v30 offset:28672
  v_mfma_f32_16x16x32_bf16 v[100:103], a[132:135], a[92:95], v[100:103]
  s_waitcnt lgkmcnt(4)
  v_mfma_f32_16x16x32_bf16 v[104:107], a[136:139], a[80:83], v[104:107]
  ds_read_b64_tr_b16 a[152:153], v31 offset:16384
  ds_read_b64_tr_b16 a[154:155], v31 offset:20480
  v_mfma_f32_16x16x32_bf16 v[104:107], a[140:143], a[88:91], v[104:107]
  buffer_load_dwordx4 a[60:63], v13, s[16:19], s51 offen offset:1024 sc1
  v_mfma_f32_16x16x32_bf16 v[108:111], a[136:139], a[84:87], v[108:111]
  ds_read_b64_tr_b16 a[156:157], v31 offset:24576
  ds_read_b64_tr_b16 a[158:159], v31 offset:28672
  v_mfma_f32_16x16x32_bf16 v[108:111], a[140:143], a[92:95], v[108:111]
  s_add_u32 s51, s51, 262144
  s_waitcnt vmcnt(40) lgkmcnt(4)
  s_barrier
  v_mfma_f32_16x16x32_bf16 v[112:115], a[144:147], a[80:83], v[112:115]
  ds_read_b64_tr_b16 a[128:129], v24 offset:32768
  ds_read_b64_tr_b16 a[130:131], v24 offset:36864
  v_mfma_f32_16x16x32_bf16 v[112:115], a[148:151], a[88:91], v[112:115]
  buffer_load_dwordx4 a[64:67], v12, s[16:19], s51 offen offset:0 sc1
  v_mfma_f32_16x16x32_bf16 v[116:119], a[144:147], a[84:87], v[116:119]
  ds_read_b64_tr_b16 a[132:133], v24 offset:40960
  ds_read_b64_tr_b16 a[134:135], v24 offset:45056
  v_mfma_f32_16x16x32_bf16 v[116:119], a[148:151], a[92:95], v[116:119]
  s_add_u32 m0, s52, 65536
  s_waitcnt lgkmcnt(4)
  v_mfma_f32_16x16x32_bf16 v[120:123], a[152:155], a[80:83], v[120:123]
  ds_read_b64_tr_b16 a[136:137], v25 offset:32768
  ds_read_b64_tr_b16 a[138:139], v25 offset:36864
  v_mfma_f32_16x16x32_bf16 v[120:123], a[156:159], a[88:91], v[120:123]
  buffer_load_dwordx4 a[68:71], v12, s[16:19], s51 offen offset:1024 sc1
  v_mfma_f32_16x16x32_bf16 v[124:127], a[152:155], a[84:87], v[124:127]
  ds_read_b64_tr_b16 a[140:141], v25 offset:40960
  ds_read_b64_tr_b16 a[142:143], v25 offset:45056
  v_mfma_f32_16x16x32_bf16 v[124:127], a[156:159], a[92:95], v[124:127]
  s_waitcnt lgkmcnt(4)
  v_mfma_f32_16x16x32_bf16 v[64:67], a[128:131], a[96:99], v[64:67]
  ds_read_b64_tr_b16 a[144:145], v26 offset:32768
  ds_read_b64_tr_b16 a[146:147], v26 offset:36864
  v_mfma_f32_16x16x32_bf16 v[64:67], a[132:135], a[104:107], v[64:67]
  buffer_load_dwordx4 v56, s[12:15], s50 offen offset:0 lds
  v_mfma_f32_16x16x32_bf16 v[68:71], a[128:131], a[100:103], v[68:71]
  ds_read_b64_tr_b16 a[148:149], v26 offset:40960
  ds_read_b64_tr_b16 a[150:151], v26 offset:45056
  v_mfma_f32_16x16x32_bf16 v[68:71], a[132:135], a[108:111], v[68:71]
  s_waitcnt lgkmcnt(4)
  v_mfma_f32_16x16x32_bf16 v[72:75], a[136:139], a[96:99], v[72:75]
  ds_read_b64_tr_b16 a[152:153], v27 offset:32768
  ds_read_b64_tr_b16 a[154:155], v27 offset:36864
  v_mfma_f32_16x16x32_bf16 v[72:75], a[140:143], a[104:107], v[72:75]
  buffer_load_dwordx4 v57, s[12:15], s50 offen offset:1024 lds
  v_mfma_f32_16x16x32_bf16 v[76:79], a[136:139], a[100:103], v[76:79]
  ds_read_b64_tr_b16 a[156:157], v27 offset:40960
  ds_read_b64_tr_b16 a[158:159], v27 offset:45056
  v_mfma_f32_16x16x32_bf16 v[76:79], a[140:143], a[108:111], v[76:79]
  s_waitcnt lgkmcnt(4)
  v_mfma_f32_16x16x32_bf16 v[80:83], a[144:147], a[96:99], v[80:83]
  ds_read_b64_tr_b16 a[128:129], v28 offset:32768
  ds_read_b64_tr_b16 a[130:131], v28 offset:36864
  v_mfma_f32_16x16x32_bf16 v[80:83], a[148:151], a[104:107], v[80:83]
  buffer_load_dwordx4 v58, s[12:15], s50 offen offset:2048 lds
  v_mfma_f32_16x16x32_bf16 v[84:87], a[144:147], a[100:103], v[84:87]
  ds_read_b64_tr_b16 a[132:133], v28 offset:40960
  ds_read_b64_tr_b16 a[134:135], v28 offset:45056
  v_mfma_f32_16x16x32_bf16 v[84:87], a[148:151], a[108:111], v[84:87]
  s_waitcnt lgkmcnt(4)
  v_mfma_f32_16x16x32_bf16 v[88:91], a[152:155], a[96:99], v[88:91]
  ds_read_b64_tr_b16 a[136:137], v29 offset:32768
  ds_read_b64_tr_b16 a[138:139], v29 offset:36864
  v_mfma_f32_16x16x32_bf16 v[88:91], a[156:159], a[104:107], v[88:91]
  buffer_load_dwordx4 v59, s[12:15], s50 offen offset:3072 lds
  v_mfma_f32_16x16x32_bf16 v[92:95], a[152:155], a[100:103], v[92:95]
  ds_read_b64_tr_b16 a[140:141], v29 offset:40960
  ds_read_b64_tr_b16 a[142:143], v29 offset:45056
  v_mfma_f32_16x16x32_bf16 v[92:95], a[156:159], a[108:111], v[92:95]
  s_add_u32 s50, s50, 131072
  s_waitcnt lgkmcnt(4)
  v_mfma_f32_16x16x32_bf16 v[96:99], a[128:131], a[96:99], v[96:99]
  ds_read_b64_tr_b16 a[144:145], v30 offset:32768
  ds_read_b64_tr_b16 a[146:147], v30 offset:36864
  v_mfma_f32_16x16x32_bf16 v[96:99], a[132:135], a[104:107], v[96:99]
  buffer_load_dwordx4 a[72:75], v13, s[16:19], s51 offen offset:0 sc1
  v_mfma_f32_16x16x32_bf16 v[100:103], a[128:131], a[100:103], v[100:103]
  ds_read_b64_tr_b16 a[148:149], v30 offset:40960
  ds_read_b64_tr_b16 a[150:151], v30 offset:45056
  v_mfma_f32_16x16x32_bf16 v[100:103], a[132:135], a[108:111], v[100:103]
  s_waitcnt lgkmcnt(4)
  v_mfma_f32_16x16x32_bf16 v[104:107], a[136:139], a[96:99], v[104:107]
  ds_read_b64_tr_b16 a[152:153], v31 offset:32768
  ds_read_b64_tr_b16 a[154:155], v31 offset:36864
  v_mfma_f32_16x16x32_bf16 v[104:107], a[140:143], a[104:107], v[104:107]
  buffer_load_dwordx4 a[76:79], v13, s[16:19], s51 offen offset:1024 sc1
  v_mfma_f32_16x16x32_bf16 v[108:111], a[136:139], a[100:103], v[108:111]
  ds_read_b64_tr_b16 a[156:157], v31 offset:40960
  ds_read_b64_tr_b16 a[158:159], v31 offset:45056
  v_mfma_f32_16x16x32_bf16 v[108:111], a[140:143], a[108:111], v[108:111]
  s_add_u32 s51, s51, 262144
  s_sub_u32 s53, s53, 1
  s_cmp_lg_u32 s53, 0
  s_cbranch_scc1 attn_kernel_gloop23
  s_waitcnt vmcnt(40) lgkmcnt(4)
  s_barrier
  v_mfma_f32_16x16x32_bf16 v[112:115], a[144:147], a[96:99], v[112:115]
  ds_read_b64_tr_b16 a[128:129], v24 offset:49152
  ds_read_b64_tr_b16 a[130:131], v24 offset:53248
  v_mfma_f32_16x16x32_bf16 v[112:115], a[148:151], a[104:107], v[112:115]
  buffer_load_dwordx4 a[80:83], v12, s[16:19], s51 offen offset:0 sc1
  v_mfma_f32_16x16x32_bf16 v[116:119], a[144:147], a[100:103], v[116:119]
  ds_read_b64_tr_b16 a[132:133], v24 offset:57344
  ds_read_b64_tr_b16 a[134:135], v24 offset:61440
  v_mfma_f32_16x16x32_bf16 v[116:119], a[148:151], a[108:111], v[116:119]
  s_add_u32 m0, s52, 81920
  s_waitcnt lgkmcnt(4)
  v_mfma_f32_16x16x32_bf16 v[120:123], a[152:155], a[96:99], v[120:123]
  ds_read_b64_tr_b16 a[136:137], v25 offset:49152
  ds_read_b64_tr_b16 a[138:139], v25 offset:53248
  v_mfma_f32_16x16x32_bf16 v[120:123], a[156:159], a[104:107], v[120:123]
  buffer_load_dwordx4 a[84:87], v12, s[16:19], s51 offen offset:1024 sc1
  v_mfma_f32_16x16x32_bf16 v[124:127], a[152:155], a[100:103], v[124:127]
  ds_read_b64_tr_b16 a[140:141], v25 offset:57344
  ds_read_b64_tr_b16 a[142:143], v25 offset:61440
  v_mfma_f32_16x16x32_bf16 v[124:127], a[156:159], a[108:111], v[124:127]
  s_waitcnt lgkmcnt(4)
  v_mfma_f32_16x16x32_bf16 v[64:67], a[128:131], a[112:115], v[64:67]
  ds_read_b64_tr_b16 a[144:145], v26 offset:49152
  ds_read_b64_tr_b16 a[146:147], v26 offset:53248
  v_mfma_f32_16x16x32_bf16 v[64:67], a[132:135], a[120:123], v[64:67]
  buffer_load_dwordx4 v56, s[12:15], s50 offen offset:0 lds
  v_mfma_f32_16x16x32_bf16 v[68:71], a[128:131], a[116:119], v[68:71]
  ds_read_b64_tr_b16 a[148:149], v26 offset:57344
  ds_read_b64_tr_b16 a[150:151], v26 offset:61440
  v_mfma_f32_16x16x32_bf16 v[68:71], a[132:135], a[124:127], v[68:71]
  s_waitcnt lgkmcnt(4)
  v_mfma_f32_16x16x32_bf16 v[72:75], a[136:139], a[112:115], v[72:75]
  ds_read_b64_tr_b16 a[152:153], v27 offset:49152
  ds_read_b64_tr_b16 a[154:155], v27 offset:53248
  v_mfma_f32_16x16x32_bf16 v[72:75], a[140:143], a[120:123], v[72:75]
  buffer_load_dwordx4 v57, s[12:15], s50 offen offset:1024 lds
  v_mfma_f32_16x16x32_bf16 v[76:79], a[136:139], a[116:119], v[76:79]
  ds_read_b64_tr_b16 a[156:157], v27 offset:57344
  ds_read_b64_tr_b16 a[158:159], v27 offset:61440
  v_mfma_f32_16x16x32_bf16 v[76:79], a[140:143], a[124:127], v[76:79]
  s_waitcnt lgkmcnt(4)
  v_mfma_f32_16x16x32_bf16 v[80:83], a[144:147], a[112:115], v[80:83]
  ds_read_b64_tr_b16 a[128:129], v28 offset:49152
  ds_read_b64_tr_b16 a[130:131], v28 offset:53248
  v_mfma_f32_16x16x32_bf16 v[80:83], a[148:151], a[120:123], v[80:83]
  buffer_load_dwordx4 v58, s[12:15], s50 offen offset:2048 lds
  v_mfma_f32_16x16x32_bf16 v[84:87], a[144:147], a[116:119], v[84:87]
  ds_read_b64_tr_b16 a[132:133], v28 offset:57344
  ds_read_b64_tr_b16 a[134:135], v28 offset:61440
  v_mfma_f32_16x16x32_bf16 v[84:87], a[148:151], a[124:127], v[84:87]
  s_waitcnt lgkmcnt(4)
  v_mfma_f32_16x16x32_bf16 v[88:91], a[152:155], a[112:115], v[88:91]
  ds_read_b64_tr_b16 a[136:137], v29 offset:49152
  ds_read_b64_tr_b16 a[138:139], v29 offset:53248
  v_mfma_f32_16x16x32_bf16 v[88:91], a[156:159], a[120:123], v[88:91]
  buffer_load_dwordx4 v59, s[12:15], s50 offen offset:3072 lds
  v_mfma_f32_16x16x32_bf16 v[92:95], a[152:155], a[116:119], v[92:95]
  ds_read_b64_tr_b16 a[140:141], v29 offset:57344
  ds_read_b64_tr_b16 a[142:143], v29 offset:61440
  v_mfma_f32_16x16x32_bf16 v[92:95], a[156:159], a[124:127], v[92:95]
  s_add_u32 s50, s50, 131072
  s_waitcnt lgkmcnt(4)
  v_mfma_f32_16x16x32_bf16 v[96:99], a[128:131], a[112:115], v[96:99]
  ds_read_b64_tr_b16 a[144:145], v30 offset:49152
  ds_read_b64_tr_b16 a[146:147], v30 offset:53248
  v_mfma_f32_16x16x32_bf16 v[96:99], a[132:135], a[120:123], v[96:99]
  buffer_load_dwordx4 a[88:91], v13, s[16:19], s51 offen offset:0 sc1
  v_mfma_f32_16x16x32_bf16 v[100:103], a[128:131], a[116:119], v[100:103]
  ds_read_b64_tr_b16 a[148:149], v30 offset:57344
  ds_read_b64_tr_b16 a[150:151], v30 offset:61440
  v_mfma_f32_16x16x32_bf16 v[100:103], a[132:135], a[124:127], v[100:103]
  s_waitcnt lgkmcnt(4)
  v_mfma_f32_16x16x32_bf16 v[104:107], a[136:139], a[112:115], v[104:107]
  ds_read_b64_tr_b16 a[152:153], v31 offset:49152
  ds_read_b64_tr_b16 a[154:155], v31 offset:53248
  v_mfma_f32_16x16x32_bf16 v[104:107], a[140:143], a[120:123], v[104:107]
  buffer_load_dwordx4 a[92:95], v13, s[16:19], s51 offen offset:1024 sc1
  v_mfma_f32_16x16x32_bf16 v[108:111], a[136:139], a[116:119], v[108:111]
  ds_read_b64_tr_b16 a[156:157], v31 offset:57344
  ds_read_b64_tr_b16 a[158:159], v31 offset:61440
  v_mfma_f32_16x16x32_bf16 v[108:111], a[140:143], a[124:127], v[108:111]
  s_add_u32 s51, s51, 262144
  s_waitcnt vmcnt(40) lgkmcnt(4)
  s_barrier
  v_mfma_f32_16x16x32_bf16 v[112:115], a[144:147], a[112:115], v[112:115]
  ds_read_b64_tr_b16 a[128:129], v16 offset:0
  ds_read_b64_tr_b16 a[130:131], v16 offset:4096
  v_mfma_f32_16x16x32_bf16 v[112:115], a[148:151], a[120:123], v[112:115]
  buffer_load_dwordx4 a[96:99], v12, s[16:19], s51 offen offset:0 sc1
  v_mfma_f32_16x16x32_bf16 v[116:119], a[144:147], a[116:119], v[116:119]
  ds_read_b64_tr_b16 a[132:133], v16 offset:8192
  ds_read_b64_tr_b16 a[134:135], v16 offset:12288
  v_mfma_f32_16x16x32_bf16 v[116:119], a[148:151], a[124:127], v[116:119]
  s_add_u32 m0, s52, 98304
  s_waitcnt lgkmcnt(4)
  v_mfma_f32_16x16x32_bf16 v[120:123], a[152:155], a[112:115], v[120:123]
  ds_read_b64_tr_b16 a[136:137], v17 offset:0
  ds_read_b64_tr_b16 a[138:139], v17 offset:4096
  v_mfma_f32_16x16x32_bf16 v[120:123], a[156:159], a[120:123], v[120:123]
  buffer_load_dwordx4 a[100:103], v12, s[16:19], s51 offen offset:1024 sc1
  v_mfma_f32_16x16x32_bf16 v[124:127], a[152:155], a[116:119], v[124:127]
  ds_read_b64_tr_b16 a[140:141], v17 offset:8192
  ds_read_b64_tr_b16 a[142:143], v17 offset:12288
  v_mfma_f32_16x16x32_bf16 v[124:127], a[156:159], a[124:127], v[124:127]
  s_waitcnt lgkmcnt(4)
  v_mfma_f32_16x16x32_bf16 v[64:67], a[128:131], a[0:3], v[64:67]
  ds_read_b64_tr_b16 a[144:145], v18 offset:0
  ds_read_b64_tr_b16 a[146:147], v18 offset:4096
  v_mfma_f32_16x16x32_bf16 v[64:67], a[132:135], a[8:11], v[64:67]
  buffer_load_dwordx4 v56, s[12:15], s50 offen offset:0 lds
  v_mfma_f32_16x16x32_bf16 v[68:71], a[128:131], a[4:7], v[68:71]
  ds_read_b64_tr_b16 a[148:149], v18 offset:8192
  ds_read_b64_tr_b16 a[150:151], v18 offset:12288
  v_mfma_f32_16x16x32_bf16 v[68:71], a[132:135], a[12:15], v[68:71]
  s_waitcnt lgkmcnt(4)
  v_mfma_f32_16x16x32_bf16 v[72:75], a[136:139], a[0:3], v[72:75]
  ds_read_b64_tr_b16 a[152:153], v19 offset:0
  ds_read_b64_tr_b16 a[154:155], v19 offset:4096
  v_mfma_f32_16x16x32_bf16 v[72:75], a[140:143], a[8:11], v[72:75]
  buffer_load_dwordx4 v57, s[12:15], s50 offen offset:1024 lds
  v_mfma_f32_16x16x32_bf16 v[76:79], a[136:139], a[4:7], v[76:79]
  ds_read_b64_tr_b16 a[156:157], v19 offset:8192
  ds_read_b64_tr_b16 a[158:159], v19 offset:12288
  v_mfma_f32_16x16x32_bf16 v[76:79], a[140:143], a[12:15], v[76:79]
  s_waitcnt lgkmcnt(4)
  v_mfma_f32_16x16x32_bf16 v[80:83], a[144:147], a[0:3], v[80:83]
  ds_read_b64_tr_b16 a[128:129], v20 offset:0
  ds_read_b64_tr_b16 a[130:131], v20 offset:4096
  v_mfma_f32_16x16x32_bf16 v[80:83], a[148:151], a[8:11], v[80:83]
  buffer_load_dwordx4 v58, s[12:15], s50 offen offset:2048 lds
  v_mfma_f32_16x16x32_bf16 v[84:87], a[144:147], a[4:7], v[84:87]
  ds_read_b64_tr_b16 a[132:133], v20 offset:8192
  ds_read_b64_tr_b16 a[134:135], v20 offset:12288
  v_mfma_f32_16x16x32_bf16 v[84:87], a[148:151], a[12:15], v[84:87]
  s_waitcnt lgkmcnt(4)
  v_mfma_f32_16x16x32_bf16 v[88:91], a[152:155], a[0:3], v[88:91]
  ds_read_b64_tr_b16 a[136:137], v21 offset:0
  ds_read_b64_tr_b16 a[138:139], v21 offset:4096
  v_mfma_f32_16x16x32_bf16 v[88:91], a[156:159], a[8:11], v[88:91]
  buffer_load_dwordx4 v59, s[12:15], s50 offen offset:3072 lds
  v_mfma_f32_16x16x32_bf16 v[92:95], a[152:155], a[4:7], v[92:95]
  ds_read_b64_tr_b16 a[140:141], v21 offset:8192
  ds_read_b64_tr_b16 a[142:143], v21 offset:12288
  v_mfma_f32_16x16x32_bf16 v[92:95], a[156:159], a[12:15], v[92:95]
  s_add_u32 s50, s50, 131072
  s_waitcnt lgkmcnt(4)
  v_mfma_f32_16x16x32_bf16 v[96:99], a[128:131], a[0:3], v[96:99]
  ds_read_b64_tr_b16 a[144:145], v22 offset:0
  ds_read_b64_tr_b16 a[146:147], v22 offset:4096
  v_mfma_f32_16x16x32_bf16 v[96:99], a[132:135], a[8:11], v[96:99]
  buffer_load_dwordx4 a[104:107], v13, s[16:19], s51 offen offset:0 sc1
  v_mfma_f32_16x16x32_bf16 v[100:103], a[128:131], a[4:7], v[100:103]
  ds_read_b64_tr_b16 a[148:149], v22 offset:8192
  ds_read_b64_tr_b16 a[150:151], v22 offset:12288
  v_mfma_f32_16x16x32_bf16 v[100:103], a[132:135], a[12:15], v[100:103]
  s_waitcnt lgkmcnt(4)
  v_mfma_f32_16x16x32_bf16 v[104:107], a[136:139], a[0:3], v[104:107]
  ds_read_b64_tr_b16 a[152:153], v23 offset:0
  ds_read_b64_tr_b16 a[154:155], v23 offset:4096
  v_mfma_f32_16x16x32_bf16 v[104:107], a[140:143], a[8:11], v[104:107]
  buffer_load_dwordx4 a[108:111], v13, s[16:19], s51 offen offset:1024 sc1
  v_mfma_f32_16x16x32_bf16 v[108:111], a[136:139], a[4:7], v[108:111]
  ds_read_b64_tr_b16 a[156:157], v23 offset:8192
  ds_read_b64_tr_b16 a[158:159], v23 offset:12288
  v_mfma_f32_16x16x32_bf16 v[108:111], a[140:143], a[12:15], v[108:111]
  s_add_u32 s51, s51, 262144
  s_waitcnt vmcnt(40) lgkmcnt(4)
  s_barrier
  v_mfma_f32_16x16x32_bf16 v[112:115], a[144:147], a[0:3], v[112:115]
  ds_read_b64_tr_b16 a[128:129], v16 offset:16384
  ds_read_b64_tr_b16 a[130:131], v16 offset:20480
  v_mfma_f32_16x16x32_bf16 v[112:115], a[148:151], a[8:11], v[112:115]
  buffer_load_dwordx4 a[112:115], v12, s[16:19], s51 offen offset:0 sc1
  v_mfma_f32_16x16x32_bf16 v[116:119], a[144:147], a[4:7], v[116:119]
  ds_read_b64_tr_b16 a[132:133], v16 offset:24576
  ds_read_b64_tr_b16 a[134:135], v16 offset:28672
  v_mfma_f32_16x16x32_bf16 v[116:119], a[148:151], a[12:15], v[116:119]
  s_add_u32 m0, s52, 114688
  s_waitcnt lgkmcnt(4)
  v_mfma_f32_16x16x32_bf16 v[120:123], a[152:155], a[0:3], v[120:123]
  ds_read_b64_tr_b16 a[136:137], v17 offset:16384
  ds_read_b64_tr_b16 a[138:139], v17 offset:20480
  v_mfma_f32_16x16x32_bf16 v[120:123], a[156:159], a[8:11], v[120:123]
  buffer_load_dwordx4 a[116:119], v12, s[16:19], s51 offen offset:1024 sc1
  v_mfma_f32_16x16x32_bf16 v[124:127], a[152:155], a[4:7], v[124:127]
  ds_read_b64_tr_b16 a[140:141], v17 offset:24576
  ds_read_b64_tr_b16 a[142:143], v17 offset:28672
  v_mfma_f32_16x16x32_bf16 v[124:127], a[156:159], a[12:15], v[124:127]
  s_waitcnt lgkmcnt(4)
  v_mfma_f32_16x16x32_bf16 v[64:67], a[128:131], a[16:19], v[64:67]
  ds_read_b64_tr_b16 a[144:145], v18 offset:16384
  ds_read_b64_tr_b16 a[146:147], v18 offset:20480
  v_mfma_f32_16x16x32_bf16 v[64:67], a[132:135], a[24:27], v[64:67]
  buffer_load_dwordx4 v56, s[12:15], s50 offen offset:0 lds
  v_mfma_f32_16x16x32_bf16 v[68:71], a[128:131], a[20:23], v[68:71]
  ds_read_b64_tr_b16 a[148:149], v18 offset:24576
  ds_read_b64_tr_b16 a[150:151], v18 offset:28672
  v_mfma_f32_16x16x32_bf16 v[68:71], a[132:135], a[28:31], v[68:71]
  s_waitcnt lgkmcnt(4)
  v_mfma_f32_16x16x32_bf16 v[72:75], a[136:139], a[16:19], v[72:75]
  ds_read_b64_tr_b16 a[152:153], v19 offset:16384
  ds_read_b64_tr_b16 a[154:155], v19 offset:20480
  v_mfma_f32_16x16x32_bf16 v[72:75], a[140:143], a[24:27], v[72:75]
  buffer_load_dwordx4 v57, s[12:15], s50 offen offset:1024 lds
  v_mfma_f32_16x16x32_bf16 v[76:79], a[136:139], a[20:23], v[76:79]
  ds_read_b64_tr_b16 a[156:157], v19 offset:24576
  ds_read_b64_tr_b16 a[158:159], v19 offset:28672
  v_mfma_f32_16x16x32_bf16 v[76:79], a[140:143], a[28:31], v[76:79]
  s_waitcnt lgkmcnt(4)
  v_mfma_f32_16x16x32_bf16 v[80:83], a[144:147], a[16:19], v[80:83]
  ds_read_b64_tr_b16 a[128:129], v20 offset:16384
  ds_read_b64_tr_b16 a[130:131], v20 offset:20480
  v_mfma_f32_16x16x32_bf16 v[80:83], a[148:151], a[24:27], v[80:83]
  buffer_load_dwordx4 v58, s[12:15], s50 offen offset:2048 lds
  v_mfma_f32_16x16x32_bf16 v[84:87], a[144:147], a[20:23], v[84:87]
  ds_read_b64_tr_b16 a[132:133], v20 offset:24576
  ds_read_b64_tr_b16 a[134:135], v20 offset:28672
  v_mfma_f32_16x16x32_bf16 v[84:87], a[148:151], a[28:31], v[84:87]
  s_waitcnt lgkmcnt(4)
  v_mfma_f32_16x16x32_bf16 v[88:91], a[152:155], a[16:19], v[88:91]
  ds_read_b64_tr_b16 a[136:137], v21 offset:16384
  ds_read_b64_tr_b16 a[138:139], v21 offset:20480
  v_mfma_f32_16x16x32_bf16 v[88:91], a[156:159], a[24:27], v[88:91]
  buffer_load_dwordx4 v59, s[12:15], s50 offen offset:3072 lds
  v_mfma_f32_16x16x32_bf16 v[92:95], a[152:155], a[20:23], v[92:95]
  ds_read_b64_tr_b16 a[140:141], v21 offset:24576
  ds_read_b64_tr_b16 a[142:143], v21 offset:28672
  v_mfma_f32_16x16x32_bf16 v[92:95], a[156:159], a[28:31], v[92:95]
  s_add_u32 s50, s50, 131072
  s_waitcnt lgkmcnt(4)
  v_mfma_f32_16x16x32_bf16 v[96:99], a[128:131], a[16:19], v[96:99]
  ds_read_b64_tr_b16 a[144:145], v22 offset:16384
  ds_read_b64_tr_b16 a[146:147], v22 offset:20480
  v_mfma_f32_16x16x32_bf16 v[96:99], a[132:135], a[24:27], v[96:99]
  buffer_load_dwordx4 a[120:123], v13, s[16:19], s51 offen offset:0 sc1
  v_mfma_f32_16x16x32_bf16 v[100:103], a[128:131], a[20:23], v[100:103]
  ds_read_b64_tr_b16 a[148:149], v22 offset:24576
  ds_read_b64_tr_b16 a[150:151], v22 offset:28672
  v_mfma_f32_16x16x32_bf16 v[100:103], a[132:135], a[28:31], v[100:103]
  s_waitcnt lgkmcnt(4)
  v_mfma_f32_16x16x32_bf16 v[104:107], a[136:139], a[16:19], v[104:107]
  ds_read_b64_tr_b16 a[152:153], v23 offset:16384
  ds_read_b64_tr_b16 a[154:155], v23 offset:20480
  v_mfma_f32_16x16x32_bf16 v[104:107], a[140:143], a[24:27], v[104:107]
  buffer_load_dwordx4 a[124:127], v13, s[16:19], s51 offen offset:1024 sc1
  v_mfma_f32_16x16x32_bf16 v[108:111], a[136:139], a[20:23], v[108:111]
  ds_read_b64_tr_b16 a[156:157], v23 offset:24576
  ds_read_b64_tr_b16 a[158:159], v23 offset:28672
  v_mfma_f32_16x16x32_bf16 v[108:111], a[140:143], a[28:31], v[108:111]
  s_add_u32 s51, s51, 262144
  s_waitcnt vmcnt(40) lgkmcnt(4)
  s_barrier
  v_mfma_f32_16x16x32_bf16 v[112:115], a[144:147], a[16:19], v[112:115]
  ds_read_b64_tr_b16 a[128:129], v16 offset:32768
  ds_read_b64_tr_b16 a[130:131], v16 offset:36864
  v_mfma_f32_16x16x32_bf16 v[112:115], a[148:151], a[24:27], v[112:115]
  buffer_load_dwordx4 v[48:51], v52, s[32:35], s55 offen
  v_mfma_f32_16x16x32_bf16 v[116:119], a[144:147], a[20:23], v[116:119]
  ds_read_b64_tr_b16 a[132:133], v16 offset:40960
  ds_read_b64_tr_b16 a[134:135], v16 offset:45056
  v_mfma_f32_16x16x32_bf16 v[116:119], a[148:151], a[28:31], v[116:119]
  s_waitcnt lgkmcnt(4)
  v_mfma_f32_16x16x32_bf16 v[120:123], a[152:155], a[16:19], v[120:123]
  ds_read_b64_tr_b16 a[136:137], v17 offset:32768
  ds_read_b64_tr_b16 a[138:139], v17 offset:36864
  v_mfma_f32_16x16x32_bf16 v[120:123], a[156:159], a[24:27], v[120:123]
  v_mfma_f32_16x16x32_bf16 v[124:127], a[152:155], a[20:23], v[124:127]
  ds_read_b64_tr_b16 a[140:141], v17 offset:40960
  ds_read_b64_tr_b16 a[142:143], v17 offset:45056
  v_mfma_f32_16x16x32_bf16 v[124:127], a[156:159], a[28:31], v[124:127]
  s_waitcnt lgkmcnt(4)
  v_mfma_f32_16x16x32_bf16 v[64:67], a[128:131], a[32:35], v[64:67]
  ds_read_b64_tr_b16 a[144:145], v18 offset:32768
  ds_read_b64_tr_b16 a[146:147], v18 offset:36864
  v_mfma_f32_16x16x32_bf16 v[64:67], a[132:135], a[40:43], v[64:67]
  v_mfma_f32_16x16x32_bf16 v[68:71], a[128:131], a[36:39], v[68:71]
  ds_read_b64_tr_b16 a[148:149], v18 offset:40960
  ds_read_b64_tr_b16 a[150:151], v18 offset:45056
  v_mfma_f32_16x16x32_bf16 v[68:71], a[132:135], a[44:47], v[68:71]
  s_waitcnt lgkmcnt(4)
  v_mfma_f32_16x16x32_bf16 v[72:75], a[136:139], a[32:35], v[72:75]
  ds_read_b64_tr_b16 a[152:153], v19 offset:32768
  ds_read_b64_tr_b16 a[154:155], v19 offset:36864
  v_mfma_f32_16x16x32_bf16 v[72:75], a[140:143], a[40:43], v[72:75]
  v_mfma_f32_16x16x32_bf16 v[76:79], a[136:139], a[36:39], v[76:79]
  ds_read_b64_tr_b16 a[156:157], v19 offset:40960
  ds_read_b64_tr_b16 a[158:159], v19 offset:45056
  v_mfma_f32_16x16x32_bf16 v[76:79], a[140:143], a[44:47], v[76:79]
  s_waitcnt lgkmcnt(4)
  v_mfma_f32_16x16x32_bf16 v[80:83], a[144:147], a[32:35], v[80:83]
  ds_read_b64_tr_b16 a[128:129], v20 offset:32768
  ds_read_b64_tr_b16 a[130:131], v20 offset:36864
  v_mfma_f32_16x16x32_bf16 v[80:83], a[148:151], a[40:43], v[80:83]
  buffer_load_dwordx4 v[48:51], v52, s[72:75], 0 offen
  v_mfma_f32_16x16x32_bf16 v[84:87], a[144:147], a[36:39], v[84:87]
  ds_read_b64_tr_b16 a[132:133], v20 offset:40960
  ds_read_b64_tr_b16 a[134:135], v20 offset:45056
  v_mfma_f32_16x16x32_bf16 v[84:87], a[148:151], a[44:47], v[84:87]
  s_waitcnt lgkmcnt(4)
  v_mfma_f32_16x16x32_bf16 v[88:91], a[152:155], a[32:35], v[88:91]
  ds_read_b64_tr_b16 a[136:137], v21 offset:32768
  ds_read_b64_tr_b16 a[138:139], v21 offset:36864
  v_mfma_f32_16x16x32_bf16 v[88:91], a[156:159], a[40:43], v[88:91]
  v_mfma_f32_16x16x32_bf16 v[92:95], a[152:155], a[36:39], v[92:95]
  ds_read_b64_tr_b16 a[140:141], v21 offset:40960
  ds_read_b64_tr_b16 a[142:143], v21 offset:45056
  v_mfma_f32_16x16x32_bf16 v[92:95], a[156:159], a[44:47], v[92:95]
  s_waitcnt lgkmcnt(4)
  v_mfma_f32_16x16x32_bf16 v[96:99], a[128:131], a[32:35], v[96:99]
  ds_read_b64_tr_b16 a[144:145], v22 offset:32768
  ds_read_b64_tr_b16 a[146:147], v22 offset:36864
  v_mfma_f32_16x16x32_bf16 v[96:99], a[132:135], a[40:43], v[96:99]
  v_mfma_f32_16x16x32_bf16 v[100:103], a[128:131], a[36:39], v[100:103]
  ds_read_b64_tr_b16 a[148:149], v22 offset:40960
  ds_read_b64_tr_b16 a[150:151], v22 offset:45056
  v_mfma_f32_16x16x32_bf16 v[100:103], a[132:135], a[44:47], v[100:103]
  s_waitcnt lgkmcnt(4)
  v_mfma_f32_16x16x32_bf16 v[104:107], a[136:139], a[32:35], v[104:107]
  ds_read_b64_tr_b16 a[152:153], v23 offset:32768
  ds_read_b64_tr_b16 a[154:155], v23 offset:36864
  v_mfma_f32_16x16x32_bf16 v[104:107], a[140:143], a[40:43], v[104:107]
  v_mfma_f32_16x16x32_bf16 v[108:111], a[136:139], a[36:39], v[108:111]
  ds_read_b64_tr_b16 a[156:157], v23 offset:40960
  ds_read_b64_tr_b16 a[158:159], v23 offset:45056
  v_mfma_f32_16x16x32_bf16 v[108:111], a[140:143], a[44:47], v[108:111]
  s_waitcnt vmcnt(34) lgkmcnt(4)
  s_barrier
  v_mfma_f32_16x16x32_bf16 v[112:115], a[144:147], a[32:35], v[112:115]
  ds_read_b64_tr_b16 a[128:129], v16 offset:49152
  ds_read_b64_tr_b16 a[130:131], v16 offset:53248
  v_mfma_f32_16x16x32_bf16 v[112:115], a[148:151], a[40:43], v[112:115]
  buffer_load_dwordx4 v[128:131], v8, s[28:31], s54 offen offset:0
  v_mfma_f32_16x16x32_bf16 v[116:119], a[144:147], a[36:39], v[116:119]
  ds_read_b64_tr_b16 a[132:133], v16 offset:57344
  ds_read_b64_tr_b16 a[134:135], v16 offset:61440
  v_mfma_f32_16x16x32_bf16 v[116:119], a[148:151], a[44:47], v[116:119]
  s_waitcnt lgkmcnt(4)
  v_mfma_f32_16x16x32_bf16 v[120:123], a[152:155], a[32:35], v[120:123]
  ds_read_b64_tr_b16 a[136:137], v17 offset:49152
  ds_read_b64_tr_b16 a[138:139], v17 offset:53248
  v_mfma_f32_16x16x32_bf16 v[120:123], a[156:159], a[40:43], v[120:123]
  v_mfma_f32_16x16x32_bf16 v[124:127], a[152:155], a[36:39], v[124:127]
  ds_read_b64_tr_b16 a[140:141], v17 offset:57344
  ds_read_b64_tr_b16 a[142:143], v17 offset:61440
  v_mfma_f32_16x16x32_bf16 v[124:127], a[156:159], a[44:47], v[124:127]
  s_waitcnt lgkmcnt(4)
  v_mfma_f32_16x16x32_bf16 v[64:67], a[128:131], a[48:51], v[64:67]
  ds_read_b64_tr_b16 a[144:145], v18 offset:49152
  ds_read_b64_tr_b16 a[146:147], v18 offset:53248
  v_mfma_f32_16x16x32_bf16 v[64:67], a[132:135], a[56:59], v[64:67]
  buffer_load_dwordx4 v[132:135], v8, s[28:31], s54 offen offset:1024
  v_mfma_f32_16x16x32_bf16 v[68:71], a[128:131], a[52:55], v[68:71]
  ds_read_b64_tr_b16 a[148:149], v18 offset:57344
  ds_read_b64_tr_b16 a[150:151], v18 offset:61440
  v_mfma_f32_16x16x32_bf16 v[68:71], a[132:135], a[60:63], v[68:71]
  s_waitcnt lgkmcnt(4)
  v_mfma_f32_16x16x32_bf16 v[72:75], a[136:139], a[48:51], v[72:75]
  ds_read_b64_tr_b16 a[152:153], v19 offset:49152
  ds_read_b64_tr_b16 a[154:155], v19 offset:53248
  v_mfma_f32_16x16x32_bf16 v[72:75], a[140:143], a[56:59], v[72:75]
  v_mfma_f32_16x16x32_bf16 v[76:79], a[136:139], a[52:55], v[76:79]
  ds_read_b64_tr_b16 a[156:157], v19 offset:57344
  ds_read_b64_tr_b16 a[158:159], v19 offset:61440
  v_mfma_f32_16x16x32_bf16 v[76:79], a[140:143], a[60:63], v[76:79]
  s_waitcnt lgkmcnt(4)
  v_mfma_f32_16x16x32_bf16 v[80:83], a[144:147], a[48:51], v[80:83]
  ds_read_b64_tr_b16 a[128:129], v20 offset:49152
  ds_read_b64_tr_b16 a[130:131], v20 offset:53248
  v_mfma_f32_16x16x32_bf16 v[80:83], a[148:151], a[56:59], v[80:83]
  buffer_load_dwordx4 v[136:139], v8, s[28:31], s54 offen offset:2048
  v_mfma_f32_16x16x32_bf16 v[84:87], a[144:147], a[52:55], v[84:87]
  ds_read_b64_tr_b16 a[132:133], v20 offset:57344
  ds_read_b64_tr_b16 a[134:135], v20 offset:61440
  v_mfma_f32_16x16x32_bf16 v[84:87], a[148:151], a[60:63], v[84:87]
  s_waitcnt lgkmcnt(4)
  v_mfma_f32_16x16x32_bf16 v[88:91], a[152:155], a[48:51], v[88:91]
  ds_read_b64_tr_b16 a[136:137], v21 offset:49152
  ds_read_b64_tr_b16 a[138:139], v21 offset:53248
  v_mfma_f32_16x16x32_bf16 v[88:91], a[156:159], a[56:59], v[88:91]
  v_mfma_f32_16x16x32_bf16 v[92:95], a[152:155], a[52:55], v[92:95]
  ds_read_b64_tr_b16 a[140:141], v21 offset:57344
  ds_read_b64_tr_b16 a[142:143], v21 offset:61440
  v_mfma_f32_16x16x32_bf16 v[92:95], a[156:159], a[60:63], v[92:95]
  s_waitcnt lgkmcnt(4)
  v_mfma_f32_16x16x32_bf16 v[96:99], a[128:131], a[48:51], v[96:99]
  ds_read_b64_tr_b16 a[144:145], v22 offset:49152
  ds_read_b64_tr_b16 a[146:147], v22 offset:53248
  v_mfma_f32_16x16x32_bf16 v[96:99], a[132:135], a[56:59], v[96:99]
  buffer_load_dwordx4 v[140:143], v8, s[28:31], s54 offen offset:3072
  v_mfma_f32_16x16x32_bf16 v[100:103], a[128:131], a[52:55], v[100:103]
  ds_read_b64_tr_b16 a[148:149], v22 offset:57344
  ds_read_b64_tr_b16 a[150:151], v22 offset:61440
  v_mfma_f32_16x16x32_bf16 v[100:103], a[132:135], a[60:63], v[100:103]
  s_waitcnt lgkmcnt(4)
  v_mfma_f32_16x16x32_bf16 v[104:107], a[136:139], a[48:51], v[104:107]
  ds_read_b64_tr_b16 a[152:153], v23 offset:49152
  ds_read_b64_tr_b16 a[154:155], v23 offset:53248
  v_mfma_f32_16x16x32_bf16 v[104:107], a[140:143], a[56:59], v[104:107]
  v_mfma_f32_16x16x32_bf16 v[108:111], a[136:139], a[52:55], v[108:111]
  ds_read_b64_tr_b16 a[156:157], v23 offset:57344
  ds_read_b64_tr_b16 a[158:159], v23 offset:61440
  v_mfma_f32_16x16x32_bf16 v[108:111], a[140:143], a[60:63], v[108:111]
  s_waitcnt vmcnt(30) lgkmcnt(4)
  s_barrier
  v_mfma_f32_16x16x32_bf16 v[112:115], a[144:147], a[48:51], v[112:115]
  ds_read_b64_tr_b16 a[128:129], v24 offset:0
  ds_read_b64_tr_b16 a[130:131], v24 offset:4096
  v_mfma_f32_16x16x32_bf16 v[112:115], a[148:151], a[56:59], v[112:115]
  s_mov_b32 s63, 65536
  s_mov_b32 s62, 73728
  v_mfma_f32_16x16x32_bf16 v[116:119], a[144:147], a[52:55], v[116:119]
  ds_read_b64_tr_b16 a[132:133], v24 offset:8192
  ds_read_b64_tr_b16 a[134:135], v24 offset:12288
  v_mfma_f32_16x16x32_bf16 v[116:119], a[148:151], a[60:63], v[116:119]
  s_waitcnt lgkmcnt(4)
  v_mfma_f32_16x16x32_bf16 v[120:123], a[152:155], a[48:51], v[120:123]
  ds_read_b64_tr_b16 a[136:137], v25 offset:0
  ds_read_b64_tr_b16 a[138:139], v25 offset:4096
  v_mfma_f32_16x16x32_bf16 v[120:123], a[156:159], a[56:59], v[120:123]
  buffer_load_dword v60, v53, s[68:71], s63 offen sc1
  v_mfma_f32_16x16x32_bf16 v[124:127], a[152:155], a[52:55], v[124:127]
  ds_read_b64_tr_b16 a[140:141], v25 offset:8192
  ds_read_b64_tr_b16 a[142:143], v25 offset:12288
  v_mfma_f32_16x16x32_bf16 v[124:127], a[156:159], a[60:63], v[124:127]
  s_waitcnt lgkmcnt(4)
  v_mfma_f32_16x16x32_bf16 v[64:67], a[128:131], a[64:67], v[64:67]
  ds_read_b64_tr_b16 a[144:145], v26 offset:0
  ds_read_b64_tr_b16 a[146:147], v26 offset:4096
  v_mfma_f32_16x16x32_bf16 v[64:67], a[132:135], a[72:75], v[64:67]
  buffer_load_dword v61, v53, s[68:71], s62 offen sc1
  v_mfma_f32_16x16x32_bf16 v[68:71], a[128:131], a[68:71], v[68:71]
  ds_read_b64_tr_b16 a[148:149], v26 offset:8192
  ds_read_b64_tr_b16 a[150:151], v26 offset:12288
  v_mfma_f32_16x16x32_bf16 v[68:71], a[132:135], a[76:79], v[68:71]
  s_waitcnt lgkmcnt(4)
  v_mfma_f32_16x16x32_bf16 v[72:75], a[136:139], a[64:67], v[72:75]
  ds_read_b64_tr_b16 a[152:153], v27 offset:0
  ds_read_b64_tr_b16 a[154:155], v27 offset:4096
  v_mfma_f32_16x16x32_bf16 v[72:75], a[140:143], a[72:75], v[72:75]
  v_mfma_f32_16x16x32_bf16 v[76:79], a[136:139], a[68:71], v[76:79]
  ds_read_b64_tr_b16 a[156:157], v27 offset:8192
  ds_read_b64_tr_b16 a[158:159], v27 offset:12288
  v_mfma_f32_16x16x32_bf16 v[76:79], a[140:143], a[76:79], v[76:79]
  s_waitcnt lgkmcnt(4)
  v_mfma_f32_16x16x32_bf16 v[80:83], a[144:147], a[64:67], v[80:83]
  ds_read_b64_tr_b16 a[128:129], v28 offset:0
  ds_read_b64_tr_b16 a[130:131], v28 offset:4096
  v_mfma_f32_16x16x32_bf16 v[80:83], a[148:151], a[72:75], v[80:83]
  buffer_load_dword v62, v54, s[68:71], s63 offen sc1
  v_mfma_f32_16x16x32_bf16 v[84:87], a[144:147], a[68:71], v[84:87]
  ds_read_b64_tr_b16 a[132:133], v28 offset:8192
  ds_read_b64_tr_b16 a[134:135], v28 offset:12288
  v_mfma_f32_16x16x32_bf16 v[84:87], a[148:151], a[76:79], v[84:87]
  s_waitcnt lgkmcnt(4)
  v_mfma_f32_16x16x32_bf16 v[88:91], a[152:155], a[64:67], v[88:91]
  ds_read_b64_tr_b16 a[136:137], v29 offset:0
  ds_read_b64_tr_b16 a[138:139], v29 offset:4096
  v_mfma_f32_16x16x32_bf16 v[88:91], a[156:159], a[72:75], v[88:91]
  v_mfma_f32_16x16x32_bf16 v[92:95], a[152:155], a[68:71], v[92:95]
  ds_read_b64_tr_b16 a[140:141], v29 offset:8192
  ds_read_b64_tr_b16 a[142:143], v29 offset:12288
  v_mfma_f32_16x16x32_bf16 v[92:95], a[156:159], a[76:79], v[92:95]
  s_waitcnt lgkmcnt(4)
  v_mfma_f32_16x16x32_bf16 v[96:99], a[128:131], a[64:67], v[96:99]
  ds_read_b64_tr_b16 a[144:145], v30 offset:0
  ds_read_b64_tr_b16 a[146:147], v30 offset:4096
  v_mfma_f32_16x16x32_bf16 v[96:99], a[132:135], a[72:75], v[96:99]
  buffer_load_dword v63, v54, s[68:71], s62 offen sc1
  v_mfma_f32_16x16x32_bf16 v[100:103], a[128:131], a[68:71], v[100:103]
  ds_read_b64_tr_b16 a[148:149], v30 offset:8192
  ds_read_b64_tr_b16 a[150:151], v30 offset:12288
  v_mfma_f32_16x16x32_bf16 v[100:103], a[132:135], a[76:79], v[100:103]
  s_waitcnt lgkmcnt(4)
  v_mfma_f32_16x16x32_bf16 v[104:107], a[136:139], a[64:67], v[104:107]
  ds_read_b64_tr_b16 a[152:153], v31 offset:0
  ds_read_b64_tr_b16 a[154:155], v31 offset:4096
  v_mfma_f32_16x16x32_bf16 v[104:107], a[140:143], a[72:75], v[104:107]
  v_mfma_f32_16x16x32_bf16 v[108:111], a[136:139], a[68:71], v[108:111]
  ds_read_b64_tr_b16 a[156:157], v31 offset:8192
  ds_read_b64_tr_b16 a[158:159], v31 offset:12288
  v_mfma_f32_16x16x32_bf16 v[108:111], a[140:143], a[76:79], v[108:111]
  s_waitcnt vmcnt(26) lgkmcnt(4)
  s_barrier
  v_mfma_f32_16x16x32_bf16 v[112:115], a[144:147], a[64:67], v[112:115]
  ds_read_b64_tr_b16 a[128:129], v24 offset:16384
  ds_read_b64_tr_b16 a[130:131], v24 offset:20480
  v_mfma_f32_16x16x32_bf16 v[112:115], a[148:151], a[72:75], v[112:115]
  s_add_u32 m0, s41, 131072
  s_nop 0
  v_mfma_f32_16x16x32_bf16 v[116:119], a[144:147], a[68:71], v[116:119]
  ds_read_b64_tr_b16 a[132:133], v24 offset:24576
  ds_read_b64_tr_b16 a[134:135], v24 offset:28672
  v_mfma_f32_16x16x32_bf16 v[116:119], a[148:151], a[76:79], v[116:119]
  s_waitcnt lgkmcnt(4)
  v_mfma_f32_16x16x32_bf16 v[120:123], a[152:155], a[64:67], v[120:123]
  ds_read_b64_tr_b16 a[136:137], v25 offset:16384
  ds_read_b64_tr_b16 a[138:139], v25 offset:20480
  v_mfma_f32_16x16x32_bf16 v[120:123], a[156:159], a[72:75], v[120:123]
  buffer_load_dwordx4 v3, s[20:23], s41 offen offset:0 sc1 lds
  v_mfma_f32_16x16x32_bf16 v[124:127], a[152:155], a[68:71], v[124:127]
  ds_read_b64_tr_b16 a[140:141], v25 offset:24576
  ds_read_b64_tr_b16 a[142:143], v25 offset:28672
  v_mfma_f32_16x16x32_bf16 v[124:127], a[156:159], a[76:79], v[124:127]
  s_waitcnt lgkmcnt(4)
  v_mfma_f32_16x16x32_bf16 v[64:67], a[128:131], a[80:83], v[64:67]
  ds_read_b64_tr_b16 a[144:145], v26 offset:16384
  ds_read_b64_tr_b16 a[146:147], v26 offset:20480
  v_mfma_f32_16x16x32_bf16 v[64:67], a[132:135], a[88:91], v[64:67]
  buffer_load_dwordx4 v3, s[20:23], s41 offen offset:1024 sc1 lds
  v_mfma_f32_16x16x32_bf16 v[68:71], a[128:131], a[84:87], v[68:71]
  ds_read_b64_tr_b16 a[148:149], v26 offset:24576
  ds_read_b64_tr_b16 a[150:151], v26 offset:28672
  v_mfma_f32_16x16x32_bf16 v[68:71], a[132:135], a[92:95], v[68:71]
  s_waitcnt lgkmcnt(4)
  v_mfma_f32_16x16x32_bf16 v[72:75], a[136:139], a[80:83], v[72:75]
  ds_read_b64_tr_b16 a[152:153], v27 offset:16384
  ds_read_b64_tr_b16 a[154:155], v27 offset:20480
  v_mfma_f32_16x16x32_bf16 v[72:75], a[140:143], a[88:91], v[72:75]
  v_mfma_f32_16x16x32_bf16 v[76:79], a[136:139], a[84:87], v[76:79]
  ds_read_b64_tr_b16 a[156:157], v27 offset:24576
  ds_read_b64_tr_b16 a[158:159], v27 offset:28672
  v_mfma_f32_16x16x32_bf16 v[76:79], a[140:143], a[92:95], v[76:79]
  s_waitcnt lgkmcnt(4)
  v_mfma_f32_16x16x32_bf16 v[80:83], a[144:147], a[80:83], v[80:83]
  ds_read_b64_tr_b16 a[128:129], v28 offset:16384
  ds_read_b64_tr_b16 a[130:131], v28 offset:20480
  v_mfma_f32_16x16x32_bf16 v[80:83], a[148:151], a[88:91], v[80:83]
  v_mfma_f32_16x16x32_bf16 v[84:87], a[144:147], a[84:87], v[84:87]
  ds_read_b64_tr_b16 a[132:133], v28 offset:24576
  ds_read_b64_tr_b16 a[134:135], v28 offset:28672
  v_mfma_f32_16x16x32_bf16 v[84:87], a[148:151], a[92:95], v[84:87]
  s_waitcnt lgkmcnt(4)
  v_mfma_f32_16x16x32_bf16 v[88:91], a[152:155], a[80:83], v[88:91]
  ds_read_b64_tr_b16 a[136:137], v29 offset:16384
  ds_read_b64_tr_b16 a[138:139], v29 offset:20480
  v_mfma_f32_16x16x32_bf16 v[88:91], a[156:159], a[88:91], v[88:91]
  buffer_load_dwordx4 v3, s[20:23], s41 offen offset:2048 sc1 lds
  v_mfma_f32_16x16x32_bf16 v[92:95], a[152:155], a[84:87], v[92:95]
  ds_read_b64_tr_b16 a[140:141], v29 offset:24576
  ds_read_b64_tr_b16 a[142:143], v29 offset:28672
  v_mfma_f32_16x16x32_bf16 v[92:95], a[156:159], a[92:95], v[92:95]
  s_waitcnt lgkmcnt(4)
  v_mfma_f32_16x16x32_bf16 v[96:99], a[128:131], a[80:83], v[96:99]
  ds_read_b64_tr_b16 a[144:145], v30 offset:16384
  ds_read_b64_tr_b16 a[146:147], v30 offset:20480
  v_mfma_f32_16x16x32_bf16 v[96:99], a[132:135], a[88:91], v[96:99]
  v_mfma_f32_16x16x32_bf16 v[100:103], a[128:131], a[84:87], v[100:103]
  ds_read_b64_tr_b16 a[148:149], v30 offset:24576
  ds_read_b64_tr_b16 a[150:151], v30 offset:28672
  v_mfma_f32_16x16x32_bf16 v[100:103], a[132:135], a[92:95], v[100:103]
  s_waitcnt lgkmcnt(4)
  v_mfma_f32_16x16x32_bf16 v[104:107], a[136:139], a[80:83], v[104:107]
  ds_read_b64_tr_b16 a[152:153], v31 offset:16384
  ds_read_b64_tr_b16 a[154:155], v31 offset:20480
  v_mfma_f32_16x16x32_bf16 v[104:107], a[140:143], a[88:91], v[104:107]
  v_mfma_f32_16x16x32_bf16 v[108:111], a[136:139], a[84:87], v[108:111]
  ds_read_b64_tr_b16 a[156:157], v31 offset:24576
  ds_read_b64_tr_b16 a[158:159], v31 offset:28672
  v_mfma_f32_16x16x32_bf16 v[108:111], a[140:143], a[92:95], v[108:111]
  s_waitcnt vmcnt(21) lgkmcnt(4)
  s_barrier
  v_mfma_f32_16x16x32_bf16 v[112:115], a[144:147], a[80:83], v[112:115]
  ds_read_b64_tr_b16 a[128:129], v24 offset:32768
  ds_read_b64_tr_b16 a[130:131], v24 offset:36864
  v_mfma_f32_16x16x32_bf16 v[112:115], a[148:151], a[88:91], v[112:115]
  v_mfma_f32_16x16x32_bf16 v[116:119], a[144:147], a[84:87], v[116:119]
  ds_read_b64_tr_b16 a[132:133], v24 offset:40960
  ds_read_b64_tr_b16 a[134:135], v24 offset:45056
  v_mfma_f32_16x16x32_bf16 v[116:119], a[148:151], a[92:95], v[116:119]
  s_waitcnt lgkmcnt(4)
  v_mfma_f32_16x16x32_bf16 v[120:123], a[152:155], a[80:83], v[120:123]
  ds_read_b64_tr_b16 a[136:137], v25 offset:32768
  ds_read_b64_tr_b16 a[138:139], v25 offset:36864
  v_mfma_f32_16x16x32_bf16 v[120:123], a[156:159], a[88:91], v[120:123]
  v_mfma_f32_16x16x32_bf16 v[124:127], a[152:155], a[84:87], v[124:127]
  ds_read_b64_tr_b16 a[140:141], v25 offset:40960
  ds_read_b64_tr_b16 a[142:143], v25 offset:45056
  v_mfma_f32_16x16x32_bf16 v[124:127], a[156:159], a[92:95], v[124:127]
  s_waitcnt lgkmcnt(4)
  v_mfma_f32_16x16x32_bf16 v[64:67], a[128:131], a[96:99], v[64:67]
  ds_read_b64_tr_b16 a[144:145], v26 offset:32768
  ds_read_b64_tr_b16 a[146:147], v26 offset:36864
  v_mfma_f32_16x16x32_bf16 v[64:67], a[132:135], a[104:107], v[64:67]
  v_mfma_f32_16x16x32_bf16 v[68:71], a[128:131], a[100:103], v[68:71]
  ds_read_b64_tr_b16 a[148:149], v26 offset:40960
  ds_read_b64_tr_b16 a[150:151], v26 offset:45056
  v_mfma_f32_16x16x32_bf16 v[68:71], a[132:135], a[108:111], v[68:71]
  s_waitcnt lgkmcnt(4)
  v_mfma_f32_16x16x32_bf16 v[72:75], a[136:139], a[96:99], v[72:75]
  ds_read_b64_tr_b16 a[152:153], v27 offset:32768
  ds_read_b64_tr_b16 a[154:155], v27 offset:36864
  v_mfma_f32_16x16x32_bf16 v[72:75], a[140:143], a[104:107], v[72:75]
  v_mfma_f32_16x16x32_bf16 v[76:79], a[136:139], a[100:103], v[76:79]
  ds_read_b64_tr_b16 a[156:157], v27 offset:40960
  ds_read_b64_tr_b16 a[158:159], v27 offset:45056
  v_mfma_f32_16x16x32_bf16 v[76:79], a[140:143], a[108:111], v[76:79]
  s_waitcnt lgkmcnt(4)
  v_mfma_f32_16x16x32_bf16 v[80:83], a[144:147], a[96:99], v[80:83]
  ds_read_b64_tr_b16 a[128:129], v28 offset:32768
  ds_read_b64_tr_b16 a[130:131], v28 offset:36864
  v_mfma_f32_16x16x32_bf16 v[80:83], a[148:151], a[104:107], v[80:83]
  v_mfma_f32_16x16x32_bf16 v[84:87], a[144:147], a[100:103], v[84:87]
  ds_read_b64_tr_b16 a[132:133], v28 offset:40960
  ds_read_b64_tr_b16 a[134:135], v28 offset:45056
  v_mfma_f32_16x16x32_bf16 v[84:87], a[148:151], a[108:111], v[84:87]
  s_waitcnt lgkmcnt(4)
  v_mfma_f32_16x16x32_bf16 v[88:91], a[152:155], a[96:99], v[88:91]
  ds_read_b64_tr_b16 a[136:137], v29 offset:32768
  ds_read_b64_tr_b16 a[138:139], v29 offset:36864
  v_mfma_f32_16x16x32_bf16 v[88:91], a[156:159], a[104:107], v[88:91]
  v_mfma_f32_16x16x32_bf16 v[92:95], a[152:155], a[100:103], v[92:95]
  ds_read_b64_tr_b16 a[140:141], v29 offset:40960
  ds_read_b64_tr_b16 a[142:143], v29 offset:45056
  v_mfma_f32_16x16x32_bf16 v[92:95], a[156:159], a[108:111], v[92:95]
  s_waitcnt lgkmcnt(4)
  v_mfma_f32_16x16x32_bf16 v[96:99], a[128:131], a[96:99], v[96:99]
  ds_read_b64_tr_b16 a[144:145], v30 offset:32768
  ds_read_b64_tr_b16 a[146:147], v30 offset:36864
  v_mfma_f32_16x16x32_bf16 v[96:99], a[132:135], a[104:107], v[96:99]
  v_mfma_f32_16x16x32_bf16 v[100:103], a[128:131], a[100:103], v[100:103]
  ds_read_b64_tr_b16 a[148:149], v30 offset:40960
  ds_read_b64_tr_b16 a[150:151], v30 offset:45056
  v_mfma_f32_16x16x32_bf16 v[100:103], a[132:135], a[108:111], v[100:103]
  s_waitcnt lgkmcnt(4)
  v_mfma_f32_16x16x32_bf16 v[104:107], a[136:139], a[96:99], v[104:107]
  ds_read_b64_tr_b16 a[152:153], v31 offset:32768
  ds_read_b64_tr_b16 a[154:155], v31 offset:36864
  v_mfma_f32_16x16x32_bf16 v[104:107], a[140:143], a[104:107], v[104:107]
  v_mfma_f32_16x16x32_bf16 v[108:111], a[136:139], a[100:103], v[108:111]
  ds_read_b64_tr_b16 a[156:157], v31 offset:40960
  ds_read_b64_tr_b16 a[158:159], v31 offset:45056
  v_mfma_f32_16x16x32_bf16 v[108:111], a[140:143], a[108:111], v[108:111]
  s_waitcnt vmcnt(13) lgkmcnt(4)
  s_barrier
  v_mfma_f32_16x16x32_bf16 v[112:115], a[144:147], a[96:99], v[112:115]
  ds_read_b64_tr_b16 a[128:129], v24 offset:49152
  ds_read_b64_tr_b16 a[130:131], v24 offset:53248
  v_mfma_f32_16x16x32_bf16 v[112:115], a[148:151], a[104:107], v[112:115]
  v_mfma_f32_16x16x32_bf16 v[116:119], a[144:147], a[100:103], v[116:119]
  ds_read_b64_tr_b16 a[132:133], v24 offset:57344
  ds_read_b64_tr_b16 a[134:135], v24 offset:61440
  v_mfma_f32_16x16x32_bf16 v[116:119], a[148:151], a[108:111], v[116:119]
  s_waitcnt lgkmcnt(4)
  v_mfma_f32_16x16x32_bf16 v[120:123], a[152:155], a[96:99], v[120:123]
  ds_read_b64_tr_b16 a[136:137], v25 offset:49152
  ds_read_b64_tr_b16 a[138:139], v25 offset:53248
  v_mfma_f32_16x16x32_bf16 v[120:123], a[156:159], a[104:107], v[120:123]
  v_mfma_f32_16x16x32_bf16 v[124:127], a[152:155], a[100:103], v[124:127]
  ds_read_b64_tr_b16 a[140:141], v25 offset:57344
  ds_read_b64_tr_b16 a[142:143], v25 offset:61440
  v_mfma_f32_16x16x32_bf16 v[124:127], a[156:159], a[108:111], v[124:127]
  s_waitcnt lgkmcnt(4)
  v_mfma_f32_16x16x32_bf16 v[64:67], a[128:131], a[112:115], v[64:67]
  ds_read_b64_tr_b16 a[144:145], v26 offset:49152
  ds_read_b64_tr_b16 a[146:147], v26 offset:53248
  v_mfma_f32_16x16x32_bf16 v[64:67], a[132:135], a[120:123], v[64:67]
  v_mfma_f32_16x16x32_bf16 v[68:71], a[128:131], a[116:119], v[68:71]
  ds_read_b64_tr_b16 a[148:149], v26 offset:57344
  ds_read_b64_tr_b16 a[150:151], v26 offset:61440
  v_mfma_f32_16x16x32_bf16 v[68:71], a[132:135], a[124:127], v[68:71]
  s_waitcnt lgkmcnt(4)
  v_mfma_f32_16x16x32_bf16 v[72:75], a[136:139], a[112:115], v[72:75]
  ds_read_b64_tr_b16 a[152:153], v27 offset:49152
  ds_read_b64_tr_b16 a[154:155], v27 offset:53248
  v_mfma_f32_16x16x32_bf16 v[72:75], a[140:143], a[120:123], v[72:75]
  v_mfma_f32_16x16x32_bf16 v[76:79], a[136:139], a[116:119], v[76:79]
  ds_read_b64_tr_b16 a[156:157], v27 offset:57344
  ds_read_b64_tr_b16 a[158:159], v27 offset:61440
  v_mfma_f32_16x16x32_bf16 v[76:79], a[140:143], a[124:127], v[76:79]
  s_waitcnt lgkmcnt(4)
  v_mfma_f32_16x16x32_bf16 v[80:83], a[144:147], a[112:115], v[80:83]
  ds_read_b64_tr_b16 a[128:129], v28 offset:49152
  ds_read_b64_tr_b16 a[130:131], v28 offset:53248
  v_mfma_f32_16x16x32_bf16 v[80:83], a[148:151], a[120:123], v[80:83]
  v_mfma_f32_16x16x32_bf16 v[84:87], a[144:147], a[116:119], v[84:87]
  ds_read_b64_tr_b16 a[132:133], v28 offset:57344
  ds_read_b64_tr_b16 a[134:135], v28 offset:61440
  v_mfma_f32_16x16x32_bf16 v[84:87], a[148:151], a[124:127], v[84:87]
  s_waitcnt lgkmcnt(4)
  v_mfma_f32_16x16x32_bf16 v[88:91], a[152:155], a[112:115], v[88:91]
  ds_read_b64_tr_b16 a[136:137], v29 offset:49152
  ds_read_b64_tr_b16 a[138:139], v29 offset:53248
  v_mfma_f32_16x16x32_bf16 v[88:91], a[156:159], a[120:123], v[88:91]
  v_mfma_f32_16x16x32_bf16 v[92:95], a[152:155], a[116:119], v[92:95]
  ds_read_b64_tr_b16 a[140:141], v29 offset:57344
  ds_read_b64_tr_b16 a[142:143], v29 offset:61440
  v_mfma_f32_16x16x32_bf16 v[92:95], a[156:159], a[124:127], v[92:95]
  s_waitcnt lgkmcnt(4)
  v_mfma_f32_16x16x32_bf16 v[96:99], a[128:131], a[112:115], v[96:99]
  ds_read_b64_tr_b16 a[144:145], v30 offset:49152
  ds_read_b64_tr_b16 a[146:147], v30 offset:53248
  v_mfma_f32_16x16x32_bf16 v[96:99], a[132:135], a[120:123], v[96:99]
  v_mfma_f32_16x16x32_bf16 v[100:103], a[128:131], a[116:119], v[100:103]
  ds_read_b64_tr_b16 a[148:149], v30 offset:57344
  ds_read_b64_tr_b16 a[150:151], v30 offset:61440
  v_mfma_f32_16x16x32_bf16 v[100:103], a[132:135], a[124:127], v[100:103]
  s_waitcnt lgkmcnt(4)
  v_mfma_f32_16x16x32_bf16 v[104:107], a[136:139], a[112:115], v[104:107]
  ds_read_b64_tr_b16 a[152:153], v31 offset:49152
  ds_read_b64_tr_b16 a[154:155], v31 offset:53248
  v_mfma_f32_16x16x32_bf16 v[104:107], a[140:143], a[120:123], v[104:107]
  v_mfma_f32_16x16x32_bf16 v[108:111], a[136:139], a[116:119], v[108:111]
  ds_read_b64_tr_b16 a[156:157], v31 offset:57344
  ds_read_b64_tr_b16 a[158:159], v31 offset:61440
  v_mfma_f32_16x16x32_bf16 v[108:111], a[140:143], a[124:127], v[108:111]
  s_waitcnt lgkmcnt(4)
  v_mfma_f32_16x16x32_bf16 v[112:115], a[144:147], a[112:115], v[112:115]
  v_mfma_f32_16x16x32_bf16 v[112:115], a[148:151], a[120:123], v[112:115]
  v_mfma_f32_16x16x32_bf16 v[116:119], a[144:147], a[116:119], v[116:119]
  v_mfma_f32_16x16x32_bf16 v[116:119], a[148:151], a[124:127], v[116:119]
  s_waitcnt lgkmcnt(0)
  v_mfma_f32_16x16x32_bf16 v[120:123], a[152:155], a[112:115], v[120:123]
  v_mfma_f32_16x16x32_bf16 v[120:123], a[156:159], a[120:123], v[120:123]
  v_mfma_f32_16x16x32_bf16 v[124:127], a[152:155], a[116:119], v[124:127]
  v_mfma_f32_16x16x32_bf16 v[124:127], a[156:159], a[124:127], v[124:127]
attn_kernel_tail21:
  s_mov_b32 s53, 0x80000
  s_mov_b32 s76, 0
  s_waitcnt vmcnt(3)
attn_kernel_allchk24:
  v_min3_u32 v4, v60, v61, v62
  v_min_u32 v4, v4, v63
  s_sub_u32 s53, s53, 1
  s_cselect_b64 s[58:59], 0, -1
  v_cmp_eq_u32 vcc, 0, v4
  s_and_b64 vcc, vcc, s[58:59]
  s_cbranch_vccz attn_kernel_allok25
  s_mov_b32 s76, -1
  buffer_load_dword v60, v53, s[68:71], s63 offen sc1
  buffer_load_dword v61, v53, s[68:71], s62 offen sc1
  buffer_load_dword v62, v54, s[68:71], s63 offen sc1
  buffer_load_dword v63, v54, s[68:71], s62 offen sc1
  s_waitcnt vmcnt(0)
  s_branch attn_kernel_allchk24
attn_kernel_allok25:
  v_cvt_pk_bf16_f32 v144, v64, v65
  v_cvt_pk_bf16_f32 v145, v66, v67
  v_cvt_pk_bf16_f32 v146, v72, v73
  v_cvt_pk_bf16_f32 v147, v74, v75
  v_cvt_pk_bf16_f32 v148, v68, v69
  v_cvt_pk_bf16_f32 v149, v70, v71
  v_cvt_pk_bf16_f32 v150, v76, v77
  v_cvt_pk_bf16_f32 v151, v78, v79
  v_permlane32_swap_b32 v144, v146
  v_permlane32_swap_b32 v145, v147
  v_permlane32_swap_b32 v148, v150
  v_permlane32_swap_b32 v149, v151
  v_permlane16_swap_b32 v144, v146
  v_permlane16_swap_b32 v145, v147
  v_permlane16_swap_b32 v148, v150
  v_permlane16_swap_b32 v149, v151
  v_cvt_pk_bf16_f32 v152, v80, v81
  v_cvt_pk_bf16_f32 v153, v82, v83
  v_cvt_pk_bf16_f32 v154, v88, v89
  v_cvt_pk_bf16_f32 v155, v90, v91
  v_cvt_pk_bf16_f32 v156, v84, v85
  v_cvt_pk_bf16_f32 v157, v86, v87
  v_cvt_pk_bf16_f32 v158, v92, v93
  v_cvt_pk_bf16_f32 v159, v94, v95
  v_permlane32_swap_b32 v152, v154
  v_permlane32_swap_b32 v153, v155
  v_permlane32_swap_b32 v156, v158
  v_permlane32_swap_b32 v157, v159
  v_permlane16_swap_b32 v152, v154
  v_permlane16_swap_b32 v153, v155
  v_permlane16_swap_b32 v156, v158
  v_permlane16_swap_b32 v157, v159
  v_mov_b32 v32, v144
  v_mov_b32 v33, v145
  v_mov_b32 v34, v146
  v_mov_b32 v35, v147
  v_mov_b32_dpp v144, v152 row_ror:8 row_mask:0xf bank_mask:0xc
  v_mov_b32_dpp v145, v153 row_ror:8 row_mask:0xf bank_mask:0xc
  v_mov_b32_dpp v146, v154 row_ror:8 row_mask:0xf bank_mask:0xc
  v_mov_b32_dpp v147, v155 row_ror:8 row_mask:0xf bank_mask:0xc
  v_mov_b32_dpp v152, v32 row_ror:8 row_mask:0xf bank_mask:0x3
  v_mov_b32_dpp v153, v33 row_ror:8 row_mask:0xf bank_mask:0x3
  v_mov_b32_dpp v154, v34 row_ror:8 row_mask:0xf bank_mask:0x3
  v_mov_b32_dpp v155, v35 row_ror:8 row_mask:0xf bank_mask:0x3
  v_mov_b32 v36, v148
  v_mov_b32 v37, v149
  v_mov_b32 v38, v150
  v_mov_b32 v39, v151
  v_mov_b32_dpp v148, v156 row_ror:8 row_mask:0xf bank_mask:0xc
  v_mov_b32_dpp v149, v157 row_ror:8 row_mask:0xf bank_mask:0xc
  v_mov_b32_dpp v150, v158 row_ror:8 row_mask:0xf bank_mask:0xc
  v_mov_b32_dpp v151, v159 row_ror:8 row_mask:0xf bank_mask:0xc
  v_mov_b32_dpp v156, v36 row_ror:8 row_mask:0xf bank_mask:0x3
  v_mov_b32_dpp v157, v37 row_ror:8 row_mask:0xf bank_mask:0x3
  v_mov_b32_dpp v158, v38 row_ror:8 row_mask:0xf bank_mask:0x3
  v_mov_b32_dpp v159, v39 row_ror:8 row_mask:0xf bank_mask:0x3
  buffer_store_dwordx4 v[144:147], v14, s[24:27], s48 offen offset:0 sc1
  buffer_store_dwordx4 v[152:155], v15, s[24:27], s48 offen offset:0 sc1
  buffer_store_dwordx4 v[148:151], v14, s[24:27], s49 offen offset:0 sc1
  buffer_store_dwordx4 v[156:159], v15, s[24:27], s49 offen offset:0 sc1
  v_cvt_pk_bf16_f32 v160, v96, v97
  v_cvt_pk_bf16_f32 v161, v98, v99
  v_cvt_pk_bf16_f32 v162, v104, v105
  v_cvt_pk_bf16_f32 v163, v106, v107
  v_cvt_pk_bf16_f32 v164, v100, v101
  v_cvt_pk_bf16_f32 v165, v102, v103
  v_cvt_pk_bf16_f32 v166, v108, v109
  v_cvt_pk_bf16_f32 v167, v110, v111
  v_permlane32_swap_b32 v160, v162
  v_permlane32_swap_b32 v161, v163
  v_permlane32_swap_b32 v164, v166
  v_permlane32_swap_b32 v165, v167
  v_permlane16_swap_b32 v160, v162
  v_permlane16_swap_b32 v161, v163
  v_permlane16_swap_b32 v164, v166
  v_permlane16_swap_b32 v165, v167
  v_cvt_pk_bf16_f32 v168, v112, v113
  v_cvt_pk_bf16_f32 v169, v114, v115
  v_cvt_pk_bf16_f32 v170, v120, v121
  v_cvt_pk_bf16_f32 v171, v122, v123
  v_cvt_pk_bf16_f32 v172, v116, v117
  v_cvt_pk_bf16_f32 v173, v118, v119
  v_cvt_pk_bf16_f32 v174, v124, v125
  v_cvt_pk_bf16_f32 v175, v126, v127
  v_permlane32_swap_b32 v168, v170
  v_permlane32_swap_b32 v169, v171
  v_permlane32_swap_b32 v172, v174
  v_permlane32_swap_b32 v173, v175
  v_permlane16_swap_b32 v168, v170
  v_permlane16_swap_b32 v169, v171
  v_permlane16_swap_b32 v172, v174
  v_permlane16_swap_b32 v173, v175
  v_mov_b32 v32, v160
  v_mov_b32 v33, v161
  v_mov_b32 v34, v162
  v_mov_b32 v35, v163
  v_mov_b32_dpp v160, v168 row_ror:8 row_mask:0xf bank_mask:0xc
  v_mov_b32_dpp v161, v169 row_ror:8 row_mask:0xf bank_mask:0xc
  v_mov_b32_dpp v162, v170 row_ror:8 row_mask:0xf bank_mask:0xc
  v_mov_b32_dpp v163, v171 row_ror:8 row_mask:0xf bank_mask:0xc
  v_mov_b32_dpp v168, v32 row_ror:8 row_mask:0xf bank_mask:0x3
  v_mov_b32_dpp v169, v33 row_ror:8 row_mask:0xf bank_mask:0x3
  v_mov_b32_dpp v170, v34 row_ror:8 row_mask:0xf bank_mask:0x3
  v_mov_b32_dpp v171, v35 row_ror:8 row_mask:0xf bank_mask:0x3
  v_mov_b32 v36, v164
  v_mov_b32 v37, v165
  v_mov_b32 v38, v166
  v_mov_b32 v39, v167
  v_mov_b32_dpp v164, v172 row_ror:8 row_mask:0xf bank_mask:0xc
  v_mov_b32_dpp v165, v173 row_ror:8 row_mask:0xf bank_mask:0xc
  v_mov_b32_dpp v166, v174 row_ror:8 row_mask:0xf bank_mask:0xc
  v_mov_b32_dpp v167, v175 row_ror:8 row_mask:0xf bank_mask:0xc
  v_mov_b32_dpp v172, v36 row_ror:8 row_mask:0xf bank_mask:0x3
  v_mov_b32_dpp v173, v37 row_ror:8 row_mask:0xf bank_mask:0x3
  v_mov_b32_dpp v174, v38 row_ror:8 row_mask:0xf bank_mask:0x3
  v_mov_b32_dpp v175, v39 row_ror:8 row_mask:0xf bank_mask:0x3
  buffer_store_dwordx4 v[160:163], v14, s[24:27], s48 offen offset:128 sc1
  buffer_store_dwordx4 v[168:171], v15, s[24:27], s48 offen offset:128 sc1
  buffer_store_dwordx4 v[164:167], v14, s[24:27], s49 offen offset:128 sc1
  buffer_store_dwordx4 v[172:175], v15, s[24:27], s49 offen offset:128 sc1
  s_waitcnt vmcnt(8)
  s_barrier
  v_add_u32 v10, 131072, v3
  ds_read_b128 v[176:179], v10 offset:0
  ds_read_b128 v[180:183], v10 offset:1024
  ds_read_b128 v[184:187], v10 offset:2048
  ds_read_b128 v[188:191], v10 offset:3072
  ds_read_b128 v[192:195], v10 offset:4096
  ds_read_b128 v[196:199], v10 offset:5120
  ds_read_b128 v[200:203], v10 offset:6144
  ds_read_b128 v[204:207], v10 offset:7168
  ds_read_b128 v[208:211], v10 offset:8192
  ds_read_b128 v[212:215], v10 offset:9216
  ds_read_b128 v[216:219], v10 offset:10240
  ds_read_b128 v[220:223], v10 offset:11264
  v_lshlrev_b32 v64, 16, v128
  v_and_b32 v65, 0xffff0000, v128
  v_lshlrev_b32 v66, 16, v129
  v_and_b32 v67, 0xffff0000, v129
  v_lshlrev_b32 v68, 16, v130
  v_and_b32 v69, 0xffff0000, v130
  v_lshlrev_b32 v70, 16, v131
  v_and_b32 v71, 0xffff0000, v131
  v_lshlrev_b32 v72, 16, v132
  v_and_b32 v73, 0xffff0000, v132
  v_lshlrev_b32 v74, 16, v133
  v_and_b32 v75, 0xffff0000, v133
  v_lshlrev_b32 v76, 16, v134
  v_and_b32 v77, 0xffff0000, v134
  v_lshlrev_b32 v78, 16, v135
  v_and_b32 v79, 0xffff0000, v135
  v_lshlrev_b32 v80, 16, v136
  v_and_b32 v81, 0xffff0000, v136
  v_lshlrev_b32 v82, 16, v137
  v_and_b32 v83, 0xffff0000, v137
  v_lshlrev_b32 v84, 16, v138
  v_and_b32 v85, 0xffff0000, v138
  v_lshlrev_b32 v86, 16, v139
  v_and_b32 v87, 0xffff0000, v139
  v_lshlrev_b32 v88, 16, v140
  v_and_b32 v89, 0xffff0000, v140
  v_lshlrev_b32 v90, 16, v141
  v_and_b32 v91, 0xffff0000, v141
  v_lshlrev_b32 v92, 16, v142
  v_and_b32 v93, 0xffff0000, v142
  v_lshlrev_b32 v94, 16, v143
  v_and_b32 v95, 0xffff0000, v143
  s_and_b32 s40, s2, 7
  s_lshr_b32 s41, s2, 3
  s_lshr_b32 s42, s40, 2
  s_lshl_b32 s42, s42, 2
  s_lshr_b32 s43, s41, 3
  s_add_u32 s42, s42, s43
  s_and_b32 s43, s40, 3
  s_lshl_b32 s43, s43, 3
  s_and_b32 s41, s41, 7
  s_add_u32 s43, s43, s41
  s_mul_i32 s62, s43, 224
  s_mov_b32 s28, s6
  s_and_b32 s29, s7, 0xffff
  s_mov_b32 s30, 7168
  s_mov_b32 s31, 0x20000
  s_load_dwordx2 s[12:13], s[0:1], 48
  s_mov_b32 s50, s62
  s_mov_b32 s60, 0x3a800000
  s_mov_b32 s61, 0xba800000
  s_mov_b32 s53, 0x40000
  s_waitcnt lgkmcnt(0)
attn_kernel_modchk26:
  v_max3_u32 v4, v176, v177, v178
  v_max3_u32 v4, v4, v179, v180
  v_max3_u32 v4, v4, v181, v182
  v_max3_u32 v4, v4, v183, v184
  v_max3_u32 v4, v4, v185, v186
  v_max3_u32 v4, v4, v187, v188
  v_max3_u32 v4, v4, v189, v190
  v_max3_u32 v4, v4, v191, v192
  v_max3_u32 v4, v4, v193, v194
  v_max3_u32 v4, v4, v195, v196
  v_max3_u32 v4, v4, v197, v198
  v_max3_u32 v4, v4, v199, v200
  v_max3_u32 v4, v4, v201, v202
  v_max3_u32 v4, v4, v203, v204
  v_max3_u32 v4, v4, v205, v206
  v_max3_u32 v4, v4, v207, v208
  v_max3_u32 v4, v4, v209, v210
  v_max3_u32 v4, v4, v211, v212
  v_max3_u32 v4, v4, v213, v214
  v_max3_u32 v4, v4, v215, v216
  v_max3_u32 v4, v4, v217, v218
  v_max3_u32 v4, v4, v219, v220
  v_max3_u32 v4, v4, v221, v222
  v_max_u32 v4, v4, v223
  v_or_b32 v4, s76, v4
  s_mov_b32 s76, 0
  s_sub_u32 s53, s53, 1
  s_cselect_b64 s[58:59], 0, -1
  v_cmp_eq_u32 vcc, -1, v4
  s_and_b64 vcc, vcc, s[58:59]
  s_cbranch_vccz attn_kernel_modok27
  s_mov_b32 s41, 0
  buffer_load_dwordx4 v[176:179], v3, s[20:23], s41 offen offset:0 sc1
  s_mov_b32 s41, 0
  buffer_load_dwordx4 v[180:183], v3, s[20:23], s41 offen offset:1024 sc1
  s_mov_b32 s41, 0
  buffer_load_dwordx4 v[184:187], v3, s[20:23], s41 offen offset:2048 sc1
  s_mov_b32 s41, 0
  buffer_load_dwordx4 v[188:191], v3, s[20:23], s41 offen offset:3072 sc1
  s_mov_b32 s41, 4096
  buffer_load_dwordx4 v[192:195], v3, s[20:23], s41 offen offset:0 sc1
  s_mov_b32 s41, 4096
  buffer_load_dwordx4 v[196:199], v3, s[20:23], s41 offen offset:1024 sc1
  s_mov_b32 s41, 4096
  buffer_load_dwordx4 v[200:203], v3, s[20:23], s41 offen offset:2048 sc1
  s_mov_b32 s41, 4096
  buffer_load_dwordx4 v[204:207], v3, s[20:23], s41 offen offset:3072 sc1
  s_mov_b32 s41, 8192
  buffer_load_dwordx4 v[208:211], v3, s[20:23], s41 offen offset:0 sc1
  s_mov_b32 s41, 8192
  buffer_load_dwordx4 v[212:215], v3, s[20:23], s41 offen offset:1024 sc1
  s_mov_b32 s41, 8192
  buffer_load_dwordx4 v[216:219], v3, s[20:23], s41 offen offset:2048 sc1
  s_mov_b32 s41, 8192
  buffer_load_dwordx4 v[220:223], v3, s[20:23], s41 offen offset:3072 sc1
  s_waitcnt vmcnt(0)
  s_branch attn_kernel_modchk26
attn_kernel_modok27:
  s_mov_b32 s53, 0x80000
  v_and_b32 v4, 7, v1
  v_lshlrev_b32 v4, 8, v4
  v_bfe_u32 v11, v1, 3, 1
  v_lshl_add_u32 v11, v11, 22, v4
  v_add_u32 v11, s52, v11
attn_kernel_poll28:
  s_branch attn_kernel_cheap130
attn_kernel_cheap29:
attn_kernel_cheap130:
  buffer_load_dword v4, v11, s[24:27], s54 offen offset:2300 sc1
  s_sub_u32 s53, s53, 1
  s_cselect_b64 s[58:59], 0, -1
  s_waitcnt vmcnt(0)
  v_cmp_eq_u32 vcc, -1, v4
  s_and_b64 vcc, vcc, s[58:59]
  s_cbranch_vccnz attn_kernel_cheap29
  s_max_i32 s53, s53, 0
  buffer_load_dwordx4 v[224:227], v8, s[24:27], s54 offen offset:0 sc1
  buffer_load_dwordx4 v[228:231], v8, s[24:27], s54 offen offset:1024 sc1
  buffer_load_dwordx4 v[232:235], v8, s[24:27], s54 offen offset:2048 sc1
  buffer_load_dwordx4 v[236:239], v8, s[24:27], s54 offen offset:3072 sc1
  buffer_load_dwordx4 v[240:243], v8, s[24:27], s45 offen offset:0 sc1
  buffer_load_dwordx4 v[244:247], v8, s[24:27], s45 offen offset:1024 sc1
  buffer_load_dwordx4 v[248:251], v8, s[24:27], s45 offen offset:2048 sc1
  buffer_load_dwordx4 v[252:255], v8, s[24:27], s45 offen offset:3072 sc1
  s_sub_u32 s53, s53, 1
  s_cselect_b64 s[58:59], 0, -1
  s_waitcnt vmcnt(0)
  v_max3_u32 v4, v224, v225, v226
  v_max3_u32 v4, v4, v227, v228
  v_max3_u32 v4, v4, v229, v230
  v_max3_u32 v4, v4, v231, v232
  v_max3_u32 v4, v4, v233, v234
  v_max3_u32 v4, v4, v235, v236
  v_max3_u32 v4, v4, v237, v238
  v_max3_u32 v4, v4, v239, v240
  v_max3_u32 v4, v4, v241, v242
  v_max3_u32 v4, v4, v243, v244
  v_max3_u32 v4, v4, v245, v246
  v_max3_u32 v4, v4, v247, v248
  v_max3_u32 v4, v4, v249, v250
  v_max3_u32 v4, v4, v251, v252
  v_max3_u32 v4, v4, v253, v254
  v_max_u32 v4, v4, v255
  v_cmp_eq_u32 vcc, -1, v4
  s_and_b64 vcc, vcc, s[58:59]
  s_cbranch_vccnz attn_kernel_poll28
  v_lshlrev_b32 v4, 3, v5
  v_lshlrev_b32 v96, 16, v224
  v_lshlrev_b32 v112, 16, v232
  v_and_b32 v97, 0xffff0000, v224
  v_and_b32 v113, 0xffff0000, v232
  v_lshlrev_b32 v98, 16, v225
  v_lshlrev_b32 v114, 16, v233
  buffer_load_dwordx2 v[40:41], v4, s[28:31], s62 offen offset:0
  v_and_b32 v99, 0xffff0000, v225
  v_and_b32 v115, 0xffff0000, v233
  v_lshlrev_b32 v100, 16, v226
  v_lshlrev_b32 v116, 16, v234
  v_and_b32 v101, 0xffff0000, v226
  v_and_b32 v117, 0xffff0000, v234
  buffer_load_dwordx2 v[42:43], v4, s[28:31], s62 offen offset:32
  v_lshlrev_b32 v102, 16, v227
  v_lshlrev_b32 v118, 16, v235
  v_and_b32 v103, 0xffff0000, v227
  v_and_b32 v119, 0xffff0000, v235
  v_lshlrev_b32 v104, 16, v228
  v_lshlrev_b32 v120, 16, v236
  buffer_load_dwordx2 v[44:45], v4, s[28:31], s62 offen offset:64
  v_and_b32 v105, 0xffff0000, v228
  v_and_b32 v121, 0xffff0000, v236
  v_lshlrev_b32 v106, 16, v229
  v_lshlrev_b32 v122, 16, v237
  v_and_b32 v107, 0xffff0000, v229
  v_and_b32 v123, 0xffff0000, v237
  buffer_load_dwordx2 v[46:47], v4, s[28:31], s62 offen offset:96
  v_lshlrev_b32 v108, 16, v230
  v_lshlrev_b32 v124, 16, v238
  v_and_b32 v109, 0xffff0000, v230
  v_and_b32 v125, 0xffff0000, v238
  v_lshlrev_b32 v110, 16, v231
  v_lshlrev_b32 v126, 16, v239
  buffer_load_dwordx2 v[48:49], v4, s[28:31], s62 offen offset:128
  v_and_b32 v111, 0xffff0000, v231
  v_and_b32 v127, 0xffff0000, v239
  v_lshlrev_b32 v144, 16, v240
  v_lshlrev_b32 v160, 16, v248
  v_and_b32 v145, 0xffff0000, v240
  v_and_b32 v161, 0xffff0000, v248
  buffer_load_dwordx2 v[50:51], v4, s[28:31], s62 offen offset:160
  v_lshlrev_b32 v146, 16, v241
  v_lshlrev_b32 v162, 16, v249
  v_and_b32 v147, 0xffff0000, v241
  v_and_b32 v163, 0xffff0000, v249
  v_lshlrev_b32 v148, 16, v242
  v_lshlrev_b32 v164, 16, v250
  buffer_load_dwordx2 v[52:53], v4, s[28:31], s62 offen offset:192
  v_and_b32 v149, 0xffff0000, v242
  v_and_b32 v165, 0xffff0000, v250
  v_lshlrev_b32 v150, 16, v243
  v_lshlrev_b32 v166, 16, v251
  v_and_b32 v151, 0xffff0000, v243
  v_and_b32 v167, 0xffff0000, v251
  v_lshlrev_b32 v152, 16, v244
  v_lshlrev_b32 v168, 16, v252
  v_and_b32 v153, 0xffff0000, v244
  v_and_b32 v169, 0xffff0000, v252
  v_lshlrev_b32 v154, 16, v245
  v_lshlrev_b32 v170, 16, v253
  v_and_b32 v155, 0xffff0000, v245
  v_and_b32 v171, 0xffff0000, v253
  v_lshlrev_b32 v156, 16, v246
  v_lshlrev_b32 v172, 16, v254
  v_and_b32 v157, 0xffff0000, v246
  v_and_b32 v173, 0xffff0000, v254
  v_lshlrev_b32 v158, 16, v247
  v_lshlrev_b32 v174, 16, v255
  v_and_b32 v159, 0xffff0000, v247
  v_and_b32 v175, 0xffff0000, v255
  v_pk_add_f32 v[96:97], v[96:97], v[144:145]
  v_pk_add_f32 v[112:113], v[112:113], v[160:161]
  v_pk_add_f32 v[98:99], v[98:99], v[146:147]
  v_pk_add_f32 v[114:115], v[114:115], v[162:163]
  v_pk_add_f32 v[100:101], v[100:101], v[148:149]
  v_pk_add_f32 v[116:117], v[116:117], v[164:165]
  v_pk_add_f32 v[102:103], v[102:103], v[150:151]
  v_pk_add_f32 v[118:119], v[118:119], v[166:167]
  v_pk_add_f32 v[104:105], v[104:105], v[152:153]
  v_pk_add_f32 v[120:121], v[120:121], v[168:169]
  v_pk_add_f32 v[106:107], v[106:107], v[154:155]
  v_pk_add_f32 v[122:123], v[122:123], v[170:171]
  v_pk_add_f32 v[108:109], v[108:109], v[156:157]
  v_pk_add_f32 v[124:125], v[124:125], v[172:173]
  v_pk_add_f32 v[110:111], v[110:111], v[158:159]
  v_pk_add_f32 v[126:127], v[126:127], v[174:175]
  v_pk_fma_f32 v[64:65], v[96:97], v[176:177], v[64:65]
  v_pk_fma_f32 v[80:81], v[112:113], v[176:177], v[80:81]
  v_pk_fma_f32 v[66:67], v[98:99], v[178:179], v[66:67]
  v_pk_fma_f32 v[82:83], v[114:115], v[178:179], v[82:83]
  v_pk_fma_f32 v[68:69], v[100:101], v[180:181], v[68:69]
  v_pk_fma_f32 v[84:85], v[116:117], v[180:181], v[84:85]
  v_pk_fma_f32 v[70:71], v[102:103], v[182:183], v[70:71]
  v_pk_fma_f32 v[86:87], v[118:119], v[182:183], v[86:87]
  v_pk_fma_f32 v[72:73], v[104:105], v[184:185], v[72:73]
  v_pk_fma_f32 v[88:89], v[120:121], v[184:185], v[88:89]
  v_pk_fma_f32 v[74:75], v[106:107], v[186:187], v[74:75]
  v_pk_fma_f32 v[90:91], v[122:123], v[186:187], v[90:91]
  v_pk_fma_f32 v[76:77], v[108:109], v[188:189], v[76:77]
  v_pk_fma_f32 v[92:93], v[124:125], v[188:189], v[92:93]
  v_pk_fma_f32 v[78:79], v[110:111], v[190:191], v[78:79]
  v_pk_fma_f32 v[94:95], v[126:127], v[190:191], v[94:95]
  v_cvt_pk_bf16_f32 v128, v64, v65
  v_cvt_pk_bf16_f32 v136, v80, v81
  v_cvt_pk_bf16_f32 v129, v66, v67
  v_cvt_pk_bf16_f32 v137, v82, v83
  v_cvt_pk_bf16_f32 v130, v68, v69
  v_cvt_pk_bf16_f32 v138, v84, v85
  v_cvt_pk_bf16_f32 v131, v70, v71
  v_cvt_pk_bf16_f32 v139, v86, v87
  v_cvt_pk_bf16_f32 v132, v72, v73
  v_cvt_pk_bf16_f32 v140, v88, v89
  v_cvt_pk_bf16_f32 v133, v74, v75
  v_cvt_pk_bf16_f32 v141, v90, v91
  v_cvt_pk_bf16_f32 v134, v76, v77
  v_cvt_pk_bf16_f32 v142, v92, v93
  v_cvt_pk_bf16_f32 v135, v78, v79
  v_cvt_pk_bf16_f32 v143, v94, v95
  buffer_store_dwordx4 v[128:131], v8, s[36:39], s54 offen offset:0 sc1
  buffer_store_dwordx4 v[136:139], v8, s[36:39], s54 offen offset:2048 sc1
  buffer_store_dwordx4 v[132:135], v8, s[36:39], s54 offen offset:1024 sc1
  buffer_store_dwordx4 v[140:143], v8, s[36:39], s54 offen offset:3072 sc1
  v_pk_add_f32 v[32:33], v[64:65], v[66:67]
  v_pk_add_f32 v[36:37], v[80:81], v[82:83]
  v_pk_add_f32 v[32:33], v[32:33], v[68:69]
  v_pk_add_f32 v[36:37], v[36:37], v[84:85]
  v_pk_add_f32 v[32:33], v[32:33], v[70:71]
  v_pk_add_f32 v[36:37], v[36:37], v[86:87]
  v_pk_add_f32 v[32:33], v[32:33], v[72:73]
  v_pk_add_f32 v[36:37], v[36:37], v[88:89]
  v_pk_add_f32 v[32:33], v[32:33], v[74:75]
  v_pk_add_f32 v[36:37], v[36:37], v[90:91]
  v_pk_add_f32 v[32:33], v[32:33], v[76:77]
  v_pk_add_f32 v[36:37], v[36:37], v[92:93]
  v_pk_add_f32 v[32:33], v[32:33], v[78:79]
  v_pk_add_f32 v[36:37], v[36:37], v[94:95]
  v_add_f32 v32, v32, v33
  v_add_f32 v36, v36, v37
  s_nop 0
  v_add_f32_dpp v32, v32, v32 quad_perm:[1,0,3,2] row_mask:0xf bank_mask:0xf
  v_add_f32_dpp v36, v36, v36 quad_perm:[1,0,3,2] row_mask:0xf bank_mask:0xf
  s_nop 0
  v_add_f32_dpp v32, v32, v32 quad_perm:[2,3,0,1] row_mask:0xf bank_mask:0xf
  v_add_f32_dpp v36, v36, v36 quad_perm:[2,3,0,1] row_mask:0xf bank_mask:0xf
  s_nop 0
  v_add_f32_dpp v32, v32, v32 row_half_mirror row_mask:0xf bank_mask:0xf
  v_add_f32_dpp v36, v36, v36 row_half_mirror row_mask:0xf bank_mask:0xf
  s_nop 0
  v_add_f32_dpp v32, v32, v32 row_mirror row_mask:0xf bank_mask:0xf
  v_add_f32_dpp v36, v36, v36 row_mirror row_mask:0xf bank_mask:0xf
  v_mov_b32 v34, v32
  v_mov_b32 v38, v36
  s_nop 0
  v_permlane16_swap_b32 v32, v34
  v_permlane16_swap_b32 v36, v38
  v_add_f32 v32, v32, v34
  v_add_f32 v36, v36, v38
  v_mov_b32 v34, v32
  v_mov_b32 v38, v36
  s_nop 0
  v_permlane32_swap_b32 v32, v34
  v_permlane32_swap_b32 v36, v38
  v_add_f32 v32, v32, v34
  v_add_f32 v36, v36, v38
  v_mul_f32 v32, s61, v32
  v_mul_f32 v36, s61, v36
  v_mov_b32 v33, v32
  v_mov_b32 v37, v36
  v_pk_add_f32 v[64:65], v[64:65], v[32:33]
  v_pk_add_f32 v[80:81], v[80:81], v[36:37]
  v_pk_add_f32 v[66:67], v[66:67], v[32:33]
  v_pk_add_f32 v[82:83], v[82:83], v[36:37]
  v_pk_add_f32 v[68:69], v[68:69], v[32:33]
  v_pk_add_f32 v[84:85], v[84:85], v[36:37]
  v_pk_add_f32 v[70:71], v[70:71], v[32:33]
  v_pk_add_f32 v[86:87], v[86:87], v[36:37]
  v_pk_add_f32 v[72:73], v[72:73], v[32:33]
  v_pk_add_f32 v[88:89], v[88:89], v[36:37]
  v_pk_add_f32 v[74:75], v[74:75], v[32:33]
  v_pk_add_f32 v[90:91], v[90:91], v[36:37]
  v_pk_add_f32 v[76:77], v[76:77], v[32:33]
  v_pk_add_f32 v[92:93], v[92:93], v[36:37]
  v_pk_add_f32 v[78:79], v[78:79], v[32:33]
  v_pk_add_f32 v[94:95], v[94:95], v[36:37]
  v_pk_mul_f32 v[32:33], v[64:65], v[64:65]
  v_pk_mul_f32 v[36:37], v[80:81], v[80:81]
  v_pk_fma_f32 v[32:33], v[66:67], v[66:67], v[32:33]
  v_pk_fma_f32 v[36:37], v[82:83], v[82:83], v[36:37]
  v_pk_fma_f32 v[32:33], v[68:69], v[68:69], v[32:33]
  v_pk_fma_f32 v[36:37], v[84:85], v[84:85], v[36:37]
  v_pk_fma_f32 v[32:33], v[70:71], v[70:71], v[32:33]
  v_pk_fma_f32 v[36:37], v[86:87], v[86:87], v[36:37]
  v_pk_fma_f32 v[32:33], v[72:73], v[72:73], v[32:33]
  v_pk_fma_f32 v[36:37], v[88:89], v[88:89], v[36:37]
  v_pk_fma_f32 v[32:33], v[74:75], v[74:75], v[32:33]
  v_pk_fma_f32 v[36:37], v[90:91], v[90:91], v[36:37]
  v_pk_fma_f32 v[32:33], v[76:77], v[76:77], v[32:33]
  v_pk_fma_f32 v[36:37], v[92:93], v[92:93], v[36:37]
  v_pk_fma_f32 v[32:33], v[78:79], v[78:79], v[32:33]
  v_pk_fma_f32 v[36:37], v[94:95], v[94:95], v[36:37]
  v_add_f32 v32, v32, v33
  v_add_f32 v36, v36, v37
  s_nop 0
  v_add_f32_dpp v32, v32, v32 quad_perm:[1,0,3,2] row_mask:0xf bank_mask:0xf
  v_add_f32_dpp v36, v36, v36 quad_perm:[1,0,3,2] row_mask:0xf bank_mask:0xf
  s_nop 0
  v_add_f32_dpp v32, v32, v32 quad_perm:[2,3,0,1] row_mask:0xf bank_mask:0xf
  v_add_f32_dpp v36, v36, v36 quad_perm:[2,3,0,1] row_mask:0xf bank_mask:0xf
  s_nop 0
  v_add_f32_dpp v32, v32, v32 row_half_mirror row_mask:0xf bank_mask:0xf
  v_add_f32_dpp v36, v36, v36 row_half_mirror row_mask:0xf bank_mask:0xf
  s_nop 0
  v_add_f32_dpp v32, v32, v32 row_mirror row_mask:0xf bank_mask:0xf
  v_add_f32_dpp v36, v36, v36 row_mirror row_mask:0xf bank_mask:0xf
  v_mov_b32 v34, v32
  v_mov_b32 v38, v36
  s_nop 0
  v_permlane16_swap_b32 v32, v34
  v_permlane16_swap_b32 v36, v38
  v_add_f32 v32, v32, v34
  v_add_f32 v36, v36, v38
  v_mov_b32 v34, v32
  v_mov_b32 v38, v36
  s_nop 0
  v_permlane32_swap_b32 v32, v34
  v_permlane32_swap_b32 v36, v38
  v_add_f32 v32, v32, v34
  v_add_f32 v36, v36, v38
  v_mov_b32 v34, 0x3727c5ac
  v_mov_b32 v38, 0x3727c5ac
  v_fmac_f32 v34, s60, v32
  v_fmac_f32 v38, s60, v36
  v_rsq_f32 v32, v34
  v_rsq_f32 v36, v38
  v_mov_b32 v33, v32
  v_mov_b32 v37, v36
  v_pk_mul_f32 v[64:65], v[64:65], v[32:33]
  v_pk_mul_f32 v[80:81], v[80:81], v[36:37]
  v_pk_mul_f32 v[66:67], v[66:67], v[32:33]
  v_pk_mul_f32 v[82:83], v[82:83], v[36:37]
  v_pk_mul_f32 v[68:69], v[68:69], v[32:33]
  v_pk_mul_f32 v[84:85], v[84:85], v[36:37]
  v_pk_mul_f32 v[70:71], v[70:71], v[32:33]
  v_pk_mul_f32 v[86:87], v[86:87], v[36:37]
  v_pk_mul_f32 v[72:73], v[72:73], v[32:33]
  v_pk_mul_f32 v[88:89], v[88:89], v[36:37]
  v_pk_mul_f32 v[74:75], v[74:75], v[32:33]
  v_pk_mul_f32 v[90:91], v[90:91], v[36:37]
  v_pk_mul_f32 v[76:77], v[76:77], v[32:33]
  v_pk_mul_f32 v[92:93], v[92:93], v[36:37]
  v_pk_mul_f32 v[78:79], v[78:79], v[32:33]
  v_pk_mul_f32 v[94:95], v[94:95], v[36:37]
  v_pk_fma_f32 v[64:65], v[64:65], v[208:209], v[192:193]
  v_pk_fma_f32 v[80:81], v[80:81], v[208:209], v[192:193]
  v_pk_fma_f32 v[66:67], v[66:67], v[210:211], v[194:195]
  v_pk_fma_f32 v[82:83], v[82:83], v[210:211], v[194:195]
  v_pk_fma_f32 v[68:69], v[68:69], v[212:213], v[196:197]
  v_pk_fma_f32 v[84:85], v[84:85], v[212:213], v[196:197]
  v_pk_fma_f32 v[70:71], v[70:71], v[214:215], v[198:199]
  v_pk_fma_f32 v[86:87], v[86:87], v[214:215], v[198:199]
  v_pk_fma_f32 v[72:73], v[72:73], v[216:217], v[200:201]
  v_pk_fma_f32 v[88:89], v[88:89], v[216:217], v[200:201]
  v_pk_fma_f32 v[74:75], v[74:75], v[218:219], v[202:203]
  v_pk_fma_f32 v[90:91], v[90:91], v[218:219], v[202:203]
  v_pk_fma_f32 v[76:77], v[76:77], v[220:221], v[204:205]
  v_pk_fma_f32 v[92:93], v[92:93], v[220:221], v[204:205]
  v_pk_fma_f32 v[78:79], v[78:79], v[222:223], v[206:207]
  v_pk_fma_f32 v[94:95], v[94:95], v[222:223], v[206:207]
  v_pk_add_f32 v[32:33], v[64:65], v[66:67]
  v_pk_add_f32 v[36:37], v[80:81], v[82:83]
  v_pk_add_f32 v[32:33], v[32:33], v[68:69]
  v_pk_add_f32 v[36:37], v[36:37], v[84:85]
  v_pk_add_f32 v[32:33], v[32:33], v[70:71]
  v_pk_add_f32 v[36:37], v[36:37], v[86:87]
  v_pk_add_f32 v[32:33], v[32:33], v[72:73]
  v_pk_add_f32 v[36:37], v[36:37], v[88:89]
  v_pk_add_f32 v[32:33], v[32:33], v[74:75]
  v_pk_add_f32 v[36:37], v[36:37], v[90:91]
  v_pk_add_f32 v[32:33], v[32:33], v[76:77]
  v_pk_add_f32 v[36:37], v[36:37], v[92:93]
  v_pk_add_f32 v[32:33], v[32:33], v[78:79]
  v_pk_add_f32 v[36:37], v[36:37], v[94:95]
  v_add_f32 v32, v32, v33
  v_add_f32 v36, v36, v37
  s_nop 0
  v_add_f32_dpp v32, v32, v32 quad_perm:[1,0,3,2] row_mask:0xf bank_mask:0xf
  v_add_f32_dpp v36, v36, v36 quad_perm:[1,0,3,2] row_mask:0xf bank_mask:0xf
  s_nop 0
  v_add_f32_dpp v32, v32, v32 quad_perm:[2,3,0,1] row_mask:0xf bank_mask:0xf
  v_add_f32_dpp v36, v36, v36 quad_perm:[2,3,0,1] row_mask:0xf bank_mask:0xf
  s_nop 0
  v_add_f32_dpp v32, v32, v32 row_half_mirror row_mask:0xf bank_mask:0xf
  v_add_f32_dpp v36, v36, v36 row_half_mirror row_mask:0xf bank_mask:0xf
  s_nop 0
  v_add_f32_dpp v32, v32, v32 row_mirror row_mask:0xf bank_mask:0xf
  v_add_f32_dpp v36, v36, v36 row_mirror row_mask:0xf bank_mask:0xf
  v_mov_b32 v34, v32
  v_mov_b32 v38, v36
  s_nop 0
  v_permlane16_swap_b32 v32, v34
  v_permlane16_swap_b32 v36, v38
  v_add_f32 v32, v32, v34
  v_add_f32 v36, v36, v38
  v_mov_b32 v34, v32
  v_mov_b32 v38, v36
  s_nop 0
  v_permlane32_swap_b32 v32, v34
  v_permlane32_swap_b32 v36, v38
  v_add_f32 v32, v32, v34
  v_add_f32 v36, v36, v38
  v_mul_f32 v32, s61, v32
  v_mul_f32 v36, s61, v36
  v_mov_b32 v33, v32
  v_mov_b32 v37, v36
  v_pk_add_f32 v[64:65], v[64:65], v[32:33]
  v_pk_add_f32 v[80:81], v[80:81], v[36:37]
  v_pk_add_f32 v[66:67], v[66:67], v[32:33]
  v_pk_add_f32 v[82:83], v[82:83], v[36:37]
  v_pk_add_f32 v[68:69], v[68:69], v[32:33]
  v_pk_add_f32 v[84:85], v[84:85], v[36:37]
  v_pk_add_f32 v[70:71], v[70:71], v[32:33]
  v_pk_add_f32 v[86:87], v[86:87], v[36:37]
  v_pk_add_f32 v[72:73], v[72:73], v[32:33]
  v_pk_add_f32 v[88:89], v[88:89], v[36:37]
  v_pk_add_f32 v[74:75], v[74:75], v[32:33]
  v_pk_add_f32 v[90:91], v[90:91], v[36:37]
  v_pk_add_f32 v[76:77], v[76:77], v[32:33]
  v_pk_add_f32 v[92:93], v[92:93], v[36:37]
  v_pk_add_f32 v[78:79], v[78:79], v[32:33]
  v_pk_add_f32 v[94:95], v[94:95], v[36:37]
  v_pk_mul_f32 v[32:33], v[64:65], v[64:65]
  v_pk_mul_f32 v[36:37], v[80:81], v[80:81]
  v_pk_fma_f32 v[32:33], v[66:67], v[66:67], v[32:33]
  v_pk_fma_f32 v[36:37], v[82:83], v[82:83], v[36:37]
  v_pk_fma_f32 v[32:33], v[68:69], v[68:69], v[32:33]
  v_pk_fma_f32 v[36:37], v[84:85], v[84:85], v[36:37]
  v_pk_fma_f32 v[32:33], v[70:71], v[70:71], v[32:33]
  v_pk_fma_f32 v[36:37], v[86:87], v[86:87], v[36:37]
  v_pk_fma_f32 v[32:33], v[72:73], v[72:73], v[32:33]
  v_pk_fma_f32 v[36:37], v[88:89], v[88:89], v[36:37]
  v_pk_fma_f32 v[32:33], v[74:75], v[74:75], v[32:33]
  v_pk_fma_f32 v[36:37], v[90:91], v[90:91], v[36:37]
  v_pk_fma_f32 v[32:33], v[76:77], v[76:77], v[32:33]
  v_pk_fma_f32 v[36:37], v[92:93], v[92:93], v[36:37]
  v_pk_fma_f32 v[32:33], v[78:79], v[78:79], v[32:33]
  v_pk_fma_f32 v[36:37], v[94:95], v[94:95], v[36:37]
  v_add_f32 v32, v32, v33
  v_add_f32 v36, v36, v37
  s_nop 0
  v_add_f32_dpp v32, v32, v32 quad_perm:[1,0,3,2] row_mask:0xf bank_mask:0xf
  v_add_f32_dpp v36, v36, v36 quad_perm:[1,0,3,2] row_mask:0xf bank_mask:0xf
  s_nop 0
  v_add_f32_dpp v32, v32, v32 quad_perm:[2,3,0,1] row_mask:0xf bank_mask:0xf
  v_add_f32_dpp v36, v36, v36 quad_perm:[2,3,0,1] row_mask:0xf bank_mask:0xf
  s_nop 0
  v_add_f32_dpp v32, v32, v32 row_half_mirror row_mask:0xf bank_mask:0xf
  v_add_f32_dpp v36, v36, v36 row_half_mirror row_mask:0xf bank_mask:0xf
  s_nop 0
  v_add_f32_dpp v32, v32, v32 row_mirror row_mask:0xf bank_mask:0xf
  v_add_f32_dpp v36, v36, v36 row_mirror row_mask:0xf bank_mask:0xf
  v_mov_b32 v34, v32
  v_mov_b32 v38, v36
  s_nop 0
  v_permlane16_swap_b32 v32, v34
  v_permlane16_swap_b32 v36, v38
  v_add_f32 v32, v32, v34
  v_add_f32 v36, v36, v38
  v_mov_b32 v34, v32
  v_mov_b32 v38, v36
  s_nop 0
  v_permlane32_swap_b32 v32, v34
  v_permlane32_swap_b32 v36, v38
  v_add_f32 v32, v32, v34
  v_add_f32 v36, v36, v38
  v_mov_b32 v34, 0x3727c5ac
  v_mov_b32 v38, 0x3727c5ac
  v_fmac_f32 v34, s60, v32
  v_fmac_f32 v38, s60, v36
  v_rsq_f32 v32, v34
  v_rsq_f32 v36, v38
  v_mov_b32 v33, v32
  v_mov_b32 v37, v36
  v_pk_mul_f32 v[64:65], v[64:65], v[32:33]
  v_pk_mul_f32 v[80:81], v[80:81], v[36:37]
  v_pk_mul_f32 v[66:67], v[66:67], v[32:33]
  v_pk_mul_f32 v[82:83], v[82:83], v[36:37]
  v_pk_mul_f32 v[68:69], v[68:69], v[32:33]
  v_pk_mul_f32 v[84:85], v[84:85], v[36:37]
  v_pk_mul_f32 v[70:71], v[70:71], v[32:33]
  v_pk_mul_f32 v[86:87], v[86:87], v[36:37]
  v_pk_mul_f32 v[72:73], v[72:73], v[32:33]
  v_pk_mul_f32 v[88:89], v[88:89], v[36:37]
  v_pk_mul_f32 v[74:75], v[74:75], v[32:33]
  v_pk_mul_f32 v[90:91], v[90:91], v[36:37]
  v_pk_mul_f32 v[76:77], v[76:77], v[32:33]
  v_pk_mul_f32 v[92:93], v[92:93], v[36:37]
  v_pk_mul_f32 v[78:79], v[78:79], v[32:33]
  v_pk_mul_f32 v[94:95], v[94:95], v[36:37]
  v_cvt_pk_bf16_f32 v96, v64, v65
  v_cvt_pk_bf16_f32 v112, v80, v81
  v_cvt_pk_bf16_f32 v97, v66, v67
  v_cvt_pk_bf16_f32 v113, v82, v83
  v_cvt_pk_bf16_f32 v98, v68, v69
  v_cvt_pk_bf16_f32 v114, v84, v85
  v_cvt_pk_bf16_f32 v99, v70, v71
  v_cvt_pk_bf16_f32 v115, v86, v87
  v_cvt_pk_bf16_f32 v100, v72, v73
  v_cvt_pk_bf16_f32 v116, v88, v89
  v_cvt_pk_bf16_f32 v101, v74, v75
  v_cvt_pk_bf16_f32 v117, v90, v91
  v_cvt_pk_bf16_f32 v102, v76, v77
  v_cvt_pk_bf16_f32 v118, v92, v93
  v_cvt_pk_bf16_f32 v103, v78, v79
  v_cvt_pk_bf16_f32 v119, v94, v95
  v_lshrrev_b32 v5, 2, v1
  v_mul_u32_u24 v5, 528, v5
  v_and_b32 v6, 1, v1
  v_lshl_add_u32 v5, v6, 8, v5
  v_bfe_u32 v6, v1, 1, 1
  v_lshl_add_u32 v5, v6, 3, v5
  v_lshl_add_u32 v5, v2, 5, v5
  ds_write_b64 v5, v[96:97] offset:0
  ds_write_b64 v5, v[98:99] offset:128
  ds_write_b64 v5, v[100:101] offset:8448
  ds_write_b64 v5, v[102:103] offset:8576
  ds_write_b64 v5, v[112:113] offset:16
  ds_write_b64 v5, v[114:115] offset:144
  ds_write_b64 v5, v[116:117] offset:8464
  ds_write_b64 v5, v[118:119] offset:8592
  v_lshrrev_b32 v6, 5, v0
  v_and_b32 v7, 31, v0
  v_mul_u32_u24 v5, 528, v6
  v_lshl_add_u32 v5, v7, 4, v5
  v_lshlrev_b32 v6, 17, v6
  v_bfe_u32 v7, v0, 3, 2
  v_lshl_add_u32 v6, v7, 8, v6
  v_and_b32 v7, 7, v0
  v_lshl_add_u32 v6, v7, 4, v6
  s_lshr_b32 s48, s46, 1
  s_lshl_b32 s48, s48, 10
  s_and_b32 s49, s46, 1
  s_lshl_b32 s49, s49, 7
  s_add_u32 s48, s48, s49
  s_waitcnt lgkmcnt(0)
  s_barrier
  ds_read_b128 v[144:147], v5 offset:0
  ds_read_b128 v[148:151], v5 offset:4224
  ds_read_b128 v[152:155], v5 offset:8448
  ds_read_b128 v[156:159], v5 offset:12672
  s_waitcnt lgkmcnt(3)
  buffer_store_dwordx4 v[144:147], v6, s[64:67], s48 offen sc1
  s_add_u32 s48, s48, 1048576
  s_waitcnt lgkmcnt(2)
  buffer_store_dwordx4 v[148:151], v6, s[64:67], s48 offen sc1
  s_add_u32 s48, s48, 1048576
  s_waitcnt lgkmcnt(1)
  buffer_store_dwordx4 v[152:155], v6, s[64:67], s48 offen sc1
  s_add_u32 s48, s48, 1048576
  s_waitcnt lgkmcnt(0)
  buffer_store_dwordx4 v[156:159], v6, s[64:67], s48 offen sc1
  s_lshl_b32 s46, s46, 7
  s_lshl_b32 s45, s42, 12
  s_lshl_b32 s47, s42, 4
  s_lshl_b32 s48, s44, 2
  s_add_u32 s47, s47, s48
  s_lshl_b32 s48, s47, 10
  v_lshl_add_u32 v12, v1, 4, s48
  v_add_u32 v13, 0x20000, v12
  s_mov_b32 s51, 0
  s_and_b32 s13, s13, 0xffff
  s_mov_b32 s14, 7340032
  s_mov_b32 s15, 0x20000
  v_lshrrev_b32 v32, 2, v1
  v_and_b32 v33, 3, v1
  v_and_b32 v34, 7, v32
  v_lshlrev_b32 v32, 8, v32
  v_lshl_add_u32 v32, v33, 3, v32
  v_xor_b32 v33, 0, v34
  v_lshl_add_u32 v16, v33, 5, v32
  v_xor_b32 v33, 1, v34
  v_lshl_add_u32 v17, v33, 5, v32
  v_xor_b32 v33, 2, v34
  v_lshl_add_u32 v18, v33, 5, v32
  v_xor_b32 v33, 3, v34
  v_lshl_add_u32 v19, v33, 5, v32
  v_xor_b32 v33, 4, v34
  v_lshl_add_u32 v20, v33, 5, v32
  v_xor_b32 v33, 5, v34
  v_lshl_add_u32 v21, v33, 5, v32
  v_xor_b32 v33, 6, v34
  v_lshl_add_u32 v22, v33, 5, v32
  v_xor_b32 v33, 7, v34
  v_lshl_add_u32 v23, v33, 5, v32
  v_add_u32 v24, 0x10000, v16
  v_add_u32 v25, 0x10000, v17
  v_add_u32 v26, 0x10000, v18
  v_add_u32 v27, 0x10000, v19
  v_add_u32 v28, 0x10000, v20
  v_add_u32 v29, 0x10000, v21
  v_add_u32 v30, 0x10000, v22
  v_add_u32 v31, 0x10000, v23
  s_mov_b32 s63, s45
  s_mov_b32 s57, s46
  v_lshrrev_b32 v32, 4, v1
  v_and_b32 v33, 15, v1
  s_lshl_b32 s45, s44, 4
  s_mov_b32 s46, 7168
  v_add_u32 v34, 0, v32
  v_and_b32 v35, 7, v34
  v_lshlrev_b32 v35, 1, v35
  v_xor_b32 v35, v35, v33
  v_add_u32 v34, s45, v34
  v_mul_lo_u32 v34, v34, s46
  v_lshl_add_u32 v208, v35, 4, v34
  v_cmp_le_u32 vcc, 14, v35
  v_mov_b32 v34, 0x7ff00000
  s_nop 0
  v_cndmask_b32 v208, v208, v34, vcc
  v_add_u32 v34, 4, v32
  v_and_b32 v35, 7, v34
  v_lshlrev_b32 v35, 1, v35
  v_xor_b32 v35, v35, v33
  v_add_u32 v34, s45, v34
  v_mul_lo_u32 v34, v34, s46
  v_lshl_add_u32 v209, v35, 4, v34
  v_subrev_u32 v209, 1024, v209
  v_cmp_le_u32 vcc, 14, v35
  v_mov_b32 v34, 0x7ff00000
  s_nop 0
  v_cndmask_b32 v209, v209, v34, vcc
  v_add_u32 v34, 8, v32
  v_and_b32 v35, 7, v34
  v_lshlrev_b32 v35, 1, v35
  v_xor_b32 v35, v35, v33
  v_add_u32 v34, s45, v34
  v_mul_lo_u32 v34, v34, s46
  v_lshl_add_u32 v210, v35, 4, v34
  v_subrev_u32 v210, 2048, v210
  v_cmp_le_u32 vcc, 14, v35
  v_mov_b32 v34, 0x7ff00000
  s_nop 0
  v_cndmask_b32 v210, v210, v34, vcc
  v_add_u32 v34, 12, v32
  v_and_b32 v35, 7, v34
  v_lshlrev_b32 v35, 1, v35
  v_xor_b32 v35, v35, v33
  v_add_u32 v34, s45, v34
  v_mul_lo_u32 v34, v34, s46
  v_lshl_add_u32 v211, v35, 4, v34
  v_subrev_u32 v211, 3072, v211
  v_cmp_le_u32 vcc, 14, v35
  v_mov_b32 v34, 0x7ff00000
  s_nop 0
  v_cndmask_b32 v211, v211, v34, vcc
  s_mov_b32 s45, s63
  s_mov_b32 s46, s57
  s_getpc_b64 s[32:33]
attn_kernel_pc32:
  s_add_u32 s32, s32, attn_kernel_epi31-attn_kernel_pc32
  s_addc_u32 s33, s33, 0
  s_and_b32 s33, s33, 0xffff
  s_mov_b32 s34, code_end-attn_kernel_epi31
  s_mov_b32 s35, 0x20000
  v_lshlrev_b32 v60, 4, v0
  s_waitcnt vmcnt(0)
  s_barrier
  s_cmp_lg_u32 s44, 0
  s_cbranch_scc1 attn_kernel_pub33
  v_mov_b32 v3, 0
  v_mov_b32 v4, 1
  buffer_store_dword v4, v3, s[68:71], s46 offen sc1
attn_kernel_pub33:
  v_lshlrev_b32 v64, 16, v40
  v_and_b32 v65, 0xffff0000, v40
  v_lshlrev_b32 v66, 16, v41
  v_and_b32 v67, 0xffff0000, v41
  v_lshlrev_b32 v68, 16, v42
  v_and_b32 v69, 0xffff0000, v42
  v_lshlrev_b32 v70, 16, v43
  v_and_b32 v71, 0xffff0000, v43
  v_lshlrev_b32 v72, 16, v44
  v_and_b32 v73, 0xffff0000, v44
  v_lshlrev_b32 v74, 16, v45
  v_and_b32 v75, 0xffff0000, v45
  v_lshlrev_b32 v76, 16, v46
  v_and_b32 v77, 0xffff0000, v46
  v_lshlrev_b32 v78, 16, v47
  v_and_b32 v79, 0xffff0000, v47
  v_lshlrev_b32 v80, 16, v48
  v_and_b32 v81, 0xffff0000, v48
  v_lshlrev_b32 v82, 16, v49
  v_and_b32 v83, 0xffff0000, v49
  v_lshlrev_b32 v84, 16, v50
  v_and_b32 v85, 0xffff0000, v50
  v_lshlrev_b32 v86, 16, v51
  v_and_b32 v87, 0xffff0000, v51
  v_lshlrev_b32 v88, 16, v52
  v_and_b32 v89, 0xffff0000, v52
  v_lshlrev_b32 v90, 16, v53
  v_and_b32 v91, 0xffff0000, v53
  v_and_b32 v3, 31, v1
  v_lshlrev_b32 v3, 7, v3
  s_add_u32 m0, s52, 32768
  s_nop 0
  buffer_load_dwordx4 v208, s[12:15], s50 offen offset:0 lds
  buffer_load_dwordx4 v209, s[12:15], s50 offen offset:1024 lds
  buffer_load_dwordx4 v210, s[12:15], s50 offen offset:2048 lds
  buffer_load_dwordx4 v211, s[12:15], s50 offen offset:3072 lds
  s_add_u32 s50, s50, 458752
  s_add_u32 m0, s52, 49152
  s_nop 0
  buffer_load_dwordx4 v208, s[12:15], s50 offen offset:0 lds
  buffer_load_dwordx4 v209, s[12:15], s50 offen offset:1024 lds
  buffer_load_dwordx4 v210, s[12:15], s50 offen offset:2048 lds
  buffer_load_dwordx4 v211, s[12:15], s50 offen offset:3072 lds
  s_add_u32 s50, s50, 458752
  s_add_u32 m0, s52, 65536
  s_nop 0
  buffer_load_dwordx4 v208, s[12:15], s50 offen offset:0 lds
  buffer_load_dwordx4 v209, s[12:15], s50 offen offset:1024 lds
  buffer_load_dwordx4 v210, s[12:15], s50 offen offset:2048 lds
  buffer_load_dwordx4 v211, s[12:15], s50 offen offset:3072 lds
  s_add_u32 s50, s50, 458752
  s_add_u32 m0, s52, 81920
  s_nop 0
  buffer_load_dwordx4 v208, s[12:15], s50 offen offset:0 lds
  buffer_load_dwordx4 v209, s[12:15], s50 offen offset:1024 lds
  buffer_load_dwordx4 v210, s[12:15], s50 offen offset:2048 lds
  buffer_load_dwordx4 v211, s[12:15], s50 offen offset:3072 lds
  s_add_u32 s50, s50, 458752
  s_add_u32 m0, s52, 98304
  s_nop 0
  buffer_load_dwordx4 v208, s[12:15], s50 offen offset:0 lds
  buffer_load_dwordx4 v209, s[12:15], s50 offen offset:1024 lds
  buffer_load_dwordx4 v210, s[12:15], s50 offen offset:2048 lds
  buffer_load_dwordx4 v211, s[12:15], s50 offen offset:3072 lds
  s_add_u32 s50, s50, 458752
  s_cmp_lg_u32 s44, 0
  s_cbranch_scc1 attn_kernel_awd35
  s_mov_b32 s53, 0x80000
attn_kernel_aw34:
  buffer_load_dword v4, v3, s[68:71], s45 offen sc1
  s_sub_u32 s53, s53, 1
  s_cselect_b64 s[58:59], 0, -1
  s_waitcnt vmcnt(0)
  v_cmp_eq_u32 vcc, 0, v4
  s_and_b64 vcc, vcc, s[58:59]
  s_cbranch_vccz attn_kernel_awd35
  s_branch attn_kernel_aw34
attn_kernel_awd35:
  s_barrier
  buffer_load_dwordx4 a[0:3], v12, s[64:67], s51 offen offset:0 sc1
  buffer_load_dwordx4 a[4:7], v12, s[64:67], s51 offen offset:1024 sc1
  buffer_load_dwordx4 a[8:11], v12, s[64:67], s51 offen offset:2048 sc1
  buffer_load_dwordx4 a[12:15], v12, s[64:67], s51 offen offset:3072 sc1
  buffer_load_dwordx4 a[16:19], v13, s[64:67], s51 offen offset:0 sc1
  buffer_load_dwordx4 a[20:23], v13, s[64:67], s51 offen offset:1024 sc1
  buffer_load_dwordx4 a[24:27], v13, s[64:67], s51 offen offset:2048 sc1
  buffer_load_dwordx4 a[28:31], v13, s[64:67], s51 offen offset:3072 sc1
  s_add_u32 s51, s51, 262144
  buffer_load_dwordx4 a[32:35], v12, s[64:67], s51 offen offset:0 sc1
  buffer_load_dwordx4 a[36:39], v12, s[64:67], s51 offen offset:1024 sc1
  buffer_load_dwordx4 a[40:43], v12, s[64:67], s51 offen offset:2048 sc1
  buffer_load_dwordx4 a[44:47], v12, s[64:67], s51 offen offset:3072 sc1
  buffer_load_dwordx4 a[48:51], v13, s[64:67], s51 offen offset:0 sc1
  buffer_load_dwordx4 a[52:55], v13, s[64:67], s51 offen offset:1024 sc1
  buffer_load_dwordx4 a[56:59], v13, s[64:67], s51 offen offset:2048 sc1
  buffer_load_dwordx4 a[60:63], v13, s[64:67], s51 offen offset:3072 sc1
  s_add_u32 s51, s51, 262144
  buffer_load_dwordx4 a[64:67], v12, s[64:67], s51 offen offset:0 sc1
  buffer_load_dwordx4 a[68:71], v12, s[64:67], s51 offen offset:1024 sc1
  buffer_load_dwordx4 a[72:75], v12, s[64:67], s51 offen offset:2048 sc1
  buffer_load_dwordx4 a[76:79], v12, s[64:67], s51 offen offset:3072 sc1
  buffer_load_dwordx4 a[80:83], v13, s[64:67], s51 offen offset:0 sc1
  buffer_load_dwordx4 a[84:87], v13, s[64:67], s51 offen offset:1024 sc1
  buffer_load_dwordx4 a[88:91], v13, s[64:67], s51 offen offset:2048 sc1
  buffer_load_dwordx4 a[92:95], v13, s[64:67], s51 offen offset:3072 sc1
  s_add_u32 s51, s51, 262144
  s_waitcnt vmcnt(16)
  s_barrier
  ds_read_b64_tr_b16 a[192:193], v16 offset:32768
  ds_read_b64_tr_b16 a[194:195], v16 offset:36864
  ds_read_b64_tr_b16 a[196:197], v16 offset:40960
  ds_read_b64_tr_b16 a[198:199], v16 offset:45056
  ds_read_b64_tr_b16 a[200:201], v17 offset:32768
  ds_read_b64_tr_b16 a[202:203], v17 offset:36864
  ds_read_b64_tr_b16 a[204:205], v17 offset:40960
  ds_read_b64_tr_b16 a[206:207], v17 offset:45056
  s_waitcnt lgkmcnt(4)
  v_mfma_f32_16x16x32_bf16 v[96:99], a[192:195], a[0:3], v[64:67]
  ds_read_b64_tr_b16 a[208:209], v18 offset:32768
  ds_read_b64_tr_b16 a[210:211], v18 offset:36864
  v_mfma_f32_16x16x32_bf16 v[96:99], a[196:199], a[16:19], v[96:99]
  buffer_load_dwordx4 a[96:99], v12, s[64:67], s51 offen offset:0 sc1
  v_mfma_f32_16x16x32_bf16 v[100:103], a[192:195], a[4:7], v[64:67]
  buffer_load_dwordx4 a[100:103], v12, s[64:67], s51 offen offset:1024 sc1
  v_mfma_f32_16x16x32_bf16 v[100:103], a[196:199], a[20:23], v[100:103]
  v_mfma_f32_16x16x32_bf16 v[104:107], a[192:195], a[8:11], v[64:67]
  ds_read_b64_tr_b16 a[212:213], v18 offset:40960
  ds_read_b64_tr_b16 a[214:215], v18 offset:45056
  v_mfma_f32_16x16x32_bf16 v[104:107], a[196:199], a[24:27], v[104:107]
  buffer_load_dwordx4 a[104:107], v12, s[64:67], s51 offen offset:2048 sc1
  v_mfma_f32_16x16x32_bf16 v[108:111], a[192:195], a[12:15], v[64:67]
  buffer_load_dwordx4 a[108:111], v12, s[64:67], s51 offen offset:3072 sc1
  v_mfma_f32_16x16x32_bf16 v[108:111], a[196:199], a[28:31], v[108:111]
  s_waitcnt lgkmcnt(4)
  v_mfma_f32_16x16x32_bf16 v[112:115], a[200:203], a[0:3], v[68:71]
  ds_read_b64_tr_b16 a[216:217], v19 offset:32768
  ds_read_b64_tr_b16 a[218:219], v19 offset:36864
  v_mfma_f32_16x16x32_bf16 v[112:115], a[204:207], a[16:19], v[112:115]
  v_mfma_f32_16x16x32_bf16 v[116:119], a[200:203], a[4:7], v[68:71]
  buffer_load_dwordx4 a[112:115], v13, s[64:67], s51 offen offset:0 sc1
  v_mfma_f32_16x16x32_bf16 v[116:119], a[204:207], a[20:23], v[116:119]
  buffer_load_dwordx4 a[116:119], v13, s[64:67], s51 offen offset:1024 sc1
  v_mfma_f32_16x16x32_bf16 v[120:123], a[200:203], a[8:11], v[68:71]
  ds_read_b64_tr_b16 a[192:193], v19 offset:40960
  ds_read_b64_tr_b16 a[194:195], v19 offset:45056
  v_mfma_f32_16x16x32_bf16 v[120:123], a[204:207], a[24:27], v[120:123]
  v_mfma_f32_16x16x32_bf16 v[124:127], a[200:203], a[12:15], v[68:71]
  buffer_load_dwordx4 a[120:123], v13, s[64:67], s51 offen offset:2048 sc1
  v_mfma_f32_16x16x32_bf16 v[124:127], a[204:207], a[28:31], v[124:127]
  s_waitcnt lgkmcnt(4)
  v_mfma_f32_16x16x32_bf16 v[128:131], a[208:211], a[0:3], v[72:75]
  ds_read_b64_tr_b16 a[196:197], v20 offset:32768
  ds_read_b64_tr_b16 a[198:199], v20 offset:36864
  v_mfma_f32_16x16x32_bf16 v[128:131], a[212:215], a[16:19], v[128:131]
  buffer_load_dwordx4 a[124:127], v13, s[64:67], s51 offen offset:3072 sc1
  v_mfma_f32_16x16x32_bf16 v[132:135], a[208:211], a[4:7], v[72:75]
  s_add_u32 s51, s51, 262144
  v_mfma_f32_16x16x32_bf16 v[132:135], a[212:215], a[20:23], v[132:135]
  buffer_load_dwordx4 a[128:131], v12, s[64:67], s51 offen offset:0 sc1
  v_mfma_f32_16x16x32_bf16 v[136:139], a[208:211], a[8:11], v[72:75]
  ds_read_b64_tr_b16 a[200:201], v20 offset:40960
  ds_read_b64_tr_b16 a[202:203], v20 offset:45056
  v_mfma_f32_16x16x32_bf16 v[136:139], a[212:215], a[24:27], v[136:139]
  v_mfma_f32_16x16x32_bf16 v[140:143], a[208:211], a[12:15], v[72:75]
  buffer_load_dwordx4 a[132:135], v12, s[64:67], s51 offen offset:1024 sc1
  v_mfma_f32_16x16x32_bf16 v[140:143], a[212:215], a[28:31], v[140:143]
  s_waitcnt lgkmcnt(4)
  v_mfma_f32_16x16x32_bf16 v[144:147], a[216:219], a[0:3], v[76:79]
  ds_read_b64_tr_b16 a[204:205], v21 offset:32768
  ds_read_b64_tr_b16 a[206:207], v21 offset:36864
  v_mfma_f32_16x16x32_bf16 v[144:147], a[192:195], a[16:19], v[144:147]
  buffer_load_dwordx4 a[136:139], v12, s[64:67], s51 offen offset:2048 sc1
  v_mfma_f32_16x16x32_bf16 v[148:151], a[216:219], a[4:7], v[76:79]
  v_mfma_f32_16x16x32_bf16 v[148:151], a[192:195], a[20:23], v[148:151]
  buffer_load_dwordx4 a[140:143], v12, s[64:67], s51 offen offset:3072 sc1
  v_mfma_f32_16x16x32_bf16 v[152:155], a[216:219], a[8:11], v[76:79]
  ds_read_b64_tr_b16 a[208:209], v21 offset:40960
  ds_read_b64_tr_b16 a[210:211], v21 offset:45056
  v_mfma_f32_16x16x32_bf16 v[152:155], a[192:195], a[24:27], v[152:155]
  buffer_load_dwordx4 a[144:147], v13, s[64:67], s51 offen offset:0 sc1
  v_mfma_f32_16x16x32_bf16 v[156:159], a[216:219], a[12:15], v[76:79]
  v_mfma_f32_16x16x32_bf16 v[156:159], a[192:195], a[28:31], v[156:159]
  s_waitcnt lgkmcnt(4)
  v_mfma_f32_16x16x32_bf16 v[160:163], a[196:199], a[0:3], v[80:83]
  ds_read_b64_tr_b16 a[212:213], v22 offset:32768
  ds_read_b64_tr_b16 a[214:215], v22 offset:36864
  v_mfma_f32_16x16x32_bf16 v[160:163], a[200:203], a[16:19], v[160:163]
  buffer_load_dwordx4 a[148:151], v13, s[64:67], s51 offen offset:1024 sc1
  v_mfma_f32_16x16x32_bf16 v[164:167], a[196:199], a[4:7], v[80:83]
  buffer_load_dwordx4 a[152:155], v13, s[64:67], s51 offen offset:2048 sc1
  v_mfma_f32_16x16x32_bf16 v[164:167], a[200:203], a[20:23], v[164:167]
  v_mfma_f32_16x16x32_bf16 v[168:171], a[196:199], a[8:11], v[80:83]
  ds_read_b64_tr_b16 a[216:217], v22 offset:40960
  ds_read_b64_tr_b16 a[218:219], v22 offset:45056
  v_mfma_f32_16x16x32_bf16 v[168:171], a[200:203], a[24:27], v[168:171]
  buffer_load_dwordx4 a[156:159], v13, s[64:67], s51 offen offset:3072 sc1
  v_mfma_f32_16x16x32_bf16 v[172:175], a[196:199], a[12:15], v[80:83]
  s_add_u32 s51, s51, 262144
  v_mfma_f32_16x16x32_bf16 v[172:175], a[200:203], a[28:31], v[172:175]
  s_waitcnt vmcnt(24) lgkmcnt(4)
  s_barrier
  v_mfma_f32_16x16x32_bf16 v[176:179], a[204:207], a[0:3], v[84:87]
  ds_read_b64_tr_b16 a[192:193], v16 offset:49152
  ds_read_b64_tr_b16 a[194:195], v16 offset:53248
  v_mfma_f32_16x16x32_bf16 v[176:179], a[208:211], a[16:19], v[176:179]
  buffer_load_dwordx4 a[160:163], v12, s[64:67], s51 offen offset:0 sc1
  v_mfma_f32_16x16x32_bf16 v[180:183], a[204:207], a[4:7], v[84:87]
  s_add_u32 m0, s52, 114688
  v_mfma_f32_16x16x32_bf16 v[180:183], a[208:211], a[20:23], v[180:183]
  buffer_load_dwordx4 a[164:167], v12, s[64:67], s51 offen offset:1024 sc1
  v_mfma_f32_16x16x32_bf16 v[184:187], a[204:207], a[8:11], v[84:87]
  ds_read_b64_tr_b16 a[196:197], v16 offset:57344
  ds_read_b64_tr_b16 a[198:199], v16 offset:61440
  v_mfma_f32_16x16x32_bf16 v[184:187], a[208:211], a[24:27], v[184:187]
  v_mfma_f32_16x16x32_bf16 v[188:191], a[204:207], a[12:15], v[84:87]
  v_mfma_f32_16x16x32_bf16 v[188:191], a[208:211], a[28:31], v[188:191]
  s_waitcnt lgkmcnt(4)
  v_mfma_f32_16x16x32_bf16 v[192:195], a[212:215], a[0:3], v[88:91]
  ds_read_b64_tr_b16 a[200:201], v17 offset:49152
  ds_read_b64_tr_b16 a[202:203], v17 offset:53248
  v_mfma_f32_16x16x32_bf16 v[192:195], a[216:219], a[16:19], v[192:195]
  buffer_load_dwordx4 v208, s[12:15], s50 offen offset:0 lds
  v_mfma_f32_16x16x32_bf16 v[196:199], a[212:215], a[4:7], v[88:91]
  v_mfma_f32_16x16x32_bf16 v[196:199], a[216:219], a[20:23], v[196:199]
  v_mfma_f32_16x16x32_bf16 v[200:203], a[212:215], a[8:11], v[88:91]
  ds_read_b64_tr_b16 a[204:205], v17 offset:57344
  ds_read_b64_tr_b16 a[206:207], v17 offset:61440
  v_mfma_f32_16x16x32_bf16 v[200:203], a[216:219], a[24:27], v[200:203]
  buffer_load_dwordx4 v209, s[12:15], s50 offen offset:1024 lds
  v_mfma_f32_16x16x32_bf16 v[204:207], a[212:215], a[12:15], v[88:91]
  v_mfma_f32_16x16x32_bf16 v[204:207], a[216:219], a[28:31], v[204:207]
  s_waitcnt lgkmcnt(4)
  v_mfma_f32_16x16x32_bf16 v[96:99], a[192:195], a[32:35], v[96:99]
  ds_read_b64_tr_b16 a[208:209], v18 offset:49152
  ds_read_b64_tr_b16 a[210:211], v18 offset:53248
  v_mfma_f32_16x16x32_bf16 v[96:99], a[196:199], a[48:51], v[96:99]
  v_mfma_f32_16x16x32_bf16 v[100:103], a[192:195], a[36:39], v[100:103]
  buffer_load_dwordx4 v210, s[12:15], s50 offen offset:2048 lds
  v_mfma_f32_16x16x32_bf16 v[100:103], a[196:199], a[52:55], v[100:103]
  v_mfma_f32_16x16x32_bf16 v[104:107], a[192:195], a[40:43], v[104:107]
  ds_read_b64_tr_b16 a[212:213], v18 offset:57344
  ds_read_b64_tr_b16 a[214:215], v18 offset:61440
  v_mfma_f32_16x16x32_bf16 v[104:107], a[196:199], a[56:59], v[104:107]
  v_mfma_f32_16x16x32_bf16 v[108:111], a[192:195], a[44:47], v[108:111]
  buffer_load_dwordx4 v211, s[12:15], s50 offen offset:3072 lds
  v_mfma_f32_16x16x32_bf16 v[108:111], a[196:199], a[60:63], v[108:111]
  s_add_u32 s50, s50, 458752
  s_waitcnt lgkmcnt(4)
  v_mfma_f32_16x16x32_bf16 v[112:115], a[200:203], a[32:35], v[112:115]
  ds_read_b64_tr_b16 a[216:217], v19 offset:49152
  ds_read_b64_tr_b16 a[218:219], v19 offset:53248
  v_mfma_f32_16x16x32_bf16 v[112:115], a[204:207], a[48:51], v[112:115]
  v_mfma_f32_16x16x32_bf16 v[116:119], a[200:203], a[36:39], v[116:119]
  v_mfma_f32_16x16x32_bf16 v[116:119], a[204:207], a[52:55], v[116:119]
  buffer_load_dwordx4 a[168:171], v12, s[64:67], s51 offen offset:2048 sc1
  v_mfma_f32_16x16x32_bf16 v[120:123], a[200:203], a[40:43], v[120:123]
  ds_read_b64_tr_b16 a[192:193], v19 offset:57344
  ds_read_b64_tr_b16 a[194:195], v19 offset:61440
  v_mfma_f32_16x16x32_bf16 v[120:123], a[204:207], a[56:59], v[120:123]
  v_mfma_f32_16x16x32_bf16 v[124:127], a[200:203], a[44:47], v[124:127]
  v_mfma_f32_16x16x32_bf16 v[124:127], a[204:207], a[60:63], v[124:127]
  s_waitcnt lgkmcnt(4)
  v_mfma_f32_16x16x32_bf16 v[128:131], a[208:211], a[32:35], v[128:131]
  ds_read_b64_tr_b16 a[196:197], v20 offset:49152
  ds_read_b64_tr_b16 a[198:199], v20 offset:53248
  v_mfma_f32_16x16x32_bf16 v[128:131], a[212:215], a[48:51], v[128:131]
  buffer_load_dwordx4 a[172:175], v12, s[64:67], s51 offen offset:3072 sc1
  v_mfma_f32_16x16x32_bf16 v[132:135], a[208:211], a[36:39], v[132:135]
  v_mfma_f32_16x16x32_bf16 v[132:135], a[212:215], a[52:55], v[132:135]
  v_mfma_f32_16x16x32_bf16 v[136:139], a[208:211], a[40:43], v[136:139]
  ds_read_b64_tr_b16 a[200:201], v20 offset:57344
  ds_read_b64_tr_b16 a[202:203], v20 offset:61440
  v_mfma_f32_16x16x32_bf16 v[136:139], a[212:215], a[56:59], v[136:139]
  buffer_load_dwordx4 a[176:179], v13, s[64:67], s51 offen offset:0 sc1
  v_mfma_f32_16x16x32_bf16 v[140:143], a[208:211], a[44:47], v[140:143]
  v_mfma_f32_16x16x32_bf16 v[140:143], a[212:215], a[60:63], v[140:143]
  s_waitcnt lgkmcnt(4)
  v_mfma_f32_16x16x32_bf16 v[144:147], a[216:219], a[32:35], v[144:147]
  ds_read_b64_tr_b16 a[204:205], v21 offset:49152
  ds_read_b64_tr_b16 a[206:207], v21 offset:53248
  v_mfma_f32_16x16x32_bf16 v[144:147], a[192:195], a[48:51], v[144:147]
  v_mfma_f32_16x16x32_bf16 v[148:151], a[216:219], a[36:39], v[148:151]
  buffer_load_dwordx4 a[180:183], v13, s[64:67], s51 offen offset:1024 sc1
  v_mfma_f32_16x16x32_bf16 v[148:151], a[192:195], a[52:55], v[148:151]
  v_mfma_f32_16x16x32_bf16 v[152:155], a[216:219], a[40:43], v[152:155]
  ds_read_b64_tr_b16 a[208:209], v21 offset:57344
  ds_read_b64_tr_b16 a[210:211], v21 offset:61440
  v_mfma_f32_16x16x32_bf16 v[152:155], a[192:195], a[56:59], v[152:155]
  v_mfma_f32_16x16x32_bf16 v[156:159], a[216:219], a[44:47], v[156:159]
  buffer_load_dwordx4 a[184:187], v13, s[64:67], s51 offen offset:2048 sc1
  v_mfma_f32_16x16x32_bf16 v[156:159], a[192:195], a[60:63], v[156:159]
  s_waitcnt lgkmcnt(4)
  v_mfma_f32_16x16x32_bf16 v[160:163], a[196:199], a[32:35], v[160:163]
  ds_read_b64_tr_b16 a[212:213], v22 offset:49152
  ds_read_b64_tr_b16 a[214:215], v22 offset:53248
  v_mfma_f32_16x16x32_bf16 v[160:163], a[200:203], a[48:51], v[160:163]
  v_mfma_f32_16x16x32_bf16 v[164:167], a[196:199], a[36:39], v[164:167]
  v_mfma_f32_16x16x32_bf16 v[164:167], a[200:203], a[52:55], v[164:167]
  buffer_load_dwordx4 a[188:191], v13, s[64:67], s51 offen offset:3072 sc1
  v_mfma_f32_16x16x32_bf16 v[168:171], a[196:199], a[40:43], v[168:171]
  ds_read_b64_tr_b16 a[216:217], v22 offset:57344
  ds_read_b64_tr_b16 a[218:219], v22 offset:61440
  v_mfma_f32_16x16x32_bf16 v[168:171], a[200:203], a[56:59], v[168:171]
  s_add_u32 s51, s51, 262144
  v_mfma_f32_16x16x32_bf16 v[172:175], a[196:199], a[44:47], v[172:175]
  v_mfma_f32_16x16x32_bf16 v[172:175], a[200:203], a[60:63], v[172:175]
  s_waitcnt vmcnt(28) lgkmcnt(4)
  s_barrier
  v_mfma_f32_16x16x32_bf16 v[176:179], a[204:207], a[32:35], v[176:179]
  ds_read_b64_tr_b16 a[192:193], v24 offset:0
  ds_read_b64_tr_b16 a[194:195], v24 offset:4096
  v_mfma_f32_16x16x32_bf16 v[176:179], a[208:211], a[48:51], v[176:179]
  buffer_load_dwordx4 a[0:3], v12, s[64:67], s51 offen offset:0 sc1
  v_mfma_f32_16x16x32_bf16 v[180:183], a[204:207], a[36:39], v[180:183]
  s_add_u32 m0, s52, 32768
  v_mfma_f32_16x16x32_bf16 v[180:183], a[208:211], a[52:55], v[180:183]
  buffer_load_dwordx4 a[4:7], v12, s[64:67], s51 offen offset:1024 sc1
  v_mfma_f32_16x16x32_bf16 v[184:187], a[204:207], a[40:43], v[184:187]
  ds_read_b64_tr_b16 a[196:197], v24 offset:8192
  ds_read_b64_tr_b16 a[198:199], v24 offset:12288
  v_mfma_f32_16x16x32_bf16 v[184:187], a[208:211], a[56:59], v[184:187]
  v_mfma_f32_16x16x32_bf16 v[188:191], a[204:207], a[44:47], v[188:191]
  v_mfma_f32_16x16x32_bf16 v[188:191], a[208:211], a[60:63], v[188:191]
  s_waitcnt lgkmcnt(4)
  v_mfma_f32_16x16x32_bf16 v[192:195], a[212:215], a[32:35], v[192:195]
  ds_read_b64_tr_b16 a[200:201], v25 offset:0
  ds_read_b64_tr_b16 a[202:203], v25 offset:4096
  v_mfma_f32_16x16x32_bf16 v[192:195], a[216:219], a[48:51], v[192:195]
  buffer_load_dwordx4 v208, s[12:15], s50 offen offset:0 lds
  v_mfma_f32_16x16x32_bf16 v[196:199], a[212:215], a[36:39], v[196:199]
  v_mfma_f32_16x16x32_bf16 v[196:199], a[216:219], a[52:55], v[196:199]
  v_mfma_f32_16x16x32_bf16 v[200:203], a[212:215], a[40:43], v[200:203]
  ds_read_b64_tr_b16 a[204:205], v25 offset:8192
  ds_read_b64_tr_b16 a[206:207], v25 offset:12288
  v_mfma_f32_16x16x32_bf16 v[200:203], a[216:219], a[56:59], v[200:203]
  buffer_load_dwordx4 v209, s[12:15], s50 offen offset:1024 lds
  v_mfma_f32_16x16x32_bf16 v[204:207], a[212:215], a[44:47], v[204:207]
  v_mfma_f32_16x16x32_bf16 v[204:207], a[216:219], a[60:63], v[204:207]
  s_waitcnt lgkmcnt(4)
  v_mfma_f32_16x16x32_bf16 v[96:99], a[192:195], a[64:67], v[96:99]
  ds_read_b64_tr_b16 a[208:209], v26 offset:0
  ds_read_b64_tr_b16 a[210:211], v26 offset:4096
  v_mfma_f32_16x16x32_bf16 v[96:99], a[196:199], a[80:83], v[96:99]
  v_mfma_f32_16x16x32_bf16 v[100:103], a[192:195], a[68:71], v[100:103]
  buffer_load_dwordx4 v210, s[12:15], s50 offen offset:2048 lds
  v_mfma_f32_16x16x32_bf16 v[100:103], a[196:199], a[84:87], v[100:103]
  v_mfma_f32_16x16x32_bf16 v[104:107], a[192:195], a[72:75], v[104:107]
  ds_read_b64_tr_b16 a[212:213], v26 offset:8192
  ds_read_b64_tr_b16 a[214:215], v26 offset:12288
  v_mfma_f32_16x16x32_bf16 v[104:107], a[196:199], a[88:91], v[104:107]
  v_mfma_f32_16x16x32_bf16 v[108:111], a[192:195], a[76:79], v[108:111]
  buffer_load_dwordx4 v211, s[12:15], s50 offen offset:3072 lds
  v_mfma_f32_16x16x32_bf16 v[108:111], a[196:199], a[92:95], v[108:111]
  s_add_u32 s50, s50, 458752
  s_waitcnt lgkmcnt(4)
  v_mfma_f32_16x16x32_bf16 v[112:115], a[200:203], a[64:67], v[112:115]
  ds_read_b64_tr_b16 a[216:217], v27 offset:0
  ds_read_b64_tr_b16 a[218:219], v27 offset:4096
  v_mfma_f32_16x16x32_bf16 v[112:115], a[204:207], a[80:83], v[112:115]
  v_mfma_f32_16x16x32_bf16 v[116:119], a[200:203], a[68:71], v[116:119]
  v_mfma_f32_16x16x32_bf16 v[116:119], a[204:207], a[84:87], v[116:119]
  buffer_load_dwordx4 a[8:11], v12, s[64:67], s51 offen offset:2048 sc1
  v_mfma_f32_16x16x32_bf16 v[120:123], a[200:203], a[72:75], v[120:123]
  ds_read_b64_tr_b16 a[192:193], v27 offset:8192
  ds_read_b64_tr_b16 a[194:195], v27 offset:12288
  v_mfma_f32_16x16x32_bf16 v[120:123], a[204:207], a[88:91], v[120:123]
  v_mfma_f32_16x16x32_bf16 v[124:127], a[200:203], a[76:79], v[124:127]
  v_mfma_f32_16x16x32_bf16 v[124:127], a[204:207], a[92:95], v[124:127]
  s_waitcnt lgkmcnt(4)
  v_mfma_f32_16x16x32_bf16 v[128:131], a[208:211], a[64:67], v[128:131]
  ds_read_b64_tr_b16 a[196:197], v28 offset:0
  ds_read_b64_tr_b16 a[198:199], v28 offset:4096
  v_mfma_f32_16x16x32_bf16 v[128:131], a[212:215], a[80:83], v[128:131]
  buffer_load_dwordx4 a[12:15], v12, s[64:67], s51 offen offset:3072 sc1
  v_mfma_f32_16x16x32_bf16 v[132:135], a[208:211], a[68:71], v[132:135]
  v_mfma_f32_16x16x32_bf16 v[132:135], a[212:215], a[84:87], v[132:135]
  v_mfma_f32_16x16x32_bf16 v[136:139], a[208:211], a[72:75], v[136:139]
  ds_read_b64_tr_b16 a[200:201], v28 offset:8192
  ds_read_b64_tr_b16 a[202:203], v28 offset:12288
  v_mfma_f32_16x16x32_bf16 v[136:139], a[212:215], a[88:91], v[136:139]
  buffer_load_dwordx4 a[16:19], v13, s[64:67], s51 offen offset:0 sc1
  v_mfma_f32_16x16x32_bf16 v[140:143], a[208:211], a[76:79], v[140:143]
  v_mfma_f32_16x16x32_bf16 v[140:143], a[212:215], a[92:95], v[140:143]
  s_waitcnt lgkmcnt(4)
  v_mfma_f32_16x16x32_bf16 v[144:147], a[216:219], a[64:67], v[144:147]
  ds_read_b64_tr_b16 a[204:205], v29 offset:0
  ds_read_b64_tr_b16 a[206:207], v29 offset:4096
  v_mfma_f32_16x16x32_bf16 v[144:147], a[192:195], a[80:83], v[144:147]
  v_mfma_f32_16x16x32_bf16 v[148:151], a[216:219], a[68:71], v[148:151]
  buffer_load_dwordx4 a[20:23], v13, s[64:67], s51 offen offset:1024 sc1
  v_mfma_f32_16x16x32_bf16 v[148:151], a[192:195], a[84:87], v[148:151]
  v_mfma_f32_16x16x32_bf16 v[152:155], a[216:219], a[72:75], v[152:155]
  ds_read_b64_tr_b16 a[208:209], v29 offset:8192
  ds_read_b64_tr_b16 a[210:211], v29 offset:12288
  v_mfma_f32_16x16x32_bf16 v[152:155], a[192:195], a[88:91], v[152:155]
  v_mfma_f32_16x16x32_bf16 v[156:159], a[216:219], a[76:79], v[156:159]
  buffer_load_dwordx4 a[24:27], v13, s[64:67], s51 offen offset:2048 sc1
  v_mfma_f32_16x16x32_bf16 v[156:159], a[192:195], a[92:95], v[156:159]
  s_waitcnt lgkmcnt(4)
  v_mfma_f32_16x16x32_bf16 v[160:163], a[196:199], a[64:67], v[160:163]
  ds_read_b64_tr_b16 a[212:213], v30 offset:0
  ds_read_b64_tr_b16 a[214:215], v30 offset:4096
  v_mfma_f32_16x16x32_bf16 v[160:163], a[200:203], a[80:83], v[160:163]
  v_mfma_f32_16x16x32_bf16 v[164:167], a[196:199], a[68:71], v[164:167]
  v_mfma_f32_16x16x32_bf16 v[164:167], a[200:203], a[84:87], v[164:167]
  buffer_load_dwordx4 a[28:31], v13, s[64:67], s51 offen offset:3072 sc1
  v_mfma_f32_16x16x32_bf16 v[168:171], a[196:199], a[72:75], v[168:171]
  ds_read_b64_tr_b16 a[216:217], v30 offset:8192
  ds_read_b64_tr_b16 a[218:219], v30 offset:12288
  v_mfma_f32_16x16x32_bf16 v[168:171], a[200:203], a[88:91], v[168:171]
  s_add_u32 s51, s51, 262144
  v_mfma_f32_16x16x32_bf16 v[172:175], a[196:199], a[76:79], v[172:175]
  v_mfma_f32_16x16x32_bf16 v[172:175], a[200:203], a[92:95], v[172:175]
  s_waitcnt vmcnt(32) lgkmcnt(4)
  s_barrier
  v_mfma_f32_16x16x32_bf16 v[176:179], a[204:207], a[64:67], v[176:179]
  ds_read_b64_tr_b16 a[192:193], v24 offset:16384
  ds_read_b64_tr_b16 a[194:195], v24 offset:20480
  v_mfma_f32_16x16x32_bf16 v[176:179], a[208:211], a[80:83], v[176:179]
  buffer_load_dwordx4 a[32:35], v12, s[64:67], s51 offen offset:0 sc1
  v_mfma_f32_16x16x32_bf16 v[180:183], a[204:207], a[68:71], v[180:183]
  s_add_u32 m0, s52, 49152
  v_mfma_f32_16x16x32_bf16 v[180:183], a[208:211], a[84:87], v[180:183]
  buffer_load_dwordx4 a[36:39], v12, s[64:67], s51 offen offset:1024 sc1
  v_mfma_f32_16x16x32_bf16 v[184:187], a[204:207], a[72:75], v[184:187]
  ds_read_b64_tr_b16 a[196:197], v24 offset:24576
  ds_read_b64_tr_b16 a[198:199], v24 offset:28672
  v_mfma_f32_16x16x32_bf16 v[184:187], a[208:211], a[88:91], v[184:187]
  v_mfma_f32_16x16x32_bf16 v[188:191], a[204:207], a[76:79], v[188:191]
  v_mfma_f32_16x16x32_bf16 v[188:191], a[208:211], a[92:95], v[188:191]
  s_waitcnt lgkmcnt(4)
  v_mfma_f32_16x16x32_bf16 v[192:195], a[212:215], a[64:67], v[192:195]
  ds_read_b64_tr_b16 a[200:201], v25 offset:16384
  ds_read_b64_tr_b16 a[202:203], v25 offset:20480
  v_mfma_f32_16x16x32_bf16 v[192:195], a[216:219], a[80:83], v[192:195]
  buffer_load_dwordx4 v208, s[12:15], s50 offen offset:0 lds
  v_mfma_f32_16x16x32_bf16 v[196:199], a[212:215], a[68:71], v[196:199]
  v_mfma_f32_16x16x32_bf16 v[196:199], a[216:219], a[84:87], v[196:199]
  v_mfma_f32_16x16x32_bf16 v[200:203], a[212:215], a[72:75], v[200:203]
  ds_read_b64_tr_b16 a[204:205], v25 offset:24576
  ds_read_b64_tr_b16 a[206:207], v25 offset:28672
  v_mfma_f32_16x16x32_bf16 v[200:203], a[216:219], a[88:91], v[200:203]
  buffer_load_dwordx4 v209, s[12:15], s50 offen offset:1024 lds
  v_mfma_f32_16x16x32_bf16 v[204:207], a[212:215], a[76:79], v[204:207]
  v_mfma_f32_16x16x32_bf16 v[204:207], a[216:219], a[92:95], v[204:207]
  s_waitcnt lgkmcnt(4)
  v_mfma_f32_16x16x32_bf16 v[96:99], a[192:195], a[96:99], v[96:99]
  ds_read_b64_tr_b16 a[208:209], v26 offset:16384
  ds_read_b64_tr_b16 a[210:211], v26 offset:20480
  v_mfma_f32_16x16x32_bf16 v[96:99], a[196:199], a[112:115], v[96:99]
  v_mfma_f32_16x16x32_bf16 v[100:103], a[192:195], a[100:103], v[100:103]
  buffer_load_dwordx4 v210, s[12:15], s50 offen offset:2048 lds
  v_mfma_f32_16x16x32_bf16 v[100:103], a[196:199], a[116:119], v[100:103]
  v_mfma_f32_16x16x32_bf16 v[104:107], a[192:195], a[104:107], v[104:107]
  ds_read_b64_tr_b16 a[212:213], v26 offset:24576
  ds_read_b64_tr_b16 a[214:215], v26 offset:28672
  v_mfma_f32_16x16x32_bf16 v[104:107], a[196:199], a[120:123], v[104:107]
  v_mfma_f32_16x16x32_bf16 v[108:111], a[192:195], a[108:111], v[108:111]
  buffer_load_dwordx4 v211, s[12:15], s50 offen offset:3072 lds
  v_mfma_f32_16x16x32_bf16 v[108:111], a[196:199], a[124:127], v[108:111]
  s_add_u32 s50, s50, 458752
  s_waitcnt lgkmcnt(4)
  v_mfma_f32_16x16x32_bf16 v[112:115], a[200:203], a[96:99], v[112:115]
  ds_read_b64_tr_b16 a[216:217], v27 offset:16384
  ds_read_b64_tr_b16 a[218:219], v27 offset:20480
  v_mfma_f32_16x16x32_bf16 v[112:115], a[204:207], a[112:115], v[112:115]
  v_mfma_f32_16x16x32_bf16 v[116:119], a[200:203], a[100:103], v[116:119]
  v_mfma_f32_16x16x32_bf16 v[116:119], a[204:207], a[116:119], v[116:119]
  buffer_load_dwordx4 a[40:43], v12, s[64:67], s51 offen offset:2048 sc1
  v_mfma_f32_16x16x32_bf16 v[120:123], a[200:203], a[104:107], v[120:123]
  ds_read_b64_tr_b16 a[192:193], v27 offset:24576
  ds_read_b64_tr_b16 a[194:195], v27 offset:28672
  v_mfma_f32_16x16x32_bf16 v[120:123], a[204:207], a[120:123], v[120:123]
  v_mfma_f32_16x16x32_bf16 v[124:127], a[200:203], a[108:111], v[124:127]
  v_mfma_f32_16x16x32_bf16 v[124:127], a[204:207], a[124:127], v[124:127]
  s_waitcnt lgkmcnt(4)
  v_mfma_f32_16x16x32_bf16 v[128:131], a[208:211], a[96:99], v[128:131]
  ds_read_b64_tr_b16 a[196:197], v28 offset:16384
  ds_read_b64_tr_b16 a[198:199], v28 offset:20480
  v_mfma_f32_16x16x32_bf16 v[128:131], a[212:215], a[112:115], v[128:131]
  buffer_load_dwordx4 a[44:47], v12, s[64:67], s51 offen offset:3072 sc1
  v_mfma_f32_16x16x32_bf16 v[132:135], a[208:211], a[100:103], v[132:135]
  v_mfma_f32_16x16x32_bf16 v[132:135], a[212:215], a[116:119], v[132:135]
  v_mfma_f32_16x16x32_bf16 v[136:139], a[208:211], a[104:107], v[136:139]
  ds_read_b64_tr_b16 a[200:201], v28 offset:24576
  ds_read_b64_tr_b16 a[202:203], v28 offset:28672
  v_mfma_f32_16x16x32_bf16 v[136:139], a[212:215], a[120:123], v[136:139]
  buffer_load_dwordx4 a[48:51], v13, s[64:67], s51 offen offset:0 sc1
  v_mfma_f32_16x16x32_bf16 v[140:143], a[208:211], a[108:111], v[140:143]
  v_mfma_f32_16x16x32_bf16 v[140:143], a[212:215], a[124:127], v[140:143]
  s_waitcnt lgkmcnt(4)
  v_mfma_f32_16x16x32_bf16 v[144:147], a[216:219], a[96:99], v[144:147]
  ds_read_b64_tr_b16 a[204:205], v29 offset:16384
  ds_read_b64_tr_b16 a[206:207], v29 offset:20480
  v_mfma_f32_16x16x32_bf16 v[144:147], a[192:195], a[112:115], v[144:147]
  v_mfma_f32_16x16x32_bf16 v[148:151], a[216:219], a[100:103], v[148:151]
  buffer_load_dwordx4 a[52:55], v13, s[64:67], s51 offen offset:1024 sc1
  v_mfma_f32_16x16x32_bf16 v[148:151], a[192:195], a[116:119], v[148:151]
  v_mfma_f32_16x16x32_bf16 v[152:155], a[216:219], a[104:107], v[152:155]
  ds_read_b64_tr_b16 a[208:209], v29 offset:24576
  ds_read_b64_tr_b16 a[210:211], v29 offset:28672
  v_mfma_f32_16x16x32_bf16 v[152:155], a[192:195], a[120:123], v[152:155]
  v_mfma_f32_16x16x32_bf16 v[156:159], a[216:219], a[108:111], v[156:159]
  buffer_load_dwordx4 a[56:59], v13, s[64:67], s51 offen offset:2048 sc1
  v_mfma_f32_16x16x32_bf16 v[156:159], a[192:195], a[124:127], v[156:159]
  s_waitcnt lgkmcnt(4)
  v_mfma_f32_16x16x32_bf16 v[160:163], a[196:199], a[96:99], v[160:163]
  ds_read_b64_tr_b16 a[212:213], v30 offset:16384
  ds_read_b64_tr_b16 a[214:215], v30 offset:20480
  v_mfma_f32_16x16x32_bf16 v[160:163], a[200:203], a[112:115], v[160:163]
  v_mfma_f32_16x16x32_bf16 v[164:167], a[196:199], a[100:103], v[164:167]
  v_mfma_f32_16x16x32_bf16 v[164:167], a[200:203], a[116:119], v[164:167]
  buffer_load_dwordx4 a[60:63], v13, s[64:67], s51 offen offset:3072 sc1
  v_mfma_f32_16x16x32_bf16 v[168:171], a[196:199], a[104:107], v[168:171]
  ds_read_b64_tr_b16 a[216:217], v30 offset:24576
  ds_read_b64_tr_b16 a[218:219], v30 offset:28672
  v_mfma_f32_16x16x32_bf16 v[168:171], a[200:203], a[120:123], v[168:171]
  s_add_u32 s51, s51, 262144
  v_mfma_f32_16x16x32_bf16 v[172:175], a[196:199], a[108:111], v[172:175]
  v_mfma_f32_16x16x32_bf16 v[172:175], a[200:203], a[124:127], v[172:175]
  s_waitcnt vmcnt(36) lgkmcnt(4)
  s_barrier
  v_mfma_f32_16x16x32_bf16 v[176:179], a[204:207], a[96:99], v[176:179]
  ds_read_b64_tr_b16 a[192:193], v24 offset:32768
  ds_read_b64_tr_b16 a[194:195], v24 offset:36864
  v_mfma_f32_16x16x32_bf16 v[176:179], a[208:211], a[112:115], v[176:179]
  buffer_load_dwordx4 a[64:67], v12, s[64:67], s51 offen offset:0 sc1
  v_mfma_f32_16x16x32_bf16 v[180:183], a[204:207], a[100:103], v[180:183]
  s_add_u32 m0, s52, 65536
  v_mfma_f32_16x16x32_bf16 v[180:183], a[208:211], a[116:119], v[180:183]
  buffer_load_dwordx4 a[68:71], v12, s[64:67], s51 offen offset:1024 sc1
  v_mfma_f32_16x16x32_bf16 v[184:187], a[204:207], a[104:107], v[184:187]
  ds_read_b64_tr_b16 a[196:197], v24 offset:40960
  ds_read_b64_tr_b16 a[198:199], v24 offset:45056
  v_mfma_f32_16x16x32_bf16 v[184:187], a[208:211], a[120:123], v[184:187]
  v_mfma_f32_16x16x32_bf16 v[188:191], a[204:207], a[108:111], v[188:191]
  v_mfma_f32_16x16x32_bf16 v[188:191], a[208:211], a[124:127], v[188:191]
  s_waitcnt lgkmcnt(4)
  v_mfma_f32_16x16x32_bf16 v[192:195], a[212:215], a[96:99], v[192:195]
  ds_read_b64_tr_b16 a[200:201], v25 offset:32768
  ds_read_b64_tr_b16 a[202:203], v25 offset:36864
  v_mfma_f32_16x16x32_bf16 v[192:195], a[216:219], a[112:115], v[192:195]
  buffer_load_dwordx4 v208, s[12:15], s50 offen offset:0 lds
  v_mfma_f32_16x16x32_bf16 v[196:199], a[212:215], a[100:103], v[196:199]
  v_mfma_f32_16x16x32_bf16 v[196:199], a[216:219], a[116:119], v[196:199]
  v_mfma_f32_16x16x32_bf16 v[200:203], a[212:215], a[104:107], v[200:203]
  ds_read_b64_tr_b16 a[204:205], v25 offset:40960
  ds_read_b64_tr_b16 a[206:207], v25 offset:45056
  v_mfma_f32_16x16x32_bf16 v[200:203], a[216:219], a[120:123], v[200:203]
  buffer_load_dwordx4 v209, s[12:15], s50 offen offset:1024 lds
  v_mfma_f32_16x16x32_bf16 v[204:207], a[212:215], a[108:111], v[204:207]
  v_mfma_f32_16x16x32_bf16 v[204:207], a[216:219], a[124:127], v[204:207]
  s_waitcnt lgkmcnt(4)
  v_mfma_f32_16x16x32_bf16 v[96:99], a[192:195], a[128:131], v[96:99]
  ds_read_b64_tr_b16 a[208:209], v26 offset:32768
  ds_read_b64_tr_b16 a[210:211], v26 offset:36864
  v_mfma_f32_16x16x32_bf16 v[96:99], a[196:199], a[144:147], v[96:99]
  v_mfma_f32_16x16x32_bf16 v[100:103], a[192:195], a[132:135], v[100:103]
  buffer_load_dwordx4 v210, s[12:15], s50 offen offset:2048 lds
  v_mfma_f32_16x16x32_bf16 v[100:103], a[196:199], a[148:151], v[100:103]
  v_mfma_f32_16x16x32_bf16 v[104:107], a[192:195], a[136:139], v[104:107]
  ds_read_b64_tr_b16 a[212:213], v26 offset:40960
  ds_read_b64_tr_b16 a[214:215], v26 offset:45056
  v_mfma_f32_16x16x32_bf16 v[104:107], a[196:199], a[152:155], v[104:107]
  v_mfma_f32_16x16x32_bf16 v[108:111], a[192:195], a[140:143], v[108:111]
  buffer_load_dwordx4 v211, s[12:15], s50 offen offset:3072 lds
  v_mfma_f32_16x16x32_bf16 v[108:111], a[196:199], a[156:159], v[108:111]
  s_add_u32 s50, s50, 458752
  s_waitcnt lgkmcnt(4)
  v_mfma_f32_16x16x32_bf16 v[112:115], a[200:203], a[128:131], v[112:115]
  ds_read_b64_tr_b16 a[216:217], v27 offset:32768
  ds_read_b64_tr_b16 a[218:219], v27 offset:36864
  v_mfma_f32_16x16x32_bf16 v[112:115], a[204:207], a[144:147], v[112:115]
  v_mfma_f32_16x16x32_bf16 v[116:119], a[200:203], a[132:135], v[116:119]
  v_mfma_f32_16x16x32_bf16 v[116:119], a[204:207], a[148:151], v[116:119]
  buffer_load_dwordx4 a[72:75], v12, s[64:67], s51 offen offset:2048 sc1
  v_mfma_f32_16x16x32_bf16 v[120:123], a[200:203], a[136:139], v[120:123]
  ds_read_b64_tr_b16 a[192:193], v27 offset:40960
  ds_read_b64_tr_b16 a[194:195], v27 offset:45056
  v_mfma_f32_16x16x32_bf16 v[120:123], a[204:207], a[152:155], v[120:123]
  v_mfma_f32_16x16x32_bf16 v[124:127], a[200:203], a[140:143], v[124:127]
  v_mfma_f32_16x16x32_bf16 v[124:127], a[204:207], a[156:159], v[124:127]
  s_waitcnt lgkmcnt(4)
  v_mfma_f32_16x16x32_bf16 v[128:131], a[208:211], a[128:131], v[128:131]
  ds_read_b64_tr_b16 a[196:197], v28 offset:32768
  ds_read_b64_tr_b16 a[198:199], v28 offset:36864
  v_mfma_f32_16x16x32_bf16 v[128:131], a[212:215], a[144:147], v[128:131]
  buffer_load_dwordx4 a[76:79], v12, s[64:67], s51 offen offset:3072 sc1
  v_mfma_f32_16x16x32_bf16 v[132:135], a[208:211], a[132:135], v[132:135]
  v_mfma_f32_16x16x32_bf16 v[132:135], a[212:215], a[148:151], v[132:135]
  v_mfma_f32_16x16x32_bf16 v[136:139], a[208:211], a[136:139], v[136:139]
  ds_read_b64_tr_b16 a[200:201], v28 offset:40960
  ds_read_b64_tr_b16 a[202:203], v28 offset:45056
  v_mfma_f32_16x16x32_bf16 v[136:139], a[212:215], a[152:155], v[136:139]
  buffer_load_dwordx4 a[80:83], v13, s[64:67], s51 offen offset:0 sc1
  v_mfma_f32_16x16x32_bf16 v[140:143], a[208:211], a[140:143], v[140:143]
  v_mfma_f32_16x16x32_bf16 v[140:143], a[212:215], a[156:159], v[140:143]
  s_waitcnt lgkmcnt(4)
  v_mfma_f32_16x16x32_bf16 v[144:147], a[216:219], a[128:131], v[144:147]
  ds_read_b64_tr_b16 a[204:205], v29 offset:32768
  ds_read_b64_tr_b16 a[206:207], v29 offset:36864
  v_mfma_f32_16x16x32_bf16 v[144:147], a[192:195], a[144:147], v[144:147]
  v_mfma_f32_16x16x32_bf16 v[148:151], a[216:219], a[132:135], v[148:151]
  buffer_load_dwordx4 a[84:87], v13, s[64:67], s51 offen offset:1024 sc1
  v_mfma_f32_16x16x32_bf16 v[148:151], a[192:195], a[148:151], v[148:151]
  v_mfma_f32_16x16x32_bf16 v[152:155], a[216:219], a[136:139], v[152:155]
  ds_read_b64_tr_b16 a[208:209], v29 offset:40960
  ds_read_b64_tr_b16 a[210:211], v29 offset:45056
  v_mfma_f32_16x16x32_bf16 v[152:155], a[192:195], a[152:155], v[152:155]
  v_mfma_f32_16x16x32_bf16 v[156:159], a[216:219], a[140:143], v[156:159]
  buffer_load_dwordx4 a[88:91], v13, s[64:67], s51 offen offset:2048 sc1
  v_mfma_f32_16x16x32_bf16 v[156:159], a[192:195], a[156:159], v[156:159]
  s_waitcnt lgkmcnt(4)
  v_mfma_f32_16x16x32_bf16 v[160:163], a[196:199], a[128:131], v[160:163]
  ds_read_b64_tr_b16 a[212:213], v30 offset:32768
  ds_read_b64_tr_b16 a[214:215], v30 offset:36864
  v_mfma_f32_16x16x32_bf16 v[160:163], a[200:203], a[144:147], v[160:163]
  v_mfma_f32_16x16x32_bf16 v[164:167], a[196:199], a[132:135], v[164:167]
  v_mfma_f32_16x16x32_bf16 v[164:167], a[200:203], a[148:151], v[164:167]
  buffer_load_dwordx4 a[92:95], v13, s[64:67], s51 offen offset:3072 sc1
  v_mfma_f32_16x16x32_bf16 v[168:171], a[196:199], a[136:139], v[168:171]
  ds_read_b64_tr_b16 a[216:217], v30 offset:40960
  ds_read_b64_tr_b16 a[218:219], v30 offset:45056
  v_mfma_f32_16x16x32_bf16 v[168:171], a[200:203], a[152:155], v[168:171]
  s_add_u32 s51, s51, 262144
  v_mfma_f32_16x16x32_bf16 v[172:175], a[196:199], a[140:143], v[172:175]
  v_mfma_f32_16x16x32_bf16 v[172:175], a[200:203], a[156:159], v[172:175]
  s_waitcnt vmcnt(36) lgkmcnt(4)
  s_barrier
  v_mfma_f32_16x16x32_bf16 v[176:179], a[204:207], a[128:131], v[176:179]
  ds_read_b64_tr_b16 a[192:193], v24 offset:49152
  ds_read_b64_tr_b16 a[194:195], v24 offset:53248
  v_mfma_f32_16x16x32_bf16 v[176:179], a[208:211], a[144:147], v[176:179]
  buffer_load_dwordx4 a[96:99], v12, s[64:67], s51 offen offset:0 sc1
  v_mfma_f32_16x16x32_bf16 v[180:183], a[204:207], a[132:135], v[180:183]
  s_add_u32 m0, s52, 81920
  v_mfma_f32_16x16x32_bf16 v[180:183], a[208:211], a[148:151], v[180:183]
  buffer_load_dwordx4 a[100:103], v12, s[64:67], s51 offen offset:1024 sc1
  v_mfma_f32_16x16x32_bf16 v[184:187], a[204:207], a[136:139], v[184:187]
  ds_read_b64_tr_b16 a[196:197], v24 offset:57344
  ds_read_b64_tr_b16 a[198:199], v24 offset:61440
  v_mfma_f32_16x16x32_bf16 v[184:187], a[208:211], a[152:155], v[184:187]
  v_mfma_f32_16x16x32_bf16 v[188:191], a[204:207], a[140:143], v[188:191]
  v_mfma_f32_16x16x32_bf16 v[188:191], a[208:211], a[156:159], v[188:191]
  s_waitcnt lgkmcnt(4)
  v_mfma_f32_16x16x32_bf16 v[192:195], a[212:215], a[128:131], v[192:195]
  ds_read_b64_tr_b16 a[200:201], v25 offset:49152
  ds_read_b64_tr_b16 a[202:203], v25 offset:53248
  v_mfma_f32_16x16x32_bf16 v[192:195], a[216:219], a[144:147], v[192:195]
  buffer_load_dwordx4 v208, s[12:15], s50 offen offset:0 lds
  v_mfma_f32_16x16x32_bf16 v[196:199], a[212:215], a[132:135], v[196:199]
  v_mfma_f32_16x16x32_bf16 v[196:199], a[216:219], a[148:151], v[196:199]
  v_mfma_f32_16x16x32_bf16 v[200:203], a[212:215], a[136:139], v[200:203]
  ds_read_b64_tr_b16 a[204:205], v25 offset:57344
  ds_read_b64_tr_b16 a[206:207], v25 offset:61440
  v_mfma_f32_16x16x32_bf16 v[200:203], a[216:219], a[152:155], v[200:203]
  buffer_load_dwordx4 v209, s[12:15], s50 offen offset:1024 lds
  v_mfma_f32_16x16x32_bf16 v[204:207], a[212:215], a[140:143], v[204:207]
  v_mfma_f32_16x16x32_bf16 v[204:207], a[216:219], a[156:159], v[204:207]
  s_waitcnt lgkmcnt(4)
  v_mfma_f32_16x16x32_bf16 v[96:99], a[192:195], a[160:163], v[96:99]
  ds_read_b64_tr_b16 a[208:209], v26 offset:49152
  ds_read_b64_tr_b16 a[210:211], v26 offset:53248
  v_mfma_f32_16x16x32_bf16 v[96:99], a[196:199], a[176:179], v[96:99]
  v_mfma_f32_16x16x32_bf16 v[100:103], a[192:195], a[164:167], v[100:103]
  buffer_load_dwordx4 v210, s[12:15], s50 offen offset:2048 lds
  v_mfma_f32_16x16x32_bf16 v[100:103], a[196:199], a[180:183], v[100:103]
  v_mfma_f32_16x16x32_bf16 v[104:107], a[192:195], a[168:171], v[104:107]
  ds_read_b64_tr_b16 a[212:213], v26 offset:57344
  ds_read_b64_tr_b16 a[214:215], v26 offset:61440
  v_mfma_f32_16x16x32_bf16 v[104:107], a[196:199], a[184:187], v[104:107]
  v_mfma_f32_16x16x32_bf16 v[108:111], a[192:195], a[172:175], v[108:111]
  buffer_load_dwordx4 v211, s[12:15], s50 offen offset:3072 lds
  v_mfma_f32_16x16x32_bf16 v[108:111], a[196:199], a[188:191], v[108:111]
  s_add_u32 s50, s50, 458752
  s_waitcnt lgkmcnt(4)
  v_mfma_f32_16x16x32_bf16 v[112:115], a[200:203], a[160:163], v[112:115]
  ds_read_b64_tr_b16 a[216:217], v27 offset:49152
  ds_read_b64_tr_b16 a[218:219], v27 offset:53248
  v_mfma_f32_16x16x32_bf16 v[112:115], a[204:207], a[176:179], v[112:115]
  v_mfma_f32_16x16x32_bf16 v[116:119], a[200:203], a[164:167], v[116:119]
  v_mfma_f32_16x16x32_bf16 v[116:119], a[204:207], a[180:183], v[116:119]
  buffer_load_dwordx4 a[104:107], v12, s[64:67], s51 offen offset:2048 sc1
  v_mfma_f32_16x16x32_bf16 v[120:123], a[200:203], a[168:171], v[120:123]
  ds_read_b64_tr_b16 a[192:193], v27 offset:57344
  ds_read_b64_tr_b16 a[194:195], v27 offset:61440
  v_mfma_f32_16x16x32_bf16 v[120:123], a[204:207], a[184:187], v[120:123]
  v_mfma_f32_16x16x32_bf16 v[124:127], a[200:203], a[172:175], v[124:127]
  v_mfma_f32_16x16x32_bf16 v[124:127], a[204:207], a[188:191], v[124:127]
  s_waitcnt lgkmcnt(4)
  v_mfma_f32_16x16x32_bf16 v[128:131], a[208:211], a[160:163], v[128:131]
  ds_read_b64_tr_b16 a[196:197], v28 offset:49152
  ds_read_b64_tr_b16 a[198:199], v28 offset:53248
  v_mfma_f32_16x16x32_bf16 v[128:131], a[212:215], a[176:179], v[128:131]
  buffer_load_dwordx4 a[108:111], v12, s[64:67], s51 offen offset:3072 sc1
  v_mfma_f32_16x16x32_bf16 v[132:135], a[208:211], a[164:167], v[132:135]
  v_mfma_f32_16x16x32_bf16 v[132:135], a[212:215], a[180:183], v[132:135]
  v_mfma_f32_16x16x32_bf16 v[136:139], a[208:211], a[168:171], v[136:139]
  ds_read_b64_tr_b16 a[200:201], v28 offset:57344
  ds_read_b64_tr_b16 a[202:203], v28 offset:61440
  v_mfma_f32_16x16x32_bf16 v[136:139], a[212:215], a[184:187], v[136:139]
  buffer_load_dwordx4 a[112:115], v13, s[64:67], s51 offen offset:0 sc1
  v_mfma_f32_16x16x32_bf16 v[140:143], a[208:211], a[172:175], v[140:143]
  v_mfma_f32_16x16x32_bf16 v[140:143], a[212:215], a[188:191], v[140:143]
  s_waitcnt lgkmcnt(4)
  v_mfma_f32_16x16x32_bf16 v[144:147], a[216:219], a[160:163], v[144:147]
  ds_read_b64_tr_b16 a[204:205], v29 offset:49152
  ds_read_b64_tr_b16 a[206:207], v29 offset:53248
  v_mfma_f32_16x16x32_bf16 v[144:147], a[192:195], a[176:179], v[144:147]
  v_mfma_f32_16x16x32_bf16 v[148:151], a[216:219], a[164:167], v[148:151]
  buffer_load_dwordx4 a[116:119], v13, s[64:67], s51 offen offset:1024 sc1
  v_mfma_f32_16x16x32_bf16 v[148:151], a[192:195], a[180:183], v[148:151]
  v_mfma_f32_16x16x32_bf16 v[152:155], a[216:219], a[168:171], v[152:155]
  ds_read_b64_tr_b16 a[208:209], v29 offset:57344
  ds_read_b64_tr_b16 a[210:211], v29 offset:61440
  v_mfma_f32_16x16x32_bf16 v[152:155], a[192:195], a[184:187], v[152:155]
  v_mfma_f32_16x16x32_bf16 v[156:159], a[216:219], a[172:175], v[156:159]
  buffer_load_dwordx4 a[120:123], v13, s[64:67], s51 offen offset:2048 sc1
  v_mfma_f32_16x16x32_bf16 v[156:159], a[192:195], a[188:191], v[156:159]
  s_waitcnt lgkmcnt(4)
  v_mfma_f32_16x16x32_bf16 v[160:163], a[196:199], a[160:163], v[160:163]
  ds_read_b64_tr_b16 a[212:213], v30 offset:49152
  ds_read_b64_tr_b16 a[214:215], v30 offset:53248
  v_mfma_f32_16x16x32_bf16 v[160:163], a[200:203], a[176:179], v[160:163]
  v_mfma_f32_16x16x32_bf16 v[164:167], a[196:199], a[164:167], v[164:167]
  v_mfma_f32_16x16x32_bf16 v[164:167], a[200:203], a[180:183], v[164:167]
  buffer_load_dwordx4 a[124:127], v13, s[64:67], s51 offen offset:3072 sc1
  v_mfma_f32_16x16x32_bf16 v[168:171], a[196:199], a[168:171], v[168:171]
  ds_read_b64_tr_b16 a[216:217], v30 offset:57344
  ds_read_b64_tr_b16 a[218:219], v30 offset:61440
  v_mfma_f32_16x16x32_bf16 v[168:171], a[200:203], a[184:187], v[168:171]
  s_add_u32 s51, s51, 262144
  v_mfma_f32_16x16x32_bf16 v[172:175], a[196:199], a[172:175], v[172:175]
  v_mfma_f32_16x16x32_bf16 v[172:175], a[200:203], a[188:191], v[172:175]
  s_waitcnt vmcnt(36) lgkmcnt(4)
  s_barrier
  v_mfma_f32_16x16x32_bf16 v[176:179], a[204:207], a[160:163], v[176:179]
  ds_read_b64_tr_b16 a[192:193], v16 offset:32768
  ds_read_b64_tr_b16 a[194:195], v16 offset:36864
  v_mfma_f32_16x16x32_bf16 v[176:179], a[208:211], a[176:179], v[176:179]
  buffer_load_dwordx4 a[128:131], v12, s[64:67], s51 offen offset:0 sc1
  v_mfma_f32_16x16x32_bf16 v[180:183], a[204:207], a[164:167], v[180:183]
  s_add_u32 m0, s52, 98304
  v_mfma_f32_16x16x32_bf16 v[180:183], a[208:211], a[180:183], v[180:183]
  buffer_load_dwordx4 a[132:135], v12, s[64:67], s51 offen offset:1024 sc1
  v_mfma_f32_16x16x32_bf16 v[184:187], a[204:207], a[168:171], v[184:187]
  ds_read_b64_tr_b16 a[196:197], v16 offset:40960
  ds_read_b64_tr_b16 a[198:199], v16 offset:45056
  v_mfma_f32_16x16x32_bf16 v[184:187], a[208:211], a[184:187], v[184:187]
  v_mfma_f32_16x16x32_bf16 v[188:191], a[204:207], a[172:175], v[188:191]
  v_mfma_f32_16x16x32_bf16 v[188:191], a[208:211], a[188:191], v[188:191]
  s_waitcnt lgkmcnt(4)
  v_mfma_f32_16x16x32_bf16 v[192:195], a[212:215], a[160:163], v[192:195]
  ds_read_b64_tr_b16 a[200:201], v17 offset:32768
  ds_read_b64_tr_b16 a[202:203], v17 offset:36864
  v_mfma_f32_16x16x32_bf16 v[192:195], a[216:219], a[176:179], v[192:195]
  buffer_load_dwordx4 v208, s[12:15], s50 offen offset:0 lds
  v_mfma_f32_16x16x32_bf16 v[196:199], a[212:215], a[164:167], v[196:199]
  v_mfma_f32_16x16x32_bf16 v[196:199], a[216:219], a[180:183], v[196:199]
  v_mfma_f32_16x16x32_bf16 v[200:203], a[212:215], a[168:171], v[200:203]
  ds_read_b64_tr_b16 a[204:205], v17 offset:40960
  ds_read_b64_tr_b16 a[206:207], v17 offset:45056
  v_mfma_f32_16x16x32_bf16 v[200:203], a[216:219], a[184:187], v[200:203]
  buffer_load_dwordx4 v209, s[12:15], s50 offen offset:1024 lds
  v_mfma_f32_16x16x32_bf16 v[204:207], a[212:215], a[172:175], v[204:207]
  v_mfma_f32_16x16x32_bf16 v[204:207], a[216:219], a[188:191], v[204:207]
  s_waitcnt lgkmcnt(4)
  v_mfma_f32_16x16x32_bf16 v[96:99], a[192:195], a[0:3], v[96:99]
  ds_read_b64_tr_b16 a[208:209], v18 offset:32768
  ds_read_b64_tr_b16 a[210:211], v18 offset:36864
  v_mfma_f32_16x16x32_bf16 v[96:99], a[196:199], a[16:19], v[96:99]
  v_mfma_f32_16x16x32_bf16 v[100:103], a[192:195], a[4:7], v[100:103]
  buffer_load_dwordx4 v210, s[12:15], s50 offen offset:2048 lds
  v_mfma_f32_16x16x32_bf16 v[100:103], a[196:199], a[20:23], v[100:103]
  v_mfma_f32_16x16x32_bf16 v[104:107], a[192:195], a[8:11], v[104:107]
  ds_read_b64_tr_b16 a[212:213], v18 offset:40960
  ds_read_b64_tr_b16 a[214:215], v18 offset:45056
  v_mfma_f32_16x16x32_bf16 v[104:107], a[196:199], a[24:27], v[104:107]
  v_mfma_f32_16x16x32_bf16 v[108:111], a[192:195], a[12:15], v[108:111]
  buffer_load_dwordx4 v211, s[12:15], s50 offen offset:3072 lds
  v_mfma_f32_16x16x32_bf16 v[108:111], a[196:199], a[28:31], v[108:111]
  s_add_u32 s50, s50, 458752
  s_waitcnt lgkmcnt(4)
  v_mfma_f32_16x16x32_bf16 v[112:115], a[200:203], a[0:3], v[112:115]
  ds_read_b64_tr_b16 a[216:217], v19 offset:32768
  ds_read_b64_tr_b16 a[218:219], v19 offset:36864
  v_mfma_f32_16x16x32_bf16 v[112:115], a[204:207], a[16:19], v[112:115]
  v_mfma_f32_16x16x32_bf16 v[116:119], a[200:203], a[4:7], v[116:119]
  v_mfma_f32_16x16x32_bf16 v[116:119], a[204:207], a[20:23], v[116:119]
  buffer_load_dwordx4 a[136:139], v12, s[64:67], s51 offen offset:2048 sc1
  v_mfma_f32_16x16x32_bf16 v[120:123], a[200:203], a[8:11], v[120:123]
  ds_read_b64_tr_b16 a[192:193], v19 offset:40960
  ds_read_b64_tr_b16 a[194:195], v19 offset:45056
  v_mfma_f32_16x16x32_bf16 v[120:123], a[204:207], a[24:27], v[120:123]
  v_mfma_f32_16x16x32_bf16 v[124:127], a[200:203], a[12:15], v[124:127]
  v_mfma_f32_16x16x32_bf16 v[124:127], a[204:207], a[28:31], v[124:127]
  s_waitcnt lgkmcnt(4)
  v_mfma_f32_16x16x32_bf16 v[128:131], a[208:211], a[0:3], v[128:131]
  ds_read_b64_tr_b16 a[196:197], v20 offset:32768
  ds_read_b64_tr_b16 a[198:199], v20 offset:36864
  v_mfma_f32_16x16x32_bf16 v[128:131], a[212:215], a[16:19], v[128:131]
  buffer_load_dwordx4 a[140:143], v12, s[64:67], s51 offen offset:3072 sc1
  v_mfma_f32_16x16x32_bf16 v[132:135], a[208:211], a[4:7], v[132:135]
  v_mfma_f32_16x16x32_bf16 v[132:135], a[212:215], a[20:23], v[132:135]
  v_mfma_f32_16x16x32_bf16 v[136:139], a[208:211], a[8:11], v[136:139]
  ds_read_b64_tr_b16 a[200:201], v20 offset:40960
  ds_read_b64_tr_b16 a[202:203], v20 offset:45056
  v_mfma_f32_16x16x32_bf16 v[136:139], a[212:215], a[24:27], v[136:139]
  buffer_load_dwordx4 a[144:147], v13, s[64:67], s51 offen offset:0 sc1
  v_mfma_f32_16x16x32_bf16 v[140:143], a[208:211], a[12:15], v[140:143]
  v_mfma_f32_16x16x32_bf16 v[140:143], a[212:215], a[28:31], v[140:143]
  s_waitcnt lgkmcnt(4)
  v_mfma_f32_16x16x32_bf16 v[144:147], a[216:219], a[0:3], v[144:147]
  ds_read_b64_tr_b16 a[204:205], v21 offset:32768
  ds_read_b64_tr_b16 a[206:207], v21 offset:36864
  v_mfma_f32_16x16x32_bf16 v[144:147], a[192:195], a[16:19], v[144:147]
  v_mfma_f32_16x16x32_bf16 v[148:151], a[216:219], a[4:7], v[148:151]
  buffer_load_dwordx4 a[148:151], v13, s[64:67], s51 offen offset:1024 sc1
  v_mfma_f32_16x16x32_bf16 v[148:151], a[192:195], a[20:23], v[148:151]
  v_mfma_f32_16x16x32_bf16 v[152:155], a[216:219], a[8:11], v[152:155]
  ds_read_b64_tr_b16 a[208:209], v21 offset:40960
  ds_read_b64_tr_b16 a[210:211], v21 offset:45056
  v_mfma_f32_16x16x32_bf16 v[152:155], a[192:195], a[24:27], v[152:155]
  v_mfma_f32_16x16x32_bf16 v[156:159], a[216:219], a[12:15], v[156:159]
  buffer_load_dwordx4 a[152:155], v13, s[64:67], s51 offen offset:2048 sc1
  v_mfma_f32_16x16x32_bf16 v[156:159], a[192:195], a[28:31], v[156:159]
  s_waitcnt lgkmcnt(4)
  v_mfma_f32_16x16x32_bf16 v[160:163], a[196:199], a[0:3], v[160:163]
  ds_read_b64_tr_b16 a[212:213], v22 offset:32768
  ds_read_b64_tr_b16 a[214:215], v22 offset:36864
  v_mfma_f32_16x16x32_bf16 v[160:163], a[200:203], a[16:19], v[160:163]
  v_mfma_f32_16x16x32_bf16 v[164:167], a[196:199], a[4:7], v[164:167]
  v_mfma_f32_16x16x32_bf16 v[164:167], a[200:203], a[20:23], v[164:167]
  buffer_load_dwordx4 a[156:159], v13, s[64:67], s51 offen offset:3072 sc1
  v_mfma_f32_16x16x32_bf16 v[168:171], a[196:199], a[8:11], v[168:171]
  ds_read_b64_tr_b16 a[216:217], v22 offset:40960
  ds_read_b64_tr_b16 a[218:219], v22 offset:45056
  v_mfma_f32_16x16x32_bf16 v[168:171], a[200:203], a[24:27], v[168:171]
  s_add_u32 s51, s51, 262144
  v_mfma_f32_16x16x32_bf16 v[172:175], a[196:199], a[12:15], v[172:175]
  v_mfma_f32_16x16x32_bf16 v[172:175], a[200:203], a[28:31], v[172:175]
  s_waitcnt vmcnt(36) lgkmcnt(4)
  s_barrier
  v_mfma_f32_16x16x32_bf16 v[176:179], a[204:207], a[0:3], v[176:179]
  ds_read_b64_tr_b16 a[192:193], v16 offset:49152
  ds_read_b64_tr_b16 a[194:195], v16 offset:53248
  v_mfma_f32_16x16x32_bf16 v[176:179], a[208:211], a[16:19], v[176:179]
  buffer_load_dwordx4 a[160:163], v12, s[64:67], s51 offen offset:0 sc1
  v_mfma_f32_16x16x32_bf16 v[180:183], a[204:207], a[4:7], v[180:183]
  s_add_u32 m0, s52, 114688
  v_mfma_f32_16x16x32_bf16 v[180:183], a[208:211], a[20:23], v[180:183]
  buffer_load_dwordx4 a[164:167], v12, s[64:67], s51 offen offset:1024 sc1
  v_mfma_f32_16x16x32_bf16 v[184:187], a[204:207], a[8:11], v[184:187]
  ds_read_b64_tr_b16 a[196:197], v16 offset:57344
  ds_read_b64_tr_b16 a[198:199], v16 offset:61440
  v_mfma_f32_16x16x32_bf16 v[184:187], a[208:211], a[24:27], v[184:187]
  v_mfma_f32_16x16x32_bf16 v[188:191], a[204:207], a[12:15], v[188:191]
  v_mfma_f32_16x16x32_bf16 v[188:191], a[208:211], a[28:31], v[188:191]
  s_waitcnt lgkmcnt(4)
  v_mfma_f32_16x16x32_bf16 v[192:195], a[212:215], a[0:3], v[192:195]
  ds_read_b64_tr_b16 a[200:201], v17 offset:49152
  ds_read_b64_tr_b16 a[202:203], v17 offset:53248
  v_mfma_f32_16x16x32_bf16 v[192:195], a[216:219], a[16:19], v[192:195]
  buffer_load_dwordx4 v208, s[12:15], s50 offen offset:0 lds
  v_mfma_f32_16x16x32_bf16 v[196:199], a[212:215], a[4:7], v[196:199]
  v_mfma_f32_16x16x32_bf16 v[196:199], a[216:219], a[20:23], v[196:199]
  v_mfma_f32_16x16x32_bf16 v[200:203], a[212:215], a[8:11], v[200:203]
  ds_read_b64_tr_b16 a[204:205], v17 offset:57344
  ds_read_b64_tr_b16 a[206:207], v17 offset:61440
  v_mfma_f32_16x16x32_bf16 v[200:203], a[216:219], a[24:27], v[200:203]
  buffer_load_dwordx4 v209, s[12:15], s50 offen offset:1024 lds
  v_mfma_f32_16x16x32_bf16 v[204:207], a[212:215], a[12:15], v[204:207]
  v_mfma_f32_16x16x32_bf16 v[204:207], a[216:219], a[28:31], v[204:207]
  s_waitcnt lgkmcnt(4)
  v_mfma_f32_16x16x32_bf16 v[96:99], a[192:195], a[32:35], v[96:99]
  ds_read_b64_tr_b16 a[208:209], v18 offset:49152
  ds_read_b64_tr_b16 a[210:211], v18 offset:53248
  v_mfma_f32_16x16x32_bf16 v[96:99], a[196:199], a[48:51], v[96:99]
  v_mfma_f32_16x16x32_bf16 v[100:103], a[192:195], a[36:39], v[100:103]
  buffer_load_dwordx4 v210, s[12:15], s50 offen offset:2048 lds
  v_mfma_f32_16x16x32_bf16 v[100:103], a[196:199], a[52:55], v[100:103]
  v_mfma_f32_16x16x32_bf16 v[104:107], a[192:195], a[40:43], v[104:107]
  ds_read_b64_tr_b16 a[212:213], v18 offset:57344
  ds_read_b64_tr_b16 a[214:215], v18 offset:61440
  v_mfma_f32_16x16x32_bf16 v[104:107], a[196:199], a[56:59], v[104:107]
  v_mfma_f32_16x16x32_bf16 v[108:111], a[192:195], a[44:47], v[108:111]
  buffer_load_dwordx4 v211, s[12:15], s50 offen offset:3072 lds
  v_mfma_f32_16x16x32_bf16 v[108:111], a[196:199], a[60:63], v[108:111]
  s_add_u32 s50, s50, 458752
  s_waitcnt lgkmcnt(4)
  v_mfma_f32_16x16x32_bf16 v[112:115], a[200:203], a[32:35], v[112:115]
  ds_read_b64_tr_b16 a[216:217], v19 offset:49152
  ds_read_b64_tr_b16 a[218:219], v19 offset:53248
  v_mfma_f32_16x16x32_bf16 v[112:115], a[204:207], a[48:51], v[112:115]
  v_mfma_f32_16x16x32_bf16 v[116:119], a[200:203], a[36:39], v[116:119]
  v_mfma_f32_16x16x32_bf16 v[116:119], a[204:207], a[52:55], v[116:119]
  buffer_load_dwordx4 a[168:171], v12, s[64:67], s51 offen offset:2048 sc1
  v_mfma_f32_16x16x32_bf16 v[120:123], a[200:203], a[40:43], v[120:123]
  ds_read_b64_tr_b16 a[192:193], v19 offset:57344
  ds_read_b64_tr_b16 a[194:195], v19 offset:61440
  v_mfma_f32_16x16x32_bf16 v[120:123], a[204:207], a[56:59], v[120:123]
  v_mfma_f32_16x16x32_bf16 v[124:127], a[200:203], a[44:47], v[124:127]
  v_mfma_f32_16x16x32_bf16 v[124:127], a[204:207], a[60:63], v[124:127]
  s_waitcnt lgkmcnt(4)
  v_mfma_f32_16x16x32_bf16 v[128:131], a[208:211], a[32:35], v[128:131]
  ds_read_b64_tr_b16 a[196:197], v20 offset:49152
  ds_read_b64_tr_b16 a[198:199], v20 offset:53248
  v_mfma_f32_16x16x32_bf16 v[128:131], a[212:215], a[48:51], v[128:131]
  buffer_load_dwordx4 a[172:175], v12, s[64:67], s51 offen offset:3072 sc1
  v_mfma_f32_16x16x32_bf16 v[132:135], a[208:211], a[36:39], v[132:135]
  v_mfma_f32_16x16x32_bf16 v[132:135], a[212:215], a[52:55], v[132:135]
  v_mfma_f32_16x16x32_bf16 v[136:139], a[208:211], a[40:43], v[136:139]
  ds_read_b64_tr_b16 a[200:201], v20 offset:57344
  ds_read_b64_tr_b16 a[202:203], v20 offset:61440
  v_mfma_f32_16x16x32_bf16 v[136:139], a[212:215], a[56:59], v[136:139]
  buffer_load_dwordx4 a[176:179], v13, s[64:67], s51 offen offset:0 sc1
  v_mfma_f32_16x16x32_bf16 v[140:143], a[208:211], a[44:47], v[140:143]
  v_mfma_f32_16x16x32_bf16 v[140:143], a[212:215], a[60:63], v[140:143]
  s_waitcnt lgkmcnt(4)
  v_mfma_f32_16x16x32_bf16 v[144:147], a[216:219], a[32:35], v[144:147]
  ds_read_b64_tr_b16 a[204:205], v21 offset:49152
  ds_read_b64_tr_b16 a[206:207], v21 offset:53248
  v_mfma_f32_16x16x32_bf16 v[144:147], a[192:195], a[48:51], v[144:147]
  v_mfma_f32_16x16x32_bf16 v[148:151], a[216:219], a[36:39], v[148:151]
  buffer_load_dwordx4 a[180:183], v13, s[64:67], s51 offen offset:1024 sc1
  v_mfma_f32_16x16x32_bf16 v[148:151], a[192:195], a[52:55], v[148:151]
  v_mfma_f32_16x16x32_bf16 v[152:155], a[216:219], a[40:43], v[152:155]
  ds_read_b64_tr_b16 a[208:209], v21 offset:57344
  ds_read_b64_tr_b16 a[210:211], v21 offset:61440
  v_mfma_f32_16x16x32_bf16 v[152:155], a[192:195], a[56:59], v[152:155]
  v_mfma_f32_16x16x32_bf16 v[156:159], a[216:219], a[44:47], v[156:159]
  buffer_load_dwordx4 a[184:187], v13, s[64:67], s51 offen offset:2048 sc1
  v_mfma_f32_16x16x32_bf16 v[156:159], a[192:195], a[60:63], v[156:159]
  s_waitcnt lgkmcnt(4)
  v_mfma_f32_16x16x32_bf16 v[160:163], a[196:199], a[32:35], v[160:163]
  ds_read_b64_tr_b16 a[212:213], v22 offset:49152
  ds_read_b64_tr_b16 a[214:215], v22 offset:53248
  v_mfma_f32_16x16x32_bf16 v[160:163], a[200:203], a[48:51], v[160:163]
  v_mfma_f32_16x16x32_bf16 v[164:167], a[196:199], a[36:39], v[164:167]
  v_mfma_f32_16x16x32_bf16 v[164:167], a[200:203], a[52:55], v[164:167]
  buffer_load_dwordx4 a[188:191], v13, s[64:67], s51 offen offset:3072 sc1
  v_mfma_f32_16x16x32_bf16 v[168:171], a[196:199], a[40:43], v[168:171]
  ds_read_b64_tr_b16 a[216:217], v22 offset:57344
  ds_read_b64_tr_b16 a[218:219], v22 offset:61440
  v_mfma_f32_16x16x32_bf16 v[168:171], a[200:203], a[56:59], v[168:171]
  s_add_u32 s51, s51, 262144
  v_mfma_f32_16x16x32_bf16 v[172:175], a[196:199], a[44:47], v[172:175]
  v_mfma_f32_16x16x32_bf16 v[172:175], a[200:203], a[60:63], v[172:175]
  s_waitcnt vmcnt(36) lgkmcnt(4)
  s_barrier
  v_mfma_f32_16x16x32_bf16 v[176:179], a[204:207], a[32:35], v[176:179]
  ds_read_b64_tr_b16 a[192:193], v24 offset:0
  ds_read_b64_tr_b16 a[194:195], v24 offset:4096
  v_mfma_f32_16x16x32_bf16 v[176:179], a[208:211], a[48:51], v[176:179]
  buffer_load_dwordx4 a[0:3], v12, s[64:67], s51 offen offset:0 sc1
  v_mfma_f32_16x16x32_bf16 v[180:183], a[204:207], a[36:39], v[180:183]
  s_add_u32 m0, s52, 32768
  v_mfma_f32_16x16x32_bf16 v[180:183], a[208:211], a[52:55], v[180:183]
  buffer_load_dwordx4 a[4:7], v12, s[64:67], s51 offen offset:1024 sc1
  v_mfma_f32_16x16x32_bf16 v[184:187], a[204:207], a[40:43], v[184:187]
  ds_read_b64_tr_b16 a[196:197], v24 offset:8192
  ds_read_b64_tr_b16 a[198:199], v24 offset:12288
  v_mfma_f32_16x16x32_bf16 v[184:187], a[208:211], a[56:59], v[184:187]
  v_mfma_f32_16x16x32_bf16 v[188:191], a[204:207], a[44:47], v[188:191]
  v_mfma_f32_16x16x32_bf16 v[188:191], a[208:211], a[60:63], v[188:191]
  s_waitcnt lgkmcnt(4)
  v_mfma_f32_16x16x32_bf16 v[192:195], a[212:215], a[32:35], v[192:195]
  ds_read_b64_tr_b16 a[200:201], v25 offset:0
  ds_read_b64_tr_b16 a[202:203], v25 offset:4096
  v_mfma_f32_16x16x32_bf16 v[192:195], a[216:219], a[48:51], v[192:195]
  buffer_load_dwordx4 v208, s[12:15], s50 offen offset:0 lds
  v_mfma_f32_16x16x32_bf16 v[196:199], a[212:215], a[36:39], v[196:199]
  v_mfma_f32_16x16x32_bf16 v[196:199], a[216:219], a[52:55], v[196:199]
  v_mfma_f32_16x16x32_bf16 v[200:203], a[212:215], a[40:43], v[200:203]
  ds_read_b64_tr_b16 a[204:205], v25 offset:8192
  ds_read_b64_tr_b16 a[206:207], v25 offset:12288
  v_mfma_f32_16x16x32_bf16 v[200:203], a[216:219], a[56:59], v[200:203]
  buffer_load_dwordx4 v209, s[12:15], s50 offen offset:1024 lds
  v_mfma_f32_16x16x32_bf16 v[204:207], a[212:215], a[44:47], v[204:207]
  v_mfma_f32_16x16x32_bf16 v[204:207], a[216:219], a[60:63], v[204:207]
  s_waitcnt lgkmcnt(4)
  v_mfma_f32_16x16x32_bf16 v[96:99], a[192:195], a[64:67], v[96:99]
  ds_read_b64_tr_b16 a[208:209], v26 offset:0
  ds_read_b64_tr_b16 a[210:211], v26 offset:4096
  v_mfma_f32_16x16x32_bf16 v[96:99], a[196:199], a[80:83], v[96:99]
  v_mfma_f32_16x16x32_bf16 v[100:103], a[192:195], a[68:71], v[100:103]
  buffer_load_dwordx4 v210, s[12:15], s50 offen offset:2048 lds
  v_mfma_f32_16x16x32_bf16 v[100:103], a[196:199], a[84:87], v[100:103]
  v_mfma_f32_16x16x32_bf16 v[104:107], a[192:195], a[72:75], v[104:107]
  ds_read_b64_tr_b16 a[212:213], v26 offset:8192
  ds_read_b64_tr_b16 a[214:215], v26 offset:12288
  v_mfma_f32_16x16x32_bf16 v[104:107], a[196:199], a[88:91], v[104:107]
  v_mfma_f32_16x16x32_bf16 v[108:111], a[192:195], a[76:79], v[108:111]
  buffer_load_dwordx4 v211, s[12:15], s50 offen offset:3072 lds
  v_mfma_f32_16x16x32_bf16 v[108:111], a[196:199], a[92:95], v[108:111]
  s_add_u32 s50, s50, 458752
  s_waitcnt lgkmcnt(4)
  v_mfma_f32_16x16x32_bf16 v[112:115], a[200:203], a[64:67], v[112:115]
  ds_read_b64_tr_b16 a[216:217], v27 offset:0
  ds_read_b64_tr_b16 a[218:219], v27 offset:4096
  v_mfma_f32_16x16x32_bf16 v[112:115], a[204:207], a[80:83], v[112:115]
  v_mfma_f32_16x16x32_bf16 v[116:119], a[200:203], a[68:71], v[116:119]
  v_mfma_f32_16x16x32_bf16 v[116:119], a[204:207], a[84:87], v[116:119]
  buffer_load_dwordx4 a[8:11], v12, s[64:67], s51 offen offset:2048 sc1
  v_mfma_f32_16x16x32_bf16 v[120:123], a[200:203], a[72:75], v[120:123]
  ds_read_b64_tr_b16 a[192:193], v27 offset:8192
  ds_read_b64_tr_b16 a[194:195], v27 offset:12288
  v_mfma_f32_16x16x32_bf16 v[120:123], a[204:207], a[88:91], v[120:123]
  v_mfma_f32_16x16x32_bf16 v[124:127], a[200:203], a[76:79], v[124:127]
  v_mfma_f32_16x16x32_bf16 v[124:127], a[204:207], a[92:95], v[124:127]
  s_waitcnt lgkmcnt(4)
  v_mfma_f32_16x16x32_bf16 v[128:131], a[208:211], a[64:67], v[128:131]
  ds_read_b64_tr_b16 a[196:197], v28 offset:0
  ds_read_b64_tr_b16 a[198:199], v28 offset:4096
  v_mfma_f32_16x16x32_bf16 v[128:131], a[212:215], a[80:83], v[128:131]
  buffer_load_dwordx4 a[12:15], v12, s[64:67], s51 offen offset:3072 sc1
  v_mfma_f32_16x16x32_bf16 v[132:135], a[208:211], a[68:71], v[132:135]
  v_mfma_f32_16x16x32_bf16 v[132:135], a[212:215], a[84:87], v[132:135]
  v_mfma_f32_16x16x32_bf16 v[136:139], a[208:211], a[72:75], v[136:139]
  ds_read_b64_tr_b16 a[200:201], v28 offset:8192
  ds_read_b64_tr_b16 a[202:203], v28 offset:12288
  v_mfma_f32_16x16x32_bf16 v[136:139], a[212:215], a[88:91], v[136:139]
  buffer_load_dwordx4 a[16:19], v13, s[64:67], s51 offen offset:0 sc1
  v_mfma_f32_16x16x32_bf16 v[140:143], a[208:211], a[76:79], v[140:143]
  v_mfma_f32_16x16x32_bf16 v[140:143], a[212:215], a[92:95], v[140:143]
  s_waitcnt lgkmcnt(4)
  v_mfma_f32_16x16x32_bf16 v[144:147], a[216:219], a[64:67], v[144:147]
  ds_read_b64_tr_b16 a[204:205], v29 offset:0
  ds_read_b64_tr_b16 a[206:207], v29 offset:4096
  v_mfma_f32_16x16x32_bf16 v[144:147], a[192:195], a[80:83], v[144:147]
  v_mfma_f32_16x16x32_bf16 v[148:151], a[216:219], a[68:71], v[148:151]
  buffer_load_dwordx4 a[20:23], v13, s[64:67], s51 offen offset:1024 sc1
  v_mfma_f32_16x16x32_bf16 v[148:151], a[192:195], a[84:87], v[148:151]
  v_mfma_f32_16x16x32_bf16 v[152:155], a[216:219], a[72:75], v[152:155]
  ds_read_b64_tr_b16 a[208:209], v29 offset:8192
  ds_read_b64_tr_b16 a[210:211], v29 offset:12288
  v_mfma_f32_16x16x32_bf16 v[152:155], a[192:195], a[88:91], v[152:155]
  v_mfma_f32_16x16x32_bf16 v[156:159], a[216:219], a[76:79], v[156:159]
  buffer_load_dwordx4 a[24:27], v13, s[64:67], s51 offen offset:2048 sc1
  v_mfma_f32_16x16x32_bf16 v[156:159], a[192:195], a[92:95], v[156:159]
  s_waitcnt lgkmcnt(4)
  v_mfma_f32_16x16x32_bf16 v[160:163], a[196:199], a[64:67], v[160:163]
  ds_read_b64_tr_b16 a[212:213], v30 offset:0
  ds_read_b64_tr_b16 a[214:215], v30 offset:4096
  v_mfma_f32_16x16x32_bf16 v[160:163], a[200:203], a[80:83], v[160:163]
  v_mfma_f32_16x16x32_bf16 v[164:167], a[196:199], a[68:71], v[164:167]
  v_mfma_f32_16x16x32_bf16 v[164:167], a[200:203], a[84:87], v[164:167]
  buffer_load_dwordx4 a[28:31], v13, s[64:67], s51 offen offset:3072 sc1
  v_mfma_f32_16x16x32_bf16 v[168:171], a[196:199], a[72:75], v[168:171]
  ds_read_b64_tr_b16 a[216:217], v30 offset:8192
  ds_read_b64_tr_b16 a[218:219], v30 offset:12288
  v_mfma_f32_16x16x32_bf16 v[168:171], a[200:203], a[88:91], v[168:171]
  s_add_u32 s51, s51, 262144
  v_mfma_f32_16x16x32_bf16 v[172:175], a[196:199], a[76:79], v[172:175]
  v_mfma_f32_16x16x32_bf16 v[172:175], a[200:203], a[92:95], v[172:175]
  s_waitcnt vmcnt(36) lgkmcnt(4)
  s_barrier
  v_mfma_f32_16x16x32_bf16 v[176:179], a[204:207], a[64:67], v[176:179]
  ds_read_b64_tr_b16 a[192:193], v24 offset:16384
  ds_read_b64_tr_b16 a[194:195], v24 offset:20480
  v_mfma_f32_16x16x32_bf16 v[176:179], a[208:211], a[80:83], v[176:179]
  buffer_load_dwordx4 a[32:35], v12, s[64:67], s51 offen offset:0 sc1
  v_mfma_f32_16x16x32_bf16 v[180:183], a[204:207], a[68:71], v[180:183]
  s_add_u32 m0, s52, 49152
  v_mfma_f32_16x16x32_bf16 v[180:183], a[208:211], a[84:87], v[180:183]
  buffer_load_dwordx4 a[36:39], v12, s[64:67], s51 offen offset:1024 sc1
  v_mfma_f32_16x16x32_bf16 v[184:187], a[204:207], a[72:75], v[184:187]
  ds_read_b64_tr_b16 a[196:197], v24 offset:24576
  ds_read_b64_tr_b16 a[198:199], v24 offset:28672
  v_mfma_f32_16x16x32_bf16 v[184:187], a[208:211], a[88:91], v[184:187]
  v_mfma_f32_16x16x32_bf16 v[188:191], a[204:207], a[76:79], v[188:191]
  v_mfma_f32_16x16x32_bf16 v[188:191], a[208:211], a[92:95], v[188:191]
  s_waitcnt lgkmcnt(4)
  v_mfma_f32_16x16x32_bf16 v[192:195], a[212:215], a[64:67], v[192:195]
  ds_read_b64_tr_b16 a[200:201], v25 offset:16384
  ds_read_b64_tr_b16 a[202:203], v25 offset:20480
  v_mfma_f32_16x16x32_bf16 v[192:195], a[216:219], a[80:83], v[192:195]
  buffer_load_dwordx4 v208, s[12:15], s50 offen offset:0 lds
  v_mfma_f32_16x16x32_bf16 v[196:199], a[212:215], a[68:71], v[196:199]
  v_mfma_f32_16x16x32_bf16 v[196:199], a[216:219], a[84:87], v[196:199]
  v_mfma_f32_16x16x32_bf16 v[200:203], a[212:215], a[72:75], v[200:203]
  ds_read_b64_tr_b16 a[204:205], v25 offset:24576
  ds_read_b64_tr_b16 a[206:207], v25 offset:28672
  v_mfma_f32_16x16x32_bf16 v[200:203], a[216:219], a[88:91], v[200:203]
  buffer_load_dwordx4 v209, s[12:15], s50 offen offset:1024 lds
  v_mfma_f32_16x16x32_bf16 v[204:207], a[212:215], a[76:79], v[204:207]
  v_mfma_f32_16x16x32_bf16 v[204:207], a[216:219], a[92:95], v[204:207]
  s_waitcnt lgkmcnt(4)
  v_mfma_f32_16x16x32_bf16 v[96:99], a[192:195], a[96:99], v[96:99]
  ds_read_b64_tr_b16 a[208:209], v26 offset:16384
  ds_read_b64_tr_b16 a[210:211], v26 offset:20480
  v_mfma_f32_16x16x32_bf16 v[96:99], a[196:199], a[112:115], v[96:99]
  v_mfma_f32_16x16x32_bf16 v[100:103], a[192:195], a[100:103], v[100:103]
  buffer_load_dwordx4 v210, s[12:15], s50 offen offset:2048 lds
  v_mfma_f32_16x16x32_bf16 v[100:103], a[196:199], a[116:119], v[100:103]
  v_mfma_f32_16x16x32_bf16 v[104:107], a[192:195], a[104:107], v[104:107]
  ds_read_b64_tr_b16 a[212:213], v26 offset:24576
  ds_read_b64_tr_b16 a[214:215], v26 offset:28672
  v_mfma_f32_16x16x32_bf16 v[104:107], a[196:199], a[120:123], v[104:107]
  v_mfma_f32_16x16x32_bf16 v[108:111], a[192:195], a[108:111], v[108:111]
  buffer_load_dwordx4 v211, s[12:15], s50 offen offset:3072 lds
  v_mfma_f32_16x16x32_bf16 v[108:111], a[196:199], a[124:127], v[108:111]
  s_add_u32 s50, s50, 458752
  s_waitcnt lgkmcnt(4)
  v_mfma_f32_16x16x32_bf16 v[112:115], a[200:203], a[96:99], v[112:115]
  ds_read_b64_tr_b16 a[216:217], v27 offset:16384
  ds_read_b64_tr_b16 a[218:219], v27 offset:20480
  v_mfma_f32_16x16x32_bf16 v[112:115], a[204:207], a[112:115], v[112:115]
  v_mfma_f32_16x16x32_bf16 v[116:119], a[200:203], a[100:103], v[116:119]
  v_mfma_f32_16x16x32_bf16 v[116:119], a[204:207], a[116:119], v[116:119]
  buffer_load_dwordx4 a[40:43], v12, s[64:67], s51 offen offset:2048 sc1
  v_mfma_f32_16x16x32_bf16 v[120:123], a[200:203], a[104:107], v[120:123]
  ds_read_b64_tr_b16 a[192:193], v27 offset:24576
  ds_read_b64_tr_b16 a[194:195], v27 offset:28672
  v_mfma_f32_16x16x32_bf16 v[120:123], a[204:207], a[120:123], v[120:123]
  v_mfma_f32_16x16x32_bf16 v[124:127], a[200:203], a[108:111], v[124:127]
  v_mfma_f32_16x16x32_bf16 v[124:127], a[204:207], a[124:127], v[124:127]
  s_waitcnt lgkmcnt(4)
  v_mfma_f32_16x16x32_bf16 v[128:131], a[208:211], a[96:99], v[128:131]
  ds_read_b64_tr_b16 a[196:197], v28 offset:16384
  ds_read_b64_tr_b16 a[198:199], v28 offset:20480
  v_mfma_f32_16x16x32_bf16 v[128:131], a[212:215], a[112:115], v[128:131]
  buffer_load_dwordx4 a[44:47], v12, s[64:67], s51 offen offset:3072 sc1
  v_mfma_f32_16x16x32_bf16 v[132:135], a[208:211], a[100:103], v[132:135]
  v_mfma_f32_16x16x32_bf16 v[132:135], a[212:215], a[116:119], v[132:135]
  v_mfma_f32_16x16x32_bf16 v[136:139], a[208:211], a[104:107], v[136:139]
  ds_read_b64_tr_b16 a[200:201], v28 offset:24576
  ds_read_b64_tr_b16 a[202:203], v28 offset:28672
  v_mfma_f32_16x16x32_bf16 v[136:139], a[212:215], a[120:123], v[136:139]
  buffer_load_dwordx4 a[48:51], v13, s[64:67], s51 offen offset:0 sc1
  v_mfma_f32_16x16x32_bf16 v[140:143], a[208:211], a[108:111], v[140:143]
  v_mfma_f32_16x16x32_bf16 v[140:143], a[212:215], a[124:127], v[140:143]
  s_waitcnt lgkmcnt(4)
  v_mfma_f32_16x16x32_bf16 v[144:147], a[216:219], a[96:99], v[144:147]
  ds_read_b64_tr_b16 a[204:205], v29 offset:16384
  ds_read_b64_tr_b16 a[206:207], v29 offset:20480
  v_mfma_f32_16x16x32_bf16 v[144:147], a[192:195], a[112:115], v[144:147]
  v_mfma_f32_16x16x32_bf16 v[148:151], a[216:219], a[100:103], v[148:151]
  buffer_load_dwordx4 a[52:55], v13, s[64:67], s51 offen offset:1024 sc1
  v_mfma_f32_16x16x32_bf16 v[148:151], a[192:195], a[116:119], v[148:151]
  v_mfma_f32_16x16x32_bf16 v[152:155], a[216:219], a[104:107], v[152:155]
  ds_read_b64_tr_b16 a[208:209], v29 offset:24576
  ds_read_b64_tr_b16 a[210:211], v29 offset:28672
  v_mfma_f32_16x16x32_bf16 v[152:155], a[192:195], a[120:123], v[152:155]
  v_mfma_f32_16x16x32_bf16 v[156:159], a[216:219], a[108:111], v[156:159]
  buffer_load_dwordx4 a[56:59], v13, s[64:67], s51 offen offset:2048 sc1
  v_mfma_f32_16x16x32_bf16 v[156:159], a[192:195], a[124:127], v[156:159]
  s_waitcnt lgkmcnt(4)
  v_mfma_f32_16x16x32_bf16 v[160:163], a[196:199], a[96:99], v[160:163]
  ds_read_b64_tr_b16 a[212:213], v30 offset:16384
  ds_read_b64_tr_b16 a[214:215], v30 offset:20480
  v_mfma_f32_16x16x32_bf16 v[160:163], a[200:203], a[112:115], v[160:163]
  v_mfma_f32_16x16x32_bf16 v[164:167], a[196:199], a[100:103], v[164:167]
  v_mfma_f32_16x16x32_bf16 v[164:167], a[200:203], a[116:119], v[164:167]
  buffer_load_dwordx4 a[60:63], v13, s[64:67], s51 offen offset:3072 sc1
  v_mfma_f32_16x16x32_bf16 v[168:171], a[196:199], a[104:107], v[168:171]
  ds_read_b64_tr_b16 a[216:217], v30 offset:24576
  ds_read_b64_tr_b16 a[218:219], v30 offset:28672
  v_mfma_f32_16x16x32_bf16 v[168:171], a[200:203], a[120:123], v[168:171]
  s_add_u32 s51, s51, 262144
  v_mfma_f32_16x16x32_bf16 v[172:175], a[196:199], a[108:111], v[172:175]
  v_mfma_f32_16x16x32_bf16 v[172:175], a[200:203], a[124:127], v[172:175]
  s_waitcnt vmcnt(36) lgkmcnt(4)
  s_barrier
  v_mfma_f32_16x16x32_bf16 v[176:179], a[204:207], a[96:99], v[176:179]
  ds_read_b64_tr_b16 a[192:193], v24 offset:32768
  ds_read_b64_tr_b16 a[194:195], v24 offset:36864
  v_mfma_f32_16x16x32_bf16 v[176:179], a[208:211], a[112:115], v[176:179]
  buffer_load_dwordx4 a[64:67], v12, s[64:67], s51 offen offset:0 sc1
  v_mfma_f32_16x16x32_bf16 v[180:183], a[204:207], a[100:103], v[180:183]
  s_add_u32 m0, s52, 65536
  v_mfma_f32_16x16x32_bf16 v[180:183], a[208:211], a[116:119], v[180:183]
  buffer_load_dwordx4 a[68:71], v12, s[64:67], s51 offen offset:1024 sc1
  v_mfma_f32_16x16x32_bf16 v[184:187], a[204:207], a[104:107], v[184:187]
  ds_read_b64_tr_b16 a[196:197], v24 offset:40960
  ds_read_b64_tr_b16 a[198:199], v24 offset:45056
  v_mfma_f32_16x16x32_bf16 v[184:187], a[208:211], a[120:123], v[184:187]
  v_mfma_f32_16x16x32_bf16 v[188:191], a[204:207], a[108:111], v[188:191]
  v_mfma_f32_16x16x32_bf16 v[188:191], a[208:211], a[124:127], v[188:191]
  s_waitcnt lgkmcnt(4)
  v_mfma_f32_16x16x32_bf16 v[192:195], a[212:215], a[96:99], v[192:195]
  ds_read_b64_tr_b16 a[200:201], v25 offset:32768
  ds_read_b64_tr_b16 a[202:203], v25 offset:36864
  v_mfma_f32_16x16x32_bf16 v[192:195], a[216:219], a[112:115], v[192:195]
  buffer_load_dwordx4 v208, s[12:15], s50 offen offset:0 lds
  v_mfma_f32_16x16x32_bf16 v[196:199], a[212:215], a[100:103], v[196:199]
  v_mfma_f32_16x16x32_bf16 v[196:199], a[216:219], a[116:119], v[196:199]
  v_mfma_f32_16x16x32_bf16 v[200:203], a[212:215], a[104:107], v[200:203]
  ds_read_b64_tr_b16 a[204:205], v25 offset:40960
  ds_read_b64_tr_b16 a[206:207], v25 offset:45056
  v_mfma_f32_16x16x32_bf16 v[200:203], a[216:219], a[120:123], v[200:203]
  buffer_load_dwordx4 v209, s[12:15], s50 offen offset:1024 lds
  v_mfma_f32_16x16x32_bf16 v[204:207], a[212:215], a[108:111], v[204:207]
  v_mfma_f32_16x16x32_bf16 v[204:207], a[216:219], a[124:127], v[204:207]
  s_waitcnt lgkmcnt(4)
  v_mfma_f32_16x16x32_bf16 v[96:99], a[192:195], a[128:131], v[96:99]
  ds_read_b64_tr_b16 a[208:209], v26 offset:32768
  ds_read_b64_tr_b16 a[210:211], v26 offset:36864
  v_mfma_f32_16x16x32_bf16 v[96:99], a[196:199], a[144:147], v[96:99]
  v_mfma_f32_16x16x32_bf16 v[100:103], a[192:195], a[132:135], v[100:103]
  buffer_load_dwordx4 v210, s[12:15], s50 offen offset:2048 lds
  v_mfma_f32_16x16x32_bf16 v[100:103], a[196:199], a[148:151], v[100:103]
  v_mfma_f32_16x16x32_bf16 v[104:107], a[192:195], a[136:139], v[104:107]
  ds_read_b64_tr_b16 a[212:213], v26 offset:40960
  ds_read_b64_tr_b16 a[214:215], v26 offset:45056
  v_mfma_f32_16x16x32_bf16 v[104:107], a[196:199], a[152:155], v[104:107]
  v_mfma_f32_16x16x32_bf16 v[108:111], a[192:195], a[140:143], v[108:111]
  buffer_load_dwordx4 v211, s[12:15], s50 offen offset:3072 lds
  v_mfma_f32_16x16x32_bf16 v[108:111], a[196:199], a[156:159], v[108:111]
  s_add_u32 s50, s50, 458752
  s_waitcnt lgkmcnt(4)
  v_mfma_f32_16x16x32_bf16 v[112:115], a[200:203], a[128:131], v[112:115]
  ds_read_b64_tr_b16 a[216:217], v27 offset:32768
  ds_read_b64_tr_b16 a[218:219], v27 offset:36864
  v_mfma_f32_16x16x32_bf16 v[112:115], a[204:207], a[144:147], v[112:115]
  v_mfma_f32_16x16x32_bf16 v[116:119], a[200:203], a[132:135], v[116:119]
  v_mfma_f32_16x16x32_bf16 v[116:119], a[204:207], a[148:151], v[116:119]
  buffer_load_dwordx4 a[72:75], v12, s[64:67], s51 offen offset:2048 sc1
  v_mfma_f32_16x16x32_bf16 v[120:123], a[200:203], a[136:139], v[120:123]
  ds_read_b64_tr_b16 a[192:193], v27 offset:40960
  ds_read_b64_tr_b16 a[194:195], v27 offset:45056
  v_mfma_f32_16x16x32_bf16 v[120:123], a[204:207], a[152:155], v[120:123]
  v_mfma_f32_16x16x32_bf16 v[124:127], a[200:203], a[140:143], v[124:127]
  v_mfma_f32_16x16x32_bf16 v[124:127], a[204:207], a[156:159], v[124:127]
  s_waitcnt lgkmcnt(4)
  v_mfma_f32_16x16x32_bf16 v[128:131], a[208:211], a[128:131], v[128:131]
  ds_read_b64_tr_b16 a[196:197], v28 offset:32768
  ds_read_b64_tr_b16 a[198:199], v28 offset:36864
  v_mfma_f32_16x16x32_bf16 v[128:131], a[212:215], a[144:147], v[128:131]
  buffer_load_dwordx4 a[76:79], v12, s[64:67], s51 offen offset:3072 sc1
  v_mfma_f32_16x16x32_bf16 v[132:135], a[208:211], a[132:135], v[132:135]
  v_mfma_f32_16x16x32_bf16 v[132:135], a[212:215], a[148:151], v[132:135]
  v_mfma_f32_16x16x32_bf16 v[136:139], a[208:211], a[136:139], v[136:139]
  ds_read_b64_tr_b16 a[200:201], v28 offset:40960
  ds_read_b64_tr_b16 a[202:203], v28 offset:45056
  v_mfma_f32_16x16x32_bf16 v[136:139], a[212:215], a[152:155], v[136:139]
  buffer_load_dwordx4 a[80:83], v13, s[64:67], s51 offen offset:0 sc1
  v_mfma_f32_16x16x32_bf16 v[140:143], a[208:211], a[140:143], v[140:143]
  v_mfma_f32_16x16x32_bf16 v[140:143], a[212:215], a[156:159], v[140:143]
  s_waitcnt lgkmcnt(4)
  v_mfma_f32_16x16x32_bf16 v[144:147], a[216:219], a[128:131], v[144:147]
  ds_read_b64_tr_b16 a[204:205], v29 offset:32768
  ds_read_b64_tr_b16 a[206:207], v29 offset:36864
  v_mfma_f32_16x16x32_bf16 v[144:147], a[192:195], a[144:147], v[144:147]
  v_mfma_f32_16x16x32_bf16 v[148:151], a[216:219], a[132:135], v[148:151]
  buffer_load_dwordx4 a[84:87], v13, s[64:67], s51 offen offset:1024 sc1
  v_mfma_f32_16x16x32_bf16 v[148:151], a[192:195], a[148:151], v[148:151]
  v_mfma_f32_16x16x32_bf16 v[152:155], a[216:219], a[136:139], v[152:155]
  ds_read_b64_tr_b16 a[208:209], v29 offset:40960
  ds_read_b64_tr_b16 a[210:211], v29 offset:45056
  v_mfma_f32_16x16x32_bf16 v[152:155], a[192:195], a[152:155], v[152:155]
  v_mfma_f32_16x16x32_bf16 v[156:159], a[216:219], a[140:143], v[156:159]
  buffer_load_dwordx4 a[88:91], v13, s[64:67], s51 offen offset:2048 sc1
  v_mfma_f32_16x16x32_bf16 v[156:159], a[192:195], a[156:159], v[156:159]
  s_waitcnt lgkmcnt(4)
  v_mfma_f32_16x16x32_bf16 v[160:163], a[196:199], a[128:131], v[160:163]
  ds_read_b64_tr_b16 a[212:213], v30 offset:32768
  ds_read_b64_tr_b16 a[214:215], v30 offset:36864
  v_mfma_f32_16x16x32_bf16 v[160:163], a[200:203], a[144:147], v[160:163]
  v_mfma_f32_16x16x32_bf16 v[164:167], a[196:199], a[132:135], v[164:167]
  v_mfma_f32_16x16x32_bf16 v[164:167], a[200:203], a[148:151], v[164:167]
  buffer_load_dwordx4 a[92:95], v13, s[64:67], s51 offen offset:3072 sc1
  v_mfma_f32_16x16x32_bf16 v[168:171], a[196:199], a[136:139], v[168:171]
  ds_read_b64_tr_b16 a[216:217], v30 offset:40960
  ds_read_b64_tr_b16 a[218:219], v30 offset:45056
  v_mfma_f32_16x16x32_bf16 v[168:171], a[200:203], a[152:155], v[168:171]
  s_add_u32 s51, s51, 262144
  v_mfma_f32_16x16x32_bf16 v[172:175], a[196:199], a[140:143], v[172:175]
  v_mfma_f32_16x16x32_bf16 v[172:175], a[200:203], a[156:159], v[172:175]
  s_waitcnt vmcnt(36) lgkmcnt(4)
  s_barrier
  v_mfma_f32_16x16x32_bf16 v[176:179], a[204:207], a[128:131], v[176:179]
  ds_read_b64_tr_b16 a[192:193], v24 offset:49152
  ds_read_b64_tr_b16 a[194:195], v24 offset:53248
  v_mfma_f32_16x16x32_bf16 v[176:179], a[208:211], a[144:147], v[176:179]
  buffer_load_dwordx4 a[96:99], v12, s[64:67], s51 offen offset:0 sc1
  v_mfma_f32_16x16x32_bf16 v[180:183], a[204:207], a[132:135], v[180:183]
  s_add_u32 m0, s52, 81920
  v_mfma_f32_16x16x32_bf16 v[180:183], a[208:211], a[148:151], v[180:183]
  buffer_load_dwordx4 a[100:103], v12, s[64:67], s51 offen offset:1024 sc1
  v_mfma_f32_16x16x32_bf16 v[184:187], a[204:207], a[136:139], v[184:187]
  ds_read_b64_tr_b16 a[196:197], v24 offset:57344
  ds_read_b64_tr_b16 a[198:199], v24 offset:61440
  v_mfma_f32_16x16x32_bf16 v[184:187], a[208:211], a[152:155], v[184:187]
  v_mfma_f32_16x16x32_bf16 v[188:191], a[204:207], a[140:143], v[188:191]
  v_mfma_f32_16x16x32_bf16 v[188:191], a[208:211], a[156:159], v[188:191]
  s_waitcnt lgkmcnt(4)
  v_mfma_f32_16x16x32_bf16 v[192:195], a[212:215], a[128:131], v[192:195]
  ds_read_b64_tr_b16 a[200:201], v25 offset:49152
  ds_read_b64_tr_b16 a[202:203], v25 offset:53248
  v_mfma_f32_16x16x32_bf16 v[192:195], a[216:219], a[144:147], v[192:195]
  buffer_load_dwordx4 v208, s[12:15], s50 offen offset:0 lds
  v_mfma_f32_16x16x32_bf16 v[196:199], a[212:215], a[132:135], v[196:199]
  v_mfma_f32_16x16x32_bf16 v[196:199], a[216:219], a[148:151], v[196:199]
  v_mfma_f32_16x16x32_bf16 v[200:203], a[212:215], a[136:139], v[200:203]
  ds_read_b64_tr_b16 a[204:205], v25 offset:57344
  ds_read_b64_tr_b16 a[206:207], v25 offset:61440
  v_mfma_f32_16x16x32_bf16 v[200:203], a[216:219], a[152:155], v[200:203]
  buffer_load_dwordx4 v209, s[12:15], s50 offen offset:1024 lds
  v_mfma_f32_16x16x32_bf16 v[204:207], a[212:215], a[140:143], v[204:207]
  v_mfma_f32_16x16x32_bf16 v[204:207], a[216:219], a[156:159], v[204:207]
  s_waitcnt lgkmcnt(4)
  v_mfma_f32_16x16x32_bf16 v[96:99], a[192:195], a[160:163], v[96:99]
  ds_read_b64_tr_b16 a[208:209], v26 offset:49152
  ds_read_b64_tr_b16 a[210:211], v26 offset:53248
  v_mfma_f32_16x16x32_bf16 v[96:99], a[196:199], a[176:179], v[96:99]
  v_mfma_f32_16x16x32_bf16 v[100:103], a[192:195], a[164:167], v[100:103]
  buffer_load_dwordx4 v210, s[12:15], s50 offen offset:2048 lds
  v_mfma_f32_16x16x32_bf16 v[100:103], a[196:199], a[180:183], v[100:103]
  v_mfma_f32_16x16x32_bf16 v[104:107], a[192:195], a[168:171], v[104:107]
  ds_read_b64_tr_b16 a[212:213], v26 offset:57344
  ds_read_b64_tr_b16 a[214:215], v26 offset:61440
  v_mfma_f32_16x16x32_bf16 v[104:107], a[196:199], a[184:187], v[104:107]
  v_mfma_f32_16x16x32_bf16 v[108:111], a[192:195], a[172:175], v[108:111]
  buffer_load_dwordx4 v211, s[12:15], s50 offen offset:3072 lds
  v_mfma_f32_16x16x32_bf16 v[108:111], a[196:199], a[188:191], v[108:111]
  s_add_u32 s50, s50, 458752
  s_waitcnt lgkmcnt(4)
  v_mfma_f32_16x16x32_bf16 v[112:115], a[200:203], a[160:163], v[112:115]
  ds_read_b64_tr_b16 a[216:217], v27 offset:49152
  ds_read_b64_tr_b16 a[218:219], v27 offset:53248
  v_mfma_f32_16x16x32_bf16 v[112:115], a[204:207], a[176:179], v[112:115]
  v_mfma_f32_16x16x32_bf16 v[116:119], a[200:203], a[164:167], v[116:119]
  v_mfma_f32_16x16x32_bf16 v[116:119], a[204:207], a[180:183], v[116:119]
  buffer_load_dwordx4 a[104:107], v12, s[64:67], s51 offen offset:2048 sc1
  v_mfma_f32_16x16x32_bf16 v[120:123], a[200:203], a[168:171], v[120:123]
  ds_read_b64_tr_b16 a[192:193], v27 offset:57344
  ds_read_b64_tr_b16 a[194:195], v27 offset:61440
  v_mfma_f32_16x16x32_bf16 v[120:123], a[204:207], a[184:187], v[120:123]
  v_mfma_f32_16x16x32_bf16 v[124:127], a[200:203], a[172:175], v[124:127]
  v_mfma_f32_16x16x32_bf16 v[124:127], a[204:207], a[188:191], v[124:127]
  s_waitcnt lgkmcnt(4)
  v_mfma_f32_16x16x32_bf16 v[128:131], a[208:211], a[160:163], v[128:131]
  ds_read_b64_tr_b16 a[196:197], v28 offset:49152
  ds_read_b64_tr_b16 a[198:199], v28 offset:53248
  v_mfma_f32_16x16x32_bf16 v[128:131], a[212:215], a[176:179], v[128:131]
  buffer_load_dwordx4 a[108:111], v12, s[64:67], s51 offen offset:3072 sc1
  v_mfma_f32_16x16x32_bf16 v[132:135], a[208:211], a[164:167], v[132:135]
  v_mfma_f32_16x16x32_bf16 v[132:135], a[212:215], a[180:183], v[132:135]
  v_mfma_f32_16x16x32_bf16 v[136:139], a[208:211], a[168:171], v[136:139]
  ds_read_b64_tr_b16 a[200:201], v28 offset:57344
  ds_read_b64_tr_b16 a[202:203], v28 offset:61440
  v_mfma_f32_16x16x32_bf16 v[136:139], a[212:215], a[184:187], v[136:139]
  buffer_load_dwordx4 a[112:115], v13, s[64:67], s51 offen offset:0 sc1
  v_mfma_f32_16x16x32_bf16 v[140:143], a[208:211], a[172:175], v[140:143]
  v_mfma_f32_16x16x32_bf16 v[140:143], a[212:215], a[188:191], v[140:143]
  s_waitcnt lgkmcnt(4)
  v_mfma_f32_16x16x32_bf16 v[144:147], a[216:219], a[160:163], v[144:147]
  ds_read_b64_tr_b16 a[204:205], v29 offset:49152
  ds_read_b64_tr_b16 a[206:207], v29 offset:53248
  v_mfma_f32_16x16x32_bf16 v[144:147], a[192:195], a[176:179], v[144:147]
  v_mfma_f32_16x16x32_bf16 v[148:151], a[216:219], a[164:167], v[148:151]
  buffer_load_dwordx4 a[116:119], v13, s[64:67], s51 offen offset:1024 sc1
  v_mfma_f32_16x16x32_bf16 v[148:151], a[192:195], a[180:183], v[148:151]
  v_mfma_f32_16x16x32_bf16 v[152:155], a[216:219], a[168:171], v[152:155]
  ds_read_b64_tr_b16 a[208:209], v29 offset:57344
  ds_read_b64_tr_b16 a[210:211], v29 offset:61440
  v_mfma_f32_16x16x32_bf16 v[152:155], a[192:195], a[184:187], v[152:155]
  v_mfma_f32_16x16x32_bf16 v[156:159], a[216:219], a[172:175], v[156:159]
  buffer_load_dwordx4 a[120:123], v13, s[64:67], s51 offen offset:2048 sc1
  v_mfma_f32_16x16x32_bf16 v[156:159], a[192:195], a[188:191], v[156:159]
  s_waitcnt lgkmcnt(4)
  v_mfma_f32_16x16x32_bf16 v[160:163], a[196:199], a[160:163], v[160:163]
  ds_read_b64_tr_b16 a[212:213], v30 offset:49152
  ds_read_b64_tr_b16 a[214:215], v30 offset:53248
  v_mfma_f32_16x16x32_bf16 v[160:163], a[200:203], a[176:179], v[160:163]
  v_mfma_f32_16x16x32_bf16 v[164:167], a[196:199], a[164:167], v[164:167]
  v_mfma_f32_16x16x32_bf16 v[164:167], a[200:203], a[180:183], v[164:167]
  buffer_load_dwordx4 a[124:127], v13, s[64:67], s51 offen offset:3072 sc1
  v_mfma_f32_16x16x32_bf16 v[168:171], a[196:199], a[168:171], v[168:171]
  ds_read_b64_tr_b16 a[216:217], v30 offset:57344
  ds_read_b64_tr_b16 a[218:219], v30 offset:61440
  v_mfma_f32_16x16x32_bf16 v[168:171], a[200:203], a[184:187], v[168:171]
  s_add_u32 s51, s51, 262144
  v_mfma_f32_16x16x32_bf16 v[172:175], a[196:199], a[172:175], v[172:175]
  v_mfma_f32_16x16x32_bf16 v[172:175], a[200:203], a[188:191], v[172:175]
  s_waitcnt vmcnt(36) lgkmcnt(4)
  s_barrier
  v_mfma_f32_16x16x32_bf16 v[176:179], a[204:207], a[160:163], v[176:179]
  ds_read_b64_tr_b16 a[192:193], v16 offset:32768
  ds_read_b64_tr_b16 a[194:195], v16 offset:36864
  v_mfma_f32_16x16x32_bf16 v[176:179], a[208:211], a[176:179], v[176:179]
  buffer_load_dwordx4 v[56:59], v60, s[32:35], s55 offen
  v_mfma_f32_16x16x32_bf16 v[180:183], a[204:207], a[164:167], v[180:183]
  v_mfma_f32_16x16x32_bf16 v[180:183], a[208:211], a[180:183], v[180:183]
  v_mfma_f32_16x16x32_bf16 v[184:187], a[204:207], a[168:171], v[184:187]
  ds_read_b64_tr_b16 a[196:197], v16 offset:40960
  ds_read_b64_tr_b16 a[198:199], v16 offset:45056
  v_mfma_f32_16x16x32_bf16 v[184:187], a[208:211], a[184:187], v[184:187]
  v_mfma_f32_16x16x32_bf16 v[188:191], a[204:207], a[172:175], v[188:191]
  v_mfma_f32_16x16x32_bf16 v[188:191], a[208:211], a[188:191], v[188:191]
  s_waitcnt lgkmcnt(4)
  v_mfma_f32_16x16x32_bf16 v[192:195], a[212:215], a[160:163], v[192:195]
  ds_read_b64_tr_b16 a[200:201], v17 offset:32768
  ds_read_b64_tr_b16 a[202:203], v17 offset:36864
  v_mfma_f32_16x16x32_bf16 v[192:195], a[216:219], a[176:179], v[192:195]
  v_mfma_f32_16x16x32_bf16 v[196:199], a[212:215], a[164:167], v[196:199]
  v_mfma_f32_16x16x32_bf16 v[196:199], a[216:219], a[180:183], v[196:199]
  v_mfma_f32_16x16x32_bf16 v[200:203], a[212:215], a[168:171], v[200:203]
  ds_read_b64_tr_b16 a[204:205], v17 offset:40960
  ds_read_b64_tr_b16 a[206:207], v17 offset:45056
  v_mfma_f32_16x16x32_bf16 v[200:203], a[216:219], a[184:187], v[200:203]
  v_mfma_f32_16x16x32_bf16 v[204:207], a[212:215], a[172:175], v[204:207]
  v_mfma_f32_16x16x32_bf16 v[204:207], a[216:219], a[188:191], v[204:207]
  s_waitcnt lgkmcnt(4)
  v_mfma_f32_16x16x32_bf16 v[96:99], a[192:195], a[0:3], v[96:99]
  ds_read_b64_tr_b16 a[208:209], v18 offset:32768
  ds_read_b64_tr_b16 a[210:211], v18 offset:36864
  v_mfma_f32_16x16x32_bf16 v[96:99], a[196:199], a[16:19], v[96:99]
  v_mfma_f32_16x16x32_bf16 v[100:103], a[192:195], a[4:7], v[100:103]
  v_mfma_f32_16x16x32_bf16 v[100:103], a[196:199], a[20:23], v[100:103]
  v_mfma_f32_16x16x32_bf16 v[104:107], a[192:195], a[8:11], v[104:107]
  ds_read_b64_tr_b16 a[212:213], v18 offset:40960
  ds_read_b64_tr_b16 a[214:215], v18 offset:45056
  v_mfma_f32_16x16x32_bf16 v[104:107], a[196:199], a[24:27], v[104:107]
  v_mfma_f32_16x16x32_bf16 v[108:111], a[192:195], a[12:15], v[108:111]
  v_mfma_f32_16x16x32_bf16 v[108:111], a[196:199], a[28:31], v[108:111]
  s_waitcnt lgkmcnt(4)
  v_mfma_f32_16x16x32_bf16 v[112:115], a[200:203], a[0:3], v[112:115]
  ds_read_b64_tr_b16 a[216:217], v19 offset:32768
  ds_read_b64_tr_b16 a[218:219], v19 offset:36864
  v_mfma_f32_16x16x32_bf16 v[112:115], a[204:207], a[16:19], v[112:115]
  v_mfma_f32_16x16x32_bf16 v[116:119], a[200:203], a[4:7], v[116:119]
  v_mfma_f32_16x16x32_bf16 v[116:119], a[204:207], a[20:23], v[116:119]
  v_mfma_f32_16x16x32_bf16 v[120:123], a[200:203], a[8:11], v[120:123]
  ds_read_b64_tr_b16 a[192:193], v19 offset:40960
  ds_read_b64_tr_b16 a[194:195], v19 offset:45056
  v_mfma_f32_16x16x32_bf16 v[120:123], a[204:207], a[24:27], v[120:123]
  v_mfma_f32_16x16x32_bf16 v[124:127], a[200:203], a[12:15], v[124:127]
  v_mfma_f32_16x16x32_bf16 v[124:127], a[204:207], a[28:31], v[124:127]
  s_waitcnt lgkmcnt(4)
  v_mfma_f32_16x16x32_bf16 v[128:131], a[208:211], a[0:3], v[128:131]
  ds_read_b64_tr_b16 a[196:197], v20 offset:32768
  ds_read_b64_tr_b16 a[198:199], v20 offset:36864
  v_mfma_f32_16x16x32_bf16 v[128:131], a[212:215], a[16:19], v[128:131]
  v_mfma_f32_16x16x32_bf16 v[132:135], a[208:211], a[4:7], v[132:135]
  v_mfma_f32_16x16x32_bf16 v[132:135], a[212:215], a[20:23], v[132:135]
  v_mfma_f32_16x16x32_bf16 v[136:139], a[208:211], a[8:11], v[136:139]
  ds_read_b64_tr_b16 a[200:201], v20 offset:40960
  ds_read_b64_tr_b16 a[202:203], v20 offset:45056
  v_mfma_f32_16x16x32_bf16 v[136:139], a[212:215], a[24:27], v[136:139]
  v_mfma_f32_16x16x32_bf16 v[140:143], a[208:211], a[12:15], v[140:143]
  v_mfma_f32_16x16x32_bf16 v[140:143], a[212:215], a[28:31], v[140:143]
  s_waitcnt lgkmcnt(4)
  v_mfma_f32_16x16x32_bf16 v[144:147], a[216:219], a[0:3], v[144:147]
  ds_read_b64_tr_b16 a[204:205], v21 offset:32768
  ds_read_b64_tr_b16 a[206:207], v21 offset:36864
  v_mfma_f32_16x16x32_bf16 v[144:147], a[192:195], a[16:19], v[144:147]
  v_mfma_f32_16x16x32_bf16 v[148:151], a[216:219], a[4:7], v[148:151]
  v_mfma_f32_16x16x32_bf16 v[148:151], a[192:195], a[20:23], v[148:151]
  v_mfma_f32_16x16x32_bf16 v[152:155], a[216:219], a[8:11], v[152:155]
  ds_read_b64_tr_b16 a[208:209], v21 offset:40960
  ds_read_b64_tr_b16 a[210:211], v21 offset:45056
  v_mfma_f32_16x16x32_bf16 v[152:155], a[192:195], a[24:27], v[152:155]
  v_mfma_f32_16x16x32_bf16 v[156:159], a[216:219], a[12:15], v[156:159]
  v_mfma_f32_16x16x32_bf16 v[156:159], a[192:195], a[28:31], v[156:159]
  s_waitcnt lgkmcnt(4)
  v_mfma_f32_16x16x32_bf16 v[160:163], a[196:199], a[0:3], v[160:163]
  ds_read_b64_tr_b16 a[212:213], v22 offset:32768
  ds_read_b64_tr_b16 a[214:215], v22 offset:36864
  v_mfma_f32_16x16x32_bf16 v[160:163], a[200:203], a[16:19], v[160:163]
  v_mfma_f32_16x16x32_bf16 v[164:167], a[196:199], a[4:7], v[164:167]
  v_mfma_f32_16x16x32_bf16 v[164:167], a[200:203], a[20:23], v[164:167]
  v_mfma_f32_16x16x32_bf16 v[168:171], a[196:199], a[8:11], v[168:171]
  ds_read_b64_tr_b16 a[216:217], v22 offset:40960
  ds_read_b64_tr_b16 a[218:219], v22 offset:45056
  v_mfma_f32_16x16x32_bf16 v[168:171], a[200:203], a[24:27], v[168:171]
  v_mfma_f32_16x16x32_bf16 v[172:175], a[196:199], a[12:15], v[172:175]
  v_mfma_f32_16x16x32_bf16 v[172:175], a[200:203], a[28:31], v[172:175]
  s_waitcnt vmcnt(25) lgkmcnt(4)
  s_barrier
  v_mfma_f32_16x16x32_bf16 v[176:179], a[204:207], a[0:3], v[176:179]
  ds_read_b64_tr_b16 a[192:193], v16 offset:49152
  ds_read_b64_tr_b16 a[194:195], v16 offset:53248
  v_mfma_f32_16x16x32_bf16 v[176:179], a[208:211], a[16:19], v[176:179]
  v_mfma_f32_16x16x32_bf16 v[180:183], a[204:207], a[4:7], v[180:183]
  v_mfma_f32_16x16x32_bf16 v[180:183], a[208:211], a[20:23], v[180:183]
  v_mfma_f32_16x16x32_bf16 v[184:187], a[204:207], a[8:11], v[184:187]
  ds_read_b64_tr_b16 a[196:197], v16 offset:57344
  ds_read_b64_tr_b16 a[198:199], v16 offset:61440
  v_mfma_f32_16x16x32_bf16 v[184:187], a[208:211], a[24:27], v[184:187]
  v_mfma_f32_16x16x32_bf16 v[188:191], a[204:207], a[12:15], v[188:191]
  v_mfma_f32_16x16x32_bf16 v[188:191], a[208:211], a[28:31], v[188:191]
  s_waitcnt lgkmcnt(4)
  v_mfma_f32_16x16x32_bf16 v[192:195], a[212:215], a[0:3], v[192:195]
  ds_read_b64_tr_b16 a[200:201], v17 offset:49152
  ds_read_b64_tr_b16 a[202:203], v17 offset:53248
  v_mfma_f32_16x16x32_bf16 v[192:195], a[216:219], a[16:19], v[192:195]
  v_mfma_f32_16x16x32_bf16 v[196:199], a[212:215], a[4:7], v[196:199]
  v_mfma_f32_16x16x32_bf16 v[196:199], a[216:219], a[20:23], v[196:199]
  v_mfma_f32_16x16x32_bf16 v[200:203], a[212:215], a[8:11], v[200:203]
  ds_read_b64_tr_b16 a[204:205], v17 offset:57344
  ds_read_b64_tr_b16 a[206:207], v17 offset:61440
  v_mfma_f32_16x16x32_bf16 v[200:203], a[216:219], a[24:27], v[200:203]
  v_mfma_f32_16x16x32_bf16 v[204:207], a[212:215], a[12:15], v[204:207]
  v_mfma_f32_16x16x32_bf16 v[204:207], a[216:219], a[28:31], v[204:207]
  s_waitcnt lgkmcnt(4)
  v_mfma_f32_16x16x32_bf16 v[96:99], a[192:195], a[32:35], v[96:99]
  ds_read_b64_tr_b16 a[208:209], v18 offset:49152
  ds_read_b64_tr_b16 a[210:211], v18 offset:53248
  v_mfma_f32_16x16x32_bf16 v[96:99], a[196:199], a[48:51], v[96:99]
  v_mfma_f32_16x16x32_bf16 v[100:103], a[192:195], a[36:39], v[100:103]
  v_mfma_f32_16x16x32_bf16 v[100:103], a[196:199], a[52:55], v[100:103]
  v_mfma_f32_16x16x32_bf16 v[104:107], a[192:195], a[40:43], v[104:107]
  ds_read_b64_tr_b16 a[212:213], v18 offset:57344
  ds_read_b64_tr_b16 a[214:215], v18 offset:61440
  v_mfma_f32_16x16x32_bf16 v[104:107], a[196:199], a[56:59], v[104:107]
  v_mfma_f32_16x16x32_bf16 v[108:111], a[192:195], a[44:47], v[108:111]
  v_mfma_f32_16x16x32_bf16 v[108:111], a[196:199], a[60:63], v[108:111]
  s_waitcnt lgkmcnt(4)
  v_mfma_f32_16x16x32_bf16 v[112:115], a[200:203], a[32:35], v[112:115]
  ds_read_b64_tr_b16 a[216:217], v19 offset:49152
  ds_read_b64_tr_b16 a[218:219], v19 offset:53248
  v_mfma_f32_16x16x32_bf16 v[112:115], a[204:207], a[48:51], v[112:115]
  v_mfma_f32_16x16x32_bf16 v[116:119], a[200:203], a[36:39], v[116:119]
  v_mfma_f32_16x16x32_bf16 v[116:119], a[204:207], a[52:55], v[116:119]
  v_mfma_f32_16x16x32_bf16 v[120:123], a[200:203], a[40:43], v[120:123]
  ds_read_b64_tr_b16 a[192:193], v19 offset:57344
  ds_read_b64_tr_b16 a[194:195], v19 offset:61440
  v_mfma_f32_16x16x32_bf16 v[120:123], a[204:207], a[56:59], v[120:123]
  v_mfma_f32_16x16x32_bf16 v[124:127], a[200:203], a[44:47], v[124:127]
  v_mfma_f32_16x16x32_bf16 v[124:127], a[204:207], a[60:63], v[124:127]
  s_waitcnt lgkmcnt(4)
  v_mfma_f32_16x16x32_bf16 v[128:131], a[208:211], a[32:35], v[128:131]
  ds_read_b64_tr_b16 a[196:197], v20 offset:49152
  ds_read_b64_tr_b16 a[198:199], v20 offset:53248
  v_mfma_f32_16x16x32_bf16 v[128:131], a[212:215], a[48:51], v[128:131]
  v_mfma_f32_16x16x32_bf16 v[132:135], a[208:211], a[36:39], v[132:135]
  v_mfma_f32_16x16x32_bf16 v[132:135], a[212:215], a[52:55], v[132:135]
  v_mfma_f32_16x16x32_bf16 v[136:139], a[208:211], a[40:43], v[136:139]
  ds_read_b64_tr_b16 a[200:201], v20 offset:57344
  ds_read_b64_tr_b16 a[202:203], v20 offset:61440
  v_mfma_f32_16x16x32_bf16 v[136:139], a[212:215], a[56:59], v[136:139]
  v_mfma_f32_16x16x32_bf16 v[140:143], a[208:211], a[44:47], v[140:143]
  v_mfma_f32_16x16x32_bf16 v[140:143], a[212:215], a[60:63], v[140:143]
  s_waitcnt lgkmcnt(4)
  v_mfma_f32_16x16x32_bf16 v[144:147], a[216:219], a[32:35], v[144:147]
  ds_read_b64_tr_b16 a[204:205], v21 offset:49152
  ds_read_b64_tr_b16 a[206:207], v21 offset:53248
  v_mfma_f32_16x16x32_bf16 v[144:147], a[192:195], a[48:51], v[144:147]
  v_mfma_f32_16x16x32_bf16 v[148:151], a[216:219], a[36:39], v[148:151]
  v_mfma_f32_16x16x32_bf16 v[148:151], a[192:195], a[52:55], v[148:151]
  v_mfma_f32_16x16x32_bf16 v[152:155], a[216:219], a[40:43], v[152:155]
  ds_read_b64_tr_b16 a[208:209], v21 offset:57344
  ds_read_b64_tr_b16 a[210:211], v21 offset:61440
  v_mfma_f32_16x16x32_bf16 v[152:155], a[192:195], a[56:59], v[152:155]
  v_mfma_f32_16x16x32_bf16 v[156:159], a[216:219], a[44:47], v[156:159]
  v_mfma_f32_16x16x32_bf16 v[156:159], a[192:195], a[60:63], v[156:159]
  s_waitcnt lgkmcnt(4)
  v_mfma_f32_16x16x32_bf16 v[160:163], a[196:199], a[32:35], v[160:163]
  ds_read_b64_tr_b16 a[212:213], v22 offset:49152
  ds_read_b64_tr_b16 a[214:215], v22 offset:53248
  v_mfma_f32_16x16x32_bf16 v[160:163], a[200:203], a[48:51], v[160:163]
  v_mfma_f32_16x16x32_bf16 v[164:167], a[196:199], a[36:39], v[164:167]
  v_mfma_f32_16x16x32_bf16 v[164:167], a[200:203], a[52:55], v[164:167]
  v_mfma_f32_16x16x32_bf16 v[168:171], a[196:199], a[40:43], v[168:171]
  ds_read_b64_tr_b16 a[216:217], v22 offset:57344
  ds_read_b64_tr_b16 a[218:219], v22 offset:61440
  v_mfma_f32_16x16x32_bf16 v[168:171], a[200:203], a[56:59], v[168:171]
  v_mfma_f32_16x16x32_bf16 v[172:175], a[196:199], a[44:47], v[172:175]
  v_mfma_f32_16x16x32_bf16 v[172:175], a[200:203], a[60:63], v[172:175]
  s_waitcnt vmcnt(13) lgkmcnt(4)
  s_barrier
  v_mfma_f32_16x16x32_bf16 v[176:179], a[204:207], a[32:35], v[176:179]
  ds_read_b64_tr_b16 a[192:193], v24 offset:0
  ds_read_b64_tr_b16 a[194:195], v24 offset:4096
  v_mfma_f32_16x16x32_bf16 v[176:179], a[208:211], a[48:51], v[176:179]
  v_mfma_f32_16x16x32_bf16 v[180:183], a[204:207], a[36:39], v[180:183]
  v_mfma_f32_16x16x32_bf16 v[180:183], a[208:211], a[52:55], v[180:183]
  v_mfma_f32_16x16x32_bf16 v[184:187], a[204:207], a[40:43], v[184:187]
  ds_read_b64_tr_b16 a[196:197], v24 offset:8192
  ds_read_b64_tr_b16 a[198:199], v24 offset:12288
  v_mfma_f32_16x16x32_bf16 v[184:187], a[208:211], a[56:59], v[184:187]
  v_mfma_f32_16x16x32_bf16 v[188:191], a[204:207], a[44:47], v[188:191]
  v_mfma_f32_16x16x32_bf16 v[188:191], a[208:211], a[60:63], v[188:191]
  s_waitcnt lgkmcnt(4)
  v_mfma_f32_16x16x32_bf16 v[192:195], a[212:215], a[32:35], v[192:195]
  ds_read_b64_tr_b16 a[200:201], v25 offset:0
  ds_read_b64_tr_b16 a[202:203], v25 offset:4096
  v_mfma_f32_16x16x32_bf16 v[192:195], a[216:219], a[48:51], v[192:195]
  v_mfma_f32_16x16x32_bf16 v[196:199], a[212:215], a[36:39], v[196:199]
  v_mfma_f32_16x16x32_bf16 v[196:199], a[216:219], a[52:55], v[196:199]
  v_mfma_f32_16x16x32_bf16 v[200:203], a[212:215], a[40:43], v[200:203]
  ds_read_b64_tr_b16 a[204:205], v25 offset:8192
  ds_read_b64_tr_b16 a[206:207], v25 offset:12288
  v_mfma_f32_16x16x32_bf16 v[200:203], a[216:219], a[56:59], v[200:203]
  v_mfma_f32_16x16x32_bf16 v[204:207], a[212:215], a[44:47], v[204:207]
  v_mfma_f32_16x16x32_bf16 v[204:207], a[216:219], a[60:63], v[204:207]
  s_waitcnt lgkmcnt(4)
  v_mfma_f32_16x16x32_bf16 v[96:99], a[192:195], a[64:67], v[96:99]
  ds_read_b64_tr_b16 a[208:209], v26 offset:0
  ds_read_b64_tr_b16 a[210:211], v26 offset:4096
  v_mfma_f32_16x16x32_bf16 v[96:99], a[196:199], a[80:83], v[96:99]
  v_mfma_f32_16x16x32_bf16 v[100:103], a[192:195], a[68:71], v[100:103]
  v_mfma_f32_16x16x32_bf16 v[100:103], a[196:199], a[84:87], v[100:103]
  v_mfma_f32_16x16x32_bf16 v[104:107], a[192:195], a[72:75], v[104:107]
  ds_read_b64_tr_b16 a[212:213], v26 offset:8192
  ds_read_b64_tr_b16 a[214:215], v26 offset:12288
  v_mfma_f32_16x16x32_bf16 v[104:107], a[196:199], a[88:91], v[104:107]
  v_mfma_f32_16x16x32_bf16 v[108:111], a[192:195], a[76:79], v[108:111]
  v_mfma_f32_16x16x32_bf16 v[108:111], a[196:199], a[92:95], v[108:111]
  s_waitcnt lgkmcnt(4)
  v_mfma_f32_16x16x32_bf16 v[112:115], a[200:203], a[64:67], v[112:115]
  ds_read_b64_tr_b16 a[216:217], v27 offset:0
  ds_read_b64_tr_b16 a[218:219], v27 offset:4096
  v_mfma_f32_16x16x32_bf16 v[112:115], a[204:207], a[80:83], v[112:115]
  v_mfma_f32_16x16x32_bf16 v[116:119], a[200:203], a[68:71], v[116:119]
  v_mfma_f32_16x16x32_bf16 v[116:119], a[204:207], a[84:87], v[116:119]
  v_mfma_f32_16x16x32_bf16 v[120:123], a[200:203], a[72:75], v[120:123]
  ds_read_b64_tr_b16 a[192:193], v27 offset:8192
  ds_read_b64_tr_b16 a[194:195], v27 offset:12288
  v_mfma_f32_16x16x32_bf16 v[120:123], a[204:207], a[88:91], v[120:123]
  v_mfma_f32_16x16x32_bf16 v[124:127], a[200:203], a[76:79], v[124:127]
  v_mfma_f32_16x16x32_bf16 v[124:127], a[204:207], a[92:95], v[124:127]
  s_waitcnt lgkmcnt(4)
  v_mfma_f32_16x16x32_bf16 v[128:131], a[208:211], a[64:67], v[128:131]
  ds_read_b64_tr_b16 a[196:197], v28 offset:0
  ds_read_b64_tr_b16 a[198:199], v28 offset:4096
  v_mfma_f32_16x16x32_bf16 v[128:131], a[212:215], a[80:83], v[128:131]
  v_mfma_f32_16x16x32_bf16 v[132:135], a[208:211], a[68:71], v[132:135]
  v_mfma_f32_16x16x32_bf16 v[132:135], a[212:215], a[84:87], v[132:135]
  v_mfma_f32_16x16x32_bf16 v[136:139], a[208:211], a[72:75], v[136:139]
  ds_read_b64_tr_b16 a[200:201], v28 offset:8192
  ds_read_b64_tr_b16 a[202:203], v28 offset:12288
  v_mfma_f32_16x16x32_bf16 v[136:139], a[212:215], a[88:91], v[136:139]
  v_mfma_f32_16x16x32_bf16 v[140:143], a[208:211], a[76:79], v[140:143]
  v_mfma_f32_16x16x32_bf16 v[140:143], a[212:215], a[92:95], v[140:143]
  s_waitcnt lgkmcnt(4)
  v_mfma_f32_16x16x32_bf16 v[144:147], a[216:219], a[64:67], v[144:147]
  ds_read_b64_tr_b16 a[204:205], v29 offset:0
  ds_read_b64_tr_b16 a[206:207], v29 offset:4096
  v_mfma_f32_16x16x32_bf16 v[144:147], a[192:195], a[80:83], v[144:147]
  v_mfma_f32_16x16x32_bf16 v[148:151], a[216:219], a[68:71], v[148:151]
  v_mfma_f32_16x16x32_bf16 v[148:151], a[192:195], a[84:87], v[148:151]
  v_mfma_f32_16x16x32_bf16 v[152:155], a[216:219], a[72:75], v[152:155]
  ds_read_b64_tr_b16 a[208:209], v29 offset:8192
  ds_read_b64_tr_b16 a[210:211], v29 offset:12288
  v_mfma_f32_16x16x32_bf16 v[152:155], a[192:195], a[88:91], v[152:155]
  v_mfma_f32_16x16x32_bf16 v[156:159], a[216:219], a[76:79], v[156:159]
  v_mfma_f32_16x16x32_bf16 v[156:159], a[192:195], a[92:95], v[156:159]
  s_waitcnt lgkmcnt(4)
  v_mfma_f32_16x16x32_bf16 v[160:163], a[196:199], a[64:67], v[160:163]
  ds_read_b64_tr_b16 a[212:213], v30 offset:0
  ds_read_b64_tr_b16 a[214:215], v30 offset:4096
  v_mfma_f32_16x16x32_bf16 v[160:163], a[200:203], a[80:83], v[160:163]
  v_mfma_f32_16x16x32_bf16 v[164:167], a[196:199], a[68:71], v[164:167]
  v_mfma_f32_16x16x32_bf16 v[164:167], a[200:203], a[84:87], v[164:167]
  v_mfma_f32_16x16x32_bf16 v[168:171], a[196:199], a[72:75], v[168:171]
  ds_read_b64_tr_b16 a[216:217], v30 offset:8192
  ds_read_b64_tr_b16 a[218:219], v30 offset:12288
  v_mfma_f32_16x16x32_bf16 v[168:171], a[200:203], a[88:91], v[168:171]
  v_mfma_f32_16x16x32_bf16 v[172:175], a[196:199], a[76:79], v[172:175]
  v_mfma_f32_16x16x32_bf16 v[172:175], a[200:203], a[92:95], v[172:175]
  s_waitcnt vmcnt(1) lgkmcnt(4)
  s_barrier
  v_mfma_f32_16x16x32_bf16 v[176:179], a[204:207], a[64:67], v[176:179]
  ds_read_b64_tr_b16 a[192:193], v24 offset:16384
  ds_read_b64_tr_b16 a[194:195], v24 offset:20480
  v_mfma_f32_16x16x32_bf16 v[176:179], a[208:211], a[80:83], v[176:179]
  v_mfma_f32_16x16x32_bf16 v[180:183], a[204:207], a[68:71], v[180:183]
  v_mfma_f32_16x16x32_bf16 v[180:183], a[208:211], a[84:87], v[180:183]
  v_mfma_f32_16x16x32_bf16 v[184:187], a[204:207], a[72:75], v[184:187]
  ds_read_b64_tr_b16 a[196:197], v24 offset:24576
  ds_read_b64_tr_b16 a[198:199], v24 offset:28672
  v_mfma_f32_16x16x32_bf16 v[184:187], a[208:211], a[88:91], v[184:187]
  v_mfma_f32_16x16x32_bf16 v[188:191], a[204:207], a[76:79], v[188:191]
  v_mfma_f32_16x16x32_bf16 v[188:191], a[208:211], a[92:95], v[188:191]
  s_waitcnt lgkmcnt(4)
  v_mfma_f32_16x16x32_bf16 v[192:195], a[212:215], a[64:67], v[192:195]
  ds_read_b64_tr_b16 a[200:201], v25 offset:16384
  ds_read_b64_tr_b16 a[202:203], v25 offset:20480
  v_mfma_f32_16x16x32_bf16 v[192:195], a[216:219], a[80:83], v[192:195]
  v_mfma_f32_16x16x32_bf16 v[196:199], a[212:215], a[68:71], v[196:199]
  v_mfma_f32_16x16x32_bf16 v[196:199], a[216:219], a[84:87], v[196:199]
  v_mfma_f32_16x16x32_bf16 v[200:203], a[212:215], a[72:75], v[200:203]
  ds_read_b64_tr_b16 a[204:205], v25 offset:24576
  ds_read_b64_tr_b16 a[206:207], v25 offset:28672
  v_mfma_f32_16x16x32_bf16 v[200:203], a[216:219], a[88:91], v[200:203]
  v_mfma_f32_16x16x32_bf16 v[204:207], a[212:215], a[76:79], v[204:207]
  v_mfma_f32_16x16x32_bf16 v[204:207], a[216:219], a[92:95], v[204:207]
  s_waitcnt lgkmcnt(4)
  v_mfma_f32_16x16x32_bf16 v[96:99], a[192:195], a[96:99], v[96:99]
  ds_read_b64_tr_b16 a[208:209], v26 offset:16384
  ds_read_b64_tr_b16 a[210:211], v26 offset:20480
  v_mfma_f32_16x16x32_bf16 v[96:99], a[196:199], a[112:115], v[96:99]
  v_mfma_f32_16x16x32_bf16 v[100:103], a[192:195], a[100:103], v[100:103]
  v_mfma_f32_16x16x32_bf16 v[100:103], a[196:199], a[116:119], v[100:103]
  v_mfma_f32_16x16x32_bf16 v[104:107], a[192:195], a[104:107], v[104:107]
  ds_read_b64_tr_b16 a[212:213], v26 offset:24576
  ds_read_b64_tr_b16 a[214:215], v26 offset:28672
  v_mfma_f32_16x16x32_bf16 v[104:107], a[196:199], a[120:123], v[104:107]
  v_mfma_f32_16x16x32_bf16 v[108:111], a[192:195], a[108:111], v[108:111]
  v_mfma_f32_16x16x32_bf16 v[108:111], a[196:199], a[124:127], v[108:111]
  s_waitcnt lgkmcnt(4)
  v_mfma_f32_16x16x32_bf16 v[112:115], a[200:203], a[96:99], v[112:115]
  ds_read_b64_tr_b16 a[216:217], v27 offset:16384
  ds_read_b64_tr_b16 a[218:219], v27 offset:20480
  v_mfma_f32_16x16x32_bf16 v[112:115], a[204:207], a[112:115], v[112:115]
  v_mfma_f32_16x16x32_bf16 v[116:119], a[200:203], a[100:103], v[116:119]
  v_mfma_f32_16x16x32_bf16 v[116:119], a[204:207], a[116:119], v[116:119]
  v_mfma_f32_16x16x32_bf16 v[120:123], a[200:203], a[104:107], v[120:123]
  ds_read_b64_tr_b16 a[192:193], v27 offset:24576
  ds_read_b64_tr_b16 a[194:195], v27 offset:28672
  v_mfma_f32_16x16x32_bf16 v[120:123], a[204:207], a[120:123], v[120:123]
  v_mfma_f32_16x16x32_bf16 v[124:127], a[200:203], a[108:111], v[124:127]
  v_mfma_f32_16x16x32_bf16 v[124:127], a[204:207], a[124:127], v[124:127]
  s_waitcnt lgkmcnt(4)
  v_mfma_f32_16x16x32_bf16 v[128:131], a[208:211], a[96:99], v[128:131]
  ds_read_b64_tr_b16 a[196:197], v28 offset:16384
  ds_read_b64_tr_b16 a[198:199], v28 offset:20480
  v_mfma_f32_16x16x32_bf16 v[128:131], a[212:215], a[112:115], v[128:131]
  v_mfma_f32_16x16x32_bf16 v[132:135], a[208:211], a[100:103], v[132:135]
  v_mfma_f32_16x16x32_bf16 v[132:135], a[212:215], a[116:119], v[132:135]
  v_mfma_f32_16x16x32_bf16 v[136:139], a[208:211], a[104:107], v[136:139]
  ds_read_b64_tr_b16 a[200:201], v28 offset:24576
  ds_read_b64_tr_b16 a[202:203], v28 offset:28672
  v_mfma_f32_16x16x32_bf16 v[136:139], a[212:215], a[120:123], v[136:139]
  v_mfma_f32_16x16x32_bf16 v[140:143], a[208:211], a[108:111], v[140:143]
  v_mfma_f32_16x16x32_bf16 v[140:143], a[212:215], a[124:127], v[140:143]
  s_waitcnt lgkmcnt(4)
  v_mfma_f32_16x16x32_bf16 v[144:147], a[216:219], a[96:99], v[144:147]
  ds_read_b64_tr_b16 a[204:205], v29 offset:16384
  ds_read_b64_tr_b16 a[206:207], v29 offset:20480
  v_mfma_f32_16x16x32_bf16 v[144:147], a[192:195], a[112:115], v[144:147]
  v_mfma_f32_16x16x32_bf16 v[148:151], a[216:219], a[100:103], v[148:151]
  v_mfma_f32_16x16x32_bf16 v[148:151], a[192:195], a[116:119], v[148:151]
  v_mfma_f32_16x16x32_bf16 v[152:155], a[216:219], a[104:107], v[152:155]
  ds_read_b64_tr_b16 a[208:209], v29 offset:24576
  ds_read_b64_tr_b16 a[210:211], v29 offset:28672
  v_mfma_f32_16x16x32_bf16 v[152:155], a[192:195], a[120:123], v[152:155]
  v_mfma_f32_16x16x32_bf16 v[156:159], a[216:219], a[108:111], v[156:159]
  v_mfma_f32_16x16x32_bf16 v[156:159], a[192:195], a[124:127], v[156:159]
  s_waitcnt lgkmcnt(4)
  v_mfma_f32_16x16x32_bf16 v[160:163], a[196:199], a[96:99], v[160:163]
  ds_read_b64_tr_b16 a[212:213], v30 offset:16384
  ds_read_b64_tr_b16 a[214:215], v30 offset:20480
  v_mfma_f32_16x16x32_bf16 v[160:163], a[200:203], a[112:115], v[160:163]
  v_mfma_f32_16x16x32_bf16 v[164:167], a[196:199], a[100:103], v[164:167]
  v_mfma_f32_16x16x32_bf16 v[164:167], a[200:203], a[116:119], v[164:167]
  v_mfma_f32_16x16x32_bf16 v[168:171], a[196:199], a[104:107], v[168:171]
  ds_read_b64_tr_b16 a[216:217], v30 offset:24576
  ds_read_b64_tr_b16 a[218:219], v30 offset:28672
  v_mfma_f32_16x16x32_bf16 v[168:171], a[200:203], a[120:123], v[168:171]
  v_mfma_f32_16x16x32_bf16 v[172:175], a[196:199], a[108:111], v[172:175]
  v_mfma_f32_16x16x32_bf16 v[172:175], a[200:203], a[124:127], v[172:175]
  s_waitcnt lgkmcnt(4)
  v_mfma_f32_16x16x32_bf16 v[176:179], a[204:207], a[96:99], v[176:179]
  v_mfma_f32_16x16x32_bf16 v[176:179], a[208:211], a[112:115], v[176:179]
  v_mfma_f32_16x16x32_bf16 v[180:183], a[204:207], a[100:103], v[180:183]
  v_mfma_f32_16x16x32_bf16 v[180:183], a[208:211], a[116:119], v[180:183]
  v_mfma_f32_16x16x32_bf16 v[184:187], a[204:207], a[104:107], v[184:187]
  v_mfma_f32_16x16x32_bf16 v[184:187], a[208:211], a[120:123], v[184:187]
  v_mfma_f32_16x16x32_bf16 v[188:191], a[204:207], a[108:111], v[188:191]
  v_mfma_f32_16x16x32_bf16 v[188:191], a[208:211], a[124:127], v[188:191]
  s_waitcnt lgkmcnt(0)
  v_mfma_f32_16x16x32_bf16 v[192:195], a[212:215], a[96:99], v[192:195]
  v_mfma_f32_16x16x32_bf16 v[192:195], a[216:219], a[112:115], v[192:195]
  v_mfma_f32_16x16x32_bf16 v[196:199], a[212:215], a[100:103], v[196:199]
  v_mfma_f32_16x16x32_bf16 v[196:199], a[216:219], a[116:119], v[196:199]
  v_mfma_f32_16x16x32_bf16 v[200:203], a[212:215], a[104:107], v[200:203]
  v_mfma_f32_16x16x32_bf16 v[200:203], a[216:219], a[120:123], v[200:203]
  v_mfma_f32_16x16x32_bf16 v[204:207], a[212:215], a[108:111], v[204:207]
  v_mfma_f32_16x16x32_bf16 v[204:207], a[216:219], a[124:127], v[204:207]
attn_kernel_epi31:
  s_waitcnt vmcnt(0)
  s_add_u32 s24, s4, 8388608
  s_addc_u32 s25, s5, 0
  s_and_b32 s25, s25, 0xffff
  s_mov_b32 s26, 14680064
  s_mov_b32 s27, 0x20000
  s_and_b32 s62, s2, 1
  s_lshl_b32 s62, s62, 2
  s_bfe_u32 s63, s2, 0x20003
  s_add_u32 s62, s62, s63
  s_bfe_u32 s63, s2, 0x10002
  s_load_dwordx2 s[12:13], s[0:1], 64
  s_lshl_b32 s50, s62, 8
  s_mul_i32 s63, s63, 3670016
  s_add_u32 s50, s50, s63
  v_lshrrev_b32 v32, 4, v1
  v_and_b32 v33, 15, v1
  s_lshl_b32 s45, s44, 4
  s_mov_b32 s46, 2048
  v_add_u32 v34, 0, v32
  v_and_b32 v35, 7, v34
  v_lshlrev_b32 v35, 1, v35
  v_xor_b32 v35, v35, v33
  v_add_u32 v34, s45, v34
  v_mul_lo_u32 v34, v34, s46
  v_lshl_add_u32 v216, v35, 4, v34
  v_add_u32 v34, 4, v32
  v_and_b32 v35, 7, v34
  v_lshlrev_b32 v35, 1, v35
  v_xor_b32 v35, v35, v33
  v_add_u32 v34, s45, v34
  v_mul_lo_u32 v34, v34, s46
  v_lshl_add_u32 v217, v35, 4, v34
  v_subrev_u32 v217, 1024, v217
  v_add_u32 v34, 8, v32
  v_and_b32 v35, 7, v34
  v_lshlrev_b32 v35, 1, v35
  v_xor_b32 v35, v35, v33
  v_add_u32 v34, s45, v34
  v_mul_lo_u32 v34, v34, s46
  v_lshl_add_u32 v218, v35, 4, v34
  v_subrev_u32 v218, 2048, v218
  v_add_u32 v34, 12, v32
  v_and_b32 v35, 7, v34
  v_lshlrev_b32 v35, 1, v35
  v_xor_b32 v35, v35, v33
  v_add_u32 v34, s45, v34
  v_mul_lo_u32 v34, v34, s46
  v_lshl_add_u32 v219, v35, 4, v34
  v_subrev_u32 v219, 3072, v219
  s_waitcnt lgkmcnt(0)
  s_and_b32 s13, s13, 0xffff
  s_mov_b32 s14, 7340032
  s_mov_b32 s15, 0x20000
  v_mov_b32 v40, 0xc0135761
  v_mov_b32 v41, 0xc0135761
  v_mov_b32 v42, 0xbdd2d3e8
  v_mov_b32 v43, 0xbdd2d3e8
  v_mov_b32 v44, 0x3f800000
  v_mov_b32 v45, 0x3f800000
  v_lshlrev_b32 v6, 4, v1
  s_mul_i32 s54, s43, 7
  s_lshr_b32 s55, s54, 1
  s_lshl_b32 s55, s55, 7
  s_add_u32 s55, s55, s47
  s_lshl_b32 s55, s55, 10
  s_add_u32 s56, s55, 131072
  s_add_u32 s57, s55, 262144
  s_add_u32 s58, s55, 393216
  s_bitcmp1_b32 s43, 0
  s_cbranch_scc1 attn_kernel_odd36
  v_pk_mul_f32 v[48:49], v[192:193], v[192:193]
  v_pk_fma_f32 v[48:49], v[48:49], v[42:43], v[40:41]
  v_pk_mul_f32 v[48:49], v[48:49], v[192:193]
  v_pk_mul_f32 v[50:51], v[194:195], v[194:195]
  v_pk_fma_f32 v[50:51], v[50:51], v[42:43], v[40:41]
  v_pk_mul_f32 v[50:51], v[50:51], v[194:195]
  v_exp_f32 v48, v48
  v_exp_f32 v49, v49
  v_exp_f32 v50, v50
  v_exp_f32 v51, v51
  v_pk_add_f32 v[48:49], v[48:49], v[44:45]
  v_pk_add_f32 v[50:51], v[50:51], v[44:45]
  v_rcp_f32 v48, v48
  v_rcp_f32 v49, v49
  v_rcp_f32 v50, v50
  v_rcp_f32 v51, v51
  v_pk_mul_f32 v[192:193], v[192:193], v[48:49]
  v_pk_mul_f32 v[194:195], v[194:195], v[50:51]
  v_cvt_pk_bf16_f32 v56, v192, v193
  v_cvt_pk_bf16_f32 v57, v194, v195
  buffer_store_dwordx2 v[56:57], v6, s[24:27], s58 offen offset:0 sc1
  v_pk_mul_f32 v[48:49], v[196:197], v[196:197]
  v_pk_fma_f32 v[48:49], v[48:49], v[42:43], v[40:41]
  v_pk_mul_f32 v[48:49], v[48:49], v[196:197]
  v_pk_mul_f32 v[50:51], v[198:199], v[198:199]
  v_pk_fma_f32 v[50:51], v[50:51], v[42:43], v[40:41]
  v_pk_mul_f32 v[50:51], v[50:51], v[198:199]
  v_exp_f32 v48, v48
  v_exp_f32 v49, v49
  v_exp_f32 v50, v50
  v_exp_f32 v51, v51
  v_pk_add_f32 v[48:49], v[48:49], v[44:45]
  v_pk_add_f32 v[50:51], v[50:51], v[44:45]
  v_rcp_f32 v48, v48
  v_rcp_f32 v49, v49
  v_rcp_f32 v50, v50
  v_rcp_f32 v51, v51
  v_pk_mul_f32 v[196:197], v[196:197], v[48:49]
  v_pk_mul_f32 v[198:199], v[198:199], v[50:51]
  v_cvt_pk_bf16_f32 v60, v196, v197
  v_cvt_pk_bf16_f32 v61, v198, v199
  buffer_store_dwordx2 v[60:61], v6, s[24:27], s58 offen offset:1024 sc1
  v_pk_mul_f32 v[48:49], v[200:201], v[200:201]
  v_pk_fma_f32 v[48:49], v[48:49], v[42:43], v[40:41]
  v_pk_mul_f32 v[48:49], v[48:49], v[200:201]
  v_pk_mul_f32 v[50:51], v[202:203], v[202:203]
  v_pk_fma_f32 v[50:51], v[50:51], v[42:43], v[40:41]
  v_pk_mul_f32 v[50:51], v[50:51], v[202:203]
  v_exp_f32 v48, v48
  v_exp_f32 v49, v49
  v_exp_f32 v50, v50
  v_exp_f32 v51, v51
  v_pk_add_f32 v[48:49], v[48:49], v[44:45]
  v_pk_add_f32 v[50:51], v[50:51], v[44:45]
  v_rcp_f32 v48, v48
  v_rcp_f32 v49, v49
  v_rcp_f32 v50, v50
  v_rcp_f32 v51, v51
  v_pk_mul_f32 v[200:201], v[200:201], v[48:49]
  v_pk_mul_f32 v[202:203], v[202:203], v[50:51]
  v_cvt_pk_bf16_f32 v56, v200, v201
  v_cvt_pk_bf16_f32 v57, v202, v203
  buffer_store_dwordx2 v[56:57], v6, s[24:27], s58 offen offset:2048 sc1
  v_pk_mul_f32 v[48:49], v[204:205], v[204:205]
  v_pk_fma_f32 v[48:49], v[48:49], v[42:43], v[40:41]
  v_pk_mul_f32 v[48:49], v[48:49], v[204:205]
  v_pk_mul_f32 v[50:51], v[206:207], v[206:207]
  v_pk_fma_f32 v[50:51], v[50:51], v[42:43], v[40:41]
  v_pk_mul_f32 v[50:51], v[50:51], v[206:207]
  v_exp_f32 v48, v48
  v_exp_f32 v49, v49
  v_exp_f32 v50, v50
  v_exp_f32 v51, v51
  v_pk_add_f32 v[48:49], v[48:49], v[44:45]
  v_pk_add_f32 v[50:51], v[50:51], v[44:45]
  v_rcp_f32 v48, v48
  v_rcp_f32 v49, v49
  v_rcp_f32 v50, v50
  v_rcp_f32 v51, v51
  v_pk_mul_f32 v[204:205], v[204:205], v[48:49]
  v_pk_mul_f32 v[206:207], v[206:207], v[50:51]
  v_cvt_pk_bf16_f32 v60, v204, v205
  v_cvt_pk_bf16_f32 v61, v206, v207
  buffer_store_dwordx2 v[60:61], v6, s[24:27], s58 offen offset:3072 sc1
  v_pk_mul_f32 v[48:49], v[96:97], v[96:97]
  v_pk_fma_f32 v[48:49], v[48:49], v[42:43], v[40:41]
  v_pk_mul_f32 v[48:49], v[48:49], v[96:97]
  v_pk_mul_f32 v[50:51], v[98:99], v[98:99]
  v_pk_fma_f32 v[50:51], v[50:51], v[42:43], v[40:41]
  v_pk_mul_f32 v[50:51], v[50:51], v[98:99]
  v_exp_f32 v48, v48
  v_exp_f32 v49, v49
  v_exp_f32 v50, v50
  v_exp_f32 v51, v51
  v_pk_add_f32 v[48:49], v[48:49], v[44:45]
  v_pk_add_f32 v[50:51], v[50:51], v[44:45]
  v_rcp_f32 v48, v48
  v_rcp_f32 v49, v49
  v_rcp_f32 v50, v50
  v_rcp_f32 v51, v51
  v_pk_mul_f32 v[96:97], v[96:97], v[48:49]
  v_pk_mul_f32 v[98:99], v[98:99], v[50:51]
  v_cvt_pk_bf16_f32 v56, v96, v97
  v_cvt_pk_bf16_f32 v57, v98, v99
  v_pk_mul_f32 v[48:49], v[112:113], v[112:113]
  v_pk_fma_f32 v[48:49], v[48:49], v[42:43], v[40:41]
  v_pk_mul_f32 v[48:49], v[48:49], v[112:113]
  v_pk_mul_f32 v[50:51], v[114:115], v[114:115]
  v_pk_fma_f32 v[50:51], v[50:51], v[42:43], v[40:41]
  v_pk_mul_f32 v[50:51], v[50:51], v[114:115]
  v_exp_f32 v48, v48
  v_exp_f32 v49, v49
  v_exp_f32 v50, v50
  v_exp_f32 v51, v51
  v_pk_add_f32 v[48:49], v[48:49], v[44:45]
  v_pk_add_f32 v[50:51], v[50:51], v[44:45]
  v_rcp_f32 v48, v48
  v_rcp_f32 v49, v49
  v_rcp_f32 v50, v50
  v_rcp_f32 v51, v51
  v_pk_mul_f32 v[112:113], v[112:113], v[48:49]
  v_pk_mul_f32 v[114:115], v[114:115], v[50:51]
  v_cvt_pk_bf16_f32 v58, v112, v113
  v_cvt_pk_bf16_f32 v59, v114, v115
  buffer_store_dwordx4 v[56:59], v6, s[24:27], s55 offen offset:0 sc1
  v_pk_mul_f32 v[48:49], v[128:129], v[128:129]
  v_pk_fma_f32 v[48:49], v[48:49], v[42:43], v[40:41]
  v_pk_mul_f32 v[48:49], v[48:49], v[128:129]
  v_pk_mul_f32 v[50:51], v[130:131], v[130:131]
  v_pk_fma_f32 v[50:51], v[50:51], v[42:43], v[40:41]
  v_pk_mul_f32 v[50:51], v[50:51], v[130:131]
  v_exp_f32 v48, v48
  v_exp_f32 v49, v49
  v_exp_f32 v50, v50
  v_exp_f32 v51, v51
  v_pk_add_f32 v[48:49], v[48:49], v[44:45]
  v_pk_add_f32 v[50:51], v[50:51], v[44:45]
  v_rcp_f32 v48, v48
  v_rcp_f32 v49, v49
  v_rcp_f32 v50, v50
  v_rcp_f32 v51, v51
  v_pk_mul_f32 v[128:129], v[128:129], v[48:49]
  v_pk_mul_f32 v[130:131], v[130:131], v[50:51]
  v_cvt_pk_bf16_f32 v60, v128, v129
  v_cvt_pk_bf16_f32 v61, v130, v131
  v_pk_mul_f32 v[48:49], v[144:145], v[144:145]
  v_pk_fma_f32 v[48:49], v[48:49], v[42:43], v[40:41]
  v_pk_mul_f32 v[48:49], v[48:49], v[144:145]
  v_pk_mul_f32 v[50:51], v[146:147], v[146:147]
  v_pk_fma_f32 v[50:51], v[50:51], v[42:43], v[40:41]
  v_pk_mul_f32 v[50:51], v[50:51], v[146:147]
  v_exp_f32 v48, v48
  v_exp_f32 v49, v49
  v_exp_f32 v50, v50
  v_exp_f32 v51, v51
  v_pk_add_f32 v[48:49], v[48:49], v[44:45]
  v_pk_add_f32 v[50:51], v[50:51], v[44:45]
  v_rcp_f32 v48, v48
  v_rcp_f32 v49, v49
  v_rcp_f32 v50, v50
  v_rcp_f32 v51, v51
  v_pk_mul_f32 v[144:145], v[144:145], v[48:49]
  v_pk_mul_f32 v[146:147], v[146:147], v[50:51]
  v_cvt_pk_bf16_f32 v62, v144, v145
  v_cvt_pk_bf16_f32 v63, v146, v147
  buffer_store_dwordx4 v[60:63], v6, s[24:27], s56 offen offset:0 sc1
  v_pk_mul_f32 v[48:49], v[160:161], v[160:161]
  v_pk_fma_f32 v[48:49], v[48:49], v[42:43], v[40:41]
  v_pk_mul_f32 v[48:49], v[48:49], v[160:161]
  v_pk_mul_f32 v[50:51], v[162:163], v[162:163]
  v_pk_fma_f32 v[50:51], v[50:51], v[42:43], v[40:41]
  v_pk_mul_f32 v[50:51], v[50:51], v[162:163]
  v_exp_f32 v48, v48
  v_exp_f32 v49, v49
  v_exp_f32 v50, v50
  v_exp_f32 v51, v51
  v_pk_add_f32 v[48:49], v[48:49], v[44:45]
  v_pk_add_f32 v[50:51], v[50:51], v[44:45]
  v_rcp_f32 v48, v48
  v_rcp_f32 v49, v49
  v_rcp_f32 v50, v50
  v_rcp_f32 v51, v51
  v_pk_mul_f32 v[160:161], v[160:161], v[48:49]
  v_pk_mul_f32 v[162:163], v[162:163], v[50:51]
  v_cvt_pk_bf16_f32 v56, v160, v161
  v_cvt_pk_bf16_f32 v57, v162, v163
  v_pk_mul_f32 v[48:49], v[176:177], v[176:177]
  v_pk_fma_f32 v[48:49], v[48:49], v[42:43], v[40:41]
  v_pk_mul_f32 v[48:49], v[48:49], v[176:177]
  v_pk_mul_f32 v[50:51], v[178:179], v[178:179]
  v_pk_fma_f32 v[50:51], v[50:51], v[42:43], v[40:41]
  v_pk_mul_f32 v[50:51], v[50:51], v[178:179]
  v_exp_f32 v48, v48
  v_exp_f32 v49, v49
  v_exp_f32 v50, v50
  v_exp_f32 v51, v51
  v_pk_add_f32 v[48:49], v[48:49], v[44:45]
  v_pk_add_f32 v[50:51], v[50:51], v[44:45]
  v_rcp_f32 v48, v48
  v_rcp_f32 v49, v49
  v_rcp_f32 v50, v50
  v_rcp_f32 v51, v51
  v_pk_mul_f32 v[176:177], v[176:177], v[48:49]
  v_pk_mul_f32 v[178:179], v[178:179], v[50:51]
  v_cvt_pk_bf16_f32 v58, v176, v177
  v_cvt_pk_bf16_f32 v59, v178, v179
  buffer_store_dwordx4 v[56:59], v6, s[24:27], s57 offen offset:0 sc1
  v_pk_mul_f32 v[48:49], v[100:101], v[100:101]
  v_pk_fma_f32 v[48:49], v[48:49], v[42:43], v[40:41]
  v_pk_mul_f32 v[48:49], v[48:49], v[100:101]
  v_pk_mul_f32 v[50:51], v[102:103], v[102:103]
  v_pk_fma_f32 v[50:51], v[50:51], v[42:43], v[40:41]
  v_pk_mul_f32 v[50:51], v[50:51], v[102:103]
  v_exp_f32 v48, v48
  v_exp_f32 v49, v49
  v_exp_f32 v50, v50
  v_exp_f32 v51, v51
  v_pk_add_f32 v[48:49], v[48:49], v[44:45]
  v_pk_add_f32 v[50:51], v[50:51], v[44:45]
  v_rcp_f32 v48, v48
  v_rcp_f32 v49, v49
  v_rcp_f32 v50, v50
  v_rcp_f32 v51, v51
  v_pk_mul_f32 v[100:101], v[100:101], v[48:49]
  v_pk_mul_f32 v[102:103], v[102:103], v[50:51]
  v_cvt_pk_bf16_f32 v60, v100, v101
  v_cvt_pk_bf16_f32 v61, v102, v103
  v_pk_mul_f32 v[48:49], v[116:117], v[116:117]
  v_pk_fma_f32 v[48:49], v[48:49], v[42:43], v[40:41]
  v_pk_mul_f32 v[48:49], v[48:49], v[116:117]
  v_pk_mul_f32 v[50:51], v[118:119], v[118:119]
  v_pk_fma_f32 v[50:51], v[50:51], v[42:43], v[40:41]
  v_pk_mul_f32 v[50:51], v[50:51], v[118:119]
  v_exp_f32 v48, v48
  v_exp_f32 v49, v49
  v_exp_f32 v50, v50
  v_exp_f32 v51, v51
  v_pk_add_f32 v[48:49], v[48:49], v[44:45]
  v_pk_add_f32 v[50:51], v[50:51], v[44:45]
  v_rcp_f32 v48, v48
  v_rcp_f32 v49, v49
  v_rcp_f32 v50, v50
  v_rcp_f32 v51, v51
  v_pk_mul_f32 v[116:117], v[116:117], v[48:49]
  v_pk_mul_f32 v[118:119], v[118:119], v[50:51]
  v_cvt_pk_bf16_f32 v62, v116, v117
  v_cvt_pk_bf16_f32 v63, v118, v119
  buffer_store_dwordx4 v[60:63], v6, s[24:27], s55 offen offset:1024 sc1
  v_pk_mul_f32 v[48:49], v[132:133], v[132:133]
  v_pk_fma_f32 v[48:49], v[48:49], v[42:43], v[40:41]
  v_pk_mul_f32 v[48:49], v[48:49], v[132:133]
  v_pk_mul_f32 v[50:51], v[134:135], v[134:135]
  v_pk_fma_f32 v[50:51], v[50:51], v[42:43], v[40:41]
  v_pk_mul_f32 v[50:51], v[50:51], v[134:135]
  v_exp_f32 v48, v48
  v_exp_f32 v49, v49
  v_exp_f32 v50, v50
  v_exp_f32 v51, v51
  v_pk_add_f32 v[48:49], v[48:49], v[44:45]
  v_pk_add_f32 v[50:51], v[50:51], v[44:45]
  v_rcp_f32 v48, v48
  v_rcp_f32 v49, v49
  v_rcp_f32 v50, v50
  v_rcp_f32 v51, v51
  v_pk_mul_f32 v[132:133], v[132:133], v[48:49]
  v_pk_mul_f32 v[134:135], v[134:135], v[50:51]
  v_cvt_pk_bf16_f32 v56, v132, v133
  v_cvt_pk_bf16_f32 v57, v134, v135
  v_pk_mul_f32 v[48:49], v[148:149], v[148:149]
  v_pk_fma_f32 v[48:49], v[48:49], v[42:43], v[40:41]
  v_pk_mul_f32 v[48:49], v[48:49], v[148:149]
  v_pk_mul_f32 v[50:51], v[150:151], v[150:151]
  v_pk_fma_f32 v[50:51], v[50:51], v[42:43], v[40:41]
  v_pk_mul_f32 v[50:51], v[50:51], v[150:151]
  v_exp_f32 v48, v48
  v_exp_f32 v49, v49
  v_exp_f32 v50, v50
  v_exp_f32 v51, v51
  v_pk_add_f32 v[48:49], v[48:49], v[44:45]
  v_pk_add_f32 v[50:51], v[50:51], v[44:45]
  v_rcp_f32 v48, v48
  v_rcp_f32 v49, v49
  v_rcp_f32 v50, v50
  v_rcp_f32 v51, v51
  v_pk_mul_f32 v[148:149], v[148:149], v[48:49]
  v_pk_mul_f32 v[150:151], v[150:151], v[50:51]
  v_cvt_pk_bf16_f32 v58, v148, v149
  v_cvt_pk_bf16_f32 v59, v150, v151
  buffer_store_dwordx4 v[56:59], v6, s[24:27], s56 offen offset:1024 sc1
  v_pk_mul_f32 v[48:49], v[164:165], v[164:165]
  v_pk_fma_f32 v[48:49], v[48:49], v[42:43], v[40:41]
  v_pk_mul_f32 v[48:49], v[48:49], v[164:165]
  v_pk_mul_f32 v[50:51], v[166:167], v[166:167]
  v_pk_fma_f32 v[50:51], v[50:51], v[42:43], v[40:41]
  v_pk_mul_f32 v[50:51], v[50:51], v[166:167]
  v_exp_f32 v48, v48
  v_exp_f32 v49, v49
  v_exp_f32 v50, v50
  v_exp_f32 v51, v51
  v_pk_add_f32 v[48:49], v[48:49], v[44:45]
  v_pk_add_f32 v[50:51], v[50:51], v[44:45]
  v_rcp_f32 v48, v48
  v_rcp_f32 v49, v49
  v_rcp_f32 v50, v50
  v_rcp_f32 v51, v51
  v_pk_mul_f32 v[164:165], v[164:165], v[48:49]
  v_pk_mul_f32 v[166:167], v[166:167], v[50:51]
  v_cvt_pk_bf16_f32 v60, v164, v165
  v_cvt_pk_bf16_f32 v61, v166, v167
  v_pk_mul_f32 v[48:49], v[180:181], v[180:181]
  v_pk_fma_f32 v[48:49], v[48:49], v[42:43], v[40:41]
  v_pk_mul_f32 v[48:49], v[48:49], v[180:181]
  v_pk_mul_f32 v[50:51], v[182:183], v[182:183]
  v_pk_fma_f32 v[50:51], v[50:51], v[42:43], v[40:41]
  v_pk_mul_f32 v[50:51], v[50:51], v[182:183]
  v_exp_f32 v48, v48
  v_exp_f32 v49, v49
  v_exp_f32 v50, v50
  v_exp_f32 v51, v51
  v_pk_add_f32 v[48:49], v[48:49], v[44:45]
  v_pk_add_f32 v[50:51], v[50:51], v[44:45]
  v_rcp_f32 v48, v48
  v_rcp_f32 v49, v49
  v_rcp_f32 v50, v50
  v_rcp_f32 v51, v51
  v_pk_mul_f32 v[180:181], v[180:181], v[48:49]
  v_pk_mul_f32 v[182:183], v[182:183], v[50:51]
  v_cvt_pk_bf16_f32 v62, v180, v181
  v_cvt_pk_bf16_f32 v63, v182, v183
  buffer_store_dwordx4 v[60:63], v6, s[24:27], s57 offen offset:1024 sc1
  v_pk_mul_f32 v[48:49], v[104:105], v[104:105]
  v_pk_fma_f32 v[48:49], v[48:49], v[42:43], v[40:41]
  v_pk_mul_f32 v[48:49], v[48:49], v[104:105]
  v_pk_mul_f32 v[50:51], v[106:107], v[106:107]
  v_pk_fma_f32 v[50:51], v[50:51], v[42:43], v[40:41]
  v_pk_mul_f32 v[50:51], v[50:51], v[106:107]
  v_exp_f32 v48, v48
  v_exp_f32 v49, v49
  v_exp_f32 v50, v50
  v_exp_f32 v51, v51
  v_pk_add_f32 v[48:49], v[48:49], v[44:45]
  v_pk_add_f32 v[50:51], v[50:51], v[44:45]
  v_rcp_f32 v48, v48
  v_rcp_f32 v49, v49
  v_rcp_f32 v50, v50
  v_rcp_f32 v51, v51
  v_pk_mul_f32 v[104:105], v[104:105], v[48:49]
  v_pk_mul_f32 v[106:107], v[106:107], v[50:51]
  v_cvt_pk_bf16_f32 v56, v104, v105
  v_cvt_pk_bf16_f32 v57, v106, v107
  v_pk_mul_f32 v[48:49], v[120:121], v[120:121]
  v_pk_fma_f32 v[48:49], v[48:49], v[42:43], v[40:41]
  v_pk_mul_f32 v[48:49], v[48:49], v[120:121]
  v_pk_mul_f32 v[50:51], v[122:123], v[122:123]
  v_pk_fma_f32 v[50:51], v[50:51], v[42:43], v[40:41]
  v_pk_mul_f32 v[50:51], v[50:51], v[122:123]
  v_exp_f32 v48, v48
  v_exp_f32 v49, v49
  v_exp_f32 v50, v50
  v_exp_f32 v51, v51
  v_pk_add_f32 v[48:49], v[48:49], v[44:45]
  v_pk_add_f32 v[50:51], v[50:51], v[44:45]
  v_rcp_f32 v48, v48
  v_rcp_f32 v49, v49
  v_rcp_f32 v50, v50
  v_rcp_f32 v51, v51
  v_pk_mul_f32 v[120:121], v[120:121], v[48:49]
  v_pk_mul_f32 v[122:123], v[122:123], v[50:51]
  v_cvt_pk_bf16_f32 v58, v120, v121
  v_cvt_pk_bf16_f32 v59, v122, v123
  buffer_store_dwordx4 v[56:59], v6, s[24:27], s55 offen offset:2048 sc1
  v_pk_mul_f32 v[48:49], v[136:137], v[136:137]
  v_pk_fma_f32 v[48:49], v[48:49], v[42:43], v[40:41]
  v_pk_mul_f32 v[48:49], v[48:49], v[136:137]
  v_pk_mul_f32 v[50:51], v[138:139], v[138:139]
  v_pk_fma_f32 v[50:51], v[50:51], v[42:43], v[40:41]
  v_pk_mul_f32 v[50:51], v[50:51], v[138:139]
  v_exp_f32 v48, v48
  v_exp_f32 v49, v49
  v_exp_f32 v50, v50
  v_exp_f32 v51, v51
  v_pk_add_f32 v[48:49], v[48:49], v[44:45]
  v_pk_add_f32 v[50:51], v[50:51], v[44:45]
  v_rcp_f32 v48, v48
  v_rcp_f32 v49, v49
  v_rcp_f32 v50, v50
  v_rcp_f32 v51, v51
  v_pk_mul_f32 v[136:137], v[136:137], v[48:49]
  v_pk_mul_f32 v[138:139], v[138:139], v[50:51]
  v_cvt_pk_bf16_f32 v60, v136, v137
  v_cvt_pk_bf16_f32 v61, v138, v139
  v_pk_mul_f32 v[48:49], v[152:153], v[152:153]
  v_pk_fma_f32 v[48:49], v[48:49], v[42:43], v[40:41]
  v_pk_mul_f32 v[48:49], v[48:49], v[152:153]
  v_pk_mul_f32 v[50:51], v[154:155], v[154:155]
  v_pk_fma_f32 v[50:51], v[50:51], v[42:43], v[40:41]
  v_pk_mul_f32 v[50:51], v[50:51], v[154:155]
  v_exp_f32 v48, v48
  v_exp_f32 v49, v49
  v_exp_f32 v50, v50
  v_exp_f32 v51, v51
  v_pk_add_f32 v[48:49], v[48:49], v[44:45]
  v_pk_add_f32 v[50:51], v[50:51], v[44:45]
  v_rcp_f32 v48, v48
  v_rcp_f32 v49, v49
  v_rcp_f32 v50, v50
  v_rcp_f32 v51, v51
  v_pk_mul_f32 v[152:153], v[152:153], v[48:49]
  v_pk_mul_f32 v[154:155], v[154:155], v[50:51]
  v_cvt_pk_bf16_f32 v62, v152, v153
  v_cvt_pk_bf16_f32 v63, v154, v155
  buffer_store_dwordx4 v[60:63], v6, s[24:27], s56 offen offset:2048 sc1
  v_pk_mul_f32 v[48:49], v[168:169], v[168:169]
  v_pk_fma_f32 v[48:49], v[48:49], v[42:43], v[40:41]
  v_pk_mul_f32 v[48:49], v[48:49], v[168:169]
  v_pk_mul_f32 v[50:51], v[170:171], v[170:171]
  v_pk_fma_f32 v[50:51], v[50:51], v[42:43], v[40:41]
  v_pk_mul_f32 v[50:51], v[50:51], v[170:171]
  v_exp_f32 v48, v48
  v_exp_f32 v49, v49
  v_exp_f32 v50, v50
  v_exp_f32 v51, v51
  v_pk_add_f32 v[48:49], v[48:49], v[44:45]
  v_pk_add_f32 v[50:51], v[50:51], v[44:45]
  v_rcp_f32 v48, v48
  v_rcp_f32 v49, v49
  v_rcp_f32 v50, v50
  v_rcp_f32 v51, v51
  v_pk_mul_f32 v[168:169], v[168:169], v[48:49]
  v_pk_mul_f32 v[170:171], v[170:171], v[50:51]
  v_cvt_pk_bf16_f32 v56, v168, v169
  v_cvt_pk_bf16_f32 v57, v170, v171
  v_pk_mul_f32 v[48:49], v[184:185], v[184:185]
  v_pk_fma_f32 v[48:49], v[48:49], v[42:43], v[40:41]
  v_pk_mul_f32 v[48:49], v[48:49], v[184:185]
  v_pk_mul_f32 v[50:51], v[186:187], v[186:187]
  v_pk_fma_f32 v[50:51], v[50:51], v[42:43], v[40:41]
  v_pk_mul_f32 v[50:51], v[50:51], v[186:187]
  v_exp_f32 v48, v48
  v_exp_f32 v49, v49
  v_exp_f32 v50, v50
  v_exp_f32 v51, v51
  v_pk_add_f32 v[48:49], v[48:49], v[44:45]
  v_pk_add_f32 v[50:51], v[50:51], v[44:45]
  v_rcp_f32 v48, v48
  v_rcp_f32 v49, v49
  v_rcp_f32 v50, v50
  v_rcp_f32 v51, v51
  v_pk_mul_f32 v[184:185], v[184:185], v[48:49]
  v_pk_mul_f32 v[186:187], v[186:187], v[50:51]
  v_cvt_pk_bf16_f32 v58, v184, v185
  v_cvt_pk_bf16_f32 v59, v186, v187
  buffer_store_dwordx4 v[56:59], v6, s[24:27], s57 offen offset:2048 sc1
  v_pk_mul_f32 v[48:49], v[108:109], v[108:109]
  v_pk_fma_f32 v[48:49], v[48:49], v[42:43], v[40:41]
  v_pk_mul_f32 v[48:49], v[48:49], v[108:109]
  v_pk_mul_f32 v[50:51], v[110:111], v[110:111]
  v_pk_fma_f32 v[50:51], v[50:51], v[42:43], v[40:41]
  v_pk_mul_f32 v[50:51], v[50:51], v[110:111]
  v_exp_f32 v48, v48
  v_exp_f32 v49, v49
  v_exp_f32 v50, v50
  v_exp_f32 v51, v51
  v_pk_add_f32 v[48:49], v[48:49], v[44:45]
  v_pk_add_f32 v[50:51], v[50:51], v[44:45]
  v_rcp_f32 v48, v48
  v_rcp_f32 v49, v49
  v_rcp_f32 v50, v50
  v_rcp_f32 v51, v51
  v_pk_mul_f32 v[108:109], v[108:109], v[48:49]
  v_pk_mul_f32 v[110:111], v[110:111], v[50:51]
  v_cvt_pk_bf16_f32 v60, v108, v109
  v_cvt_pk_bf16_f32 v61, v110, v111
  v_pk_mul_f32 v[48:49], v[124:125], v[124:125]
  v_pk_fma_f32 v[48:49], v[48:49], v[42:43], v[40:41]
  v_pk_mul_f32 v[48:49], v[48:49], v[124:125]
  v_pk_mul_f32 v[50:51], v[126:127], v[126:127]
  v_pk_fma_f32 v[50:51], v[50:51], v[42:43], v[40:41]
  v_pk_mul_f32 v[50:51], v[50:51], v[126:127]
  v_exp_f32 v48, v48
  v_exp_f32 v49, v49
  v_exp_f32 v50, v50
  v_exp_f32 v51, v51
  v_pk_add_f32 v[48:49], v[48:49], v[44:45]
  v_pk_add_f32 v[50:51], v[50:51], v[44:45]
  v_rcp_f32 v48, v48
  v_rcp_f32 v49, v49
  v_rcp_f32 v50, v50
  v_rcp_f32 v51, v51
  v_pk_mul_f32 v[124:125], v[124:125], v[48:49]
  v_pk_mul_f32 v[126:127], v[126:127], v[50:51]
  v_cvt_pk_bf16_f32 v62, v124, v125
  v_cvt_pk_bf16_f32 v63, v126, v127
  buffer_store_dwordx4 v[60:63], v6, s[24:27], s55 offen offset:3072 sc1
  v_pk_mul_f32 v[48:49], v[140:141], v[140:141]
  v_pk_fma_f32 v[48:49], v[48:49], v[42:43], v[40:41]
  v_pk_mul_f32 v[48:49], v[48:49], v[140:141]
  v_pk_mul_f32 v[50:51], v[142:143], v[142:143]
  v_pk_fma_f32 v[50:51], v[50:51], v[42:43], v[40:41]
  v_pk_mul_f32 v[50:51], v[50:51], v[142:143]
  v_exp_f32 v48, v48
  v_exp_f32 v49, v49
  v_exp_f32 v50, v50
  v_exp_f32 v51, v51
  v_pk_add_f32 v[48:49], v[48:49], v[44:45]
  v_pk_add_f32 v[50:51], v[50:51], v[44:45]
  v_rcp_f32 v48, v48
  v_rcp_f32 v49, v49
  v_rcp_f32 v50, v50
  v_rcp_f32 v51, v51
  v_pk_mul_f32 v[140:141], v[140:141], v[48:49]
  v_pk_mul_f32 v[142:143], v[142:143], v[50:51]
  v_cvt_pk_bf16_f32 v56, v140, v141
  v_cvt_pk_bf16_f32 v57, v142, v143
  v_pk_mul_f32 v[48:49], v[156:157], v[156:157]
  v_pk_fma_f32 v[48:49], v[48:49], v[42:43], v[40:41]
  v_pk_mul_f32 v[48:49], v[48:49], v[156:157]
  v_pk_mul_f32 v[50:51], v[158:159], v[158:159]
  v_pk_fma_f32 v[50:51], v[50:51], v[42:43], v[40:41]
  v_pk_mul_f32 v[50:51], v[50:51], v[158:159]
  v_exp_f32 v48, v48
  v_exp_f32 v49, v49
  v_exp_f32 v50, v50
  v_exp_f32 v51, v51
  v_pk_add_f32 v[48:49], v[48:49], v[44:45]
  v_pk_add_f32 v[50:51], v[50:51], v[44:45]
  v_rcp_f32 v48, v48
  v_rcp_f32 v49, v49
  v_rcp_f32 v50, v50
  v_rcp_f32 v51, v51
  v_pk_mul_f32 v[156:157], v[156:157], v[48:49]
  v_pk_mul_f32 v[158:159], v[158:159], v[50:51]
  v_cvt_pk_bf16_f32 v58, v156, v157
  v_cvt_pk_bf16_f32 v59, v158, v159
  buffer_store_dwordx4 v[56:59], v6, s[24:27], s56 offen offset:3072 sc1
  v_pk_mul_f32 v[48:49], v[172:173], v[172:173]
  v_pk_fma_f32 v[48:49], v[48:49], v[42:43], v[40:41]
  v_pk_mul_f32 v[48:49], v[48:49], v[172:173]
  v_pk_mul_f32 v[50:51], v[174:175], v[174:175]
  v_pk_fma_f32 v[50:51], v[50:51], v[42:43], v[40:41]
  v_pk_mul_f32 v[50:51], v[50:51], v[174:175]
  v_exp_f32 v48, v48
  v_exp_f32 v49, v49
  v_exp_f32 v50, v50
  v_exp_f32 v51, v51
  v_pk_add_f32 v[48:49], v[48:49], v[44:45]
  v_pk_add_f32 v[50:51], v[50:51], v[44:45]
  v_rcp_f32 v48, v48
  v_rcp_f32 v49, v49
  v_rcp_f32 v50, v50
  v_rcp_f32 v51, v51
  v_pk_mul_f32 v[172:173], v[172:173], v[48:49]
  v_pk_mul_f32 v[174:175], v[174:175], v[50:51]
  v_cvt_pk_bf16_f32 v60, v172, v173
  v_cvt_pk_bf16_f32 v61, v174, v175
  v_pk_mul_f32 v[48:49], v[188:189], v[188:189]
  v_pk_fma_f32 v[48:49], v[48:49], v[42:43], v[40:41]
  v_pk_mul_f32 v[48:49], v[48:49], v[188:189]
  v_pk_mul_f32 v[50:51], v[190:191], v[190:191]
  v_pk_fma_f32 v[50:51], v[50:51], v[42:43], v[40:41]
  v_pk_mul_f32 v[50:51], v[50:51], v[190:191]
  v_exp_f32 v48, v48
  v_exp_f32 v49, v49
  v_exp_f32 v50, v50
  v_exp_f32 v51, v51
  v_pk_add_f32 v[48:49], v[48:49], v[44:45]
  v_pk_add_f32 v[50:51], v[50:51], v[44:45]
  v_rcp_f32 v48, v48
  v_rcp_f32 v49, v49
  v_rcp_f32 v50, v50
  v_rcp_f32 v51, v51
  v_pk_mul_f32 v[188:189], v[188:189], v[48:49]
  v_pk_mul_f32 v[190:191], v[190:191], v[50:51]
  v_cvt_pk_bf16_f32 v62, v188, v189
  v_cvt_pk_bf16_f32 v63, v190, v191
  buffer_store_dwordx4 v[60:63], v6, s[24:27], s57 offen offset:3072 sc1
  s_branch attn_kernel_join37
attn_kernel_odd36:
  v_pk_mul_f32 v[48:49], v[96:97], v[96:97]
  v_pk_fma_f32 v[48:49], v[48:49], v[42:43], v[40:41]
  v_pk_mul_f32 v[48:49], v[48:49], v[96:97]
  v_pk_mul_f32 v[50:51], v[98:99], v[98:99]
  v_pk_fma_f32 v[50:51], v[50:51], v[42:43], v[40:41]
  v_pk_mul_f32 v[50:51], v[50:51], v[98:99]
  v_exp_f32 v48, v48
  v_exp_f32 v49, v49
  v_exp_f32 v50, v50
  v_exp_f32 v51, v51
  v_pk_add_f32 v[48:49], v[48:49], v[44:45]
  v_pk_add_f32 v[50:51], v[50:51], v[44:45]
  v_rcp_f32 v48, v48
  v_rcp_f32 v49, v49
  v_rcp_f32 v50, v50
  v_rcp_f32 v51, v51
  v_pk_mul_f32 v[96:97], v[96:97], v[48:49]
  v_pk_mul_f32 v[98:99], v[98:99], v[50:51]
  v_cvt_pk_bf16_f32 v58, v96, v97
  v_cvt_pk_bf16_f32 v59, v98, v99
  buffer_store_dwordx2 v[58:59], v6, s[24:27], s55 offen offset:8 sc1
  v_pk_mul_f32 v[48:49], v[100:101], v[100:101]
  v_pk_fma_f32 v[48:49], v[48:49], v[42:43], v[40:41]
  v_pk_mul_f32 v[48:49], v[48:49], v[100:101]
  v_pk_mul_f32 v[50:51], v[102:103], v[102:103]
  v_pk_fma_f32 v[50:51], v[50:51], v[42:43], v[40:41]
  v_pk_mul_f32 v[50:51], v[50:51], v[102:103]
  v_exp_f32 v48, v48
  v_exp_f32 v49, v49
  v_exp_f32 v50, v50
  v_exp_f32 v51, v51
  v_pk_add_f32 v[48:49], v[48:49], v[44:45]
  v_pk_add_f32 v[50:51], v[50:51], v[44:45]
  v_rcp_f32 v48, v48
  v_rcp_f32 v49, v49
  v_rcp_f32 v50, v50
  v_rcp_f32 v51, v51
  v_pk_mul_f32 v[100:101], v[100:101], v[48:49]
  v_pk_mul_f32 v[102:103], v[102:103], v[50:51]
  v_cvt_pk_bf16_f32 v62, v100, v101
  v_cvt_pk_bf16_f32 v63, v102, v103
  buffer_store_dwordx2 v[62:63], v6, s[24:27], s55 offen offset:1032 sc1
  v_pk_mul_f32 v[48:49], v[104:105], v[104:105]
  v_pk_fma_f32 v[48:49], v[48:49], v[42:43], v[40:41]
  v_pk_mul_f32 v[48:49], v[48:49], v[104:105]
  v_pk_mul_f32 v[50:51], v[106:107], v[106:107]
  v_pk_fma_f32 v[50:51], v[50:51], v[42:43], v[40:41]
  v_pk_mul_f32 v[50:51], v[50:51], v[106:107]
  v_exp_f32 v48, v48
  v_exp_f32 v49, v49
  v_exp_f32 v50, v50
  v_exp_f32 v51, v51
  v_pk_add_f32 v[48:49], v[48:49], v[44:45]
  v_pk_add_f32 v[50:51], v[50:51], v[44:45]
  v_rcp_f32 v48, v48
  v_rcp_f32 v49, v49
  v_rcp_f32 v50, v50
  v_rcp_f32 v51, v51
  v_pk_mul_f32 v[104:105], v[104:105], v[48:49]
  v_pk_mul_f32 v[106:107], v[106:107], v[50:51]
  v_cvt_pk_bf16_f32 v58, v104, v105
  v_cvt_pk_bf16_f32 v59, v106, v107
  buffer_store_dwordx2 v[58:59], v6, s[24:27], s55 offen offset:2056 sc1
  v_pk_mul_f32 v[48:49], v[108:109], v[108:109]
  v_pk_fma_f32 v[48:49], v[48:49], v[42:43], v[40:41]
  v_pk_mul_f32 v[48:49], v[48:49], v[108:109]
  v_pk_mul_f32 v[50:51], v[110:111], v[110:111]
  v_pk_fma_f32 v[50:51], v[50:51], v[42:43], v[40:41]
  v_pk_mul_f32 v[50:51], v[50:51], v[110:111]
  v_exp_f32 v48, v48
  v_exp_f32 v49, v49
  v_exp_f32 v50, v50
  v_exp_f32 v51, v51
  v_pk_add_f32 v[48:49], v[48:49], v[44:45]
  v_pk_add_f32 v[50:51], v[50:51], v[44:45]
  v_rcp_f32 v48, v48
  v_rcp_f32 v49, v49
  v_rcp_f32 v50, v50
  v_rcp_f32 v51, v51
  v_pk_mul_f32 v[108:109], v[108:109], v[48:49]
  v_pk_mul_f32 v[110:111], v[110:111], v[50:51]
  v_cvt_pk_bf16_f32 v62, v108, v109
  v_cvt_pk_bf16_f32 v63, v110, v111
  buffer_store_dwordx2 v[62:63], v6, s[24:27], s55 offen offset:3080 sc1
  v_pk_mul_f32 v[48:49], v[112:113], v[112:113]
  v_pk_fma_f32 v[48:49], v[48:49], v[42:43], v[40:41]
  v_pk_mul_f32 v[48:49], v[48:49], v[112:113]
  v_pk_mul_f32 v[50:51], v[114:115], v[114:115]
  v_pk_fma_f32 v[50:51], v[50:51], v[42:43], v[40:41]
  v_pk_mul_f32 v[50:51], v[50:51], v[114:115]
  v_exp_f32 v48, v48
  v_exp_f32 v49, v49
  v_exp_f32 v50, v50
  v_exp_f32 v51, v51
  v_pk_add_f32 v[48:49], v[48:49], v[44:45]
  v_pk_add_f32 v[50:51], v[50:51], v[44:45]
  v_rcp_f32 v48, v48
  v_rcp_f32 v49, v49
  v_rcp_f32 v50, v50
  v_rcp_f32 v51, v51
  v_pk_mul_f32 v[112:113], v[112:113], v[48:49]
  v_pk_mul_f32 v[114:115], v[114:115], v[50:51]
  v_cvt_pk_bf16_f32 v56, v112, v113
  v_cvt_pk_bf16_f32 v57, v114, v115
  v_pk_mul_f32 v[48:49], v[128:129], v[128:129]
  v_pk_fma_f32 v[48:49], v[48:49], v[42:43], v[40:41]
  v_pk_mul_f32 v[48:49], v[48:49], v[128:129]
  v_pk_mul_f32 v[50:51], v[130:131], v[130:131]
  v_pk_fma_f32 v[50:51], v[50:51], v[42:43], v[40:41]
  v_pk_mul_f32 v[50:51], v[50:51], v[130:131]
  v_exp_f32 v48, v48
  v_exp_f32 v49, v49
  v_exp_f32 v50, v50
  v_exp_f32 v51, v51
  v_pk_add_f32 v[48:49], v[48:49], v[44:45]
  v_pk_add_f32 v[50:51], v[50:51], v[44:45]
  v_rcp_f32 v48, v48
  v_rcp_f32 v49, v49
  v_rcp_f32 v50, v50
  v_rcp_f32 v51, v51
  v_pk_mul_f32 v[128:129], v[128:129], v[48:49]
  v_pk_mul_f32 v[130:131], v[130:131], v[50:51]
  v_cvt_pk_bf16_f32 v58, v128, v129
  v_cvt_pk_bf16_f32 v59, v130, v131
  buffer_store_dwordx4 v[56:59], v6, s[24:27], s56 offen offset:0 sc1
  v_pk_mul_f32 v[48:49], v[144:145], v[144:145]
  v_pk_fma_f32 v[48:49], v[48:49], v[42:43], v[40:41]
  v_pk_mul_f32 v[48:49], v[48:49], v[144:145]
  v_pk_mul_f32 v[50:51], v[146:147], v[146:147]
  v_pk_fma_f32 v[50:51], v[50:51], v[42:43], v[40:41]
  v_pk_mul_f32 v[50:51], v[50:51], v[146:147]
  v_exp_f32 v48, v48
  v_exp_f32 v49, v49
  v_exp_f32 v50, v50
  v_exp_f32 v51, v51
  v_pk_add_f32 v[48:49], v[48:49], v[44:45]
  v_pk_add_f32 v[50:51], v[50:51], v[44:45]
  v_rcp_f32 v48, v48
  v_rcp_f32 v49, v49
  v_rcp_f32 v50, v50
  v_rcp_f32 v51, v51
  v_pk_mul_f32 v[144:145], v[144:145], v[48:49]
  v_pk_mul_f32 v[146:147], v[146:147], v[50:51]
  v_cvt_pk_bf16_f32 v60, v144, v145
  v_cvt_pk_bf16_f32 v61, v146, v147
  v_pk_mul_f32 v[48:49], v[160:161], v[160:161]
  v_pk_fma_f32 v[48:49], v[48:49], v[42:43], v[40:41]
  v_pk_mul_f32 v[48:49], v[48:49], v[160:161]
  v_pk_mul_f32 v[50:51], v[162:163], v[162:163]
  v_pk_fma_f32 v[50:51], v[50:51], v[42:43], v[40:41]
  v_pk_mul_f32 v[50:51], v[50:51], v[162:163]
  v_exp_f32 v48, v48
  v_exp_f32 v49, v49
  v_exp_f32 v50, v50
  v_exp_f32 v51, v51
  v_pk_add_f32 v[48:49], v[48:49], v[44:45]
  v_pk_add_f32 v[50:51], v[50:51], v[44:45]
  v_rcp_f32 v48, v48
  v_rcp_f32 v49, v49
  v_rcp_f32 v50, v50
  v_rcp_f32 v51, v51
  v_pk_mul_f32 v[160:161], v[160:161], v[48:49]
  v_pk_mul_f32 v[162:163], v[162:163], v[50:51]
  v_cvt_pk_bf16_f32 v62, v160, v161
  v_cvt_pk_bf16_f32 v63, v162, v163
  buffer_store_dwordx4 v[60:63], v6, s[24:27], s57 offen offset:0 sc1
  v_pk_mul_f32 v[48:49], v[176:177], v[176:177]
  v_pk_fma_f32 v[48:49], v[48:49], v[42:43], v[40:41]
  v_pk_mul_f32 v[48:49], v[48:49], v[176:177]
  v_pk_mul_f32 v[50:51], v[178:179], v[178:179]
  v_pk_fma_f32 v[50:51], v[50:51], v[42:43], v[40:41]
  v_pk_mul_f32 v[50:51], v[50:51], v[178:179]
  v_exp_f32 v48, v48
  v_exp_f32 v49, v49
  v_exp_f32 v50, v50
  v_exp_f32 v51, v51
  v_pk_add_f32 v[48:49], v[48:49], v[44:45]
  v_pk_add_f32 v[50:51], v[50:51], v[44:45]
  v_rcp_f32 v48, v48
  v_rcp_f32 v49, v49
  v_rcp_f32 v50, v50
  v_rcp_f32 v51, v51
  v_pk_mul_f32 v[176:177], v[176:177], v[48:49]
  v_pk_mul_f32 v[178:179], v[178:179], v[50:51]
  v_cvt_pk_bf16_f32 v56, v176, v177
  v_cvt_pk_bf16_f32 v57, v178, v179
  v_pk_mul_f32 v[48:49], v[192:193], v[192:193]
  v_pk_fma_f32 v[48:49], v[48:49], v[42:43], v[40:41]
  v_pk_mul_f32 v[48:49], v[48:49], v[192:193]
  v_pk_mul_f32 v[50:51], v[194:195], v[194:195]
  v_pk_fma_f32 v[50:51], v[50:51], v[42:43], v[40:41]
  v_pk_mul_f32 v[50:51], v[50:51], v[194:195]
  v_exp_f32 v48, v48
  v_exp_f32 v49, v49
  v_exp_f32 v50, v50
  v_exp_f32 v51, v51
  v_pk_add_f32 v[48:49], v[48:49], v[44:45]
  v_pk_add_f32 v[50:51], v[50:51], v[44:45]
  v_rcp_f32 v48, v48
  v_rcp_f32 v49, v49
  v_rcp_f32 v50, v50
  v_rcp_f32 v51, v51
  v_pk_mul_f32 v[192:193], v[192:193], v[48:49]
  v_pk_mul_f32 v[194:195], v[194:195], v[50:51]
  v_cvt_pk_bf16_f32 v58, v192, v193
  v_cvt_pk_bf16_f32 v59, v194, v195
  buffer_store_dwordx4 v[56:59], v6, s[24:27], s58 offen offset:0 sc1
  v_pk_mul_f32 v[48:49], v[116:117], v[116:117]
  v_pk_fma_f32 v[48:49], v[48:49], v[42:43], v[40:41]
  v_pk_mul_f32 v[48:49], v[48:49], v[116:117]
  v_pk_mul_f32 v[50:51], v[118:119], v[118:119]
  v_pk_fma_f32 v[50:51], v[50:51], v[42:43], v[40:41]
  v_pk_mul_f32 v[50:51], v[50:51], v[118:119]
  v_exp_f32 v48, v48
  v_exp_f32 v49, v49
  v_exp_f32 v50, v50
  v_exp_f32 v51, v51
  v_pk_add_f32 v[48:49], v[48:49], v[44:45]
  v_pk_add_f32 v[50:51], v[50:51], v[44:45]
  v_rcp_f32 v48, v48
  v_rcp_f32 v49, v49
  v_rcp_f32 v50, v50
  v_rcp_f32 v51, v51
  v_pk_mul_f32 v[116:117], v[116:117], v[48:49]
  v_pk_mul_f32 v[118:119], v[118:119], v[50:51]
  v_cvt_pk_bf16_f32 v60, v116, v117
  v_cvt_pk_bf16_f32 v61, v118, v119
  v_pk_mul_f32 v[48:49], v[132:133], v[132:133]
  v_pk_fma_f32 v[48:49], v[48:49], v[42:43], v[40:41]
  v_pk_mul_f32 v[48:49], v[48:49], v[132:133]
  v_pk_mul_f32 v[50:51], v[134:135], v[134:135]
  v_pk_fma_f32 v[50:51], v[50:51], v[42:43], v[40:41]
  v_pk_mul_f32 v[50:51], v[50:51], v[134:135]
  v_exp_f32 v48, v48
  v_exp_f32 v49, v49
  v_exp_f32 v50, v50
  v_exp_f32 v51, v51
  v_pk_add_f32 v[48:49], v[48:49], v[44:45]
  v_pk_add_f32 v[50:51], v[50:51], v[44:45]
  v_rcp_f32 v48, v48
  v_rcp_f32 v49, v49
  v_rcp_f32 v50, v50
  v_rcp_f32 v51, v51
  v_pk_mul_f32 v[132:133], v[132:133], v[48:49]
  v_pk_mul_f32 v[134:135], v[134:135], v[50:51]
  v_cvt_pk_bf16_f32 v62, v132, v133
  v_cvt_pk_bf16_f32 v63, v134, v135
  buffer_store_dwordx4 v[60:63], v6, s[24:27], s56 offen offset:1024 sc1
  v_pk_mul_f32 v[48:49], v[148:149], v[148:149]
  v_pk_fma_f32 v[48:49], v[48:49], v[42:43], v[40:41]
  v_pk_mul_f32 v[48:49], v[48:49], v[148:149]
  v_pk_mul_f32 v[50:51], v[150:151], v[150:151]
  v_pk_fma_f32 v[50:51], v[50:51], v[42:43], v[40:41]
  v_pk_mul_f32 v[50:51], v[50:51], v[150:151]
  v_exp_f32 v48, v48
  v_exp_f32 v49, v49
  v_exp_f32 v50, v50
  v_exp_f32 v51, v51
  v_pk_add_f32 v[48:49], v[48:49], v[44:45]
  v_pk_add_f32 v[50:51], v[50:51], v[44:45]
  v_rcp_f32 v48, v48
  v_rcp_f32 v49, v49
  v_rcp_f32 v50, v50
  v_rcp_f32 v51, v51
  v_pk_mul_f32 v[148:149], v[148:149], v[48:49]
  v_pk_mul_f32 v[150:151], v[150:151], v[50:51]
  v_cvt_pk_bf16_f32 v56, v148, v149
  v_cvt_pk_bf16_f32 v57, v150, v151
  v_pk_mul_f32 v[48:49], v[164:165], v[164:165]
  v_pk_fma_f32 v[48:49], v[48:49], v[42:43], v[40:41]
  v_pk_mul_f32 v[48:49], v[48:49], v[164:165]
  v_pk_mul_f32 v[50:51], v[166:167], v[166:167]
  v_pk_fma_f32 v[50:51], v[50:51], v[42:43], v[40:41]
  v_pk_mul_f32 v[50:51], v[50:51], v[166:167]
  v_exp_f32 v48, v48
  v_exp_f32 v49, v49
  v_exp_f32 v50, v50
  v_exp_f32 v51, v51
  v_pk_add_f32 v[48:49], v[48:49], v[44:45]
  v_pk_add_f32 v[50:51], v[50:51], v[44:45]
  v_rcp_f32 v48, v48
  v_rcp_f32 v49, v49
  v_rcp_f32 v50, v50
  v_rcp_f32 v51, v51
  v_pk_mul_f32 v[164:165], v[164:165], v[48:49]
  v_pk_mul_f32 v[166:167], v[166:167], v[50:51]
  v_cvt_pk_bf16_f32 v58, v164, v165
  v_cvt_pk_bf16_f32 v59, v166, v167
  buffer_store_dwordx4 v[56:59], v6, s[24:27], s57 offen offset:1024 sc1
  v_pk_mul_f32 v[48:49], v[180:181], v[180:181]
  v_pk_fma_f32 v[48:49], v[48:49], v[42:43], v[40:41]
  v_pk_mul_f32 v[48:49], v[48:49], v[180:181]
  v_pk_mul_f32 v[50:51], v[182:183], v[182:183]
  v_pk_fma_f32 v[50:51], v[50:51], v[42:43], v[40:41]
  v_pk_mul_f32 v[50:51], v[50:51], v[182:183]
  v_exp_f32 v48, v48
  v_exp_f32 v49, v49
  v_exp_f32 v50, v50
  v_exp_f32 v51, v51
  v_pk_add_f32 v[48:49], v[48:49], v[44:45]
  v_pk_add_f32 v[50:51], v[50:51], v[44:45]
  v_rcp_f32 v48, v48
  v_rcp_f32 v49, v49
  v_rcp_f32 v50, v50
  v_rcp_f32 v51, v51
  v_pk_mul_f32 v[180:181], v[180:181], v[48:49]
  v_pk_mul_f32 v[182:183], v[182:183], v[50:51]
  v_cvt_pk_bf16_f32 v60, v180, v181
  v_cvt_pk_bf16_f32 v61, v182, v183
  v_pk_mul_f32 v[48:49], v[196:197], v[196:197]
  v_pk_fma_f32 v[48:49], v[48:49], v[42:43], v[40:41]
  v_pk_mul_f32 v[48:49], v[48:49], v[196:197]
  v_pk_mul_f32 v[50:51], v[198:199], v[198:199]
  v_pk_fma_f32 v[50:51], v[50:51], v[42:43], v[40:41]
  v_pk_mul_f32 v[50:51], v[50:51], v[198:199]
  v_exp_f32 v48, v48
  v_exp_f32 v49, v49
  v_exp_f32 v50, v50
  v_exp_f32 v51, v51
  v_pk_add_f32 v[48:49], v[48:49], v[44:45]
  v_pk_add_f32 v[50:51], v[50:51], v[44:45]
  v_rcp_f32 v48, v48
  v_rcp_f32 v49, v49
  v_rcp_f32 v50, v50
  v_rcp_f32 v51, v51
  v_pk_mul_f32 v[196:197], v[196:197], v[48:49]
  v_pk_mul_f32 v[198:199], v[198:199], v[50:51]
  v_cvt_pk_bf16_f32 v62, v196, v197
  v_cvt_pk_bf16_f32 v63, v198, v199
  buffer_store_dwordx4 v[60:63], v6, s[24:27], s58 offen offset:1024 sc1
  v_pk_mul_f32 v[48:49], v[120:121], v[120:121]
  v_pk_fma_f32 v[48:49], v[48:49], v[42:43], v[40:41]
  v_pk_mul_f32 v[48:49], v[48:49], v[120:121]
  v_pk_mul_f32 v[50:51], v[122:123], v[122:123]
  v_pk_fma_f32 v[50:51], v[50:51], v[42:43], v[40:41]
  v_pk_mul_f32 v[50:51], v[50:51], v[122:123]
  v_exp_f32 v48, v48
  v_exp_f32 v49, v49
  v_exp_f32 v50, v50
  v_exp_f32 v51, v51
  v_pk_add_f32 v[48:49], v[48:49], v[44:45]
  v_pk_add_f32 v[50:51], v[50:51], v[44:45]
  v_rcp_f32 v48, v48
  v_rcp_f32 v49, v49
  v_rcp_f32 v50, v50
  v_rcp_f32 v51, v51
  v_pk_mul_f32 v[120:121], v[120:121], v[48:49]
  v_pk_mul_f32 v[122:123], v[122:123], v[50:51]
  v_cvt_pk_bf16_f32 v56, v120, v121
  v_cvt_pk_bf16_f32 v57, v122, v123
  v_pk_mul_f32 v[48:49], v[136:137], v[136:137]
  v_pk_fma_f32 v[48:49], v[48:49], v[42:43], v[40:41]
  v_pk_mul_f32 v[48:49], v[48:49], v[136:137]
  v_pk_mul_f32 v[50:51], v[138:139], v[138:139]
  v_pk_fma_f32 v[50:51], v[50:51], v[42:43], v[40:41]
  v_pk_mul_f32 v[50:51], v[50:51], v[138:139]
  v_exp_f32 v48, v48
  v_exp_f32 v49, v49
  v_exp_f32 v50, v50
  v_exp_f32 v51, v51
  v_pk_add_f32 v[48:49], v[48:49], v[44:45]
  v_pk_add_f32 v[50:51], v[50:51], v[44:45]
  v_rcp_f32 v48, v48
  v_rcp_f32 v49, v49
  v_rcp_f32 v50, v50
  v_rcp_f32 v51, v51
  v_pk_mul_f32 v[136:137], v[136:137], v[48:49]
  v_pk_mul_f32 v[138:139], v[138:139], v[50:51]
  v_cvt_pk_bf16_f32 v58, v136, v137
  v_cvt_pk_bf16_f32 v59, v138, v139
  buffer_store_dwordx4 v[56:59], v6, s[24:27], s56 offen offset:2048 sc1
  v_pk_mul_f32 v[48:49], v[152:153], v[152:153]
  v_pk_fma_f32 v[48:49], v[48:49], v[42:43], v[40:41]
  v_pk_mul_f32 v[48:49], v[48:49], v[152:153]
  v_pk_mul_f32 v[50:51], v[154:155], v[154:155]
  v_pk_fma_f32 v[50:51], v[50:51], v[42:43], v[40:41]
  v_pk_mul_f32 v[50:51], v[50:51], v[154:155]
  v_exp_f32 v48, v48
  v_exp_f32 v49, v49
  v_exp_f32 v50, v50
  v_exp_f32 v51, v51
  v_pk_add_f32 v[48:49], v[48:49], v[44:45]
  v_pk_add_f32 v[50:51], v[50:51], v[44:45]
  v_rcp_f32 v48, v48
  v_rcp_f32 v49, v49
  v_rcp_f32 v50, v50
  v_rcp_f32 v51, v51
  v_pk_mul_f32 v[152:153], v[152:153], v[48:49]
  v_pk_mul_f32 v[154:155], v[154:155], v[50:51]
  v_cvt_pk_bf16_f32 v60, v152, v153
  v_cvt_pk_bf16_f32 v61, v154, v155
  v_pk_mul_f32 v[48:49], v[168:169], v[168:169]
  v_pk_fma_f32 v[48:49], v[48:49], v[42:43], v[40:41]
  v_pk_mul_f32 v[48:49], v[48:49], v[168:169]
  v_pk_mul_f32 v[50:51], v[170:171], v[170:171]
  v_pk_fma_f32 v[50:51], v[50:51], v[42:43], v[40:41]
  v_pk_mul_f32 v[50:51], v[50:51], v[170:171]
  v_exp_f32 v48, v48
  v_exp_f32 v49, v49
  v_exp_f32 v50, v50
  v_exp_f32 v51, v51
  v_pk_add_f32 v[48:49], v[48:49], v[44:45]
  v_pk_add_f32 v[50:51], v[50:51], v[44:45]
  v_rcp_f32 v48, v48
  v_rcp_f32 v49, v49
  v_rcp_f32 v50, v50
  v_rcp_f32 v51, v51
  v_pk_mul_f32 v[168:169], v[168:169], v[48:49]
  v_pk_mul_f32 v[170:171], v[170:171], v[50:51]
  v_cvt_pk_bf16_f32 v62, v168, v169
  v_cvt_pk_bf16_f32 v63, v170, v171
  buffer_store_dwordx4 v[60:63], v6, s[24:27], s57 offen offset:2048 sc1
  v_pk_mul_f32 v[48:49], v[184:185], v[184:185]
  v_pk_fma_f32 v[48:49], v[48:49], v[42:43], v[40:41]
  v_pk_mul_f32 v[48:49], v[48:49], v[184:185]
  v_pk_mul_f32 v[50:51], v[186:187], v[186:187]
  v_pk_fma_f32 v[50:51], v[50:51], v[42:43], v[40:41]
  v_pk_mul_f32 v[50:51], v[50:51], v[186:187]
  v_exp_f32 v48, v48
  v_exp_f32 v49, v49
  v_exp_f32 v50, v50
  v_exp_f32 v51, v51
  v_pk_add_f32 v[48:49], v[48:49], v[44:45]
  v_pk_add_f32 v[50:51], v[50:51], v[44:45]
  v_rcp_f32 v48, v48
  v_rcp_f32 v49, v49
  v_rcp_f32 v50, v50
  v_rcp_f32 v51, v51
  v_pk_mul_f32 v[184:185], v[184:185], v[48:49]
  v_pk_mul_f32 v[186:187], v[186:187], v[50:51]
  v_cvt_pk_bf16_f32 v56, v184, v185
  v_cvt_pk_bf16_f32 v57, v186, v187
  v_pk_mul_f32 v[48:49], v[200:201], v[200:201]
  v_pk_fma_f32 v[48:49], v[48:49], v[42:43], v[40:41]
  v_pk_mul_f32 v[48:49], v[48:49], v[200:201]
  v_pk_mul_f32 v[50:51], v[202:203], v[202:203]
  v_pk_fma_f32 v[50:51], v[50:51], v[42:43], v[40:41]
  v_pk_mul_f32 v[50:51], v[50:51], v[202:203]
  v_exp_f32 v48, v48
  v_exp_f32 v49, v49
  v_exp_f32 v50, v50
  v_exp_f32 v51, v51
  v_pk_add_f32 v[48:49], v[48:49], v[44:45]
  v_pk_add_f32 v[50:51], v[50:51], v[44:45]
  v_rcp_f32 v48, v48
  v_rcp_f32 v49, v49
  v_rcp_f32 v50, v50
  v_rcp_f32 v51, v51
  v_pk_mul_f32 v[200:201], v[200:201], v[48:49]
  v_pk_mul_f32 v[202:203], v[202:203], v[50:51]
  v_cvt_pk_bf16_f32 v58, v200, v201
  v_cvt_pk_bf16_f32 v59, v202, v203
  buffer_store_dwordx4 v[56:59], v6, s[24:27], s58 offen offset:2048 sc1
  v_pk_mul_f32 v[48:49], v[124:125], v[124:125]
  v_pk_fma_f32 v[48:49], v[48:49], v[42:43], v[40:41]
  v_pk_mul_f32 v[48:49], v[48:49], v[124:125]
  v_pk_mul_f32 v[50:51], v[126:127], v[126:127]
  v_pk_fma_f32 v[50:51], v[50:51], v[42:43], v[40:41]
  v_pk_mul_f32 v[50:51], v[50:51], v[126:127]
  v_exp_f32 v48, v48
  v_exp_f32 v49, v49
  v_exp_f32 v50, v50
  v_exp_f32 v51, v51
  v_pk_add_f32 v[48:49], v[48:49], v[44:45]
  v_pk_add_f32 v[50:51], v[50:51], v[44:45]
  v_rcp_f32 v48, v48
  v_rcp_f32 v49, v49
  v_rcp_f32 v50, v50
  v_rcp_f32 v51, v51
  v_pk_mul_f32 v[124:125], v[124:125], v[48:49]
  v_pk_mul_f32 v[126:127], v[126:127], v[50:51]
  v_cvt_pk_bf16_f32 v60, v124, v125
  v_cvt_pk_bf16_f32 v61, v126, v127
  v_pk_mul_f32 v[48:49], v[140:141], v[140:141]
  v_pk_fma_f32 v[48:49], v[48:49], v[42:43], v[40:41]
  v_pk_mul_f32 v[48:49], v[48:49], v[140:141]
  v_pk_mul_f32 v[50:51], v[142:143], v[142:143]
  v_pk_fma_f32 v[50:51], v[50:51], v[42:43], v[40:41]
  v_pk_mul_f32 v[50:51], v[50:51], v[142:143]
  v_exp_f32 v48, v48
  v_exp_f32 v49, v49
  v_exp_f32 v50, v50
  v_exp_f32 v51, v51
  v_pk_add_f32 v[48:49], v[48:49], v[44:45]
  v_pk_add_f32 v[50:51], v[50:51], v[44:45]
  v_rcp_f32 v48, v48
  v_rcp_f32 v49, v49
  v_rcp_f32 v50, v50
  v_rcp_f32 v51, v51
  v_pk_mul_f32 v[140:141], v[140:141], v[48:49]
  v_pk_mul_f32 v[142:143], v[142:143], v[50:51]
  v_cvt_pk_bf16_f32 v62, v140, v141
  v_cvt_pk_bf16_f32 v63, v142, v143
  buffer_store_dwordx4 v[60:63], v6, s[24:27], s56 offen offset:3072 sc1
  v_pk_mul_f32 v[48:49], v[156:157], v[156:157]
  v_pk_fma_f32 v[48:49], v[48:49], v[42:43], v[40:41]
  v_pk_mul_f32 v[48:49], v[48:49], v[156:157]
  v_pk_mul_f32 v[50:51], v[158:159], v[158:159]
  v_pk_fma_f32 v[50:51], v[50:51], v[42:43], v[40:41]
  v_pk_mul_f32 v[50:51], v[50:51], v[158:159]
  v_exp_f32 v48, v48
  v_exp_f32 v49, v49
  v_exp_f32 v50, v50
  v_exp_f32 v51, v51
  v_pk_add_f32 v[48:49], v[48:49], v[44:45]
  v_pk_add_f32 v[50:51], v[50:51], v[44:45]
  v_rcp_f32 v48, v48
  v_rcp_f32 v49, v49
  v_rcp_f32 v50, v50
  v_rcp_f32 v51, v51
  v_pk_mul_f32 v[156:157], v[156:157], v[48:49]
  v_pk_mul_f32 v[158:159], v[158:159], v[50:51]
  v_cvt_pk_bf16_f32 v56, v156, v157
  v_cvt_pk_bf16_f32 v57, v158, v159
  v_pk_mul_f32 v[48:49], v[172:173], v[172:173]
  v_pk_fma_f32 v[48:49], v[48:49], v[42:43], v[40:41]
  v_pk_mul_f32 v[48:49], v[48:49], v[172:173]
  v_pk_mul_f32 v[50:51], v[174:175], v[174:175]
  v_pk_fma_f32 v[50:51], v[50:51], v[42:43], v[40:41]
  v_pk_mul_f32 v[50:51], v[50:51], v[174:175]
  v_exp_f32 v48, v48
  v_exp_f32 v49, v49
  v_exp_f32 v50, v50
  v_exp_f32 v51, v51
  v_pk_add_f32 v[48:49], v[48:49], v[44:45]
  v_pk_add_f32 v[50:51], v[50:51], v[44:45]
  v_rcp_f32 v48, v48
  v_rcp_f32 v49, v49
  v_rcp_f32 v50, v50
  v_rcp_f32 v51, v51
  v_pk_mul_f32 v[172:173], v[172:173], v[48:49]
  v_pk_mul_f32 v[174:175], v[174:175], v[50:51]
  v_cvt_pk_bf16_f32 v58, v172, v173
  v_cvt_pk_bf16_f32 v59, v174, v175
  buffer_store_dwordx4 v[56:59], v6, s[24:27], s57 offen offset:3072 sc1
  v_pk_mul_f32 v[48:49], v[188:189], v[188:189]
  v_pk_fma_f32 v[48:49], v[48:49], v[42:43], v[40:41]
  v_pk_mul_f32 v[48:49], v[48:49], v[188:189]
  v_pk_mul_f32 v[50:51], v[190:191], v[190:191]
  v_pk_fma_f32 v[50:51], v[50:51], v[42:43], v[40:41]
  v_pk_mul_f32 v[50:51], v[50:51], v[190:191]
  v_exp_f32 v48, v48
  v_exp_f32 v49, v49
  v_exp_f32 v50, v50
  v_exp_f32 v51, v51
  v_pk_add_f32 v[48:49], v[48:49], v[44:45]
  v_pk_add_f32 v[50:51], v[50:51], v[44:45]
  v_rcp_f32 v48, v48
  v_rcp_f32 v49, v49
  v_rcp_f32 v50, v50
  v_rcp_f32 v51, v51
  v_pk_mul_f32 v[188:189], v[188:189], v[48:49]
  v_pk_mul_f32 v[190:191], v[190:191], v[50:51]
  v_cvt_pk_bf16_f32 v60, v188, v189
  v_cvt_pk_bf16_f32 v61, v190, v191
  v_pk_mul_f32 v[48:49], v[204:205], v[204:205]
  v_pk_fma_f32 v[48:49], v[48:49], v[42:43], v[40:41]
  v_pk_mul_f32 v[48:49], v[48:49], v[204:205]
  v_pk_mul_f32 v[50:51], v[206:207], v[206:207]
  v_pk_fma_f32 v[50:51], v[50:51], v[42:43], v[40:41]
  v_pk_mul_f32 v[50:51], v[50:51], v[206:207]
  v_exp_f32 v48, v48
  v_exp_f32 v49, v49
  v_exp_f32 v50, v50
  v_exp_f32 v51, v51
  v_pk_add_f32 v[48:49], v[48:49], v[44:45]
  v_pk_add_f32 v[50:51], v[50:51], v[44:45]
  v_rcp_f32 v48, v48
  v_rcp_f32 v49, v49
  v_rcp_f32 v50, v50
  v_rcp_f32 v51, v51
  v_pk_mul_f32 v[204:205], v[204:205], v[48:49]
  v_pk_mul_f32 v[206:207], v[206:207], v[50:51]
  v_cvt_pk_bf16_f32 v62, v204, v205
  v_cvt_pk_bf16_f32 v63, v206, v207
  buffer_store_dwordx4 v[60:63], v6, s[24:27], s58 offen offset:3072 sc1
attn_kernel_join37:
  s_lshl_b32 s46, s42, 5
  s_add_u32 s46, s46, s43
  s_lshl_b32 s46, s46, 7
  s_add_u32 s57, s46, 32768
  s_bfe_u32 s40, s2, 0x10002
  s_bfe_u32 s42, s2, 0x10001
  s_lshl_b32 s42, s42, 3
  s_lshr_b32 s43, s2, 5
  s_add_u32 s42, s42, s43
  s_and_b32 s43, s2, 1
  s_lshl_b32 s43, s43, 2
  s_bfe_u32 s41, s2, 0x20003
  s_add_u32 s43, s43, s41
  s_lshl_b32 s47, s42, 3
  s_lshl_b32 s48, s44, 1
  s_add_u32 s47, s47, s48
  s_lshr_b32 s45, s42, 1
  s_lshl_b32 s45, s45, 12
  s_lshl_b32 s46, s40, 11
  s_add_u32 s45, s45, s46
  s_add_u32 s60, s45, 32768
  s_lshl_b32 s48, s47, 10
  v_lshl_add_u32 v12, v1, 4, s48
  v_add_u32 v13, 0x20000, v12
  s_mul_i32 s51, s40, 7340032
  s_xor_b32 s45, s40, 1
  s_lshl_b32 s45, s45, 2
  v_lshrrev_b32 v32, 2, v1
  v_and_b32 v33, 3, v1
  v_and_b32 v34, 7, v32
  v_xor_b32 v34, s45, v34
  v_lshlrev_b32 v32, 8, v32
  v_lshl_add_u32 v32, v33, 3, v32
  v_xor_b32 v33, 0, v34
  v_lshl_add_u32 v16, v33, 5, v32
  v_xor_b32 v33, 1, v34
  v_lshl_add_u32 v17, v33, 5, v32
  v_xor_b32 v33, 2, v34
  v_lshl_add_u32 v18, v33, 5, v32
  v_xor_b32 v33, 3, v34
  v_lshl_add_u32 v19, v33, 5, v32
  v_xor_b32 v33, 4, v34
  v_lshl_add_u32 v20, v33, 5, v32
  v_xor_b32 v33, 5, v34
  v_lshl_add_u32 v21, v33, 5, v32
  v_xor_b32 v33, 6, v34
  v_lshl_add_u32 v22, v33, 5, v32
  v_xor_b32 v33, 7, v34
  v_lshl_add_u32 v23, v33, 5, v32
  v_add_u32 v24, 0x10000, v16
  v_add_u32 v25, 0x10000, v17
  v_add_u32 v26, 0x10000, v18
  v_add_u32 v27, 0x10000, v19
  v_add_u32 v28, 0x10000, v20
  v_add_u32 v29, 0x10000, v21
  v_add_u32 v30, 0x10000, v22
  v_add_u32 v31, 0x10000, v23
  s_add_u32 s16, s4, 92274688
  s_addc_u32 s17, s5, 0
  s_and_b32 s17, s17, 0xffff
  s_mov_b32 s18, 4194304
  s_mov_b32 s19, 0x20000
  s_lshl_b32 s55, s2, 14
  s_xor_b32 s56, s55, 0x10000
  s_mov_b32 s20, s8
  s_and_b32 s21, s9, 0xffff
  s_mov_b32 s22, 4194304
  s_mov_b32 s23, 0x20000
  s_add_u32 s28, s4, 20480
  s_addc_u32 s29, s5, 0
  s_and_b32 s29, s29, 0xffff
  s_mov_b32 s30, 4096
  s_mov_b32 s31, 0x20000
  v_and_b32 v4, 15, v1
  v_lshrrev_b32 v5, 4, v1
  v_lshlrev_b32 v6, 11, v4
  v_lshl_add_u32 v7, v5, 4, v6
  s_lshl_b32 s46, s43, 1
  s_add_u32 s46, s46, s40
  s_lshl_b32 s48, s47, 15
  s_lshl_b32 s49, s46, 7
  s_add_u32 s48, s48, s49
  s_add_u32 s49, s48, 32768
  v_lshlrev_b32 v10, 5, v5
  v_lshlrev_b32 v11, 4, v5
  s_lshl_b32 s54, s46, 8
  s_lshl_b32 s61, s46, 7
  s_waitcnt vmcnt(0)
  s_barrier
  s_cmp_lg_u32 s44, 0
  s_cbranch_scc1 attn_kernel_pub38
  v_mov_b32 v3, 0
  v_mov_b32 v4, 1
  buffer_store_dword v4, v3, s[68:71], s57 offen sc1
attn_kernel_pub38:
  v_and_b32 v3, 15, v1
  v_lshlrev_b32 v3, 7, v3
  s_add_u32 m0, s52, 0
  s_nop 0
  buffer_load_dwordx4 v216, s[12:15], s50 offen offset:0 lds
  buffer_load_dwordx4 v217, s[12:15], s50 offen offset:1024 lds
  buffer_load_dwordx4 v218, s[12:15], s50 offen offset:2048 lds
  buffer_load_dwordx4 v219, s[12:15], s50 offen offset:3072 lds
  s_add_u32 s50, s50, 131072
  s_add_u32 m0, s52, 16384
  s_nop 0
  buffer_load_dwordx4 v216, s[12:15], s50 offen offset:0 lds
  buffer_load_dwordx4 v217, s[12:15], s50 offen offset:1024 lds
  buffer_load_dwordx4 v218, s[12:15], s50 offen offset:2048 lds
  buffer_load_dwordx4 v219, s[12:15], s50 offen offset:3072 lds
  s_add_u32 s50, s50, 131072
  s_add_u32 m0, s52, 32768
  s_nop 0
  buffer_load_dwordx4 v216, s[12:15], s50 offen offset:0 lds
  buffer_load_dwordx4 v217, s[12:15], s50 offen offset:1024 lds
  buffer_load_dwordx4 v218, s[12:15], s50 offen offset:2048 lds
  buffer_load_dwordx4 v219, s[12:15], s50 offen offset:3072 lds
  s_add_u32 s50, s50, 131072
  s_add_u32 m0, s52, 49152
  s_nop 0
  buffer_load_dwordx4 v216, s[12:15], s50 offen offset:0 lds
  buffer_load_dwordx4 v217, s[12:15], s50 offen offset:1024 lds
  buffer_load_dwordx4 v218, s[12:15], s50 offen offset:2048 lds
  buffer_load_dwordx4 v219, s[12:15], s50 offen offset:3072 lds
  s_add_u32 s50, s50, 131072
  s_add_u32 m0, s52, 65536
  s_nop 0
  buffer_load_dwordx4 v216, s[12:15], s50 offen offset:0 lds
  buffer_load_dwordx4 v217, s[12:15], s50 offen offset:1024 lds
  buffer_load_dwordx4 v218, s[12:15], s50 offen offset:2048 lds
  buffer_load_dwordx4 v219, s[12:15], s50 offen offset:3072 lds
  s_add_u32 s50, s50, 131072
  s_add_u32 m0, s52, 81920
  s_nop 0
  buffer_load_dwordx4 v216, s[12:15], s50 offen offset:0 lds
  buffer_load_dwordx4 v217, s[12:15], s50 offen offset:1024 lds
  buffer_load_dwordx4 v218, s[12:15], s50 offen offset:2048 lds
  buffer_load_dwordx4 v219, s[12:15], s50 offen offset:3072 lds
  s_add_u32 s50, s50, 131072
  s_add_u32 m0, s52, 98304
  s_nop 0
  buffer_load_dwordx4 v216, s[12:15], s50 offen offset:0 lds
  buffer_load_dwordx4 v217, s[12:15], s50 offen offset:1024 lds
  buffer_load_dwordx4 v218, s[12:15], s50 offen offset:2048 lds
  buffer_load_dwordx4 v219, s[12:15], s50 offen offset:3072 lds
  s_add_u32 s50, s50, 131072
  s_cmp_lg_u32 s44, 0
  s_cbranch_scc1 attn_kernel_awd40
  s_mov_b32 s53, 0x80000
attn_kernel_aw39:
  buffer_load_dword v4, v3, s[68:71], s60 offen sc1
  s_sub_u32 s53, s53, 1
  s_cselect_b64 s[58:59], 0, -1
  s_waitcnt vmcnt(0)
  v_cmp_eq_u32 vcc, 0, v4
  s_and_b64 vcc, vcc, s[58:59]
  s_cbranch_vccz attn_kernel_awd40
  s_branch attn_kernel_aw39
attn_kernel_awd40:
  s_barrier
  buffer_load_dwordx4 a[0:3], v12, s[24:27], s51 offen offset:0 sc1
  buffer_load_dwordx4 a[4:7], v12, s[24:27], s51 offen offset:1024 sc1
  buffer_load_dwordx4 a[8:11], v13, s[24:27], s51 offen offset:0 sc1
  buffer_load_dwordx4 a[12:15], v13, s[24:27], s51 offen offset:1024 sc1
  s_add_u32 s51, s51, 262144
  buffer_load_dwordx4 a[16:19], v12, s[24:27], s51 offen offset:0 sc1
  buffer_load_dwordx4 a[20:23], v12, s[24:27], s51 offen offset:1024 sc1
  buffer_load_dwordx4 a[24:27], v13, s[24:27], s51 offen offset:0 sc1
  buffer_load_dwordx4 a[28:31], v13, s[24:27], s51 offen offset:1024 sc1
  s_add_u32 s51, s51, 262144
  buffer_load_dwordx4 a[32:35], v12, s[24:27], s51 offen offset:0 sc1
  buffer_load_dwordx4 a[36:39], v12, s[24:27], s51 offen offset:1024 sc1
  buffer_load_dwordx4 a[40:43], v13, s[24:27], s51 offen offset:0 sc1
  buffer_load_dwordx4 a[44:47], v13, s[24:27], s51 offen offset:1024 sc1
  s_add_u32 s51, s51, 262144
  buffer_load_dwordx4 a[48:51], v12, s[24:27], s51 offen offset:0 sc1
  buffer_load_dwordx4 a[52:55], v12, s[24:27], s51 offen offset:1024 sc1
  buffer_load_dwordx4 a[56:59], v13, s[24:27], s51 offen offset:0 sc1
  buffer_load_dwordx4 a[60:63], v13, s[24:27], s51 offen offset:1024 sc1
  s_add_u32 s51, s51, 262144
  buffer_load_dwordx4 a[64:67], v12, s[24:27], s51 offen offset:0 sc1
  buffer_load_dwordx4 a[68:71], v12, s[24:27], s51 offen offset:1024 sc1
  buffer_load_dwordx4 a[72:75], v13, s[24:27], s51 offen offset:0 sc1
  buffer_load_dwordx4 a[76:79], v13, s[24:27], s51 offen offset:1024 sc1
  s_add_u32 s51, s51, 262144
  buffer_load_dwordx4 v[32:35], v7, s[36:39], s48 offen offset:0 sc1
  buffer_load_dwordx4 v[36:39], v7, s[36:39], s48 offen offset:64 sc1
  buffer_load_dwordx4 v[40:43], v7, s[36:39], s49 offen offset:0 sc1
  buffer_load_dwordx4 v[44:47], v7, s[36:39], s49 offen offset:64 sc1
  buffer_load_dwordx4 v[48:51], v10, s[28:31], s54 offen offset:0 sc1
  buffer_load_dwordx4 v[52:55], v10, s[28:31], s54 offen offset:16 sc1
  buffer_load_dwordx4 v[56:59], v10, s[28:31], s54 offen offset:128 sc1
  buffer_load_dwordx4 v[60:63], v10, s[28:31], s54 offen offset:144 sc1
  buffer_load_dwordx4 v[192:195], v11, s[72:75], s61 offen offset:0
  buffer_load_dwordx4 v[196:199], v11, s[72:75], s61 offen offset:64
  s_waitcnt vmcnt(26)
  s_barrier
  ds_read_b64_tr_b16 a[128:129], v16 offset:0
  ds_read_b64_tr_b16 a[130:131], v16 offset:4096
  ds_read_b64_tr_b16 a[132:133], v16 offset:8192
  ds_read_b64_tr_b16 a[134:135], v16 offset:12288
  ds_read_b64_tr_b16 a[136:137], v17 offset:0
  ds_read_b64_tr_b16 a[138:139], v17 offset:4096
  ds_read_b64_tr_b16 a[140:141], v17 offset:8192
  ds_read_b64_tr_b16 a[142:143], v17 offset:12288
  s_waitcnt lgkmcnt(4)
  v_mfma_f32_16x16x32_bf16 v[64:67], a[128:131], a[0:3], 0
  ds_read_b64_tr_b16 a[144:145], v18 offset:0
  ds_read_b64_tr_b16 a[146:147], v18 offset:4096
  v_mfma_f32_16x16x32_bf16 v[64:67], a[132:135], a[8:11], v[64:67]
  buffer_load_dwordx4 a[80:83], v12, s[24:27], s51 offen offset:0 sc1
  v_mfma_f32_16x16x32_bf16 v[68:71], a[128:131], a[4:7], 0
  ds_read_b64_tr_b16 a[148:149], v18 offset:8192
  ds_read_b64_tr_b16 a[150:151], v18 offset:12288
  v_mfma_f32_16x16x32_bf16 v[68:71], a[132:135], a[12:15], v[68:71]
  buffer_load_dwordx4 a[84:87], v12, s[24:27], s51 offen offset:1024 sc1
  s_waitcnt lgkmcnt(4)
  v_mfma_f32_16x16x32_bf16 v[72:75], a[136:139], a[0:3], 0
  ds_read_b64_tr_b16 a[152:153], v19 offset:0
  ds_read_b64_tr_b16 a[154:155], v19 offset:4096
  v_mfma_f32_16x16x32_bf16 v[72:75], a[140:143], a[8:11], v[72:75]
  v_mfma_f32_16x16x32_bf16 v[76:79], a[136:139], a[4:7], 0
  ds_read_b64_tr_b16 a[156:157], v19 offset:8192
  ds_read_b64_tr_b16 a[158:159], v19 offset:12288
  v_mfma_f32_16x16x32_bf16 v[76:79], a[140:143], a[12:15], v[76:79]
  buffer_load_dwordx4 a[88:91], v13, s[24:27], s51 offen offset:0 sc1
  s_waitcnt lgkmcnt(4)
  v_mfma_f32_16x16x32_bf16 v[80:83], a[144:147], a[0:3], 0
  ds_read_b64_tr_b16 a[128:129], v20 offset:0
  ds_read_b64_tr_b16 a[130:131], v20 offset:4096
  v_mfma_f32_16x16x32_bf16 v[80:83], a[148:151], a[8:11], v[80:83]
  buffer_load_dwordx4 a[92:95], v13, s[24:27], s51 offen offset:1024 sc1
  s_add_u32 s51, s51, 262144
  v_mfma_f32_16x16x32_bf16 v[84:87], a[144:147], a[4:7], 0
  ds_read_b64_tr_b16 a[132:133], v20 offset:8192
  ds_read_b64_tr_b16 a[134:135], v20 offset:12288
  v_mfma_f32_16x16x32_bf16 v[84:87], a[148:151], a[12:15], v[84:87]
  s_waitcnt lgkmcnt(4)
  v_mfma_f32_16x16x32_bf16 v[88:91], a[152:155], a[0:3], 0
  ds_read_b64_tr_b16 a[136:137], v21 offset:0
  ds_read_b64_tr_b16 a[138:139], v21 offset:4096
  v_mfma_f32_16x16x32_bf16 v[88:91], a[156:159], a[8:11], v[88:91]
  buffer_load_dwordx4 a[96:99], v12, s[24:27], s51 offen offset:0 sc1
  v_mfma_f32_16x16x32_bf16 v[92:95], a[152:155], a[4:7], 0
  ds_read_b64_tr_b16 a[140:141], v21 offset:8192
  ds_read_b64_tr_b16 a[142:143], v21 offset:12288
  v_mfma_f32_16x16x32_bf16 v[92:95], a[156:159], a[12:15], v[92:95]
  buffer_load_dwordx4 a[100:103], v12, s[24:27], s51 offen offset:1024 sc1
  s_waitcnt lgkmcnt(4)
  v_mfma_f32_16x16x32_bf16 v[96:99], a[128:131], a[0:3], 0
  ds_read_b64_tr_b16 a[144:145], v22 offset:0
  ds_read_b64_tr_b16 a[146:147], v22 offset:4096
  v_mfma_f32_16x16x32_bf16 v[96:99], a[132:135], a[8:11], v[96:99]
  v_mfma_f32_16x16x32_bf16 v[100:103], a[128:131], a[4:7], 0
  ds_read_b64_tr_b16 a[148:149], v22 offset:8192
  ds_read_b64_tr_b16 a[150:151], v22 offset:12288
  v_mfma_f32_16x16x32_bf16 v[100:103], a[132:135], a[12:15], v[100:103]
  buffer_load_dwordx4 a[104:107], v13, s[24:27], s51 offen offset:0 sc1
  s_waitcnt lgkmcnt(4)
  v_mfma_f32_16x16x32_bf16 v[104:107], a[136:139], a[0:3], 0
  ds_read_b64_tr_b16 a[152:153], v23 offset:0
  ds_read_b64_tr_b16 a[154:155], v23 offset:4096
  v_mfma_f32_16x16x32_bf16 v[104:107], a[140:143], a[8:11], v[104:107]
  buffer_load_dwordx4 a[108:111], v13, s[24:27], s51 offen offset:1024 sc1
  s_add_u32 s51, s51, 262144
  v_mfma_f32_16x16x32_bf16 v[108:111], a[136:139], a[4:7], 0
  ds_read_b64_tr_b16 a[156:157], v23 offset:8192
  ds_read_b64_tr_b16 a[158:159], v23 offset:12288
  v_mfma_f32_16x16x32_bf16 v[108:111], a[140:143], a[12:15], v[108:111]
  s_waitcnt vmcnt(30) lgkmcnt(4)
  s_barrier
  v_mfma_f32_16x16x32_bf16 v[112:115], a[144:147], a[0:3], 0
  ds_read_b64_tr_b16 a[128:129], v16 offset:16384
  ds_read_b64_tr_b16 a[130:131], v16 offset:20480
  v_mfma_f32_16x16x32_bf16 v[112:115], a[148:151], a[8:11], v[112:115]
  buffer_load_dwordx4 a[112:115], v12, s[24:27], s51 offen offset:0 sc1
  v_mfma_f32_16x16x32_bf16 v[116:119], a[144:147], a[4:7], 0
  ds_read_b64_tr_b16 a[132:133], v16 offset:24576
  ds_read_b64_tr_b16 a[134:135], v16 offset:28672
  v_mfma_f32_16x16x32_bf16 v[116:119], a[148:151], a[12:15], v[116:119]
  s_add_u32 m0, s52, 114688
  s_waitcnt lgkmcnt(4)
  v_mfma_f32_16x16x32_bf16 v[120:123], a[152:155], a[0:3], 0
  ds_read_b64_tr_b16 a[136:137], v17 offset:16384
  ds_read_b64_tr_b16 a[138:139], v17 offset:20480
  v_mfma_f32_16x16x32_bf16 v[120:123], a[156:159], a[8:11], v[120:123]
  buffer_load_dwordx4 a[116:119], v12, s[24:27], s51 offen offset:1024 sc1
  v_mfma_f32_16x16x32_bf16 v[124:127], a[152:155], a[4:7], 0
  ds_read_b64_tr_b16 a[140:141], v17 offset:24576
  ds_read_b64_tr_b16 a[142:143], v17 offset:28672
  v_mfma_f32_16x16x32_bf16 v[124:127], a[156:159], a[12:15], v[124:127]
  s_waitcnt lgkmcnt(4)
  v_mfma_f32_16x16x32_bf16 v[64:67], a[128:131], a[16:19], v[64:67]
  ds_read_b64_tr_b16 a[144:145], v18 offset:16384
  ds_read_b64_tr_b16 a[146:147], v18 offset:20480
  v_mfma_f32_16x16x32_bf16 v[64:67], a[132:135], a[24:27], v[64:67]
  buffer_load_dwordx4 v216, s[12:15], s50 offen offset:0 lds
  v_mfma_f32_16x16x32_bf16 v[68:71], a[128:131], a[20:23], v[68:71]
  ds_read_b64_tr_b16 a[148:149], v18 offset:24576
  ds_read_b64_tr_b16 a[150:151], v18 offset:28672
  v_mfma_f32_16x16x32_bf16 v[68:71], a[132:135], a[28:31], v[68:71]
  s_waitcnt lgkmcnt(4)
  v_mfma_f32_16x16x32_bf16 v[72:75], a[136:139], a[16:19], v[72:75]
  ds_read_b64_tr_b16 a[152:153], v19 offset:16384
  ds_read_b64_tr_b16 a[154:155], v19 offset:20480
  v_mfma_f32_16x16x32_bf16 v[72:75], a[140:143], a[24:27], v[72:75]
  buffer_load_dwordx4 v217, s[12:15], s50 offen offset:1024 lds
  v_mfma_f32_16x16x32_bf16 v[76:79], a[136:139], a[20:23], v[76:79]
  ds_read_b64_tr_b16 a[156:157], v19 offset:24576
  ds_read_b64_tr_b16 a[158:159], v19 offset:28672
  v_mfma_f32_16x16x32_bf16 v[76:79], a[140:143], a[28:31], v[76:79]
  s_waitcnt lgkmcnt(4)
  v_mfma_f32_16x16x32_bf16 v[80:83], a[144:147], a[16:19], v[80:83]
  ds_read_b64_tr_b16 a[128:129], v20 offset:16384
  ds_read_b64_tr_b16 a[130:131], v20 offset:20480
  v_mfma_f32_16x16x32_bf16 v[80:83], a[148:151], a[24:27], v[80:83]
  buffer_load_dwordx4 v218, s[12:15], s50 offen offset:2048 lds
  v_mfma_f32_16x16x32_bf16 v[84:87], a[144:147], a[20:23], v[84:87]
  ds_read_b64_tr_b16 a[132:133], v20 offset:24576
  ds_read_b64_tr_b16 a[134:135], v20 offset:28672
  v_mfma_f32_16x16x32_bf16 v[84:87], a[148:151], a[28:31], v[84:87]
  s_waitcnt lgkmcnt(4)
  v_mfma_f32_16x16x32_bf16 v[88:91], a[152:155], a[16:19], v[88:91]
  ds_read_b64_tr_b16 a[136:137], v21 offset:16384
  ds_read_b64_tr_b16 a[138:139], v21 offset:20480
  v_mfma_f32_16x16x32_bf16 v[88:91], a[156:159], a[24:27], v[88:91]
  buffer_load_dwordx4 v219, s[12:15], s50 offen offset:3072 lds
  v_mfma_f32_16x16x32_bf16 v[92:95], a[152:155], a[20:23], v[92:95]
  ds_read_b64_tr_b16 a[140:141], v21 offset:24576
  ds_read_b64_tr_b16 a[142:143], v21 offset:28672
  v_mfma_f32_16x16x32_bf16 v[92:95], a[156:159], a[28:31], v[92:95]
  s_add_u32 s50, s50, 131072
  s_waitcnt lgkmcnt(4)
  v_mfma_f32_16x16x32_bf16 v[96:99], a[128:131], a[16:19], v[96:99]
  ds_read_b64_tr_b16 a[144:145], v22 offset:16384
  ds_read_b64_tr_b16 a[146:147], v22 offset:20480
  v_mfma_f32_16x16x32_bf16 v[96:99], a[132:135], a[24:27], v[96:99]
  buffer_load_dwordx4 a[120:123], v13, s[24:27], s51 offen offset:0 sc1
  v_mfma_f32_16x16x32_bf16 v[100:103], a[128:131], a[20:23], v[100:103]
  ds_read_b64_tr_b16 a[148:149], v22 offset:24576
  ds_read_b64_tr_b16 a[150:151], v22 offset:28672
  v_mfma_f32_16x16x32_bf16 v[100:103], a[132:135], a[28:31], v[100:103]
  s_waitcnt lgkmcnt(4)
  v_mfma_f32_16x16x32_bf16 v[104:107], a[136:139], a[16:19], v[104:107]
  ds_read_b64_tr_b16 a[152:153], v23 offset:16384
  ds_read_b64_tr_b16 a[154:155], v23 offset:20480
  v_mfma_f32_16x16x32_bf16 v[104:107], a[140:143], a[24:27], v[104:107]
  buffer_load_dwordx4 a[124:127], v13, s[24:27], s51 offen offset:1024 sc1
  v_mfma_f32_16x16x32_bf16 v[108:111], a[136:139], a[20:23], v[108:111]
  ds_read_b64_tr_b16 a[156:157], v23 offset:24576
  ds_read_b64_tr_b16 a[158:159], v23 offset:28672
  v_mfma_f32_16x16x32_bf16 v[108:111], a[140:143], a[28:31], v[108:111]
  s_add_u32 s51, s51, 262144
  s_waitcnt vmcnt(34) lgkmcnt(4)
  s_barrier
  v_mfma_f32_16x16x32_bf16 v[112:115], a[144:147], a[16:19], v[112:115]
  ds_read_b64_tr_b16 a[128:129], v16 offset:32768
  ds_read_b64_tr_b16 a[130:131], v16 offset:36864
  v_mfma_f32_16x16x32_bf16 v[112:115], a[148:151], a[24:27], v[112:115]
  buffer_load_dwordx4 a[0:3], v12, s[24:27], s51 offen offset:0 sc1
  v_mfma_f32_16x16x32_bf16 v[116:119], a[144:147], a[20:23], v[116:119]
  ds_read_b64_tr_b16 a[132:133], v16 offset:40960
  ds_read_b64_tr_b16 a[134:135], v16 offset:45056
  v_mfma_f32_16x16x32_bf16 v[116:119], a[148:151], a[28:31], v[116:119]
  s_add_u32 m0, s52, 0
  s_waitcnt lgkmcnt(4)
  v_mfma_f32_16x16x32_bf16 v[120:123], a[152:155], a[16:19], v[120:123]
  ds_read_b64_tr_b16 a[136:137], v17 offset:32768
  ds_read_b64_tr_b16 a[138:139], v17 offset:36864
  v_mfma_f32_16x16x32_bf16 v[120:123], a[156:159], a[24:27], v[120:123]
  buffer_load_dwordx4 a[4:7], v12, s[24:27], s51 offen offset:1024 sc1
  v_mfma_f32_16x16x32_bf16 v[124:127], a[152:155], a[20:23], v[124:127]
  ds_read_b64_tr_b16 a[140:141], v17 offset:40960
  ds_read_b64_tr_b16 a[142:143], v17 offset:45056
  v_mfma_f32_16x16x32_bf16 v[124:127], a[156:159], a[28:31], v[124:127]
  s_waitcnt lgkmcnt(4)
  v_mfma_f32_16x16x32_bf16 v[64:67], a[128:131], a[32:35], v[64:67]
  ds_read_b64_tr_b16 a[144:145], v18 offset:32768
  ds_read_b64_tr_b16 a[146:147], v18 offset:36864
  v_mfma_f32_16x16x32_bf16 v[64:67], a[132:135], a[40:43], v[64:67]
  buffer_load_dwordx4 v216, s[12:15], s50 offen offset:0 lds
  v_mfma_f32_16x16x32_bf16 v[68:71], a[128:131], a[36:39], v[68:71]
  ds_read_b64_tr_b16 a[148:149], v18 offset:40960
  ds_read_b64_tr_b16 a[150:151], v18 offset:45056
  v_mfma_f32_16x16x32_bf16 v[68:71], a[132:135], a[44:47], v[68:71]
  s_waitcnt lgkmcnt(4)
  v_mfma_f32_16x16x32_bf16 v[72:75], a[136:139], a[32:35], v[72:75]
  ds_read_b64_tr_b16 a[152:153], v19 offset:32768
  ds_read_b64_tr_b16 a[154:155], v19 offset:36864
  v_mfma_f32_16x16x32_bf16 v[72:75], a[140:143], a[40:43], v[72:75]
  buffer_load_dwordx4 v217, s[12:15], s50 offen offset:1024 lds
  v_mfma_f32_16x16x32_bf16 v[76:79], a[136:139], a[36:39], v[76:79]
  ds_read_b64_tr_b16 a[156:157], v19 offset:40960
  ds_read_b64_tr_b16 a[158:159], v19 offset:45056
  v_mfma_f32_16x16x32_bf16 v[76:79], a[140:143], a[44:47], v[76:79]
  s_waitcnt lgkmcnt(4)
  v_mfma_f32_16x16x32_bf16 v[80:83], a[144:147], a[32:35], v[80:83]
  ds_read_b64_tr_b16 a[128:129], v20 offset:32768
  ds_read_b64_tr_b16 a[130:131], v20 offset:36864
  v_mfma_f32_16x16x32_bf16 v[80:83], a[148:151], a[40:43], v[80:83]
  buffer_load_dwordx4 v218, s[12:15], s50 offen offset:2048 lds
  v_mfma_f32_16x16x32_bf16 v[84:87], a[144:147], a[36:39], v[84:87]
  ds_read_b64_tr_b16 a[132:133], v20 offset:40960
  ds_read_b64_tr_b16 a[134:135], v20 offset:45056
  v_mfma_f32_16x16x32_bf16 v[84:87], a[148:151], a[44:47], v[84:87]
  s_waitcnt lgkmcnt(4)
  v_mfma_f32_16x16x32_bf16 v[88:91], a[152:155], a[32:35], v[88:91]
  ds_read_b64_tr_b16 a[136:137], v21 offset:32768
  ds_read_b64_tr_b16 a[138:139], v21 offset:36864
  v_mfma_f32_16x16x32_bf16 v[88:91], a[156:159], a[40:43], v[88:91]
  buffer_load_dwordx4 v219, s[12:15], s50 offen offset:3072 lds
  v_mfma_f32_16x16x32_bf16 v[92:95], a[152:155], a[36:39], v[92:95]
  ds_read_b64_tr_b16 a[140:141], v21 offset:40960
  ds_read_b64_tr_b16 a[142:143], v21 offset:45056
  v_mfma_f32_16x16x32_bf16 v[92:95], a[156:159], a[44:47], v[92:95]
  s_add_u32 s50, s50, 131072
  s_waitcnt lgkmcnt(4)
  v_mfma_f32_16x16x32_bf16 v[96:99], a[128:131], a[32:35], v[96:99]
  ds_read_b64_tr_b16 a[144:145], v22 offset:32768
  ds_read_b64_tr_b16 a[146:147], v22 offset:36864
  v_mfma_f32_16x16x32_bf16 v[96:99], a[132:135], a[40:43], v[96:99]
  buffer_load_dwordx4 a[8:11], v13, s[24:27], s51 offen offset:0 sc1
  v_mfma_f32_16x16x32_bf16 v[100:103], a[128:131], a[36:39], v[100:103]
  ds_read_b64_tr_b16 a[148:149], v22 offset:40960
  ds_read_b64_tr_b16 a[150:151], v22 offset:45056
  v_mfma_f32_16x16x32_bf16 v[100:103], a[132:135], a[44:47], v[100:103]
  s_waitcnt lgkmcnt(4)
  v_mfma_f32_16x16x32_bf16 v[104:107], a[136:139], a[32:35], v[104:107]
  ds_read_b64_tr_b16 a[152:153], v23 offset:32768
  ds_read_b64_tr_b16 a[154:155], v23 offset:36864
  v_mfma_f32_16x16x32_bf16 v[104:107], a[140:143], a[40:43], v[104:107]
  buffer_load_dwordx4 a[12:15], v13, s[24:27], s51 offen offset:1024 sc1
  v_mfma_f32_16x16x32_bf16 v[108:111], a[136:139], a[36:39], v[108:111]
  ds_read_b64_tr_b16 a[156:157], v23 offset:40960
  ds_read_b64_tr_b16 a[158:159], v23 offset:45056
  v_mfma_f32_16x16x32_bf16 v[108:111], a[140:143], a[44:47], v[108:111]
  s_add_u32 s51, s51, 262144
  s_waitcnt vmcnt(38) lgkmcnt(4)
  s_barrier
  v_mfma_f32_16x16x32_bf16 v[112:115], a[144:147], a[32:35], v[112:115]
  ds_read_b64_tr_b16 a[128:129], v16 offset:49152
  ds_read_b64_tr_b16 a[130:131], v16 offset:53248
  v_mfma_f32_16x16x32_bf16 v[112:115], a[148:151], a[40:43], v[112:115]
  buffer_load_dwordx4 a[16:19], v12, s[24:27], s51 offen offset:0 sc1
  v_mfma_f32_16x16x32_bf16 v[116:119], a[144:147], a[36:39], v[116:119]
  ds_read_b64_tr_b16 a[132:133], v16 offset:57344
  ds_read_b64_tr_b16 a[134:135], v16 offset:61440
  v_mfma_f32_16x16x32_bf16 v[116:119], a[148:151], a[44:47], v[116:119]
  s_add_u32 m0, s52, 16384
  s_waitcnt lgkmcnt(4)
  v_mfma_f32_16x16x32_bf16 v[120:123], a[152:155], a[32:35], v[120:123]
  ds_read_b64_tr_b16 a[136:137], v17 offset:49152
  ds_read_b64_tr_b16 a[138:139], v17 offset:53248
  v_mfma_f32_16x16x32_bf16 v[120:123], a[156:159], a[40:43], v[120:123]
  buffer_load_dwordx4 a[20:23], v12, s[24:27], s51 offen offset:1024 sc1
  v_mfma_f32_16x16x32_bf16 v[124:127], a[152:155], a[36:39], v[124:127]
  ds_read_b64_tr_b16 a[140:141], v17 offset:57344
  ds_read_b64_tr_b16 a[142:143], v17 offset:61440
  v_mfma_f32_16x16x32_bf16 v[124:127], a[156:159], a[44:47], v[124:127]
  s_waitcnt lgkmcnt(4)
  v_mfma_f32_16x16x32_bf16 v[64:67], a[128:131], a[48:51], v[64:67]
  ds_read_b64_tr_b16 a[144:145], v18 offset:49152
  ds_read_b64_tr_b16 a[146:147], v18 offset:53248
  v_mfma_f32_16x16x32_bf16 v[64:67], a[132:135], a[56:59], v[64:67]
  buffer_load_dwordx4 v216, s[12:15], s50 offen offset:0 lds
  v_mfma_f32_16x16x32_bf16 v[68:71], a[128:131], a[52:55], v[68:71]
  ds_read_b64_tr_b16 a[148:149], v18 offset:57344
  ds_read_b64_tr_b16 a[150:151], v18 offset:61440
  v_mfma_f32_16x16x32_bf16 v[68:71], a[132:135], a[60:63], v[68:71]
  s_waitcnt lgkmcnt(4)
  v_mfma_f32_16x16x32_bf16 v[72:75], a[136:139], a[48:51], v[72:75]
  ds_read_b64_tr_b16 a[152:153], v19 offset:49152
  ds_read_b64_tr_b16 a[154:155], v19 offset:53248
  v_mfma_f32_16x16x32_bf16 v[72:75], a[140:143], a[56:59], v[72:75]
  buffer_load_dwordx4 v217, s[12:15], s50 offen offset:1024 lds
  v_mfma_f32_16x16x32_bf16 v[76:79], a[136:139], a[52:55], v[76:79]
  ds_read_b64_tr_b16 a[156:157], v19 offset:57344
  ds_read_b64_tr_b16 a[158:159], v19 offset:61440
  v_mfma_f32_16x16x32_bf16 v[76:79], a[140:143], a[60:63], v[76:79]
  s_waitcnt lgkmcnt(4)
  v_mfma_f32_16x16x32_bf16 v[80:83], a[144:147], a[48:51], v[80:83]
  ds_read_b64_tr_b16 a[128:129], v20 offset:49152
  ds_read_b64_tr_b16 a[130:131], v20 offset:53248
  v_mfma_f32_16x16x32_bf16 v[80:83], a[148:151], a[56:59], v[80:83]
  buffer_load_dwordx4 v218, s[12:15], s50 offen offset:2048 lds
  v_mfma_f32_16x16x32_bf16 v[84:87], a[144:147], a[52:55], v[84:87]
  ds_read_b64_tr_b16 a[132:133], v20 offset:57344
  ds_read_b64_tr_b16 a[134:135], v20 offset:61440
  v_mfma_f32_16x16x32_bf16 v[84:87], a[148:151], a[60:63], v[84:87]
  s_waitcnt lgkmcnt(4)
  v_mfma_f32_16x16x32_bf16 v[88:91], a[152:155], a[48:51], v[88:91]
  ds_read_b64_tr_b16 a[136:137], v21 offset:49152
  ds_read_b64_tr_b16 a[138:139], v21 offset:53248
  v_mfma_f32_16x16x32_bf16 v[88:91], a[156:159], a[56:59], v[88:91]
  buffer_load_dwordx4 v219, s[12:15], s50 offen offset:3072 lds
  v_mfma_f32_16x16x32_bf16 v[92:95], a[152:155], a[52:55], v[92:95]
  ds_read_b64_tr_b16 a[140:141], v21 offset:57344
  ds_read_b64_tr_b16 a[142:143], v21 offset:61440
  v_mfma_f32_16x16x32_bf16 v[92:95], a[156:159], a[60:63], v[92:95]
  s_add_u32 s50, s50, 131072
  s_waitcnt lgkmcnt(4)
  v_mfma_f32_16x16x32_bf16 v[96:99], a[128:131], a[48:51], v[96:99]
  ds_read_b64_tr_b16 a[144:145], v22 offset:49152
  ds_read_b64_tr_b16 a[146:147], v22 offset:53248
  v_mfma_f32_16x16x32_bf16 v[96:99], a[132:135], a[56:59], v[96:99]
  buffer_load_dwordx4 a[24:27], v13, s[24:27], s51 offen offset:0 sc1
  v_mfma_f32_16x16x32_bf16 v[100:103], a[128:131], a[52:55], v[100:103]
  ds_read_b64_tr_b16 a[148:149], v22 offset:57344
  ds_read_b64_tr_b16 a[150:151], v22 offset:61440
  v_mfma_f32_16x16x32_bf16 v[100:103], a[132:135], a[60:63], v[100:103]
  s_waitcnt lgkmcnt(4)
  v_mfma_f32_16x16x32_bf16 v[104:107], a[136:139], a[48:51], v[104:107]
  ds_read_b64_tr_b16 a[152:153], v23 offset:49152
  ds_read_b64_tr_b16 a[154:155], v23 offset:53248
  v_mfma_f32_16x16x32_bf16 v[104:107], a[140:143], a[56:59], v[104:107]
  buffer_load_dwordx4 a[28:31], v13, s[24:27], s51 offen offset:1024 sc1
  v_mfma_f32_16x16x32_bf16 v[108:111], a[136:139], a[52:55], v[108:111]
  ds_read_b64_tr_b16 a[156:157], v23 offset:57344
  ds_read_b64_tr_b16 a[158:159], v23 offset:61440
  v_mfma_f32_16x16x32_bf16 v[108:111], a[140:143], a[60:63], v[108:111]
  s_add_u32 s51, s51, 262144
  s_waitcnt vmcnt(42) lgkmcnt(4)
  s_barrier
  v_mfma_f32_16x16x32_bf16 v[112:115], a[144:147], a[48:51], v[112:115]
  ds_read_b64_tr_b16 a[128:129], v24 offset:0
  ds_read_b64_tr_b16 a[130:131], v24 offset:4096
  v_mfma_f32_16x16x32_bf16 v[112:115], a[148:151], a[56:59], v[112:115]
  buffer_load_dwordx4 a[32:35], v12, s[24:27], s51 offen offset:0 sc1
  v_mfma_f32_16x16x32_bf16 v[116:119], a[144:147], a[52:55], v[116:119]
  ds_read_b64_tr_b16 a[132:133], v24 offset:8192
  ds_read_b64_tr_b16 a[134:135], v24 offset:12288
  v_mfma_f32_16x16x32_bf16 v[116:119], a[148:151], a[60:63], v[116:119]
  s_add_u32 m0, s52, 32768
  s_waitcnt lgkmcnt(4)
  v_mfma_f32_16x16x32_bf16 v[120:123], a[152:155], a[48:51], v[120:123]
  ds_read_b64_tr_b16 a[136:137], v25 offset:0
  ds_read_b64_tr_b16 a[138:139], v25 offset:4096
  v_mfma_f32_16x16x32_bf16 v[120:123], a[156:159], a[56:59], v[120:123]
  buffer_load_dwordx4 a[36:39], v12, s[24:27], s51 offen offset:1024 sc1
  v_mfma_f32_16x16x32_bf16 v[124:127], a[152:155], a[52:55], v[124:127]
  ds_read_b64_tr_b16 a[140:141], v25 offset:8192
  ds_read_b64_tr_b16 a[142:143], v25 offset:12288
  v_mfma_f32_16x16x32_bf16 v[124:127], a[156:159], a[60:63], v[124:127]
  s_waitcnt lgkmcnt(4)
  v_mfma_f32_16x16x32_bf16 v[64:67], a[128:131], a[64:67], v[64:67]
  ds_read_b64_tr_b16 a[144:145], v26 offset:0
  ds_read_b64_tr_b16 a[146:147], v26 offset:4096
  v_mfma_f32_16x16x32_bf16 v[64:67], a[132:135], a[72:75], v[64:67]
  buffer_load_dwordx4 v216, s[12:15], s50 offen offset:0 lds
  v_mfma_f32_16x16x32_bf16 v[68:71], a[128:131], a[68:71], v[68:71]
  ds_read_b64_tr_b16 a[148:149], v26 offset:8192
  ds_read_b64_tr_b16 a[150:151], v26 offset:12288
  v_mfma_f32_16x16x32_bf16 v[68:71], a[132:135], a[76:79], v[68:71]
  s_waitcnt lgkmcnt(4)
  v_mfma_f32_16x16x32_bf16 v[72:75], a[136:139], a[64:67], v[72:75]
  ds_read_b64_tr_b16 a[152:153], v27 offset:0
  ds_read_b64_tr_b16 a[154:155], v27 offset:4096
  v_mfma_f32_16x16x32_bf16 v[72:75], a[140:143], a[72:75], v[72:75]
  buffer_load_dwordx4 v217, s[12:15], s50 offen offset:1024 lds
  v_mfma_f32_16x16x32_bf16 v[76:79], a[136:139], a[68:71], v[76:79]
  ds_read_b64_tr_b16 a[156:157], v27 offset:8192
  ds_read_b64_tr_b16 a[158:159], v27 offset:12288
  v_mfma_f32_16x16x32_bf16 v[76:79], a[140:143], a[76:79], v[76:79]
  s_waitcnt lgkmcnt(4)
  v_mfma_f32_16x16x32_bf16 v[80:83], a[144:147], a[64:67], v[80:83]
  ds_read_b64_tr_b16 a[128:129], v28 offset:0
  ds_read_b64_tr_b16 a[130:131], v28 offset:4096
  v_mfma_f32_16x16x32_bf16 v[80:83], a[148:151], a[72:75], v[80:83]
  buffer_load_dwordx4 v218, s[12:15], s50 offen offset:2048 lds
  v_mfma_f32_16x16x32_bf16 v[84:87], a[144:147], a[68:71], v[84:87]
  ds_read_b64_tr_b16 a[132:133], v28 offset:8192
  ds_read_b64_tr_b16 a[134:135], v28 offset:12288
  v_mfma_f32_16x16x32_bf16 v[84:87], a[148:151], a[76:79], v[84:87]
  s_waitcnt lgkmcnt(4)
  v_mfma_f32_16x16x32_bf16 v[88:91], a[152:155], a[64:67], v[88:91]
  ds_read_b64_tr_b16 a[136:137], v29 offset:0
  ds_read_b64_tr_b16 a[138:139], v29 offset:4096
  v_mfma_f32_16x16x32_bf16 v[88:91], a[156:159], a[72:75], v[88:91]
  buffer_load_dwordx4 v219, s[12:15], s50 offen offset:3072 lds
  v_mfma_f32_16x16x32_bf16 v[92:95], a[152:155], a[68:71], v[92:95]
  ds_read_b64_tr_b16 a[140:141], v29 offset:8192
  ds_read_b64_tr_b16 a[142:143], v29 offset:12288
  v_mfma_f32_16x16x32_bf16 v[92:95], a[156:159], a[76:79], v[92:95]
  s_add_u32 s50, s50, 131072
  s_waitcnt lgkmcnt(4)
  v_mfma_f32_16x16x32_bf16 v[96:99], a[128:131], a[64:67], v[96:99]
  ds_read_b64_tr_b16 a[144:145], v30 offset:0
  ds_read_b64_tr_b16 a[146:147], v30 offset:4096
  v_mfma_f32_16x16x32_bf16 v[96:99], a[132:135], a[72:75], v[96:99]
  buffer_load_dwordx4 a[40:43], v13, s[24:27], s51 offen offset:0 sc1
  v_mfma_f32_16x16x32_bf16 v[100:103], a[128:131], a[68:71], v[100:103]
  ds_read_b64_tr_b16 a[148:149], v30 offset:8192
  ds_read_b64_tr_b16 a[150:151], v30 offset:12288
  v_mfma_f32_16x16x32_bf16 v[100:103], a[132:135], a[76:79], v[100:103]
  s_waitcnt lgkmcnt(4)
  v_mfma_f32_16x16x32_bf16 v[104:107], a[136:139], a[64:67], v[104:107]
  ds_read_b64_tr_b16 a[152:153], v31 offset:0
  ds_read_b64_tr_b16 a[154:155], v31 offset:4096
  v_mfma_f32_16x16x32_bf16 v[104:107], a[140:143], a[72:75], v[104:107]
  buffer_load_dwordx4 a[44:47], v13, s[24:27], s51 offen offset:1024 sc1
  v_mfma_f32_16x16x32_bf16 v[108:111], a[136:139], a[68:71], v[108:111]
  ds_read_b64_tr_b16 a[156:157], v31 offset:8192
  ds_read_b64_tr_b16 a[158:159], v31 offset:12288
  v_mfma_f32_16x16x32_bf16 v[108:111], a[140:143], a[76:79], v[108:111]
  s_add_u32 s51, s51, 262144
  s_waitcnt vmcnt(36) lgkmcnt(4)
  s_barrier
  v_mfma_f32_16x16x32_bf16 v[112:115], a[144:147], a[64:67], v[112:115]
  ds_read_b64_tr_b16 a[128:129], v24 offset:16384
  ds_read_b64_tr_b16 a[130:131], v24 offset:20480
  v_mfma_f32_16x16x32_bf16 v[112:115], a[148:151], a[72:75], v[112:115]
  buffer_load_dwordx4 a[48:51], v12, s[24:27], s51 offen offset:0 sc1
  v_mfma_f32_16x16x32_bf16 v[116:119], a[144:147], a[68:71], v[116:119]
  ds_read_b64_tr_b16 a[132:133], v24 offset:24576
  ds_read_b64_tr_b16 a[134:135], v24 offset:28672
  v_mfma_f32_16x16x32_bf16 v[116:119], a[148:151], a[76:79], v[116:119]
  s_add_u32 m0, s52, 49152
  s_waitcnt lgkmcnt(4)
  v_mfma_f32_16x16x32_bf16 v[120:123], a[152:155], a[64:67], v[120:123]
  ds_read_b64_tr_b16 a[136:137], v25 offset:16384
  ds_read_b64_tr_b16 a[138:139], v25 offset:20480
  v_mfma_f32_16x16x32_bf16 v[120:123], a[156:159], a[72:75], v[120:123]
  buffer_load_dwordx4 a[52:55], v12, s[24:27], s51 offen offset:1024 sc1
  v_mfma_f32_16x16x32_bf16 v[124:127], a[152:155], a[68:71], v[124:127]
  ds_read_b64_tr_b16 a[140:141], v25 offset:24576
  ds_read_b64_tr_b16 a[142:143], v25 offset:28672
  v_mfma_f32_16x16x32_bf16 v[124:127], a[156:159], a[76:79], v[124:127]
  s_waitcnt lgkmcnt(4)
  v_mfma_f32_16x16x32_bf16 v[64:67], a[128:131], a[80:83], v[64:67]
  ds_read_b64_tr_b16 a[144:145], v26 offset:16384
  ds_read_b64_tr_b16 a[146:147], v26 offset:20480
  v_mfma_f32_16x16x32_bf16 v[64:67], a[132:135], a[88:91], v[64:67]
  buffer_load_dwordx4 v216, s[12:15], s50 offen offset:0 lds
  v_mfma_f32_16x16x32_bf16 v[68:71], a[128:131], a[84:87], v[68:71]
  ds_read_b64_tr_b16 a[148:149], v26 offset:24576
  ds_read_b64_tr_b16 a[150:151], v26 offset:28672
  v_mfma_f32_16x16x32_bf16 v[68:71], a[132:135], a[92:95], v[68:71]
  s_waitcnt lgkmcnt(4)
  v_mfma_f32_16x16x32_bf16 v[72:75], a[136:139], a[80:83], v[72:75]
  ds_read_b64_tr_b16 a[152:153], v27 offset:16384
  ds_read_b64_tr_b16 a[154:155], v27 offset:20480
  v_mfma_f32_16x16x32_bf16 v[72:75], a[140:143], a[88:91], v[72:75]
  buffer_load_dwordx4 v217, s[12:15], s50 offen offset:1024 lds
  v_mfma_f32_16x16x32_bf16 v[76:79], a[136:139], a[84:87], v[76:79]
  ds_read_b64_tr_b16 a[156:157], v27 offset:24576
  ds_read_b64_tr_b16 a[158:159], v27 offset:28672
  v_mfma_f32_16x16x32_bf16 v[76:79], a[140:143], a[92:95], v[76:79]
  s_waitcnt lgkmcnt(4)
  v_mfma_f32_16x16x32_bf16 v[80:83], a[144:147], a[80:83], v[80:83]
  ds_read_b64_tr_b16 a[128:129], v28 offset:16384
  ds_read_b64_tr_b16 a[130:131], v28 offset:20480
  v_mfma_f32_16x16x32_bf16 v[80:83], a[148:151], a[88:91], v[80:83]
  buffer_load_dwordx4 v218, s[12:15], s50 offen offset:2048 lds
  v_mfma_f32_16x16x32_bf16 v[84:87], a[144:147], a[84:87], v[84:87]
  ds_read_b64_tr_b16 a[132:133], v28 offset:24576
  ds_read_b64_tr_b16 a[134:135], v28 offset:28672
  v_mfma_f32_16x16x32_bf16 v[84:87], a[148:151], a[92:95], v[84:87]
  s_waitcnt lgkmcnt(4)
  v_mfma_f32_16x16x32_bf16 v[88:91], a[152:155], a[80:83], v[88:91]
  ds_read_b64_tr_b16 a[136:137], v29 offset:16384
  ds_read_b64_tr_b16 a[138:139], v29 offset:20480
  v_mfma_f32_16x16x32_bf16 v[88:91], a[156:159], a[88:91], v[88:91]
  buffer_load_dwordx4 v219, s[12:15], s50 offen offset:3072 lds
  v_mfma_f32_16x16x32_bf16 v[92:95], a[152:155], a[84:87], v[92:95]
  ds_read_b64_tr_b16 a[140:141], v29 offset:24576
  ds_read_b64_tr_b16 a[142:143], v29 offset:28672
  v_mfma_f32_16x16x32_bf16 v[92:95], a[156:159], a[92:95], v[92:95]
  s_add_u32 s50, s50, 131072
  s_waitcnt lgkmcnt(4)
  v_mfma_f32_16x16x32_bf16 v[96:99], a[128:131], a[80:83], v[96:99]
  ds_read_b64_tr_b16 a[144:145], v30 offset:16384
  ds_read_b64_tr_b16 a[146:147], v30 offset:20480
  v_mfma_f32_16x16x32_bf16 v[96:99], a[132:135], a[88:91], v[96:99]
  buffer_load_dwordx4 a[56:59], v13, s[24:27], s51 offen offset:0 sc1
  v_mfma_f32_16x16x32_bf16 v[100:103], a[128:131], a[84:87], v[100:103]
  ds_read_b64_tr_b16 a[148:149], v30 offset:24576
  ds_read_b64_tr_b16 a[150:151], v30 offset:28672
  v_mfma_f32_16x16x32_bf16 v[100:103], a[132:135], a[92:95], v[100:103]
  s_waitcnt lgkmcnt(4)
  v_mfma_f32_16x16x32_bf16 v[104:107], a[136:139], a[80:83], v[104:107]
  ds_read_b64_tr_b16 a[152:153], v31 offset:16384
  ds_read_b64_tr_b16 a[154:155], v31 offset:20480
  v_mfma_f32_16x16x32_bf16 v[104:107], a[140:143], a[88:91], v[104:107]
  buffer_load_dwordx4 a[60:63], v13, s[24:27], s51 offen offset:1024 sc1
  v_mfma_f32_16x16x32_bf16 v[108:111], a[136:139], a[84:87], v[108:111]
  ds_read_b64_tr_b16 a[156:157], v31 offset:24576
  ds_read_b64_tr_b16 a[158:159], v31 offset:28672
  v_mfma_f32_16x16x32_bf16 v[108:111], a[140:143], a[92:95], v[108:111]
  s_add_u32 s51, s51, 262144
  s_mov_b32 s53, 2
attn_kernel_gloop41:
  s_waitcnt vmcnt(40) lgkmcnt(4)
  s_barrier
  v_mfma_f32_16x16x32_bf16 v[112:115], a[144:147], a[80:83], v[112:115]
  ds_read_b64_tr_b16 a[128:129], v24 offset:32768
  ds_read_b64_tr_b16 a[130:131], v24 offset:36864
  v_mfma_f32_16x16x32_bf16 v[112:115], a[148:151], a[88:91], v[112:115]
  buffer_load_dwordx4 a[64:67], v12, s[24:27], s51 offen offset:0 sc1
  v_mfma_f32_16x16x32_bf16 v[116:119], a[144:147], a[84:87], v[116:119]
  ds_read_b64_tr_b16 a[132:133], v24 offset:40960
  ds_read_b64_tr_b16 a[134:135], v24 offset:45056
  v_mfma_f32_16x16x32_bf16 v[116:119], a[148:151], a[92:95], v[116:119]
  s_add_u32 m0, s52, 65536
  s_waitcnt lgkmcnt(4)
  v_mfma_f32_16x16x32_bf16 v[120:123], a[152:155], a[80:83], v[120:123]
  ds_read_b64_tr_b16 a[136:137], v25 offset:32768
  ds_read_b64_tr_b16 a[138:139], v25 offset:36864
  v_mfma_f32_16x16x32_bf16 v[120:123], a[156:159], a[88:91], v[120:123]
  buffer_load_dwordx4 a[68:71], v12, s[24:27], s51 offen offset:1024 sc1
  v_mfma_f32_16x16x32_bf16 v[124:127], a[152:155], a[84:87], v[124:127]
  ds_read_b64_tr_b16 a[140:141], v25 offset:40960
  ds_read_b64_tr_b16 a[142:143], v25 offset:45056
  v_mfma_f32_16x16x32_bf16 v[124:127], a[156:159], a[92:95], v[124:127]
  s_waitcnt lgkmcnt(4)
  v_mfma_f32_16x16x32_bf16 v[64:67], a[128:131], a[96:99], v[64:67]
  ds_read_b64_tr_b16 a[144:145], v26 offset:32768
  ds_read_b64_tr_b16 a[146:147], v26 offset:36864
  v_mfma_f32_16x16x32_bf16 v[64:67], a[132:135], a[104:107], v[64:67]
  buffer_load_dwordx4 v216, s[12:15], s50 offen offset:0 lds
  v_mfma_f32_16x16x32_bf16 v[68:71], a[128:131], a[100:103], v[68:71]
  ds_read_b64_tr_b16 a[148:149], v26 offset:40960
  ds_read_b64_tr_b16 a[150:151], v26 offset:45056
  v_mfma_f32_16x16x32_bf16 v[68:71], a[132:135], a[108:111], v[68:71]
  s_waitcnt lgkmcnt(4)
  v_mfma_f32_16x16x32_bf16 v[72:75], a[136:139], a[96:99], v[72:75]
  ds_read_b64_tr_b16 a[152:153], v27 offset:32768
  ds_read_b64_tr_b16 a[154:155], v27 offset:36864
  v_mfma_f32_16x16x32_bf16 v[72:75], a[140:143], a[104:107], v[72:75]
  buffer_load_dwordx4 v217, s[12:15], s50 offen offset:1024 lds
  v_mfma_f32_16x16x32_bf16 v[76:79], a[136:139], a[100:103], v[76:79]
  ds_read_b64_tr_b16 a[156:157], v27 offset:40960
  ds_read_b64_tr_b16 a[158:159], v27 offset:45056
  v_mfma_f32_16x16x32_bf16 v[76:79], a[140:143], a[108:111], v[76:79]
  s_waitcnt lgkmcnt(4)
  v_mfma_f32_16x16x32_bf16 v[80:83], a[144:147], a[96:99], v[80:83]
  ds_read_b64_tr_b16 a[128:129], v28 offset:32768
  ds_read_b64_tr_b16 a[130:131], v28 offset:36864
  v_mfma_f32_16x16x32_bf16 v[80:83], a[148:151], a[104:107], v[80:83]
  buffer_load_dwordx4 v218, s[12:15], s50 offen offset:2048 lds
  v_mfma_f32_16x16x32_bf16 v[84:87], a[144:147], a[100:103], v[84:87]
  ds_read_b64_tr_b16 a[132:133], v28 offset:40960
  ds_read_b64_tr_b16 a[134:135], v28 offset:45056
  v_mfma_f32_16x16x32_bf16 v[84:87], a[148:151], a[108:111], v[84:87]
  s_waitcnt lgkmcnt(4)
  v_mfma_f32_16x16x32_bf16 v[88:91], a[152:155], a[96:99], v[88:91]
  ds_read_b64_tr_b16 a[136:137], v29 offset:32768
  ds_read_b64_tr_b16 a[138:139], v29 offset:36864
  v_mfma_f32_16x16x32_bf16 v[88:91], a[156:159], a[104:107], v[88:91]
  buffer_load_dwordx4 v219, s[12:15], s50 offen offset:3072 lds
  v_mfma_f32_16x16x32_bf16 v[92:95], a[152:155], a[100:103], v[92:95]
  ds_read_b64_tr_b16 a[140:141], v29 offset:40960
  ds_read_b64_tr_b16 a[142:143], v29 offset:45056
  v_mfma_f32_16x16x32_bf16 v[92:95], a[156:159], a[108:111], v[92:95]
  s_add_u32 s50, s50, 131072
  s_waitcnt lgkmcnt(4)
  v_mfma_f32_16x16x32_bf16 v[96:99], a[128:131], a[96:99], v[96:99]
  ds_read_b64_tr_b16 a[144:145], v30 offset:32768
  ds_read_b64_tr_b16 a[146:147], v30 offset:36864
  v_mfma_f32_16x16x32_bf16 v[96:99], a[132:135], a[104:107], v[96:99]
  buffer_load_dwordx4 a[72:75], v13, s[24:27], s51 offen offset:0 sc1
  v_mfma_f32_16x16x32_bf16 v[100:103], a[128:131], a[100:103], v[100:103]
  ds_read_b64_tr_b16 a[148:149], v30 offset:40960
  ds_read_b64_tr_b16 a[150:151], v30 offset:45056
  v_mfma_f32_16x16x32_bf16 v[100:103], a[132:135], a[108:111], v[100:103]
  s_waitcnt lgkmcnt(4)
  v_mfma_f32_16x16x32_bf16 v[104:107], a[136:139], a[96:99], v[104:107]
  ds_read_b64_tr_b16 a[152:153], v31 offset:32768
  ds_read_b64_tr_b16 a[154:155], v31 offset:36864
  v_mfma_f32_16x16x32_bf16 v[104:107], a[140:143], a[104:107], v[104:107]
  buffer_load_dwordx4 a[76:79], v13, s[24:27], s51 offen offset:1024 sc1
  v_mfma_f32_16x16x32_bf16 v[108:111], a[136:139], a[100:103], v[108:111]
  ds_read_b64_tr_b16 a[156:157], v31 offset:40960
  ds_read_b64_tr_b16 a[158:159], v31 offset:45056
  v_mfma_f32_16x16x32_bf16 v[108:111], a[140:143], a[108:111], v[108:111]
  s_add_u32 s51, s51, 262144
  s_waitcnt vmcnt(40) lgkmcnt(4)
  s_barrier
  v_mfma_f32_16x16x32_bf16 v[112:115], a[144:147], a[96:99], v[112:115]
  ds_read_b64_tr_b16 a[128:129], v24 offset:49152
  ds_read_b64_tr_b16 a[130:131], v24 offset:53248
  v_mfma_f32_16x16x32_bf16 v[112:115], a[148:151], a[104:107], v[112:115]
  buffer_load_dwordx4 a[80:83], v12, s[24:27], s51 offen offset:0 sc1
  v_mfma_f32_16x16x32_bf16 v[116:119], a[144:147], a[100:103], v[116:119]
  ds_read_b64_tr_b16 a[132:133], v24 offset:57344
  ds_read_b64_tr_b16 a[134:135], v24 offset:61440
  v_mfma_f32_16x16x32_bf16 v[116:119], a[148:151], a[108:111], v[116:119]
  s_add_u32 m0, s52, 81920
  s_waitcnt lgkmcnt(4)
  v_mfma_f32_16x16x32_bf16 v[120:123], a[152:155], a[96:99], v[120:123]
  ds_read_b64_tr_b16 a[136:137], v25 offset:49152
  ds_read_b64_tr_b16 a[138:139], v25 offset:53248
  v_mfma_f32_16x16x32_bf16 v[120:123], a[156:159], a[104:107], v[120:123]
  buffer_load_dwordx4 a[84:87], v12, s[24:27], s51 offen offset:1024 sc1
  v_mfma_f32_16x16x32_bf16 v[124:127], a[152:155], a[100:103], v[124:127]
  ds_read_b64_tr_b16 a[140:141], v25 offset:57344
  ds_read_b64_tr_b16 a[142:143], v25 offset:61440
  v_mfma_f32_16x16x32_bf16 v[124:127], a[156:159], a[108:111], v[124:127]
  s_waitcnt lgkmcnt(4)
  v_mfma_f32_16x16x32_bf16 v[64:67], a[128:131], a[112:115], v[64:67]
  ds_read_b64_tr_b16 a[144:145], v26 offset:49152
  ds_read_b64_tr_b16 a[146:147], v26 offset:53248
  v_mfma_f32_16x16x32_bf16 v[64:67], a[132:135], a[120:123], v[64:67]
  buffer_load_dwordx4 v216, s[12:15], s50 offen offset:0 lds
  v_mfma_f32_16x16x32_bf16 v[68:71], a[128:131], a[116:119], v[68:71]
  ds_read_b64_tr_b16 a[148:149], v26 offset:57344
  ds_read_b64_tr_b16 a[150:151], v26 offset:61440
  v_mfma_f32_16x16x32_bf16 v[68:71], a[132:135], a[124:127], v[68:71]
  s_waitcnt lgkmcnt(4)
  v_mfma_f32_16x16x32_bf16 v[72:75], a[136:139], a[112:115], v[72:75]
  ds_read_b64_tr_b16 a[152:153], v27 offset:49152
  ds_read_b64_tr_b16 a[154:155], v27 offset:53248
  v_mfma_f32_16x16x32_bf16 v[72:75], a[140:143], a[120:123], v[72:75]
  buffer_load_dwordx4 v217, s[12:15], s50 offen offset:1024 lds
  v_mfma_f32_16x16x32_bf16 v[76:79], a[136:139], a[116:119], v[76:79]
  ds_read_b64_tr_b16 a[156:157], v27 offset:57344
  ds_read_b64_tr_b16 a[158:159], v27 offset:61440
  v_mfma_f32_16x16x32_bf16 v[76:79], a[140:143], a[124:127], v[76:79]
  s_waitcnt lgkmcnt(4)
  v_mfma_f32_16x16x32_bf16 v[80:83], a[144:147], a[112:115], v[80:83]
  ds_read_b64_tr_b16 a[128:129], v28 offset:49152
  ds_read_b64_tr_b16 a[130:131], v28 offset:53248
  v_mfma_f32_16x16x32_bf16 v[80:83], a[148:151], a[120:123], v[80:83]
  buffer_load_dwordx4 v218, s[12:15], s50 offen offset:2048 lds
  v_mfma_f32_16x16x32_bf16 v[84:87], a[144:147], a[116:119], v[84:87]
  ds_read_b64_tr_b16 a[132:133], v28 offset:57344
  ds_read_b64_tr_b16 a[134:135], v28 offset:61440
  v_mfma_f32_16x16x32_bf16 v[84:87], a[148:151], a[124:127], v[84:87]
  s_waitcnt lgkmcnt(4)
  v_mfma_f32_16x16x32_bf16 v[88:91], a[152:155], a[112:115], v[88:91]
  ds_read_b64_tr_b16 a[136:137], v29 offset:49152
  ds_read_b64_tr_b16 a[138:139], v29 offset:53248
  v_mfma_f32_16x16x32_bf16 v[88:91], a[156:159], a[120:123], v[88:91]
  buffer_load_dwordx4 v219, s[12:15], s50 offen offset:3072 lds
  v_mfma_f32_16x16x32_bf16 v[92:95], a[152:155], a[116:119], v[92:95]
  ds_read_b64_tr_b16 a[140:141], v29 offset:57344
  ds_read_b64_tr_b16 a[142:143], v29 offset:61440
  v_mfma_f32_16x16x32_bf16 v[92:95], a[156:159], a[124:127], v[92:95]
  s_add_u32 s50, s50, 131072
  s_waitcnt lgkmcnt(4)
  v_mfma_f32_16x16x32_bf16 v[96:99], a[128:131], a[112:115], v[96:99]
  ds_read_b64_tr_b16 a[144:145], v30 offset:49152
  ds_read_b64_tr_b16 a[146:147], v30 offset:53248
  v_mfma_f32_16x16x32_bf16 v[96:99], a[132:135], a[120:123], v[96:99]
  buffer_load_dwordx4 a[88:91], v13, s[24:27], s51 offen offset:0 sc1
  v_mfma_f32_16x16x32_bf16 v[100:103], a[128:131], a[116:119], v[100:103]
  ds_read_b64_tr_b16 a[148:149], v30 offset:57344
  ds_read_b64_tr_b16 a[150:151], v30 offset:61440
  v_mfma_f32_16x16x32_bf16 v[100:103], a[132:135], a[124:127], v[100:103]
  s_waitcnt lgkmcnt(4)
  v_mfma_f32_16x16x32_bf16 v[104:107], a[136:139], a[112:115], v[104:107]
  ds_read_b64_tr_b16 a[152:153], v31 offset:49152
  ds_read_b64_tr_b16 a[154:155], v31 offset:53248
  v_mfma_f32_16x16x32_bf16 v[104:107], a[140:143], a[120:123], v[104:107]
  buffer_load_dwordx4 a[92:95], v13, s[24:27], s51 offen offset:1024 sc1
  v_mfma_f32_16x16x32_bf16 v[108:111], a[136:139], a[116:119], v[108:111]
  ds_read_b64_tr_b16 a[156:157], v31 offset:57344
  ds_read_b64_tr_b16 a[158:159], v31 offset:61440
  v_mfma_f32_16x16x32_bf16 v[108:111], a[140:143], a[124:127], v[108:111]
  s_add_u32 s51, s51, 262144
  s_waitcnt vmcnt(40) lgkmcnt(4)
  s_barrier
  v_mfma_f32_16x16x32_bf16 v[112:115], a[144:147], a[112:115], v[112:115]
  ds_read_b64_tr_b16 a[128:129], v16 offset:0
  ds_read_b64_tr_b16 a[130:131], v16 offset:4096
  v_mfma_f32_16x16x32_bf16 v[112:115], a[148:151], a[120:123], v[112:115]
  buffer_load_dwordx4 a[96:99], v12, s[24:27], s51 offen offset:0 sc1
  v_mfma_f32_16x16x32_bf16 v[116:119], a[144:147], a[116:119], v[116:119]
  ds_read_b64_tr_b16 a[132:133], v16 offset:8192
  ds_read_b64_tr_b16 a[134:135], v16 offset:12288
  v_mfma_f32_16x16x32_bf16 v[116:119], a[148:151], a[124:127], v[116:119]
  s_add_u32 m0, s52, 98304
  s_waitcnt lgkmcnt(4)
  v_mfma_f32_16x16x32_bf16 v[120:123], a[152:155], a[112:115], v[120:123]
  ds_read_b64_tr_b16 a[136:137], v17 offset:0
  ds_read_b64_tr_b16 a[138:139], v17 offset:4096
  v_mfma_f32_16x16x32_bf16 v[120:123], a[156:159], a[120:123], v[120:123]
  buffer_load_dwordx4 a[100:103], v12, s[24:27], s51 offen offset:1024 sc1
  v_mfma_f32_16x16x32_bf16 v[124:127], a[152:155], a[116:119], v[124:127]
  ds_read_b64_tr_b16 a[140:141], v17 offset:8192
  ds_read_b64_tr_b16 a[142:143], v17 offset:12288
  v_mfma_f32_16x16x32_bf16 v[124:127], a[156:159], a[124:127], v[124:127]
  s_waitcnt lgkmcnt(4)
  v_mfma_f32_16x16x32_bf16 v[64:67], a[128:131], a[0:3], v[64:67]
  ds_read_b64_tr_b16 a[144:145], v18 offset:0
  ds_read_b64_tr_b16 a[146:147], v18 offset:4096
  v_mfma_f32_16x16x32_bf16 v[64:67], a[132:135], a[8:11], v[64:67]
  buffer_load_dwordx4 v216, s[12:15], s50 offen offset:0 lds
  v_mfma_f32_16x16x32_bf16 v[68:71], a[128:131], a[4:7], v[68:71]
  ds_read_b64_tr_b16 a[148:149], v18 offset:8192
  ds_read_b64_tr_b16 a[150:151], v18 offset:12288
  v_mfma_f32_16x16x32_bf16 v[68:71], a[132:135], a[12:15], v[68:71]
  s_waitcnt lgkmcnt(4)
  v_mfma_f32_16x16x32_bf16 v[72:75], a[136:139], a[0:3], v[72:75]
  ds_read_b64_tr_b16 a[152:153], v19 offset:0
  ds_read_b64_tr_b16 a[154:155], v19 offset:4096
  v_mfma_f32_16x16x32_bf16 v[72:75], a[140:143], a[8:11], v[72:75]
  buffer_load_dwordx4 v217, s[12:15], s50 offen offset:1024 lds
  v_mfma_f32_16x16x32_bf16 v[76:79], a[136:139], a[4:7], v[76:79]
  ds_read_b64_tr_b16 a[156:157], v19 offset:8192
  ds_read_b64_tr_b16 a[158:159], v19 offset:12288
  v_mfma_f32_16x16x32_bf16 v[76:79], a[140:143], a[12:15], v[76:79]
  s_waitcnt lgkmcnt(4)
  v_mfma_f32_16x16x32_bf16 v[80:83], a[144:147], a[0:3], v[80:83]
  ds_read_b64_tr_b16 a[128:129], v20 offset:0
  ds_read_b64_tr_b16 a[130:131], v20 offset:4096
  v_mfma_f32_16x16x32_bf16 v[80:83], a[148:151], a[8:11], v[80:83]
  buffer_load_dwordx4 v218, s[12:15], s50 offen offset:2048 lds
  v_mfma_f32_16x16x32_bf16 v[84:87], a[144:147], a[4:7], v[84:87]
  ds_read_b64_tr_b16 a[132:133], v20 offset:8192
  ds_read_b64_tr_b16 a[134:135], v20 offset:12288
  v_mfma_f32_16x16x32_bf16 v[84:87], a[148:151], a[12:15], v[84:87]
  s_waitcnt lgkmcnt(4)
  v_mfma_f32_16x16x32_bf16 v[88:91], a[152:155], a[0:3], v[88:91]
  ds_read_b64_tr_b16 a[136:137], v21 offset:0
  ds_read_b64_tr_b16 a[138:139], v21 offset:4096
  v_mfma_f32_16x16x32_bf16 v[88:91], a[156:159], a[8:11], v[88:91]
  buffer_load_dwordx4 v219, s[12:15], s50 offen offset:3072 lds
  v_mfma_f32_16x16x32_bf16 v[92:95], a[152:155], a[4:7], v[92:95]
  ds_read_b64_tr_b16 a[140:141], v21 offset:8192
  ds_read_b64_tr_b16 a[142:143], v21 offset:12288
  v_mfma_f32_16x16x32_bf16 v[92:95], a[156:159], a[12:15], v[92:95]
  s_add_u32 s50, s50, 131072
  s_waitcnt lgkmcnt(4)
  v_mfma_f32_16x16x32_bf16 v[96:99], a[128:131], a[0:3], v[96:99]
  ds_read_b64_tr_b16 a[144:145], v22 offset:0
  ds_read_b64_tr_b16 a[146:147], v22 offset:4096
  v_mfma_f32_16x16x32_bf16 v[96:99], a[132:135], a[8:11], v[96:99]
  buffer_load_dwordx4 a[104:107], v13, s[24:27], s51 offen offset:0 sc1
  v_mfma_f32_16x16x32_bf16 v[100:103], a[128:131], a[4:7], v[100:103]
  ds_read_b64_tr_b16 a[148:149], v22 offset:8192
  ds_read_b64_tr_b16 a[150:151], v22 offset:12288
  v_mfma_f32_16x16x32_bf16 v[100:103], a[132:135], a[12:15], v[100:103]
  s_waitcnt lgkmcnt(4)
  v_mfma_f32_16x16x32_bf16 v[104:107], a[136:139], a[0:3], v[104:107]
  ds_read_b64_tr_b16 a[152:153], v23 offset:0
  ds_read_b64_tr_b16 a[154:155], v23 offset:4096
  v_mfma_f32_16x16x32_bf16 v[104:107], a[140:143], a[8:11], v[104:107]
  buffer_load_dwordx4 a[108:111], v13, s[24:27], s51 offen offset:1024 sc1
  v_mfma_f32_16x16x32_bf16 v[108:111], a[136:139], a[4:7], v[108:111]
  ds_read_b64_tr_b16 a[156:157], v23 offset:8192
  ds_read_b64_tr_b16 a[158:159], v23 offset:12288
  v_mfma_f32_16x16x32_bf16 v[108:111], a[140:143], a[12:15], v[108:111]
  s_add_u32 s51, s51, 262144
  s_waitcnt vmcnt(40) lgkmcnt(4)
  s_barrier
  v_mfma_f32_16x16x32_bf16 v[112:115], a[144:147], a[0:3], v[112:115]
  ds_read_b64_tr_b16 a[128:129], v16 offset:16384
  ds_read_b64_tr_b16 a[130:131], v16 offset:20480
  v_mfma_f32_16x16x32_bf16 v[112:115], a[148:151], a[8:11], v[112:115]
  buffer_load_dwordx4 a[112:115], v12, s[24:27], s51 offen offset:0 sc1
  v_mfma_f32_16x16x32_bf16 v[116:119], a[144:147], a[4:7], v[116:119]
  ds_read_b64_tr_b16 a[132:133], v16 offset:24576
  ds_read_b64_tr_b16 a[134:135], v16 offset:28672
  v_mfma_f32_16x16x32_bf16 v[116:119], a[148:151], a[12:15], v[116:119]
  s_add_u32 m0, s52, 114688
  s_waitcnt lgkmcnt(4)
  v_mfma_f32_16x16x32_bf16 v[120:123], a[152:155], a[0:3], v[120:123]
  ds_read_b64_tr_b16 a[136:137], v17 offset:16384
  ds_read_b64_tr_b16 a[138:139], v17 offset:20480
  v_mfma_f32_16x16x32_bf16 v[120:123], a[156:159], a[8:11], v[120:123]
  buffer_load_dwordx4 a[116:119], v12, s[24:27], s51 offen offset:1024 sc1
  v_mfma_f32_16x16x32_bf16 v[124:127], a[152:155], a[4:7], v[124:127]
  ds_read_b64_tr_b16 a[140:141], v17 offset:24576
  ds_read_b64_tr_b16 a[142:143], v17 offset:28672
  v_mfma_f32_16x16x32_bf16 v[124:127], a[156:159], a[12:15], v[124:127]
  s_waitcnt lgkmcnt(4)
  v_mfma_f32_16x16x32_bf16 v[64:67], a[128:131], a[16:19], v[64:67]
  ds_read_b64_tr_b16 a[144:145], v18 offset:16384
  ds_read_b64_tr_b16 a[146:147], v18 offset:20480
  v_mfma_f32_16x16x32_bf16 v[64:67], a[132:135], a[24:27], v[64:67]
  buffer_load_dwordx4 v216, s[12:15], s50 offen offset:0 lds
  v_mfma_f32_16x16x32_bf16 v[68:71], a[128:131], a[20:23], v[68:71]
  ds_read_b64_tr_b16 a[148:149], v18 offset:24576
  ds_read_b64_tr_b16 a[150:151], v18 offset:28672
  v_mfma_f32_16x16x32_bf16 v[68:71], a[132:135], a[28:31], v[68:71]
  s_waitcnt lgkmcnt(4)
  v_mfma_f32_16x16x32_bf16 v[72:75], a[136:139], a[16:19], v[72:75]
  ds_read_b64_tr_b16 a[152:153], v19 offset:16384
  ds_read_b64_tr_b16 a[154:155], v19 offset:20480
  v_mfma_f32_16x16x32_bf16 v[72:75], a[140:143], a[24:27], v[72:75]
  buffer_load_dwordx4 v217, s[12:15], s50 offen offset:1024 lds
  v_mfma_f32_16x16x32_bf16 v[76:79], a[136:139], a[20:23], v[76:79]
  ds_read_b64_tr_b16 a[156:157], v19 offset:24576
  ds_read_b64_tr_b16 a[158:159], v19 offset:28672
  v_mfma_f32_16x16x32_bf16 v[76:79], a[140:143], a[28:31], v[76:79]
  s_waitcnt lgkmcnt(4)
  v_mfma_f32_16x16x32_bf16 v[80:83], a[144:147], a[16:19], v[80:83]
  ds_read_b64_tr_b16 a[128:129], v20 offset:16384
  ds_read_b64_tr_b16 a[130:131], v20 offset:20480
  v_mfma_f32_16x16x32_bf16 v[80:83], a[148:151], a[24:27], v[80:83]
  buffer_load_dwordx4 v218, s[12:15], s50 offen offset:2048 lds
  v_mfma_f32_16x16x32_bf16 v[84:87], a[144:147], a[20:23], v[84:87]
  ds_read_b64_tr_b16 a[132:133], v20 offset:24576
  ds_read_b64_tr_b16 a[134:135], v20 offset:28672
  v_mfma_f32_16x16x32_bf16 v[84:87], a[148:151], a[28:31], v[84:87]
  s_waitcnt lgkmcnt(4)
  v_mfma_f32_16x16x32_bf16 v[88:91], a[152:155], a[16:19], v[88:91]
  ds_read_b64_tr_b16 a[136:137], v21 offset:16384
  ds_read_b64_tr_b16 a[138:139], v21 offset:20480
  v_mfma_f32_16x16x32_bf16 v[88:91], a[156:159], a[24:27], v[88:91]
  buffer_load_dwordx4 v219, s[12:15], s50 offen offset:3072 lds
  v_mfma_f32_16x16x32_bf16 v[92:95], a[152:155], a[20:23], v[92:95]
  ds_read_b64_tr_b16 a[140:141], v21 offset:24576
  ds_read_b64_tr_b16 a[142:143], v21 offset:28672
  v_mfma_f32_16x16x32_bf16 v[92:95], a[156:159], a[28:31], v[92:95]
  s_add_u32 s50, s50, 131072
  s_waitcnt lgkmcnt(4)
  v_mfma_f32_16x16x32_bf16 v[96:99], a[128:131], a[16:19], v[96:99]
  ds_read_b64_tr_b16 a[144:145], v22 offset:16384
  ds_read_b64_tr_b16 a[146:147], v22 offset:20480
  v_mfma_f32_16x16x32_bf16 v[96:99], a[132:135], a[24:27], v[96:99]
  buffer_load_dwordx4 a[120:123], v13, s[24:27], s51 offen offset:0 sc1
  v_mfma_f32_16x16x32_bf16 v[100:103], a[128:131], a[20:23], v[100:103]
  ds_read_b64_tr_b16 a[148:149], v22 offset:24576
  ds_read_b64_tr_b16 a[150:151], v22 offset:28672
  v_mfma_f32_16x16x32_bf16 v[100:103], a[132:135], a[28:31], v[100:103]
  s_waitcnt lgkmcnt(4)
  v_mfma_f32_16x16x32_bf16 v[104:107], a[136:139], a[16:19], v[104:107]
  ds_read_b64_tr_b16 a[152:153], v23 offset:16384
  ds_read_b64_tr_b16 a[154:155], v23 offset:20480
  v_mfma_f32_16x16x32_bf16 v[104:107], a[140:143], a[24:27], v[104:107]
  buffer_load_dwordx4 a[124:127], v13, s[24:27], s51 offen offset:1024 sc1
  v_mfma_f32_16x16x32_bf16 v[108:111], a[136:139], a[20:23], v[108:111]
  ds_read_b64_tr_b16 a[156:157], v23 offset:24576
  ds_read_b64_tr_b16 a[158:159], v23 offset:28672
  v_mfma_f32_16x16x32_bf16 v[108:111], a[140:143], a[28:31], v[108:111]
  s_add_u32 s51, s51, 262144
  s_waitcnt vmcnt(40) lgkmcnt(4)
  s_barrier
  v_mfma_f32_16x16x32_bf16 v[112:115], a[144:147], a[16:19], v[112:115]
  ds_read_b64_tr_b16 a[128:129], v16 offset:32768
  ds_read_b64_tr_b16 a[130:131], v16 offset:36864
  v_mfma_f32_16x16x32_bf16 v[112:115], a[148:151], a[24:27], v[112:115]
  buffer_load_dwordx4 a[0:3], v12, s[24:27], s51 offen offset:0 sc1
  v_mfma_f32_16x16x32_bf16 v[116:119], a[144:147], a[20:23], v[116:119]
  ds_read_b64_tr_b16 a[132:133], v16 offset:40960
  ds_read_b64_tr_b16 a[134:135], v16 offset:45056
  v_mfma_f32_16x16x32_bf16 v[116:119], a[148:151], a[28:31], v[116:119]
  s_add_u32 m0, s52, 0
  s_waitcnt lgkmcnt(4)
  v_mfma_f32_16x16x32_bf16 v[120:123], a[152:155], a[16:19], v[120:123]
  ds_read_b64_tr_b16 a[136:137], v17 offset:32768
  ds_read_b64_tr_b16 a[138:139], v17 offset:36864
  v_mfma_f32_16x16x32_bf16 v[120:123], a[156:159], a[24:27], v[120:123]
  buffer_load_dwordx4 a[4:7], v12, s[24:27], s51 offen offset:1024 sc1
  v_mfma_f32_16x16x32_bf16 v[124:127], a[152:155], a[20:23], v[124:127]
  ds_read_b64_tr_b16 a[140:141], v17 offset:40960
  ds_read_b64_tr_b16 a[142:143], v17 offset:45056
  v_mfma_f32_16x16x32_bf16 v[124:127], a[156:159], a[28:31], v[124:127]
  s_waitcnt lgkmcnt(4)
  v_mfma_f32_16x16x32_bf16 v[64:67], a[128:131], a[32:35], v[64:67]
  ds_read_b64_tr_b16 a[144:145], v18 offset:32768
  ds_read_b64_tr_b16 a[146:147], v18 offset:36864
  v_mfma_f32_16x16x32_bf16 v[64:67], a[132:135], a[40:43], v[64:67]
  buffer_load_dwordx4 v216, s[12:15], s50 offen offset:0 lds
  v_mfma_f32_16x16x32_bf16 v[68:71], a[128:131], a[36:39], v[68:71]
  ds_read_b64_tr_b16 a[148:149], v18 offset:40960
  ds_read_b64_tr_b16 a[150:151], v18 offset:45056
  v_mfma_f32_16x16x32_bf16 v[68:71], a[132:135], a[44:47], v[68:71]
  s_waitcnt lgkmcnt(4)
  v_mfma_f32_16x16x32_bf16 v[72:75], a[136:139], a[32:35], v[72:75]
  ds_read_b64_tr_b16 a[152:153], v19 offset:32768
  ds_read_b64_tr_b16 a[154:155], v19 offset:36864
  v_mfma_f32_16x16x32_bf16 v[72:75], a[140:143], a[40:43], v[72:75]
  buffer_load_dwordx4 v217, s[12:15], s50 offen offset:1024 lds
  v_mfma_f32_16x16x32_bf16 v[76:79], a[136:139], a[36:39], v[76:79]
  ds_read_b64_tr_b16 a[156:157], v19 offset:40960
  ds_read_b64_tr_b16 a[158:159], v19 offset:45056
  v_mfma_f32_16x16x32_bf16 v[76:79], a[140:143], a[44:47], v[76:79]
  s_waitcnt lgkmcnt(4)
  v_mfma_f32_16x16x32_bf16 v[80:83], a[144:147], a[32:35], v[80:83]
  ds_read_b64_tr_b16 a[128:129], v20 offset:32768
  ds_read_b64_tr_b16 a[130:131], v20 offset:36864
  v_mfma_f32_16x16x32_bf16 v[80:83], a[148:151], a[40:43], v[80:83]
  buffer_load_dwordx4 v218, s[12:15], s50 offen offset:2048 lds
  v_mfma_f32_16x16x32_bf16 v[84:87], a[144:147], a[36:39], v[84:87]
  ds_read_b64_tr_b16 a[132:133], v20 offset:40960
  ds_read_b64_tr_b16 a[134:135], v20 offset:45056
  v_mfma_f32_16x16x32_bf16 v[84:87], a[148:151], a[44:47], v[84:87]
  s_waitcnt lgkmcnt(4)
  v_mfma_f32_16x16x32_bf16 v[88:91], a[152:155], a[32:35], v[88:91]
  ds_read_b64_tr_b16 a[136:137], v21 offset:32768
  ds_read_b64_tr_b16 a[138:139], v21 offset:36864
  v_mfma_f32_16x16x32_bf16 v[88:91], a[156:159], a[40:43], v[88:91]
  buffer_load_dwordx4 v219, s[12:15], s50 offen offset:3072 lds
  v_mfma_f32_16x16x32_bf16 v[92:95], a[152:155], a[36:39], v[92:95]
  ds_read_b64_tr_b16 a[140:141], v21 offset:40960
  ds_read_b64_tr_b16 a[142:143], v21 offset:45056
  v_mfma_f32_16x16x32_bf16 v[92:95], a[156:159], a[44:47], v[92:95]
  s_add_u32 s50, s50, 131072
  s_waitcnt lgkmcnt(4)
  v_mfma_f32_16x16x32_bf16 v[96:99], a[128:131], a[32:35], v[96:99]
  ds_read_b64_tr_b16 a[144:145], v22 offset:32768
  ds_read_b64_tr_b16 a[146:147], v22 offset:36864
  v_mfma_f32_16x16x32_bf16 v[96:99], a[132:135], a[40:43], v[96:99]
  buffer_load_dwordx4 a[8:11], v13, s[24:27], s51 offen offset:0 sc1
  v_mfma_f32_16x16x32_bf16 v[100:103], a[128:131], a[36:39], v[100:103]
  ds_read_b64_tr_b16 a[148:149], v22 offset:40960
  ds_read_b64_tr_b16 a[150:151], v22 offset:45056
  v_mfma_f32_16x16x32_bf16 v[100:103], a[132:135], a[44:47], v[100:103]
  s_waitcnt lgkmcnt(4)
  v_mfma_f32_16x16x32_bf16 v[104:107], a[136:139], a[32:35], v[104:107]
  ds_read_b64_tr_b16 a[152:153], v23 offset:32768
  ds_read_b64_tr_b16 a[154:155], v23 offset:36864
  v_mfma_f32_16x16x32_bf16 v[104:107], a[140:143], a[40:43], v[104:107]
  buffer_load_dwordx4 a[12:15], v13, s[24:27], s51 offen offset:1024 sc1
  v_mfma_f32_16x16x32_bf16 v[108:111], a[136:139], a[36:39], v[108:111]
  ds_read_b64_tr_b16 a[156:157], v23 offset:40960
  ds_read_b64_tr_b16 a[158:159], v23 offset:45056
  v_mfma_f32_16x16x32_bf16 v[108:111], a[140:143], a[44:47], v[108:111]
  s_add_u32 s51, s51, 262144
  s_waitcnt vmcnt(40) lgkmcnt(4)
  s_barrier
  v_mfma_f32_16x16x32_bf16 v[112:115], a[144:147], a[32:35], v[112:115]
  ds_read_b64_tr_b16 a[128:129], v16 offset:49152
  ds_read_b64_tr_b16 a[130:131], v16 offset:53248
  v_mfma_f32_16x16x32_bf16 v[112:115], a[148:151], a[40:43], v[112:115]
  buffer_load_dwordx4 a[16:19], v12, s[24:27], s51 offen offset:0 sc1
  v_mfma_f32_16x16x32_bf16 v[116:119], a[144:147], a[36:39], v[116:119]
  ds_read_b64_tr_b16 a[132:133], v16 offset:57344
  ds_read_b64_tr_b16 a[134:135], v16 offset:61440
  v_mfma_f32_16x16x32_bf16 v[116:119], a[148:151], a[44:47], v[116:119]
  s_add_u32 m0, s52, 16384
  s_waitcnt lgkmcnt(4)
  v_mfma_f32_16x16x32_bf16 v[120:123], a[152:155], a[32:35], v[120:123]
  ds_read_b64_tr_b16 a[136:137], v17 offset:49152
  ds_read_b64_tr_b16 a[138:139], v17 offset:53248
  v_mfma_f32_16x16x32_bf16 v[120:123], a[156:159], a[40:43], v[120:123]
  buffer_load_dwordx4 a[20:23], v12, s[24:27], s51 offen offset:1024 sc1
  v_mfma_f32_16x16x32_bf16 v[124:127], a[152:155], a[36:39], v[124:127]
  ds_read_b64_tr_b16 a[140:141], v17 offset:57344
  ds_read_b64_tr_b16 a[142:143], v17 offset:61440
  v_mfma_f32_16x16x32_bf16 v[124:127], a[156:159], a[44:47], v[124:127]
  s_waitcnt lgkmcnt(4)
  v_mfma_f32_16x16x32_bf16 v[64:67], a[128:131], a[48:51], v[64:67]
  ds_read_b64_tr_b16 a[144:145], v18 offset:49152
  ds_read_b64_tr_b16 a[146:147], v18 offset:53248
  v_mfma_f32_16x16x32_bf16 v[64:67], a[132:135], a[56:59], v[64:67]
  buffer_load_dwordx4 v216, s[12:15], s50 offen offset:0 lds
  v_mfma_f32_16x16x32_bf16 v[68:71], a[128:131], a[52:55], v[68:71]
  ds_read_b64_tr_b16 a[148:149], v18 offset:57344
  ds_read_b64_tr_b16 a[150:151], v18 offset:61440
  v_mfma_f32_16x16x32_bf16 v[68:71], a[132:135], a[60:63], v[68:71]
  s_waitcnt lgkmcnt(4)
  v_mfma_f32_16x16x32_bf16 v[72:75], a[136:139], a[48:51], v[72:75]
  ds_read_b64_tr_b16 a[152:153], v19 offset:49152
  ds_read_b64_tr_b16 a[154:155], v19 offset:53248
  v_mfma_f32_16x16x32_bf16 v[72:75], a[140:143], a[56:59], v[72:75]
  buffer_load_dwordx4 v217, s[12:15], s50 offen offset:1024 lds
  v_mfma_f32_16x16x32_bf16 v[76:79], a[136:139], a[52:55], v[76:79]
  ds_read_b64_tr_b16 a[156:157], v19 offset:57344
  ds_read_b64_tr_b16 a[158:159], v19 offset:61440
  v_mfma_f32_16x16x32_bf16 v[76:79], a[140:143], a[60:63], v[76:79]
  s_waitcnt lgkmcnt(4)
  v_mfma_f32_16x16x32_bf16 v[80:83], a[144:147], a[48:51], v[80:83]
  ds_read_b64_tr_b16 a[128:129], v20 offset:49152
  ds_read_b64_tr_b16 a[130:131], v20 offset:53248
  v_mfma_f32_16x16x32_bf16 v[80:83], a[148:151], a[56:59], v[80:83]
  buffer_load_dwordx4 v218, s[12:15], s50 offen offset:2048 lds
  v_mfma_f32_16x16x32_bf16 v[84:87], a[144:147], a[52:55], v[84:87]
  ds_read_b64_tr_b16 a[132:133], v20 offset:57344
  ds_read_b64_tr_b16 a[134:135], v20 offset:61440
  v_mfma_f32_16x16x32_bf16 v[84:87], a[148:151], a[60:63], v[84:87]
  s_waitcnt lgkmcnt(4)
  v_mfma_f32_16x16x32_bf16 v[88:91], a[152:155], a[48:51], v[88:91]
  ds_read_b64_tr_b16 a[136:137], v21 offset:49152
  ds_read_b64_tr_b16 a[138:139], v21 offset:53248
  v_mfma_f32_16x16x32_bf16 v[88:91], a[156:159], a[56:59], v[88:91]
  buffer_load_dwordx4 v219, s[12:15], s50 offen offset:3072 lds
  v_mfma_f32_16x16x32_bf16 v[92:95], a[152:155], a[52:55], v[92:95]
  ds_read_b64_tr_b16 a[140:141], v21 offset:57344
  ds_read_b64_tr_b16 a[142:143], v21 offset:61440
  v_mfma_f32_16x16x32_bf16 v[92:95], a[156:159], a[60:63], v[92:95]
  s_add_u32 s50, s50, 131072
  s_waitcnt lgkmcnt(4)
  v_mfma_f32_16x16x32_bf16 v[96:99], a[128:131], a[48:51], v[96:99]
  ds_read_b64_tr_b16 a[144:145], v22 offset:49152
  ds_read_b64_tr_b16 a[146:147], v22 offset:53248
  v_mfma_f32_16x16x32_bf16 v[96:99], a[132:135], a[56:59], v[96:99]
  buffer_load_dwordx4 a[24:27], v13, s[24:27], s51 offen offset:0 sc1
  v_mfma_f32_16x16x32_bf16 v[100:103], a[128:131], a[52:55], v[100:103]
  ds_read_b64_tr_b16 a[148:149], v22 offset:57344
  ds_read_b64_tr_b16 a[150:151], v22 offset:61440
  v_mfma_f32_16x16x32_bf16 v[100:103], a[132:135], a[60:63], v[100:103]
  s_waitcnt lgkmcnt(4)
  v_mfma_f32_16x16x32_bf16 v[104:107], a[136:139], a[48:51], v[104:107]
  ds_read_b64_tr_b16 a[152:153], v23 offset:49152
  ds_read_b64_tr_b16 a[154:155], v23 offset:53248
  v_mfma_f32_16x16x32_bf16 v[104:107], a[140:143], a[56:59], v[104:107]
  buffer_load_dwordx4 a[28:31], v13, s[24:27], s51 offen offset:1024 sc1
  v_mfma_f32_16x16x32_bf16 v[108:111], a[136:139], a[52:55], v[108:111]
  ds_read_b64_tr_b16 a[156:157], v23 offset:57344
  ds_read_b64_tr_b16 a[158:159], v23 offset:61440
  v_mfma_f32_16x16x32_bf16 v[108:111], a[140:143], a[60:63], v[108:111]
  s_add_u32 s51, s51, 262144
  s_waitcnt vmcnt(40) lgkmcnt(4)
  s_barrier
  v_mfma_f32_16x16x32_bf16 v[112:115], a[144:147], a[48:51], v[112:115]
  ds_read_b64_tr_b16 a[128:129], v24 offset:0
  ds_read_b64_tr_b16 a[130:131], v24 offset:4096
  v_mfma_f32_16x16x32_bf16 v[112:115], a[148:151], a[56:59], v[112:115]
  buffer_load_dwordx4 a[32:35], v12, s[24:27], s51 offen offset:0 sc1
  v_mfma_f32_16x16x32_bf16 v[116:119], a[144:147], a[52:55], v[116:119]
  ds_read_b64_tr_b16 a[132:133], v24 offset:8192
  ds_read_b64_tr_b16 a[134:135], v24 offset:12288
  v_mfma_f32_16x16x32_bf16 v[116:119], a[148:151], a[60:63], v[116:119]
  s_add_u32 m0, s52, 32768
  s_waitcnt lgkmcnt(4)
  v_mfma_f32_16x16x32_bf16 v[120:123], a[152:155], a[48:51], v[120:123]
  ds_read_b64_tr_b16 a[136:137], v25 offset:0
  ds_read_b64_tr_b16 a[138:139], v25 offset:4096
  v_mfma_f32_16x16x32_bf16 v[120:123], a[156:159], a[56:59], v[120:123]
  buffer_load_dwordx4 a[36:39], v12, s[24:27], s51 offen offset:1024 sc1
  v_mfma_f32_16x16x32_bf16 v[124:127], a[152:155], a[52:55], v[124:127]
  ds_read_b64_tr_b16 a[140:141], v25 offset:8192
  ds_read_b64_tr_b16 a[142:143], v25 offset:12288
  v_mfma_f32_16x16x32_bf16 v[124:127], a[156:159], a[60:63], v[124:127]
  s_waitcnt lgkmcnt(4)
  v_mfma_f32_16x16x32_bf16 v[64:67], a[128:131], a[64:67], v[64:67]
  ds_read_b64_tr_b16 a[144:145], v26 offset:0
  ds_read_b64_tr_b16 a[146:147], v26 offset:4096
  v_mfma_f32_16x16x32_bf16 v[64:67], a[132:135], a[72:75], v[64:67]
  buffer_load_dwordx4 v216, s[12:15], s50 offen offset:0 lds
  v_mfma_f32_16x16x32_bf16 v[68:71], a[128:131], a[68:71], v[68:71]
  ds_read_b64_tr_b16 a[148:149], v26 offset:8192
  ds_read_b64_tr_b16 a[150:151], v26 offset:12288
  v_mfma_f32_16x16x32_bf16 v[68:71], a[132:135], a[76:79], v[68:71]
  s_waitcnt lgkmcnt(4)
  v_mfma_f32_16x16x32_bf16 v[72:75], a[136:139], a[64:67], v[72:75]
  ds_read_b64_tr_b16 a[152:153], v27 offset:0
  ds_read_b64_tr_b16 a[154:155], v27 offset:4096
  v_mfma_f32_16x16x32_bf16 v[72:75], a[140:143], a[72:75], v[72:75]
  buffer_load_dwordx4 v217, s[12:15], s50 offen offset:1024 lds
  v_mfma_f32_16x16x32_bf16 v[76:79], a[136:139], a[68:71], v[76:79]
  ds_read_b64_tr_b16 a[156:157], v27 offset:8192
  ds_read_b64_tr_b16 a[158:159], v27 offset:12288
  v_mfma_f32_16x16x32_bf16 v[76:79], a[140:143], a[76:79], v[76:79]
  s_waitcnt lgkmcnt(4)
  v_mfma_f32_16x16x32_bf16 v[80:83], a[144:147], a[64:67], v[80:83]
  ds_read_b64_tr_b16 a[128:129], v28 offset:0
  ds_read_b64_tr_b16 a[130:131], v28 offset:4096
  v_mfma_f32_16x16x32_bf16 v[80:83], a[148:151], a[72:75], v[80:83]
  buffer_load_dwordx4 v218, s[12:15], s50 offen offset:2048 lds
  v_mfma_f32_16x16x32_bf16 v[84:87], a[144:147], a[68:71], v[84:87]
  ds_read_b64_tr_b16 a[132:133], v28 offset:8192
  ds_read_b64_tr_b16 a[134:135], v28 offset:12288
  v_mfma_f32_16x16x32_bf16 v[84:87], a[148:151], a[76:79], v[84:87]
  s_waitcnt lgkmcnt(4)
  v_mfma_f32_16x16x32_bf16 v[88:91], a[152:155], a[64:67], v[88:91]
  ds_read_b64_tr_b16 a[136:137], v29 offset:0
  ds_read_b64_tr_b16 a[138:139], v29 offset:4096
  v_mfma_f32_16x16x32_bf16 v[88:91], a[156:159], a[72:75], v[88:91]
  buffer_load_dwordx4 v219, s[12:15], s50 offen offset:3072 lds
  v_mfma_f32_16x16x32_bf16 v[92:95], a[152:155], a[68:71], v[92:95]
  ds_read_b64_tr_b16 a[140:141], v29 offset:8192
  ds_read_b64_tr_b16 a[142:143], v29 offset:12288
  v_mfma_f32_16x16x32_bf16 v[92:95], a[156:159], a[76:79], v[92:95]
  s_add_u32 s50, s50, 131072
  s_waitcnt lgkmcnt(4)
  v_mfma_f32_16x16x32_bf16 v[96:99], a[128:131], a[64:67], v[96:99]
  ds_read_b64_tr_b16 a[144:145], v30 offset:0
  ds_read_b64_tr_b16 a[146:147], v30 offset:4096
  v_mfma_f32_16x16x32_bf16 v[96:99], a[132:135], a[72:75], v[96:99]
  buffer_load_dwordx4 a[40:43], v13, s[24:27], s51 offen offset:0 sc1
  v_mfma_f32_16x16x32_bf16 v[100:103], a[128:131], a[68:71], v[100:103]
  ds_read_b64_tr_b16 a[148:149], v30 offset:8192
  ds_read_b64_tr_b16 a[150:151], v30 offset:12288
  v_mfma_f32_16x16x32_bf16 v[100:103], a[132:135], a[76:79], v[100:103]
  s_waitcnt lgkmcnt(4)
  v_mfma_f32_16x16x32_bf16 v[104:107], a[136:139], a[64:67], v[104:107]
  ds_read_b64_tr_b16 a[152:153], v31 offset:0
  ds_read_b64_tr_b16 a[154:155], v31 offset:4096
  v_mfma_f32_16x16x32_bf16 v[104:107], a[140:143], a[72:75], v[104:107]
  buffer_load_dwordx4 a[44:47], v13, s[24:27], s51 offen offset:1024 sc1
  v_mfma_f32_16x16x32_bf16 v[108:111], a[136:139], a[68:71], v[108:111]
  ds_read_b64_tr_b16 a[156:157], v31 offset:8192
  ds_read_b64_tr_b16 a[158:159], v31 offset:12288
  v_mfma_f32_16x16x32_bf16 v[108:111], a[140:143], a[76:79], v[108:111]
  s_add_u32 s51, s51, 262144
  s_waitcnt vmcnt(40) lgkmcnt(4)
  s_barrier
  v_mfma_f32_16x16x32_bf16 v[112:115], a[144:147], a[64:67], v[112:115]
  ds_read_b64_tr_b16 a[128:129], v24 offset:16384
  ds_read_b64_tr_b16 a[130:131], v24 offset:20480
  v_mfma_f32_16x16x32_bf16 v[112:115], a[148:151], a[72:75], v[112:115]
  buffer_load_dwordx4 a[48:51], v12, s[24:27], s51 offen offset:0 sc1
  v_mfma_f32_16x16x32_bf16 v[116:119], a[144:147], a[68:71], v[116:119]
  ds_read_b64_tr_b16 a[132:133], v24 offset:24576
  ds_read_b64_tr_b16 a[134:135], v24 offset:28672
  v_mfma_f32_16x16x32_bf16 v[116:119], a[148:151], a[76:79], v[116:119]
  s_add_u32 m0, s52, 49152
  s_waitcnt lgkmcnt(4)
  v_mfma_f32_16x16x32_bf16 v[120:123], a[152:155], a[64:67], v[120:123]
  ds_read_b64_tr_b16 a[136:137], v25 offset:16384
  ds_read_b64_tr_b16 a[138:139], v25 offset:20480
  v_mfma_f32_16x16x32_bf16 v[120:123], a[156:159], a[72:75], v[120:123]
  buffer_load_dwordx4 a[52:55], v12, s[24:27], s51 offen offset:1024 sc1
  v_mfma_f32_16x16x32_bf16 v[124:127], a[152:155], a[68:71], v[124:127]
  ds_read_b64_tr_b16 a[140:141], v25 offset:24576
  ds_read_b64_tr_b16 a[142:143], v25 offset:28672
  v_mfma_f32_16x16x32_bf16 v[124:127], a[156:159], a[76:79], v[124:127]
  s_waitcnt lgkmcnt(4)
  v_mfma_f32_16x16x32_bf16 v[64:67], a[128:131], a[80:83], v[64:67]
  ds_read_b64_tr_b16 a[144:145], v26 offset:16384
  ds_read_b64_tr_b16 a[146:147], v26 offset:20480
  v_mfma_f32_16x16x32_bf16 v[64:67], a[132:135], a[88:91], v[64:67]
  buffer_load_dwordx4 v216, s[12:15], s50 offen offset:0 lds
  v_mfma_f32_16x16x32_bf16 v[68:71], a[128:131], a[84:87], v[68:71]
  ds_read_b64_tr_b16 a[148:149], v26 offset:24576
  ds_read_b64_tr_b16 a[150:151], v26 offset:28672
  v_mfma_f32_16x16x32_bf16 v[68:71], a[132:135], a[92:95], v[68:71]
  s_waitcnt lgkmcnt(4)
  v_mfma_f32_16x16x32_bf16 v[72:75], a[136:139], a[80:83], v[72:75]
  ds_read_b64_tr_b16 a[152:153], v27 offset:16384
  ds_read_b64_tr_b16 a[154:155], v27 offset:20480
  v_mfma_f32_16x16x32_bf16 v[72:75], a[140:143], a[88:91], v[72:75]
  buffer_load_dwordx4 v217, s[12:15], s50 offen offset:1024 lds
  v_mfma_f32_16x16x32_bf16 v[76:79], a[136:139], a[84:87], v[76:79]
  ds_read_b64_tr_b16 a[156:157], v27 offset:24576
  ds_read_b64_tr_b16 a[158:159], v27 offset:28672
  v_mfma_f32_16x16x32_bf16 v[76:79], a[140:143], a[92:95], v[76:79]
  s_waitcnt lgkmcnt(4)
  v_mfma_f32_16x16x32_bf16 v[80:83], a[144:147], a[80:83], v[80:83]
  ds_read_b64_tr_b16 a[128:129], v28 offset:16384
  ds_read_b64_tr_b16 a[130:131], v28 offset:20480
  v_mfma_f32_16x16x32_bf16 v[80:83], a[148:151], a[88:91], v[80:83]
  buffer_load_dwordx4 v218, s[12:15], s50 offen offset:2048 lds
  v_mfma_f32_16x16x32_bf16 v[84:87], a[144:147], a[84:87], v[84:87]
  ds_read_b64_tr_b16 a[132:133], v28 offset:24576
  ds_read_b64_tr_b16 a[134:135], v28 offset:28672
  v_mfma_f32_16x16x32_bf16 v[84:87], a[148:151], a[92:95], v[84:87]
  s_waitcnt lgkmcnt(4)
  v_mfma_f32_16x16x32_bf16 v[88:91], a[152:155], a[80:83], v[88:91]
  ds_read_b64_tr_b16 a[136:137], v29 offset:16384
  ds_read_b64_tr_b16 a[138:139], v29 offset:20480
  v_mfma_f32_16x16x32_bf16 v[88:91], a[156:159], a[88:91], v[88:91]
  buffer_load_dwordx4 v219, s[12:15], s50 offen offset:3072 lds
  v_mfma_f32_16x16x32_bf16 v[92:95], a[152:155], a[84:87], v[92:95]
  ds_read_b64_tr_b16 a[140:141], v29 offset:24576
  ds_read_b64_tr_b16 a[142:143], v29 offset:28672
  v_mfma_f32_16x16x32_bf16 v[92:95], a[156:159], a[92:95], v[92:95]
  s_add_u32 s50, s50, 131072
  s_waitcnt lgkmcnt(4)
  v_mfma_f32_16x16x32_bf16 v[96:99], a[128:131], a[80:83], v[96:99]
  ds_read_b64_tr_b16 a[144:145], v30 offset:16384
  ds_read_b64_tr_b16 a[146:147], v30 offset:20480
  v_mfma_f32_16x16x32_bf16 v[96:99], a[132:135], a[88:91], v[96:99]
  buffer_load_dwordx4 a[56:59], v13, s[24:27], s51 offen offset:0 sc1
  v_mfma_f32_16x16x32_bf16 v[100:103], a[128:131], a[84:87], v[100:103]
  ds_read_b64_tr_b16 a[148:149], v30 offset:24576
  ds_read_b64_tr_b16 a[150:151], v30 offset:28672
  v_mfma_f32_16x16x32_bf16 v[100:103], a[132:135], a[92:95], v[100:103]
  s_waitcnt lgkmcnt(4)
  v_mfma_f32_16x16x32_bf16 v[104:107], a[136:139], a[80:83], v[104:107]
  ds_read_b64_tr_b16 a[152:153], v31 offset:16384
  ds_read_b64_tr_b16 a[154:155], v31 offset:20480
  v_mfma_f32_16x16x32_bf16 v[104:107], a[140:143], a[88:91], v[104:107]
  buffer_load_dwordx4 a[60:63], v13, s[24:27], s51 offen offset:1024 sc1
  v_mfma_f32_16x16x32_bf16 v[108:111], a[136:139], a[84:87], v[108:111]
  ds_read_b64_tr_b16 a[156:157], v31 offset:24576
  ds_read_b64_tr_b16 a[158:159], v31 offset:28672
  v_mfma_f32_16x16x32_bf16 v[108:111], a[140:143], a[92:95], v[108:111]
  s_add_u32 s51, s51, 262144
  s_sub_u32 s53, s53, 1
  s_cmp_lg_u32 s53, 0
  s_cbranch_scc1 attn_kernel_gloop41
  s_waitcnt vmcnt(40) lgkmcnt(4)
  s_barrier
  v_mfma_f32_16x16x32_bf16 v[112:115], a[144:147], a[80:83], v[112:115]
  ds_read_b64_tr_b16 a[128:129], v24 offset:32768
  ds_read_b64_tr_b16 a[130:131], v24 offset:36864
  v_mfma_f32_16x16x32_bf16 v[112:115], a[148:151], a[88:91], v[112:115]
  v_mfma_f32_16x16x32_bf16 v[116:119], a[144:147], a[84:87], v[116:119]
  ds_read_b64_tr_b16 a[132:133], v24 offset:40960
  ds_read_b64_tr_b16 a[134:135], v24 offset:45056
  v_mfma_f32_16x16x32_bf16 v[116:119], a[148:151], a[92:95], v[116:119]
  s_waitcnt lgkmcnt(4)
  v_mfma_f32_16x16x32_bf16 v[120:123], a[152:155], a[80:83], v[120:123]
  ds_read_b64_tr_b16 a[136:137], v25 offset:32768
  ds_read_b64_tr_b16 a[138:139], v25 offset:36864
  v_mfma_f32_16x16x32_bf16 v[120:123], a[156:159], a[88:91], v[120:123]
  v_mfma_f32_16x16x32_bf16 v[124:127], a[152:155], a[84:87], v[124:127]
  ds_read_b64_tr_b16 a[140:141], v25 offset:40960
  ds_read_b64_tr_b16 a[142:143], v25 offset:45056
  v_mfma_f32_16x16x32_bf16 v[124:127], a[156:159], a[92:95], v[124:127]
  s_waitcnt lgkmcnt(4)
  v_mfma_f32_16x16x32_bf16 v[64:67], a[128:131], a[96:99], v[64:67]
  ds_read_b64_tr_b16 a[144:145], v26 offset:32768
  ds_read_b64_tr_b16 a[146:147], v26 offset:36864
  v_mfma_f32_16x16x32_bf16 v[64:67], a[132:135], a[104:107], v[64:67]
  v_mfma_f32_16x16x32_bf16 v[68:71], a[128:131], a[100:103], v[68:71]
  ds_read_b64_tr_b16 a[148:149], v26 offset:40960
  ds_read_b64_tr_b16 a[150:151], v26 offset:45056
  v_mfma_f32_16x16x32_bf16 v[68:71], a[132:135], a[108:111], v[68:71]
  s_waitcnt lgkmcnt(4)
  v_mfma_f32_16x16x32_bf16 v[72:75], a[136:139], a[96:99], v[72:75]
  ds_read_b64_tr_b16 a[152:153], v27 offset:32768
  ds_read_b64_tr_b16 a[154:155], v27 offset:36864
  v_mfma_f32_16x16x32_bf16 v[72:75], a[140:143], a[104:107], v[72:75]
  v_mfma_f32_16x16x32_bf16 v[76:79], a[136:139], a[100:103], v[76:79]
  ds_read_b64_tr_b16 a[156:157], v27 offset:40960
  ds_read_b64_tr_b16 a[158:159], v27 offset:45056
  v_mfma_f32_16x16x32_bf16 v[76:79], a[140:143], a[108:111], v[76:79]
  s_waitcnt lgkmcnt(4)
  v_mfma_f32_16x16x32_bf16 v[80:83], a[144:147], a[96:99], v[80:83]
  ds_read_b64_tr_b16 a[128:129], v28 offset:32768
  ds_read_b64_tr_b16 a[130:131], v28 offset:36864
  v_mfma_f32_16x16x32_bf16 v[80:83], a[148:151], a[104:107], v[80:83]
  v_mfma_f32_16x16x32_bf16 v[84:87], a[144:147], a[100:103], v[84:87]
  ds_read_b64_tr_b16 a[132:133], v28 offset:40960
  ds_read_b64_tr_b16 a[134:135], v28 offset:45056
  v_mfma_f32_16x16x32_bf16 v[84:87], a[148:151], a[108:111], v[84:87]
  s_waitcnt lgkmcnt(4)
  v_mfma_f32_16x16x32_bf16 v[88:91], a[152:155], a[96:99], v[88:91]
  ds_read_b64_tr_b16 a[136:137], v29 offset:32768
  ds_read_b64_tr_b16 a[138:139], v29 offset:36864
  v_mfma_f32_16x16x32_bf16 v[88:91], a[156:159], a[104:107], v[88:91]
  v_mfma_f32_16x16x32_bf16 v[92:95], a[152:155], a[100:103], v[92:95]
  ds_read_b64_tr_b16 a[140:141], v29 offset:40960
  ds_read_b64_tr_b16 a[142:143], v29 offset:45056
  v_mfma_f32_16x16x32_bf16 v[92:95], a[156:159], a[108:111], v[92:95]
  s_waitcnt lgkmcnt(4)
  v_mfma_f32_16x16x32_bf16 v[96:99], a[128:131], a[96:99], v[96:99]
  ds_read_b64_tr_b16 a[144:145], v30 offset:32768
  ds_read_b64_tr_b16 a[146:147], v30 offset:36864
  v_mfma_f32_16x16x32_bf16 v[96:99], a[132:135], a[104:107], v[96:99]
  v_mfma_f32_16x16x32_bf16 v[100:103], a[128:131], a[100:103], v[100:103]
  ds_read_b64_tr_b16 a[148:149], v30 offset:40960
  ds_read_b64_tr_b16 a[150:151], v30 offset:45056
  v_mfma_f32_16x16x32_bf16 v[100:103], a[132:135], a[108:111], v[100:103]
  s_waitcnt lgkmcnt(4)
  v_mfma_f32_16x16x32_bf16 v[104:107], a[136:139], a[96:99], v[104:107]
  ds_read_b64_tr_b16 a[152:153], v31 offset:32768
  ds_read_b64_tr_b16 a[154:155], v31 offset:36864
  v_mfma_f32_16x16x32_bf16 v[104:107], a[140:143], a[104:107], v[104:107]
  v_mfma_f32_16x16x32_bf16 v[108:111], a[136:139], a[100:103], v[108:111]
  ds_read_b64_tr_b16 a[156:157], v31 offset:40960
  ds_read_b64_tr_b16 a[158:159], v31 offset:45056
  v_mfma_f32_16x16x32_bf16 v[108:111], a[140:143], a[108:111], v[108:111]
  s_waitcnt vmcnt(32) lgkmcnt(4)
  s_barrier
  v_mfma_f32_16x16x32_bf16 v[112:115], a[144:147], a[96:99], v[112:115]
  ds_read_b64_tr_b16 a[128:129], v24 offset:49152
  ds_read_b64_tr_b16 a[130:131], v24 offset:53248
  v_mfma_f32_16x16x32_bf16 v[112:115], a[148:151], a[104:107], v[112:115]
  v_mfma_f32_16x16x32_bf16 v[116:119], a[144:147], a[100:103], v[116:119]
  ds_read_b64_tr_b16 a[132:133], v24 offset:57344
  ds_read_b64_tr_b16 a[134:135], v24 offset:61440
  v_mfma_f32_16x16x32_bf16 v[116:119], a[148:151], a[108:111], v[116:119]
  s_waitcnt lgkmcnt(4)
  v_mfma_f32_16x16x32_bf16 v[120:123], a[152:155], a[96:99], v[120:123]
  ds_read_b64_tr_b16 a[136:137], v25 offset:49152
  ds_read_b64_tr_b16 a[138:139], v25 offset:53248
  v_mfma_f32_16x16x32_bf16 v[120:123], a[156:159], a[104:107], v[120:123]
  v_mfma_f32_16x16x32_bf16 v[124:127], a[152:155], a[100:103], v[124:127]
  ds_read_b64_tr_b16 a[140:141], v25 offset:57344
  ds_read_b64_tr_b16 a[142:143], v25 offset:61440
  v_mfma_f32_16x16x32_bf16 v[124:127], a[156:159], a[108:111], v[124:127]
  s_waitcnt lgkmcnt(4)
  v_mfma_f32_16x16x32_bf16 v[64:67], a[128:131], a[112:115], v[64:67]
  ds_read_b64_tr_b16 a[144:145], v26 offset:49152
  ds_read_b64_tr_b16 a[146:147], v26 offset:53248
  v_mfma_f32_16x16x32_bf16 v[64:67], a[132:135], a[120:123], v[64:67]
  v_mfma_f32_16x16x32_bf16 v[68:71], a[128:131], a[116:119], v[68:71]
  ds_read_b64_tr_b16 a[148:149], v26 offset:57344
  ds_read_b64_tr_b16 a[150:151], v26 offset:61440
  v_mfma_f32_16x16x32_bf16 v[68:71], a[132:135], a[124:127], v[68:71]
  s_waitcnt lgkmcnt(4)
  v_mfma_f32_16x16x32_bf16 v[72:75], a[136:139], a[112:115], v[72:75]
  ds_read_b64_tr_b16 a[152:153], v27 offset:49152
  ds_read_b64_tr_b16 a[154:155], v27 offset:53248
  v_mfma_f32_16x16x32_bf16 v[72:75], a[140:143], a[120:123], v[72:75]
  v_mfma_f32_16x16x32_bf16 v[76:79], a[136:139], a[116:119], v[76:79]
  ds_read_b64_tr_b16 a[156:157], v27 offset:57344
  ds_read_b64_tr_b16 a[158:159], v27 offset:61440
  v_mfma_f32_16x16x32_bf16 v[76:79], a[140:143], a[124:127], v[76:79]
  s_waitcnt lgkmcnt(4)
  v_mfma_f32_16x16x32_bf16 v[80:83], a[144:147], a[112:115], v[80:83]
  ds_read_b64_tr_b16 a[128:129], v28 offset:49152
  ds_read_b64_tr_b16 a[130:131], v28 offset:53248
  v_mfma_f32_16x16x32_bf16 v[80:83], a[148:151], a[120:123], v[80:83]
  v_mfma_f32_16x16x32_bf16 v[84:87], a[144:147], a[116:119], v[84:87]
  ds_read_b64_tr_b16 a[132:133], v28 offset:57344
  ds_read_b64_tr_b16 a[134:135], v28 offset:61440
  v_mfma_f32_16x16x32_bf16 v[84:87], a[148:151], a[124:127], v[84:87]
  s_waitcnt lgkmcnt(4)
  v_mfma_f32_16x16x32_bf16 v[88:91], a[152:155], a[112:115], v[88:91]
  ds_read_b64_tr_b16 a[136:137], v29 offset:49152
  ds_read_b64_tr_b16 a[138:139], v29 offset:53248
  v_mfma_f32_16x16x32_bf16 v[88:91], a[156:159], a[120:123], v[88:91]
  v_mfma_f32_16x16x32_bf16 v[92:95], a[152:155], a[116:119], v[92:95]
  ds_read_b64_tr_b16 a[140:141], v29 offset:57344
  ds_read_b64_tr_b16 a[142:143], v29 offset:61440
  v_mfma_f32_16x16x32_bf16 v[92:95], a[156:159], a[124:127], v[92:95]
  s_waitcnt lgkmcnt(4)
  v_mfma_f32_16x16x32_bf16 v[96:99], a[128:131], a[112:115], v[96:99]
  ds_read_b64_tr_b16 a[144:145], v30 offset:49152
  ds_read_b64_tr_b16 a[146:147], v30 offset:53248
  v_mfma_f32_16x16x32_bf16 v[96:99], a[132:135], a[120:123], v[96:99]
  v_mfma_f32_16x16x32_bf16 v[100:103], a[128:131], a[116:119], v[100:103]
  ds_read_b64_tr_b16 a[148:149], v30 offset:57344
  ds_read_b64_tr_b16 a[150:151], v30 offset:61440
  v_mfma_f32_16x16x32_bf16 v[100:103], a[132:135], a[124:127], v[100:103]
  s_waitcnt lgkmcnt(4)
  v_mfma_f32_16x16x32_bf16 v[104:107], a[136:139], a[112:115], v[104:107]
  ds_read_b64_tr_b16 a[152:153], v31 offset:49152
  ds_read_b64_tr_b16 a[154:155], v31 offset:53248
  v_mfma_f32_16x16x32_bf16 v[104:107], a[140:143], a[120:123], v[104:107]
  v_mfma_f32_16x16x32_bf16 v[108:111], a[136:139], a[116:119], v[108:111]
  ds_read_b64_tr_b16 a[156:157], v31 offset:57344
  ds_read_b64_tr_b16 a[158:159], v31 offset:61440
  v_mfma_f32_16x16x32_bf16 v[108:111], a[140:143], a[124:127], v[108:111]
  s_waitcnt vmcnt(24) lgkmcnt(4)
  s_barrier
  v_mfma_f32_16x16x32_bf16 v[112:115], a[144:147], a[112:115], v[112:115]
  ds_read_b64_tr_b16 a[128:129], v16 offset:0
  ds_read_b64_tr_b16 a[130:131], v16 offset:4096
  v_mfma_f32_16x16x32_bf16 v[112:115], a[148:151], a[120:123], v[112:115]
  v_mfma_f32_16x16x32_bf16 v[116:119], a[144:147], a[116:119], v[116:119]
  ds_read_b64_tr_b16 a[132:133], v16 offset:8192
  ds_read_b64_tr_b16 a[134:135], v16 offset:12288
  v_mfma_f32_16x16x32_bf16 v[116:119], a[148:151], a[124:127], v[116:119]
  s_waitcnt lgkmcnt(4)
  v_mfma_f32_16x16x32_bf16 v[120:123], a[152:155], a[112:115], v[120:123]
  ds_read_b64_tr_b16 a[136:137], v17 offset:0
  ds_read_b64_tr_b16 a[138:139], v17 offset:4096
  v_mfma_f32_16x16x32_bf16 v[120:123], a[156:159], a[120:123], v[120:123]
  v_mfma_f32_16x16x32_bf16 v[124:127], a[152:155], a[116:119], v[124:127]
  ds_read_b64_tr_b16 a[140:141], v17 offset:8192
  ds_read_b64_tr_b16 a[142:143], v17 offset:12288
  v_mfma_f32_16x16x32_bf16 v[124:127], a[156:159], a[124:127], v[124:127]
  s_waitcnt lgkmcnt(4)
  v_mfma_f32_16x16x32_bf16 v[64:67], a[128:131], a[0:3], v[64:67]
  ds_read_b64_tr_b16 a[144:145], v18 offset:0
  ds_read_b64_tr_b16 a[146:147], v18 offset:4096
  v_mfma_f32_16x16x32_bf16 v[64:67], a[132:135], a[8:11], v[64:67]
  v_mfma_f32_16x16x32_bf16 v[68:71], a[128:131], a[4:7], v[68:71]
  ds_read_b64_tr_b16 a[148:149], v18 offset:8192
  ds_read_b64_tr_b16 a[150:151], v18 offset:12288
  v_mfma_f32_16x16x32_bf16 v[68:71], a[132:135], a[12:15], v[68:71]
  s_waitcnt lgkmcnt(4)
  v_mfma_f32_16x16x32_bf16 v[72:75], a[136:139], a[0:3], v[72:75]
  ds_read_b64_tr_b16 a[152:153], v19 offset:0
  ds_read_b64_tr_b16 a[154:155], v19 offset:4096
  v_mfma_f32_16x16x32_bf16 v[72:75], a[140:143], a[8:11], v[72:75]
  v_mfma_f32_16x16x32_bf16 v[76:79], a[136:139], a[4:7], v[76:79]
  ds_read_b64_tr_b16 a[156:157], v19 offset:8192
  ds_read_b64_tr_b16 a[158:159], v19 offset:12288
  v_mfma_f32_16x16x32_bf16 v[76:79], a[140:143], a[12:15], v[76:79]
  s_waitcnt lgkmcnt(4)
  v_mfma_f32_16x16x32_bf16 v[80:83], a[144:147], a[0:3], v[80:83]
  ds_read_b64_tr_b16 a[128:129], v20 offset:0
  ds_read_b64_tr_b16 a[130:131], v20 offset:4096
  v_mfma_f32_16x16x32_bf16 v[80:83], a[148:151], a[8:11], v[80:83]
  v_mfma_f32_16x16x32_bf16 v[84:87], a[144:147], a[4:7], v[84:87]
  ds_read_b64_tr_b16 a[132:133], v20 offset:8192
  ds_read_b64_tr_b16 a[134:135], v20 offset:12288
  v_mfma_f32_16x16x32_bf16 v[84:87], a[148:151], a[12:15], v[84:87]
  s_waitcnt lgkmcnt(4)
  v_mfma_f32_16x16x32_bf16 v[88:91], a[152:155], a[0:3], v[88:91]
  ds_read_b64_tr_b16 a[136:137], v21 offset:0
  ds_read_b64_tr_b16 a[138:139], v21 offset:4096
  v_mfma_f32_16x16x32_bf16 v[88:91], a[156:159], a[8:11], v[88:91]
  v_mfma_f32_16x16x32_bf16 v[92:95], a[152:155], a[4:7], v[92:95]
  ds_read_b64_tr_b16 a[140:141], v21 offset:8192
  ds_read_b64_tr_b16 a[142:143], v21 offset:12288
  v_mfma_f32_16x16x32_bf16 v[92:95], a[156:159], a[12:15], v[92:95]
  s_waitcnt lgkmcnt(4)
  v_mfma_f32_16x16x32_bf16 v[96:99], a[128:131], a[0:3], v[96:99]
  ds_read_b64_tr_b16 a[144:145], v22 offset:0
  ds_read_b64_tr_b16 a[146:147], v22 offset:4096
  v_mfma_f32_16x16x32_bf16 v[96:99], a[132:135], a[8:11], v[96:99]
  v_mfma_f32_16x16x32_bf16 v[100:103], a[128:131], a[4:7], v[100:103]
  ds_read_b64_tr_b16 a[148:149], v22 offset:8192
  ds_read_b64_tr_b16 a[150:151], v22 offset:12288
  v_mfma_f32_16x16x32_bf16 v[100:103], a[132:135], a[12:15], v[100:103]
  s_waitcnt lgkmcnt(4)
  v_mfma_f32_16x16x32_bf16 v[104:107], a[136:139], a[0:3], v[104:107]
  ds_read_b64_tr_b16 a[152:153], v23 offset:0
  ds_read_b64_tr_b16 a[154:155], v23 offset:4096
  v_mfma_f32_16x16x32_bf16 v[104:107], a[140:143], a[8:11], v[104:107]
  v_mfma_f32_16x16x32_bf16 v[108:111], a[136:139], a[4:7], v[108:111]
  ds_read_b64_tr_b16 a[156:157], v23 offset:8192
  ds_read_b64_tr_b16 a[158:159], v23 offset:12288
  v_mfma_f32_16x16x32_bf16 v[108:111], a[140:143], a[12:15], v[108:111]
  s_waitcnt vmcnt(16) lgkmcnt(4)
  s_barrier
  v_mfma_f32_16x16x32_bf16 v[112:115], a[144:147], a[0:3], v[112:115]
  ds_read_b64_tr_b16 a[128:129], v16 offset:16384
  ds_read_b64_tr_b16 a[130:131], v16 offset:20480
  v_mfma_f32_16x16x32_bf16 v[112:115], a[148:151], a[8:11], v[112:115]
  v_mfma_f32_16x16x32_bf16 v[116:119], a[144:147], a[4:7], v[116:119]
  ds_read_b64_tr_b16 a[132:133], v16 offset:24576
  ds_read_b64_tr_b16 a[134:135], v16 offset:28672
  v_mfma_f32_16x16x32_bf16 v[116:119], a[148:151], a[12:15], v[116:119]
  s_waitcnt lgkmcnt(4)
  v_mfma_f32_16x16x32_bf16 v[120:123], a[152:155], a[0:3], v[120:123]
  ds_read_b64_tr_b16 a[136:137], v17 offset:16384
  ds_read_b64_tr_b16 a[138:139], v17 offset:20480
  v_mfma_f32_16x16x32_bf16 v[120:123], a[156:159], a[8:11], v[120:123]
  v_mfma_f32_16x16x32_bf16 v[124:127], a[152:155], a[4:7], v[124:127]
  ds_read_b64_tr_b16 a[140:141], v17 offset:24576
  ds_read_b64_tr_b16 a[142:143], v17 offset:28672
  v_mfma_f32_16x16x32_bf16 v[124:127], a[156:159], a[12:15], v[124:127]
  s_waitcnt lgkmcnt(4)
  v_mfma_f32_16x16x32_bf16 v[64:67], a[128:131], a[16:19], v[64:67]
  ds_read_b64_tr_b16 a[144:145], v18 offset:16384
  ds_read_b64_tr_b16 a[146:147], v18 offset:20480
  v_mfma_f32_16x16x32_bf16 v[64:67], a[132:135], a[24:27], v[64:67]
  v_mfma_f32_16x16x32_bf16 v[68:71], a[128:131], a[20:23], v[68:71]
  ds_read_b64_tr_b16 a[148:149], v18 offset:24576
  ds_read_b64_tr_b16 a[150:151], v18 offset:28672
  v_mfma_f32_16x16x32_bf16 v[68:71], a[132:135], a[28:31], v[68:71]
  s_waitcnt lgkmcnt(4)
  v_mfma_f32_16x16x32_bf16 v[72:75], a[136:139], a[16:19], v[72:75]
  ds_read_b64_tr_b16 a[152:153], v19 offset:16384
  ds_read_b64_tr_b16 a[154:155], v19 offset:20480
  v_mfma_f32_16x16x32_bf16 v[72:75], a[140:143], a[24:27], v[72:75]
  v_mfma_f32_16x16x32_bf16 v[76:79], a[136:139], a[20:23], v[76:79]
  ds_read_b64_tr_b16 a[156:157], v19 offset:24576
  ds_read_b64_tr_b16 a[158:159], v19 offset:28672
  v_mfma_f32_16x16x32_bf16 v[76:79], a[140:143], a[28:31], v[76:79]
  s_waitcnt lgkmcnt(4)
  v_mfma_f32_16x16x32_bf16 v[80:83], a[144:147], a[16:19], v[80:83]
  ds_read_b64_tr_b16 a[128:129], v20 offset:16384
  ds_read_b64_tr_b16 a[130:131], v20 offset:20480
  v_mfma_f32_16x16x32_bf16 v[80:83], a[148:151], a[24:27], v[80:83]
  v_mfma_f32_16x16x32_bf16 v[84:87], a[144:147], a[20:23], v[84:87]
  ds_read_b64_tr_b16 a[132:133], v20 offset:24576
  ds_read_b64_tr_b16 a[134:135], v20 offset:28672
  v_mfma_f32_16x16x32_bf16 v[84:87], a[148:151], a[28:31], v[84:87]
  s_waitcnt lgkmcnt(4)
  v_mfma_f32_16x16x32_bf16 v[88:91], a[152:155], a[16:19], v[88:91]
  ds_read_b64_tr_b16 a[136:137], v21 offset:16384
  ds_read_b64_tr_b16 a[138:139], v21 offset:20480
  v_mfma_f32_16x16x32_bf16 v[88:91], a[156:159], a[24:27], v[88:91]
  v_mfma_f32_16x16x32_bf16 v[92:95], a[152:155], a[20:23], v[92:95]
  ds_read_b64_tr_b16 a[140:141], v21 offset:24576
  ds_read_b64_tr_b16 a[142:143], v21 offset:28672
  v_mfma_f32_16x16x32_bf16 v[92:95], a[156:159], a[28:31], v[92:95]
  s_waitcnt lgkmcnt(4)
  v_mfma_f32_16x16x32_bf16 v[96:99], a[128:131], a[16:19], v[96:99]
  ds_read_b64_tr_b16 a[144:145], v22 offset:16384
  ds_read_b64_tr_b16 a[146:147], v22 offset:20480
  v_mfma_f32_16x16x32_bf16 v[96:99], a[132:135], a[24:27], v[96:99]
  v_mfma_f32_16x16x32_bf16 v[100:103], a[128:131], a[20:23], v[100:103]
  ds_read_b64_tr_b16 a[148:149], v22 offset:24576
  ds_read_b64_tr_b16 a[150:151], v22 offset:28672
  v_mfma_f32_16x16x32_bf16 v[100:103], a[132:135], a[28:31], v[100:103]
  s_waitcnt lgkmcnt(4)
  v_mfma_f32_16x16x32_bf16 v[104:107], a[136:139], a[16:19], v[104:107]
  ds_read_b64_tr_b16 a[152:153], v23 offset:16384
  ds_read_b64_tr_b16 a[154:155], v23 offset:20480
  v_mfma_f32_16x16x32_bf16 v[104:107], a[140:143], a[24:27], v[104:107]
  v_mfma_f32_16x16x32_bf16 v[108:111], a[136:139], a[20:23], v[108:111]
  ds_read_b64_tr_b16 a[156:157], v23 offset:24576
  ds_read_b64_tr_b16 a[158:159], v23 offset:28672
  v_mfma_f32_16x16x32_bf16 v[108:111], a[140:143], a[28:31], v[108:111]
  s_waitcnt vmcnt(8) lgkmcnt(4)
  s_barrier
  v_mfma_f32_16x16x32_bf16 v[112:115], a[144:147], a[16:19], v[112:115]
  ds_read_b64_tr_b16 a[128:129], v16 offset:32768
  ds_read_b64_tr_b16 a[130:131], v16 offset:36864
  v_mfma_f32_16x16x32_bf16 v[112:115], a[148:151], a[24:27], v[112:115]
  v_mfma_f32_16x16x32_bf16 v[116:119], a[144:147], a[20:23], v[116:119]
  ds_read_b64_tr_b16 a[132:133], v16 offset:40960
  ds_read_b64_tr_b16 a[134:135], v16 offset:45056
  v_mfma_f32_16x16x32_bf16 v[116:119], a[148:151], a[28:31], v[116:119]
  s_waitcnt lgkmcnt(4)
  v_mfma_f32_16x16x32_bf16 v[120:123], a[152:155], a[16:19], v[120:123]
  ds_read_b64_tr_b16 a[136:137], v17 offset:32768
  ds_read_b64_tr_b16 a[138:139], v17 offset:36864
  v_mfma_f32_16x16x32_bf16 v[120:123], a[156:159], a[24:27], v[120:123]
  v_mfma_f32_16x16x32_bf16 v[124:127], a[152:155], a[20:23], v[124:127]
  ds_read_b64_tr_b16 a[140:141], v17 offset:40960
  ds_read_b64_tr_b16 a[142:143], v17 offset:45056
  v_mfma_f32_16x16x32_bf16 v[124:127], a[156:159], a[28:31], v[124:127]
  s_waitcnt lgkmcnt(4)
  v_mfma_f32_16x16x32_bf16 v[64:67], a[128:131], a[32:35], v[64:67]
  ds_read_b64_tr_b16 a[144:145], v18 offset:32768
  ds_read_b64_tr_b16 a[146:147], v18 offset:36864
  v_mfma_f32_16x16x32_bf16 v[64:67], a[132:135], a[40:43], v[64:67]
  v_mfma_f32_16x16x32_bf16 v[68:71], a[128:131], a[36:39], v[68:71]
  ds_read_b64_tr_b16 a[148:149], v18 offset:40960
  ds_read_b64_tr_b16 a[150:151], v18 offset:45056
  v_mfma_f32_16x16x32_bf16 v[68:71], a[132:135], a[44:47], v[68:71]
  s_waitcnt lgkmcnt(4)
  v_mfma_f32_16x16x32_bf16 v[72:75], a[136:139], a[32:35], v[72:75]
  ds_read_b64_tr_b16 a[152:153], v19 offset:32768
  ds_read_b64_tr_b16 a[154:155], v19 offset:36864
  v_mfma_f32_16x16x32_bf16 v[72:75], a[140:143], a[40:43], v[72:75]
  v_mfma_f32_16x16x32_bf16 v[76:79], a[136:139], a[36:39], v[76:79]
  ds_read_b64_tr_b16 a[156:157], v19 offset:40960
  ds_read_b64_tr_b16 a[158:159], v19 offset:45056
  v_mfma_f32_16x16x32_bf16 v[76:79], a[140:143], a[44:47], v[76:79]
  s_waitcnt lgkmcnt(4)
  v_mfma_f32_16x16x32_bf16 v[80:83], a[144:147], a[32:35], v[80:83]
  ds_read_b64_tr_b16 a[128:129], v20 offset:32768
  ds_read_b64_tr_b16 a[130:131], v20 offset:36864
  v_mfma_f32_16x16x32_bf16 v[80:83], a[148:151], a[40:43], v[80:83]
  v_mfma_f32_16x16x32_bf16 v[84:87], a[144:147], a[36:39], v[84:87]
  ds_read_b64_tr_b16 a[132:133], v20 offset:40960
  ds_read_b64_tr_b16 a[134:135], v20 offset:45056
  v_mfma_f32_16x16x32_bf16 v[84:87], a[148:151], a[44:47], v[84:87]
  s_waitcnt lgkmcnt(4)
  v_mfma_f32_16x16x32_bf16 v[88:91], a[152:155], a[32:35], v[88:91]
  ds_read_b64_tr_b16 a[136:137], v21 offset:32768
  ds_read_b64_tr_b16 a[138:139], v21 offset:36864
  v_mfma_f32_16x16x32_bf16 v[88:91], a[156:159], a[40:43], v[88:91]
  v_mfma_f32_16x16x32_bf16 v[92:95], a[152:155], a[36:39], v[92:95]
  ds_read_b64_tr_b16 a[140:141], v21 offset:40960
  ds_read_b64_tr_b16 a[142:143], v21 offset:45056
  v_mfma_f32_16x16x32_bf16 v[92:95], a[156:159], a[44:47], v[92:95]
  s_waitcnt lgkmcnt(4)
  v_mfma_f32_16x16x32_bf16 v[96:99], a[128:131], a[32:35], v[96:99]
  ds_read_b64_tr_b16 a[144:145], v22 offset:32768
  ds_read_b64_tr_b16 a[146:147], v22 offset:36864
  v_mfma_f32_16x16x32_bf16 v[96:99], a[132:135], a[40:43], v[96:99]
  v_mfma_f32_16x16x32_bf16 v[100:103], a[128:131], a[36:39], v[100:103]
  ds_read_b64_tr_b16 a[148:149], v22 offset:40960
  ds_read_b64_tr_b16 a[150:151], v22 offset:45056
  v_mfma_f32_16x16x32_bf16 v[100:103], a[132:135], a[44:47], v[100:103]
  s_waitcnt lgkmcnt(4)
  v_mfma_f32_16x16x32_bf16 v[104:107], a[136:139], a[32:35], v[104:107]
  ds_read_b64_tr_b16 a[152:153], v23 offset:32768
  ds_read_b64_tr_b16 a[154:155], v23 offset:36864
  v_mfma_f32_16x16x32_bf16 v[104:107], a[140:143], a[40:43], v[104:107]
  v_mfma_f32_16x16x32_bf16 v[108:111], a[136:139], a[36:39], v[108:111]
  ds_read_b64_tr_b16 a[156:157], v23 offset:40960
  ds_read_b64_tr_b16 a[158:159], v23 offset:45056
  v_mfma_f32_16x16x32_bf16 v[108:111], a[140:143], a[44:47], v[108:111]
  s_waitcnt vmcnt(0) lgkmcnt(4)
  s_barrier
  v_mfma_f32_16x16x32_bf16 v[112:115], a[144:147], a[32:35], v[112:115]
  ds_read_b64_tr_b16 a[128:129], v16 offset:49152
  ds_read_b64_tr_b16 a[130:131], v16 offset:53248
  v_mfma_f32_16x16x32_bf16 v[112:115], a[148:151], a[40:43], v[112:115]
  v_mfma_f32_16x16x32_bf16 v[116:119], a[144:147], a[36:39], v[116:119]
  ds_read_b64_tr_b16 a[132:133], v16 offset:57344
  ds_read_b64_tr_b16 a[134:135], v16 offset:61440
  v_mfma_f32_16x16x32_bf16 v[116:119], a[148:151], a[44:47], v[116:119]
  s_waitcnt lgkmcnt(4)
  v_mfma_f32_16x16x32_bf16 v[120:123], a[152:155], a[32:35], v[120:123]
  ds_read_b64_tr_b16 a[136:137], v17 offset:49152
  ds_read_b64_tr_b16 a[138:139], v17 offset:53248
  v_mfma_f32_16x16x32_bf16 v[120:123], a[156:159], a[40:43], v[120:123]
  v_mfma_f32_16x16x32_bf16 v[124:127], a[152:155], a[36:39], v[124:127]
  ds_read_b64_tr_b16 a[140:141], v17 offset:57344
  ds_read_b64_tr_b16 a[142:143], v17 offset:61440
  v_mfma_f32_16x16x32_bf16 v[124:127], a[156:159], a[44:47], v[124:127]
  s_waitcnt lgkmcnt(4)
  v_mfma_f32_16x16x32_bf16 v[64:67], a[128:131], a[48:51], v[64:67]
  ds_read_b64_tr_b16 a[144:145], v18 offset:49152
  ds_read_b64_tr_b16 a[146:147], v18 offset:53248
  v_mfma_f32_16x16x32_bf16 v[64:67], a[132:135], a[56:59], v[64:67]
  v_mfma_f32_16x16x32_bf16 v[68:71], a[128:131], a[52:55], v[68:71]
  ds_read_b64_tr_b16 a[148:149], v18 offset:57344
  ds_read_b64_tr_b16 a[150:151], v18 offset:61440
  v_mfma_f32_16x16x32_bf16 v[68:71], a[132:135], a[60:63], v[68:71]
  s_waitcnt lgkmcnt(4)
  v_mfma_f32_16x16x32_bf16 v[72:75], a[136:139], a[48:51], v[72:75]
  ds_read_b64_tr_b16 a[152:153], v19 offset:49152
  ds_read_b64_tr_b16 a[154:155], v19 offset:53248
  v_mfma_f32_16x16x32_bf16 v[72:75], a[140:143], a[56:59], v[72:75]
  v_mfma_f32_16x16x32_bf16 v[76:79], a[136:139], a[52:55], v[76:79]
  ds_read_b64_tr_b16 a[156:157], v19 offset:57344
  ds_read_b64_tr_b16 a[158:159], v19 offset:61440
  v_mfma_f32_16x16x32_bf16 v[76:79], a[140:143], a[60:63], v[76:79]
  s_waitcnt lgkmcnt(4)
  v_mfma_f32_16x16x32_bf16 v[80:83], a[144:147], a[48:51], v[80:83]
  ds_read_b64_tr_b16 a[128:129], v20 offset:49152
  ds_read_b64_tr_b16 a[130:131], v20 offset:53248
  v_mfma_f32_16x16x32_bf16 v[80:83], a[148:151], a[56:59], v[80:83]
  v_mfma_f32_16x16x32_bf16 v[84:87], a[144:147], a[52:55], v[84:87]
  ds_read_b64_tr_b16 a[132:133], v20 offset:57344
  ds_read_b64_tr_b16 a[134:135], v20 offset:61440
  v_mfma_f32_16x16x32_bf16 v[84:87], a[148:151], a[60:63], v[84:87]
  s_waitcnt lgkmcnt(4)
  v_mfma_f32_16x16x32_bf16 v[88:91], a[152:155], a[48:51], v[88:91]
  ds_read_b64_tr_b16 a[136:137], v21 offset:49152
  ds_read_b64_tr_b16 a[138:139], v21 offset:53248
  v_mfma_f32_16x16x32_bf16 v[88:91], a[156:159], a[56:59], v[88:91]
  v_mfma_f32_16x16x32_bf16 v[92:95], a[152:155], a[52:55], v[92:95]
  ds_read_b64_tr_b16 a[140:141], v21 offset:57344
  ds_read_b64_tr_b16 a[142:143], v21 offset:61440
  v_mfma_f32_16x16x32_bf16 v[92:95], a[156:159], a[60:63], v[92:95]
  s_waitcnt lgkmcnt(4)
  v_mfma_f32_16x16x32_bf16 v[96:99], a[128:131], a[48:51], v[96:99]
  ds_read_b64_tr_b16 a[144:145], v22 offset:49152
  ds_read_b64_tr_b16 a[146:147], v22 offset:53248
  v_mfma_f32_16x16x32_bf16 v[96:99], a[132:135], a[56:59], v[96:99]
  v_mfma_f32_16x16x32_bf16 v[100:103], a[128:131], a[52:55], v[100:103]
  ds_read_b64_tr_b16 a[148:149], v22 offset:57344
  ds_read_b64_tr_b16 a[150:151], v22 offset:61440
  v_mfma_f32_16x16x32_bf16 v[100:103], a[132:135], a[60:63], v[100:103]
  s_waitcnt lgkmcnt(4)
  v_mfma_f32_16x16x32_bf16 v[104:107], a[136:139], a[48:51], v[104:107]
  ds_read_b64_tr_b16 a[152:153], v23 offset:49152
  ds_read_b64_tr_b16 a[154:155], v23 offset:53248
  v_mfma_f32_16x16x32_bf16 v[104:107], a[140:143], a[56:59], v[104:107]
  v_mfma_f32_16x16x32_bf16 v[108:111], a[136:139], a[52:55], v[108:111]
  ds_read_b64_tr_b16 a[156:157], v23 offset:57344
  ds_read_b64_tr_b16 a[158:159], v23 offset:61440
  v_mfma_f32_16x16x32_bf16 v[108:111], a[140:143], a[60:63], v[108:111]
  s_waitcnt lgkmcnt(4)
  v_mfma_f32_16x16x32_bf16 v[112:115], a[144:147], a[48:51], v[112:115]
  v_cvt_pk_bf16_f32 v200, v64, v65
  v_cvt_pk_bf16_f32 v201, v66, v67
  v_mfma_f32_16x16x32_bf16 v[112:115], a[148:151], a[56:59], v[112:115]
  v_cvt_pk_bf16_f32 v202, v68, v69
  v_cvt_pk_bf16_f32 v203, v70, v71
  v_mfma_f32_16x16x32_bf16 v[116:119], a[144:147], a[52:55], v[116:119]
  v_cvt_pk_bf16_f32 v204, v72, v73
  v_cvt_pk_bf16_f32 v205, v74, v75
  v_mfma_f32_16x16x32_bf16 v[116:119], a[148:151], a[60:63], v[116:119]
  v_cvt_pk_bf16_f32 v206, v76, v77
  s_waitcnt lgkmcnt(0)
  v_mfma_f32_16x16x32_bf16 v[120:123], a[152:155], a[48:51], v[120:123]
  v_cvt_pk_bf16_f32 v207, v78, v79
  v_cvt_pk_bf16_f32 v208, v80, v81
  v_mfma_f32_16x16x32_bf16 v[120:123], a[156:159], a[56:59], v[120:123]
  v_cvt_pk_bf16_f32 v209, v82, v83
  v_cvt_pk_bf16_f32 v210, v84, v85
  v_mfma_f32_16x16x32_bf16 v[124:127], a[152:155], a[52:55], v[124:127]
  v_cvt_pk_bf16_f32 v211, v86, v87
  v_cvt_pk_bf16_f32 v212, v88, v89
  v_mfma_f32_16x16x32_bf16 v[124:127], a[156:159], a[60:63], v[124:127]
  v_cvt_pk_bf16_f32 v213, v90, v91
  v_cvt_pk_bf16_f32 v214, v92, v93
  v_cvt_pk_bf16_f32 v215, v94, v95
  buffer_store_dwordx4 v[200:203], v8, s[16:19], s55 offen offset:0 sc1
  buffer_store_dwordx4 v[204:207], v8, s[16:19], s55 offen offset:1024 sc1
  buffer_store_dwordx4 v[208:211], v8, s[16:19], s55 offen offset:2048 sc1
  buffer_store_dwordx4 v[212:215], v8, s[16:19], s55 offen offset:3072 sc1
  v_lshlrev_b32 v168, 16, v192
  v_and_b32 v169, 0xffff0000, v192
  v_lshlrev_b32 v170, 16, v193
  v_and_b32 v171, 0xffff0000, v193
  v_lshlrev_b32 v172, 16, v194
  v_and_b32 v173, 0xffff0000, v194
  v_lshlrev_b32 v174, 16, v195
  v_and_b32 v175, 0xffff0000, v195
  v_lshlrev_b32 v176, 16, v196
  v_and_b32 v177, 0xffff0000, v196
  v_lshlrev_b32 v178, 16, v197
  v_and_b32 v179, 0xffff0000, v197
  v_lshlrev_b32 v180, 16, v198
  v_and_b32 v181, 0xffff0000, v198
  v_lshlrev_b32 v182, 16, v199
  v_and_b32 v183, 0xffff0000, v199
  v_lshlrev_b32 v64, 16, v32
  v_and_b32 v65, 0xffff0000, v32
  v_lshlrev_b32 v66, 16, v33
  v_and_b32 v67, 0xffff0000, v33
  v_lshlrev_b32 v68, 16, v34
  v_and_b32 v69, 0xffff0000, v34
  v_lshlrev_b32 v70, 16, v35
  v_and_b32 v71, 0xffff0000, v35
  v_lshlrev_b32 v72, 16, v36
  v_and_b32 v73, 0xffff0000, v36
  v_lshlrev_b32 v74, 16, v37
  v_and_b32 v75, 0xffff0000, v37
  v_lshlrev_b32 v76, 16, v38
  v_and_b32 v77, 0xffff0000, v38
  v_lshlrev_b32 v78, 16, v39
  v_and_b32 v79, 0xffff0000, v39
  v_lshlrev_b32 v80, 16, v40
  v_and_b32 v81, 0xffff0000, v40
  v_lshlrev_b32 v82, 16, v41
  v_and_b32 v83, 0xffff0000, v41
  v_lshlrev_b32 v84, 16, v42
  v_and_b32 v85, 0xffff0000, v42
  v_lshlrev_b32 v86, 16, v43
  v_and_b32 v87, 0xffff0000, v43
  v_lshlrev_b32 v88, 16, v44
  v_and_b32 v89, 0xffff0000, v44
  v_lshlrev_b32 v90, 16, v45
  v_and_b32 v91, 0xffff0000, v45
  v_lshlrev_b32 v92, 16, v46
  v_and_b32 v93, 0xffff0000, v46
  v_lshlrev_b32 v94, 16, v47
  v_and_b32 v95, 0xffff0000, v47
  s_mov_b32 s53, 0x40000
attn_kernel_gchk42:
  v_max3_u32 v4, v48, v49, v50
  v_max3_u32 v4, v4, v51, v52
  v_max3_u32 v4, v4, v53, v54
  v_max3_u32 v4, v4, v55, v56
  v_max3_u32 v4, v4, v57, v58
  v_max3_u32 v4, v4, v59, v60
  v_max3_u32 v4, v4, v61, v62
  v_max_u32 v4, v4, v63
  s_sub_u32 s53, s53, 1
  s_cselect_b64 s[58:59], 0, -1
  v_cmp_eq_u32 vcc, -1, v4
  s_and_b64 vcc, vcc, s[58:59]
  s_cbranch_vccz attn_kernel_gok43
  buffer_load_dwordx4 v[48:51], v10, s[28:31], s54 offen offset:0 sc1
  buffer_load_dwordx4 v[52:55], v10, s[28:31], s54 offen offset:16 sc1
  buffer_load_dwordx4 v[56:59], v10, s[28:31], s54 offen offset:128 sc1
  buffer_load_dwordx4 v[60:63], v10, s[28:31], s54 offen offset:144 sc1
  s_waitcnt vmcnt(0)
  s_branch attn_kernel_gchk42
attn_kernel_gok43:
  s_mov_b32 s53, 0x80000
  v_mov_b32 v3, s52
attn_kernel_poll44:
  s_branch attn_kernel_cheap146
attn_kernel_cheap45:
attn_kernel_cheap146:
  buffer_load_dword v4, v3, s[16:19], s56 offen offset:4092 sc1
  s_sub_u32 s53, s53, 1
  s_cselect_b64 s[58:59], 0, -1
  s_waitcnt vmcnt(0)
  v_cmp_eq_u32 vcc, -1, v4
  s_and_b64 vcc, vcc, s[58:59]
  s_cbranch_vccnz attn_kernel_cheap45
  s_max_i32 s53, s53, 0
  buffer_load_dwordx4 v[136:139], v8, s[16:19], s56 offen offset:0 sc1
  buffer_load_dwordx4 v[140:143], v8, s[16:19], s56 offen offset:1024 sc1
  buffer_load_dwordx4 v[144:147], v8, s[16:19], s56 offen offset:2048 sc1
  buffer_load_dwordx4 v[148:151], v8, s[16:19], s56 offen offset:3072 sc1
  s_sub_u32 s53, s53, 1
  s_cselect_b64 s[58:59], 0, -1
  s_waitcnt vmcnt(0)
  v_max3_u32 v4, v136, v137, v138
  v_max3_u32 v4, v4, v139, v140
  v_max3_u32 v4, v4, v141, v142
  v_max3_u32 v4, v4, v143, v144
  v_max3_u32 v4, v4, v145, v146
  v_max3_u32 v4, v4, v147, v148
  v_max3_u32 v4, v4, v149, v150
  v_max_u32 v4, v4, v151
  v_cmp_eq_u32 vcc, -1, v4
  s_and_b64 vcc, vcc, s[58:59]
  s_cbranch_vccnz attn_kernel_poll44
  v_lshlrev_b32 v152, 16, v136
  v_and_b32 v153, 0xffff0000, v136
  v_pk_add_f32 v[96:97], v[96:97], v[152:153]
  v_lshlrev_b32 v154, 16, v137
  v_and_b32 v155, 0xffff0000, v137
  v_pk_add_f32 v[98:99], v[98:99], v[154:155]
  v_lshlrev_b32 v156, 16, v138
  v_and_b32 v157, 0xffff0000, v138
  v_pk_add_f32 v[100:101], v[100:101], v[156:157]
  v_lshlrev_b32 v158, 16, v139
  v_and_b32 v159, 0xffff0000, v139
  v_pk_add_f32 v[102:103], v[102:103], v[158:159]
  v_lshlrev_b32 v152, 16, v140
  v_and_b32 v153, 0xffff0000, v140
  v_pk_add_f32 v[104:105], v[104:105], v[152:153]
  v_lshlrev_b32 v154, 16, v141
  v_and_b32 v155, 0xffff0000, v141
  v_pk_add_f32 v[106:107], v[106:107], v[154:155]
  v_lshlrev_b32 v156, 16, v142
  v_and_b32 v157, 0xffff0000, v142
  v_pk_add_f32 v[108:109], v[108:109], v[156:157]
  v_lshlrev_b32 v158, 16, v143
  v_and_b32 v159, 0xffff0000, v143
  v_pk_add_f32 v[110:111], v[110:111], v[158:159]
  v_lshlrev_b32 v152, 16, v144
  v_and_b32 v153, 0xffff0000, v144
  v_pk_add_f32 v[112:113], v[112:113], v[152:153]
  v_lshlrev_b32 v154, 16, v145
  v_and_b32 v155, 0xffff0000, v145
  v_pk_add_f32 v[114:115], v[114:115], v[154:155]
  v_lshlrev_b32 v156, 16, v146
  v_and_b32 v157, 0xffff0000, v146
  v_pk_add_f32 v[116:117], v[116:117], v[156:157]
  v_lshlrev_b32 v158, 16, v147
  v_and_b32 v159, 0xffff0000, v147
  v_pk_add_f32 v[118:119], v[118:119], v[158:159]
  v_lshlrev_b32 v152, 16, v148
  v_and_b32 v153, 0xffff0000, v148
  v_pk_add_f32 v[120:121], v[120:121], v[152:153]
  v_lshlrev_b32 v154, 16, v149
  v_and_b32 v155, 0xffff0000, v149
  v_pk_add_f32 v[122:123], v[122:123], v[154:155]
  v_lshlrev_b32 v156, 16, v150
  v_and_b32 v157, 0xffff0000, v150
  v_pk_add_f32 v[124:125], v[124:125], v[156:157]
  v_lshlrev_b32 v158, 16, v151
  v_and_b32 v159, 0xffff0000, v151
  v_pk_add_f32 v[126:127], v[126:127], v[158:159]
  s_nop 0
  v_permlane32_swap_b32 v96, v104
  v_permlane32_swap_b32 v97, v105
  v_permlane32_swap_b32 v98, v106
  v_permlane32_swap_b32 v99, v107
  v_permlane32_swap_b32 v112, v120
  v_permlane32_swap_b32 v113, v121
  v_permlane32_swap_b32 v114, v122
  v_permlane32_swap_b32 v115, v123
  v_permlane32_swap_b32 v100, v108
  v_permlane32_swap_b32 v101, v109
  v_permlane32_swap_b32 v102, v110
  v_permlane32_swap_b32 v103, v111
  v_permlane32_swap_b32 v116, v124
  v_permlane32_swap_b32 v117, v125
  v_permlane32_swap_b32 v118, v126
  v_permlane32_swap_b32 v119, v127
  v_permlane16_swap_b32 v96, v104
  v_permlane16_swap_b32 v97, v105
  v_permlane16_swap_b32 v98, v106
  v_permlane16_swap_b32 v99, v107
  v_permlane16_swap_b32 v112, v120
  v_permlane16_swap_b32 v113, v121
  v_permlane16_swap_b32 v114, v122
  v_permlane16_swap_b32 v115, v123
  v_permlane16_swap_b32 v100, v108
  v_permlane16_swap_b32 v101, v109
  v_permlane16_swap_b32 v102, v110
  v_permlane16_swap_b32 v103, v111
  v_permlane16_swap_b32 v116, v124
  v_permlane16_swap_b32 v117, v125
  v_permlane16_swap_b32 v118, v126
  v_permlane16_swap_b32 v119, v127
  v_pk_add_f32 v[96:97], v[96:97], v[168:169]
  v_pk_fma_f32 v[96:97], v[96:97], v[48:49], v[64:65]
  v_pk_add_f32 v[98:99], v[98:99], v[170:171]
  v_pk_fma_f32 v[98:99], v[98:99], v[50:51], v[66:67]
  v_cvt_pk_bf16_f32 v136, v96, v97
  v_cvt_pk_bf16_f32 v137, v98, v99
  v_pk_add_f32 v[104:105], v[104:105], v[172:173]
  v_pk_fma_f32 v[104:105], v[104:105], v[52:53], v[68:69]
  v_pk_add_f32 v[106:107], v[106:107], v[174:175]
  v_pk_fma_f32 v[106:107], v[106:107], v[54:55], v[70:71]
  v_cvt_pk_bf16_f32 v138, v104, v105
  v_cvt_pk_bf16_f32 v139, v106, v107
  v_pk_add_f32 v[112:113], v[112:113], v[176:177]
  v_pk_fma_f32 v[112:113], v[112:113], v[56:57], v[72:73]
  v_pk_add_f32 v[114:115], v[114:115], v[178:179]
  v_pk_fma_f32 v[114:115], v[114:115], v[58:59], v[74:75]
  v_cvt_pk_bf16_f32 v140, v112, v113
  v_cvt_pk_bf16_f32 v141, v114, v115
  v_pk_add_f32 v[120:121], v[120:121], v[180:181]
  v_pk_fma_f32 v[120:121], v[120:121], v[60:61], v[76:77]
  v_pk_add_f32 v[122:123], v[122:123], v[182:183]
  v_pk_fma_f32 v[122:123], v[122:123], v[62:63], v[78:79]
  v_cvt_pk_bf16_f32 v142, v120, v121
  v_cvt_pk_bf16_f32 v143, v122, v123
  v_mov_b32 v152, v136
  v_mov_b32 v153, v137
  v_mov_b32 v154, v138
  v_mov_b32 v155, v139
  v_mov_b32_dpp v136, v140 row_ror:8 row_mask:0xf bank_mask:0xc
  v_mov_b32_dpp v137, v141 row_ror:8 row_mask:0xf bank_mask:0xc
  v_mov_b32_dpp v138, v142 row_ror:8 row_mask:0xf bank_mask:0xc
  v_mov_b32_dpp v139, v143 row_ror:8 row_mask:0xf bank_mask:0xc
  v_mov_b32_dpp v140, v152 row_ror:8 row_mask:0xf bank_mask:0x3
  v_mov_b32_dpp v141, v153 row_ror:8 row_mask:0xf bank_mask:0x3
  v_mov_b32_dpp v142, v154 row_ror:8 row_mask:0xf bank_mask:0x3
  v_mov_b32_dpp v143, v155 row_ror:8 row_mask:0xf bank_mask:0x3
  buffer_store_dwordx4 v[136:139], v14, s[20:23], s48 offen sc1
  buffer_store_dwordx4 v[140:143], v15, s[20:23], s48 offen sc1
  v_pk_add_f32 v[100:101], v[100:101], v[168:169]
  v_pk_fma_f32 v[100:101], v[100:101], v[48:49], v[80:81]
  v_pk_add_f32 v[102:103], v[102:103], v[170:171]
  v_pk_fma_f32 v[102:103], v[102:103], v[50:51], v[82:83]
  v_cvt_pk_bf16_f32 v144, v100, v101
  v_cvt_pk_bf16_f32 v145, v102, v103
  v_pk_add_f32 v[108:109], v[108:109], v[172:173]
  v_pk_fma_f32 v[108:109], v[108:109], v[52:53], v[84:85]
  v_pk_add_f32 v[110:111], v[110:111], v[174:175]
  v_pk_fma_f32 v[110:111], v[110:111], v[54:55], v[86:87]
  v_cvt_pk_bf16_f32 v146, v108, v109
  v_cvt_pk_bf16_f32 v147, v110, v111
  v_pk_add_f32 v[116:117], v[116:117], v[176:177]
  v_pk_fma_f32 v[116:117], v[116:117], v[56:57], v[88:89]
  v_pk_add_f32 v[118:119], v[118:119], v[178:179]
  v_pk_fma_f32 v[118:119], v[118:119], v[58:59], v[90:91]
  v_cvt_pk_bf16_f32 v148, v116, v117
  v_cvt_pk_bf16_f32 v149, v118, v119
  v_pk_add_f32 v[124:125], v[124:125], v[180:181]
  v_pk_fma_f32 v[124:125], v[124:125], v[60:61], v[92:93]
  v_pk_add_f32 v[126:127], v[126:127], v[182:183]
  v_pk_fma_f32 v[126:127], v[126:127], v[62:63], v[94:95]
  v_cvt_pk_bf16_f32 v150, v124, v125
  v_cvt_pk_bf16_f32 v151, v126, v127
  v_mov_b32 v156, v144
  v_mov_b32 v157, v145
  v_mov_b32 v158, v146
  v_mov_b32 v159, v147
  v_mov_b32_dpp v144, v148 row_ror:8 row_mask:0xf bank_mask:0xc
  v_mov_b32_dpp v145, v149 row_ror:8 row_mask:0xf bank_mask:0xc
  v_mov_b32_dpp v146, v150 row_ror:8 row_mask:0xf bank_mask:0xc
  v_mov_b32_dpp v147, v151 row_ror:8 row_mask:0xf bank_mask:0xc
  v_mov_b32_dpp v148, v156 row_ror:8 row_mask:0xf bank_mask:0x3
  v_mov_b32_dpp v149, v157 row_ror:8 row_mask:0xf bank_mask:0x3
  v_mov_b32_dpp v150, v158 row_ror:8 row_mask:0xf bank_mask:0x3
  v_mov_b32_dpp v151, v159 row_ror:8 row_mask:0xf bank_mask:0x3
  buffer_store_dwordx4 v[144:147], v14, s[20:23], s49 offen sc1
  buffer_store_dwordx4 v[148:151], v15, s[20:23], s49 offen sc1
attn_kernel_end17:
  s_endpgm
code_end:
  s_endpgm
.section .rodata,"a"
.p2align 6
.amdhsa_kernel mod_kernel
  .amdhsa_next_free_vgpr 64
  .amdhsa_next_free_sgpr 48
  .amdhsa_accum_offset 64
  .amdhsa_group_segment_fixed_size 0
  .amdhsa_kernarg_size 120
  .amdhsa_user_sgpr_count 2
  .amdhsa_user_sgpr_kernarg_segment_ptr 1
  .amdhsa_system_sgpr_workgroup_id_x 1
.end_amdhsa_kernel
.p2align 6
.amdhsa_kernel attn_kernel
  .amdhsa_next_free_vgpr 512
  .amdhsa_next_free_sgpr 102
  .amdhsa_accum_offset 256
  .amdhsa_group_segment_fixed_size 0
  .amdhsa_kernarg_size 120
  .amdhsa_user_sgpr_count 2
  .amdhsa_user_sgpr_kernarg_segment_ptr 1
  .amdhsa_system_sgpr_workgroup_id_x 1
.end_amdhsa_kernel
```
